```python
import torch

def _softmax(x, axis=-1):
    return torch.softmax(x, dim=axis)

def _gelu(x):
    return torch.nn.functional.gelu(x, approximate='tanh')

def _silu(x):
    return torch.nn.functional.silu(x)

def _sigmoid(x):
    return torch.sigmoid(x)

def _layernorm(x, axis=-1, eps=1e-05):
    m = x.mean(dim=axis, keepdim=True)
    v = x.var(dim=axis, keepdim=True, unbiased=False)
    return (x - m) / torch.sqrt(v + eps)

def _scatter_add(tgt, idx, src, axis=0):
    return tgt.clone().index_add_(axis, idx, src)

def _segment_sum(src, seg, n):
    out = torch.zeros((n,) + src.shape[1:], dtype=src.dtype)
    return out.index_add_(0, seg, src)

def _pad(x, pw):
    flat = tuple((v for pair in reversed(pw) for v in pair))
    return torch.nn.functional.pad(x, flat)
kernel_name = 'adaLN_cond__sliding_block_cached__swiglu_ffn__prompt'

def setup_inputs():

    _w = lambda a: (lambda t: t.to(torch.bfloat16) if t.is_floating_point() else t)(torch.as_tensor(a))

    def _A_setup():
        B, Sq, D = (1, 2048, 1024)
        Hq, Hkv, Sk, Dh = (32, 4, 2048, 128)
        assert Hq % Hkv == 0, (Hq, Hkv)
        return {'x': _w((lambda *s: torch.randn(*s, dtype=torch.bfloat16) * 0.05)(B, Sq, D)), 'k_cache': _w((lambda *s: torch.randn(*s, dtype=torch.bfloat16) * 3.2)(B, Hkv, Sk, Dh)), 'v_cache': _w((lambda *s: torch.randn(*s, dtype=torch.bfloat16) * 0.4)(B, Hkv, Sk, Dh)), 'wq': _w((lambda *s: torch.randn(*s, dtype=torch.bfloat16) * 3.2)(D, Hq * Dh) * D ** (-0.5)), 'wo': _w((lambda *s: torch.randn(*s, dtype=torch.bfloat16) * 0.4)(Hq * Dh, D) * (Hq * Dh) ** (-0.5))}
    _A_in = _A_setup()

    def _B_setup():
        B, S, D, F = (1, 2048, 1024, 3584)
        return {'x': _w((lambda *s: torch.randn(*s, dtype=torch.bfloat16) * 0.05)(B, S, D)), 'w_gate': _w((lambda *s: torch.randn(*s, dtype=torch.bfloat16) * 0.05)(D, F)), 'w_up': _w((lambda *s: torch.randn(*s, dtype=torch.bfloat16) * 0.05)(D, F)), 'w_down': _w((lambda *s: torch.randn(*s, dtype=torch.bfloat16) * 0.05)(F, D))}
    _B_in = _B_setup()
    return {'A_x': _A_in['x'], 'A_k_cache': _A_in['k_cache'], 'A_v_cache': _A_in['v_cache'], 'A_wq': _A_in['wq'], 'A_wo': _A_in['wo'], 'B_x': _B_in['x'], 'B_w_gate': _B_in['w_gate'], 'B_w_up': _B_in['w_up'], 'B_w_down': _B_in['w_down'], 'c': _w((lambda *s: torch.randn(*s, dtype=torch.bfloat16) * 0.1)(1, 1024) * 8.0), 'w_mod': _w((lambda *s: torch.randn(*s, dtype=torch.bfloat16) * 0.1)(1024, 6 * 1024) * 1024 ** (-0.5) * 8.0)}

def reference(A_x, A_k_cache, A_v_cache, A_wq, A_wo, B_x, B_w_gate, B_w_up, B_w_down, c, w_mod):

    def _A_ref(x, k_cache, v_cache, wq, wo):
        B, Sq, D = x.shape
        Hq, Dh = (32, 128)
        Hkv, Sk = (k_cache.shape[1], k_cache.shape[2])
        W = min(4096, max(256, Sk // 4))
        rep = Hq // Hkv
        q = (lambda x, *d: x.permute(*d))((x @ wq).reshape(B, Sq, Hq, Dh), 0, 2, 1, 3)
        k = (lambda x, n, axis: torch.repeat_interleave(x, n, dim=axis))(k_cache[:, :, Sk - W:, :], rep, axis=1)
        v = (lambda x, n, axis: torch.repeat_interleave(x, n, dim=axis))(v_cache[:, :, Sk - W:, :], rep, axis=1)
        scores = torch.einsum('bhqd,bhkd->bhqk', q, k) * Dh ** (-0.5)
        p = _softmax(scores, axis=-1)
        o = torch.einsum('bhqk,bhkd->bhqd', p, v)
        return (lambda x, *d: x.permute(*d))(o, 0, 2, 1, 3).reshape(B, Sq, Hq * Dh) @ wo

    def _B_ref(x, w_gate, w_up, w_down):
        g = _silu(x @ w_gate)
        u = x @ w_up
        return g * u @ w_down
    x = A_x
    mod = (_silu(c) @ w_mod).reshape(c.shape[0], 6, 1, -1)
    sa, ca, ga, sb, cb, gb = (mod[:, 0].clone(), mod[:, 1].clone(), mod[:, 2].clone(), mod[:, 3].clone(), mod[:, 4].clone(), mod[:, 5].clone())
    h = _layernorm(x, axis=-1) * (1 + ca) + sa
    x = x + ga * _A_ref(h, A_k_cache, A_v_cache, A_wq, A_wo)
    h = _layernorm(x, axis=-1) * (1 + cb) + sb
    x = x + gb * _B_ref(h, B_w_gate, B_w_up, B_w_down)
    return x
```

```asm
; @launch kernel=first_kernel grid=(144,1,1) block=(256,1,1) lds=12288
; @launch kernel=main_kernel grid=(256,1,1) block=(256,1,1) lds=135168
.amdgcn_target "amdgcn-amd-amdhsa--gfx950"
.text
.globl first_kernel
.p2align 8
.type first_kernel,@function
first_kernel:
s_cmp_ge_u32 s2, 144
s_cbranch_scc1 L_end_first_kernel
s_load_dwordx4 s[4:7], s[0:1], 72
s_load_dwordx2 s[8:9], s[0:1], 104
s_cmp_ge_u32 s2, 128
s_cbranch_scc1 L_aux_first_kernel
s_mul_hi_u32 s27, s2, 134217728
s_mul_i32 s24, s27, 32
s_sub_u32 s26, s2, s24
v_lshrrev_b32 v4, 3, v0
v_mul_u32_u24 v12, 12288, v4
v_and_b32 v5, 7, v0
v_lshlrev_b32 v5, 4, v5
s_lshl_b32 s24, s26, 7
v_add3_u32 v12, v12, v5, s24
v_lshlrev_b32 v6, 1, v0
s_lshl_b32 s25, s27, 9
s_mul_i32 s24, s27, 3145728
s_waitcnt lgkmcnt(0)
s_mov_b32 s16, s6
s_mov_b32 s17, s7
s_mov_b32 s18, 12582912
s_mov_b32 s19, 0x20000
s_mov_b32 s12, s4
s_mov_b32 s13, s5
s_mov_b32 s14, 2048
s_mov_b32 s15, 0x20000
buffer_load_ushort v72, v6, s[12:15], s25 offen
buffer_load_dwordx4 v[16:19], v12, s[16:19], s24 offen nt
s_add_u32 s24, s24, 393216
buffer_load_dwordx4 v[20:23], v12, s[16:19], s24 offen nt
s_add_u32 s24, s24, 393216
buffer_load_dwordx4 v[24:27], v12, s[16:19], s24 offen nt
s_add_u32 s24, s24, 393216
buffer_load_dwordx4 v[28:31], v12, s[16:19], s24 offen nt
s_add_u32 s24, s24, 393216
buffer_load_dwordx4 v[32:35], v12, s[16:19], s24 offen nt
s_add_u32 s24, s24, 393216
buffer_load_dwordx4 v[36:39], v12, s[16:19], s24 offen nt
s_add_u32 s24, s24, 393216
buffer_load_dwordx4 v[40:43], v12, s[16:19], s24 offen nt
s_add_u32 s24, s24, 393216
buffer_load_dwordx4 v[44:47], v12, s[16:19], s24 offen nt
s_add_u32 s20, s8, 76546048
s_addc_u32 s21, s9, 0
s_mov_b32 s22, 98304
s_mov_b32 s23, 0x20000
s_waitcnt vmcnt(8)
v_lshlrev_b32 v8, 16, v72
v_mul_f32 v9, 0xbfb8aa3b, v8
v_exp_f32 v9, v9
s_nop 0
v_add_f32 v9, 1.0, v9
v_rcp_f32 v9, v9
s_nop 0
v_mul_f32 v9, v9, v8
v_cvt_pk_bf16_f32 v8, v9, 0
v_lshlrev_b32 v9, 16, v8
v_lshlrev_b32 v13, 3, v0
ds_write_b64 v13, v[8:9]
s_waitcnt lgkmcnt(0)
s_barrier
v_lshrrev_b32 v4, 3, v0
v_lshlrev_b32 v4, 3, v4
ds_read_b64 v[48:49], v4 offset:0
ds_read_b64 v[50:51], v4 offset:256
ds_read_b64 v[52:53], v4 offset:512
ds_read_b64 v[54:55], v4 offset:768
ds_read_b64 v[56:57], v4 offset:1024
ds_read_b64 v[58:59], v4 offset:1280
ds_read_b64 v[60:61], v4 offset:1536
ds_read_b64 v[62:63], v4 offset:1792
v_mov_b32 v64, 0
v_mov_b32 v65, 0
v_mov_b32 v66, 0
v_mov_b32 v67, 0
v_mov_b32 v68, 0
v_mov_b32 v69, 0
v_mov_b32 v70, 0
v_mov_b32 v71, 0
s_waitcnt lgkmcnt(0)
s_waitcnt vmcnt(7)
v_dot2_f32_bf16 v64, v16, v48, v64
v_dot2_f32_bf16 v65, v16, v49, v65
v_dot2_f32_bf16 v66, v17, v48, v66
v_dot2_f32_bf16 v67, v17, v49, v67
v_dot2_f32_bf16 v68, v18, v48, v68
v_dot2_f32_bf16 v69, v18, v49, v69
v_dot2_f32_bf16 v70, v19, v48, v70
v_dot2_f32_bf16 v71, v19, v49, v71
s_waitcnt vmcnt(6)
v_dot2_f32_bf16 v64, v20, v50, v64
v_dot2_f32_bf16 v65, v20, v51, v65
v_dot2_f32_bf16 v66, v21, v50, v66
v_dot2_f32_bf16 v67, v21, v51, v67
v_dot2_f32_bf16 v68, v22, v50, v68
v_dot2_f32_bf16 v69, v22, v51, v69
v_dot2_f32_bf16 v70, v23, v50, v70
v_dot2_f32_bf16 v71, v23, v51, v71
s_waitcnt vmcnt(5)
v_dot2_f32_bf16 v64, v24, v52, v64
v_dot2_f32_bf16 v65, v24, v53, v65
v_dot2_f32_bf16 v66, v25, v52, v66
v_dot2_f32_bf16 v67, v25, v53, v67
v_dot2_f32_bf16 v68, v26, v52, v68
v_dot2_f32_bf16 v69, v26, v53, v69
v_dot2_f32_bf16 v70, v27, v52, v70
v_dot2_f32_bf16 v71, v27, v53, v71
s_waitcnt vmcnt(4)
v_dot2_f32_bf16 v64, v28, v54, v64
v_dot2_f32_bf16 v65, v28, v55, v65
v_dot2_f32_bf16 v66, v29, v54, v66
v_dot2_f32_bf16 v67, v29, v55, v67
v_dot2_f32_bf16 v68, v30, v54, v68
v_dot2_f32_bf16 v69, v30, v55, v69
v_dot2_f32_bf16 v70, v31, v54, v70
v_dot2_f32_bf16 v71, v31, v55, v71
s_waitcnt vmcnt(3)
v_dot2_f32_bf16 v64, v32, v56, v64
v_dot2_f32_bf16 v65, v32, v57, v65
v_dot2_f32_bf16 v66, v33, v56, v66
v_dot2_f32_bf16 v67, v33, v57, v67
v_dot2_f32_bf16 v68, v34, v56, v68
v_dot2_f32_bf16 v69, v34, v57, v69
v_dot2_f32_bf16 v70, v35, v56, v70
v_dot2_f32_bf16 v71, v35, v57, v71
s_waitcnt vmcnt(2)
v_dot2_f32_bf16 v64, v36, v58, v64
v_dot2_f32_bf16 v65, v36, v59, v65
v_dot2_f32_bf16 v66, v37, v58, v66
v_dot2_f32_bf16 v67, v37, v59, v67
v_dot2_f32_bf16 v68, v38, v58, v68
v_dot2_f32_bf16 v69, v38, v59, v69
v_dot2_f32_bf16 v70, v39, v58, v70
v_dot2_f32_bf16 v71, v39, v59, v71
s_waitcnt vmcnt(1)
v_dot2_f32_bf16 v64, v40, v60, v64
v_dot2_f32_bf16 v65, v40, v61, v65
v_dot2_f32_bf16 v66, v41, v60, v66
v_dot2_f32_bf16 v67, v41, v61, v67
v_dot2_f32_bf16 v68, v42, v60, v68
v_dot2_f32_bf16 v69, v42, v61, v69
v_dot2_f32_bf16 v70, v43, v60, v70
v_dot2_f32_bf16 v71, v43, v61, v71
s_waitcnt vmcnt(0)
v_dot2_f32_bf16 v64, v44, v62, v64
v_dot2_f32_bf16 v65, v44, v63, v65
v_dot2_f32_bf16 v66, v45, v62, v66
v_dot2_f32_bf16 v67, v45, v63, v67
v_dot2_f32_bf16 v68, v46, v62, v68
v_dot2_f32_bf16 v69, v46, v63, v69
v_dot2_f32_bf16 v70, v47, v62, v70
v_dot2_f32_bf16 v71, v47, v63, v71
v_lshlrev_b32 v13, 5, v0
s_nop 1
ds_write_b128 v13, v[64:67] offset:2048
ds_write_b128 v13, v[68:71] offset:2064
s_waitcnt lgkmcnt(0)
s_barrier
v_and_b32 v4, 63, v0
v_lshlrev_b32 v4, 2, v4
v_lshrrev_b32 v5, 6, v0
v_lshlrev_b32 v6, 11, v5
v_add_u32 v13, v4, v6
ds_read_b32 v48, v13 offset:2048
ds_read_b32 v49, v13 offset:2304
ds_read_b32 v50, v13 offset:2560
ds_read_b32 v51, v13 offset:2816
ds_read_b32 v52, v13 offset:3072
ds_read_b32 v53, v13 offset:3328
ds_read_b32 v54, v13 offset:3584
ds_read_b32 v55, v13 offset:3840
s_waitcnt lgkmcnt(0)
v_add_f32 v48, v48, v49
v_add_f32 v50, v50, v51
v_add_f32 v52, v52, v53
v_add_f32 v54, v54, v55
v_add_f32 v48, v48, v50
v_add_f32 v52, v52, v54
v_add_f32 v48, v48, v52
v_lshlrev_b32 v6, 8, v5
v_add_u32 v13, v4, v6
ds_write_b32 v13, v48 offset:10240
s_waitcnt lgkmcnt(0)
s_barrier
ds_read_b32 v48, v4 offset:10240
ds_read_b32 v49, v4 offset:10496
ds_read_b32 v50, v4 offset:10752
ds_read_b32 v51, v4 offset:11008
s_waitcnt lgkmcnt(0)
v_add_f32 v48, v48, v49
v_add_f32 v50, v50, v51
v_add_f32 v48, v48, v50
s_mul_i32 s24, s27, 24576
s_lshl_b32 s25, s26, 8
s_add_u32 s24, s24, s25
v_cmp_gt_u32 vcc, 64, v0
s_nop 0
s_and_saveexec_b64 s[90:91], vcc
s_nop 2
s_cbranch_execz L_fin_first_kernel
buffer_store_dword v48, v4, s[20:23], s24 offen
L_fin_first_kernel:
s_endpgm
L_aux_first_kernel:
s_waitcnt lgkmcnt(0)
s_cmp_lg_u32 s2, 128
s_cbranch_scc1 L_aux2_first_kernel
s_add_u32 s20, s8, 77594624
s_addc_u32 s21, s9, 0
s_mov_b32 s22, 65536
s_mov_b32 s23, 0x20000
v_lshlrev_b32 v12, 7, v0
v_mov_b32 v64, 0
s_mov_b32 s24, 32768
buffer_store_dword v64, v12, s[20:23], 0 offen
buffer_store_dword v64, v12, s[20:23], s24 offen
s_endpgm
L_aux2_first_kernel:
s_cmp_ge_u32 s2, 144
s_cbranch_scc1 L_aux3_first_kernel
s_cmp_lt_u32 s2, 136
s_cbranch_scc1 L_end_first_kernel
s_getpc_b64 s[28:29]
L_pc_first_kernel:
s_add_u32 s28, s28, main_kernel-L_pc_first_kernel
s_addc_u32 s29, s29, 0
v_lshlrev_b32 v12, 7, v0
global_load_dword v4, v12, s[28:29]
v_add_u32 v12, 32768, v12
global_load_dword v4, v12, s[28:29]
v_add_u32 v12, 32768, v12
global_load_dword v4, v12, s[28:29]
v_add_u32 v12, 32768, v12
s_waitcnt vmcnt(0)
s_endpgm
L_aux3_first_kernel:
s_load_dwordx2 s[60:61], s[0:1], 0
s_load_dwordx2 s[62:63], s[0:1], 24
s_waitcnt lgkmcnt(0)
s_sub_u32 s24, s2, 144
s_cmp_lt_u32 s24, 0
s_cselect_b32 s12, s60, s62
s_cselect_b32 s13, s61, s63
s_cselect_b32 s25, 0, 0
s_sub_u32 s24, s24, s25
s_mov_b32 s14, 8388608
s_mov_b32 s15, 0x20000
s_lshl_b32 s24, s24, 17
v_lshlrev_b32 v12, 7, v0
buffer_load_dword v4, v12, s[12:15], s24 offen
s_add_u32 s24, s24, 32768
buffer_load_dword v4, v12, s[12:15], s24 offen
s_add_u32 s24, s24, 32768
buffer_load_dword v4, v12, s[12:15], s24 offen
s_add_u32 s24, s24, 32768
buffer_load_dword v4, v12, s[12:15], s24 offen
s_add_u32 s24, s24, 32768
s_waitcnt vmcnt(0)
s_endpgm
L_end_first_kernel:
s_endpgm
.globl main_kernel
.p2align 8
.type main_kernel,@function
main_kernel:
s_cmp_ge_u32 s2, 256
s_cbranch_scc1 L_end_main_kernel
s_load_dwordx8 s[4:11], s[0:1], 0
s_load_dwordx2 s[12:13], s[0:1], 32
s_load_dwordx2 s[14:15], s[0:1], 48
s_load_dwordx2 s[16:17], s[0:1], 56
s_load_dwordx2 s[18:19], s[0:1], 64
s_load_dwordx2 s[20:21], s[0:1], 88
s_load_dwordx2 s[22:23], s[0:1], 104
v_lshrrev_b32 v2, 6, v0
v_and_b32 v1, 63, v0
s_nop 0
v_readfirstlane_b32 s24, v2
s_and_b32 s26, s2, 7
s_lshr_b32 s30, s2, 3
s_and_b32 s25, s30, 7
s_lshr_b32 s27, s2, 6
s_lshl_b32 s28, s26, 2
s_add_u32 s28, s28, s27
s_lshl_b32 s30, s25, 4
s_lshl_b32 s31, s24, 2
s_add_u32 s30, s30, s31
s_lshl_b32 s30, s30, 11
v_lshlrev_b32 v14, 4, v1
v_add_u32 v14, s30, v14
v_add_u32 v15, 4096, v14
s_waitcnt lgkmcnt(0)
s_add_u32 s34, s22, 77594624
s_addc_u32 s35, s23, 0
s_cmp_lt_u32 s25, 4
s_cbranch_scc1 L_m21
s_load_dwordx4 s[84:87], s[0:1], 72
s_sub_u32 s67, s25, 4
s_lshl_b32 s67, s67, 5
s_add_u32 s67, s67, s28
s_and_b32 s68, s67, 63
s_lshr_b32 s69, s67, 6
s_lshl_b32 s69, s69, 1
v_lshrrev_b32 v20, 3, v0
v_mul_u32_u24 v28, 12288, v20
v_and_b32 v21, 7, v0
v_lshlrev_b32 v21, 4, v21
s_lshl_b32 s30, s68, 7
s_add_u32 s30, s30, 4096
v_add3_u32 v28, v28, v21, s30
v_lshlrev_b32 v22, 1, v0
s_lshl_b32 s31, s69, 9
s_mul_i32 s30, s69, 3145728
s_waitcnt lgkmcnt(0)
s_mov_b32 s52, s86
s_mov_b32 s53, s87
s_mov_b32 s54, 12582912
s_mov_b32 s55, 0x20000
s_mov_b32 s48, s84
s_mov_b32 s49, s85
s_mov_b32 s50, 2048
s_mov_b32 s51, 0x20000
buffer_load_ushort v30, v22, s[48:51], s31 offen
buffer_load_ushort v31, v22, s[48:51], s31 offen offset:512
buffer_load_dwordx4 v[64:67], v28, s[52:55], s30 offen nt
s_add_u32 s30, s30, 393216
buffer_load_dwordx4 v[68:71], v28, s[52:55], s30 offen nt
s_add_u32 s30, s30, 393216
buffer_load_dwordx4 v[72:75], v28, s[52:55], s30 offen nt
s_add_u32 s30, s30, 393216
buffer_load_dwordx4 v[76:79], v28, s[52:55], s30 offen nt
s_add_u32 s30, s30, 393216
buffer_load_dwordx4 v[80:83], v28, s[52:55], s30 offen nt
s_add_u32 s30, s30, 393216
buffer_load_dwordx4 v[84:87], v28, s[52:55], s30 offen nt
s_add_u32 s30, s30, 393216
buffer_load_dwordx4 v[88:91], v28, s[52:55], s30 offen nt
s_add_u32 s30, s30, 393216
buffer_load_dwordx4 v[92:95], v28, s[52:55], s30 offen nt
s_add_u32 s30, s30, 393216
buffer_load_dwordx4 v[96:99], v28, s[52:55], s30 offen nt
s_add_u32 s30, s30, 393216
buffer_load_dwordx4 v[100:103], v28, s[52:55], s30 offen nt
s_add_u32 s30, s30, 393216
buffer_load_dwordx4 v[104:107], v28, s[52:55], s30 offen nt
s_add_u32 s30, s30, 393216
buffer_load_dwordx4 v[108:111], v28, s[52:55], s30 offen nt
s_add_u32 s30, s30, 393216
buffer_load_dwordx4 v[112:115], v28, s[52:55], s30 offen nt
s_add_u32 s30, s30, 393216
buffer_load_dwordx4 v[116:119], v28, s[52:55], s30 offen nt
s_add_u32 s30, s30, 393216
buffer_load_dwordx4 v[120:123], v28, s[52:55], s30 offen nt
s_add_u32 s30, s30, 393216
buffer_load_dwordx4 v[124:127], v28, s[52:55], s30 offen nt
s_add_u32 s30, s30, 393216
s_add_u32 s56, s22, 76546048
s_addc_u32 s57, s23, 0
s_mov_b32 s58, 98304
s_mov_b32 s59, 0x20000
s_waitcnt vmcnt(16)
v_lshlrev_b32 v24, 16, v30
v_mul_f32 v25, 0xbfb8aa3b, v24
v_exp_f32 v25, v25
s_nop 0
v_add_f32 v25, 1.0, v25
v_rcp_f32 v25, v25
s_nop 0
v_mul_f32 v25, v25, v24
v_cvt_pk_bf16_f32 v24, v25, 0
v_lshlrev_b32 v25, 16, v24
v_lshlrev_b32 v29, 3, v0
ds_write_b64 v29, v[24:25] offset:0
v_lshlrev_b32 v24, 16, v31
v_mul_f32 v25, 0xbfb8aa3b, v24
v_exp_f32 v25, v25
s_nop 0
v_add_f32 v25, 1.0, v25
v_rcp_f32 v25, v25
s_nop 0
v_mul_f32 v25, v25, v24
v_cvt_pk_bf16_f32 v24, v25, 0
v_lshlrev_b32 v25, 16, v24
v_lshlrev_b32 v29, 3, v0
ds_write_b64 v29, v[24:25] offset:2048
s_waitcnt lgkmcnt(0)
s_barrier
v_lshrrev_b32 v20, 3, v0
v_lshlrev_b32 v20, 3, v20
ds_read_b64 v[128:129], v20 offset:0
ds_read_b64 v[130:131], v20 offset:256
ds_read_b64 v[132:133], v20 offset:512
ds_read_b64 v[134:135], v20 offset:768
ds_read_b64 v[136:137], v20 offset:1024
ds_read_b64 v[138:139], v20 offset:1280
ds_read_b64 v[140:141], v20 offset:1536
ds_read_b64 v[142:143], v20 offset:1792
v_mov_b32 v160, 0
v_mov_b32 v161, 0
v_mov_b32 v162, 0
v_mov_b32 v163, 0
v_mov_b32 v164, 0
v_mov_b32 v165, 0
v_mov_b32 v166, 0
v_mov_b32 v167, 0
ds_read_b64 v[144:145], v20 offset:2048
ds_read_b64 v[146:147], v20 offset:2304
ds_read_b64 v[148:149], v20 offset:2560
ds_read_b64 v[150:151], v20 offset:2816
ds_read_b64 v[152:153], v20 offset:3072
ds_read_b64 v[154:155], v20 offset:3328
ds_read_b64 v[156:157], v20 offset:3584
ds_read_b64 v[158:159], v20 offset:3840
v_mov_b32 v168, 0
v_mov_b32 v169, 0
v_mov_b32 v170, 0
v_mov_b32 v171, 0
v_mov_b32 v172, 0
v_mov_b32 v173, 0
v_mov_b32 v174, 0
v_mov_b32 v175, 0
s_waitcnt lgkmcnt(0)
s_waitcnt vmcnt(15)
v_dot2_f32_bf16 v160, v64, v128, v160
v_dot2_f32_bf16 v161, v64, v129, v161
v_dot2_f32_bf16 v162, v65, v128, v162
v_dot2_f32_bf16 v163, v65, v129, v163
v_dot2_f32_bf16 v164, v66, v128, v164
v_dot2_f32_bf16 v165, v66, v129, v165
v_dot2_f32_bf16 v166, v67, v128, v166
v_dot2_f32_bf16 v167, v67, v129, v167
s_waitcnt vmcnt(14)
v_dot2_f32_bf16 v160, v68, v130, v160
v_dot2_f32_bf16 v161, v68, v131, v161
v_dot2_f32_bf16 v162, v69, v130, v162
v_dot2_f32_bf16 v163, v69, v131, v163
v_dot2_f32_bf16 v164, v70, v130, v164
v_dot2_f32_bf16 v165, v70, v131, v165
v_dot2_f32_bf16 v166, v71, v130, v166
v_dot2_f32_bf16 v167, v71, v131, v167
s_waitcnt vmcnt(13)
v_dot2_f32_bf16 v160, v72, v132, v160
v_dot2_f32_bf16 v161, v72, v133, v161
v_dot2_f32_bf16 v162, v73, v132, v162
v_dot2_f32_bf16 v163, v73, v133, v163
v_dot2_f32_bf16 v164, v74, v132, v164
v_dot2_f32_bf16 v165, v74, v133, v165
v_dot2_f32_bf16 v166, v75, v132, v166
v_dot2_f32_bf16 v167, v75, v133, v167
s_waitcnt vmcnt(12)
v_dot2_f32_bf16 v160, v76, v134, v160
v_dot2_f32_bf16 v161, v76, v135, v161
v_dot2_f32_bf16 v162, v77, v134, v162
v_dot2_f32_bf16 v163, v77, v135, v163
v_dot2_f32_bf16 v164, v78, v134, v164
v_dot2_f32_bf16 v165, v78, v135, v165
v_dot2_f32_bf16 v166, v79, v134, v166
v_dot2_f32_bf16 v167, v79, v135, v167
s_waitcnt vmcnt(11)
v_dot2_f32_bf16 v160, v80, v136, v160
v_dot2_f32_bf16 v161, v80, v137, v161
v_dot2_f32_bf16 v162, v81, v136, v162
v_dot2_f32_bf16 v163, v81, v137, v163
v_dot2_f32_bf16 v164, v82, v136, v164
v_dot2_f32_bf16 v165, v82, v137, v165
v_dot2_f32_bf16 v166, v83, v136, v166
v_dot2_f32_bf16 v167, v83, v137, v167
s_waitcnt vmcnt(10)
v_dot2_f32_bf16 v160, v84, v138, v160
v_dot2_f32_bf16 v161, v84, v139, v161
v_dot2_f32_bf16 v162, v85, v138, v162
v_dot2_f32_bf16 v163, v85, v139, v163
v_dot2_f32_bf16 v164, v86, v138, v164
v_dot2_f32_bf16 v165, v86, v139, v165
v_dot2_f32_bf16 v166, v87, v138, v166
v_dot2_f32_bf16 v167, v87, v139, v167
s_waitcnt vmcnt(9)
v_dot2_f32_bf16 v160, v88, v140, v160
v_dot2_f32_bf16 v161, v88, v141, v161
v_dot2_f32_bf16 v162, v89, v140, v162
v_dot2_f32_bf16 v163, v89, v141, v163
v_dot2_f32_bf16 v164, v90, v140, v164
v_dot2_f32_bf16 v165, v90, v141, v165
v_dot2_f32_bf16 v166, v91, v140, v166
v_dot2_f32_bf16 v167, v91, v141, v167
s_waitcnt vmcnt(8)
v_dot2_f32_bf16 v160, v92, v142, v160
v_dot2_f32_bf16 v161, v92, v143, v161
v_dot2_f32_bf16 v162, v93, v142, v162
v_dot2_f32_bf16 v163, v93, v143, v163
v_dot2_f32_bf16 v164, v94, v142, v164
v_dot2_f32_bf16 v165, v94, v143, v165
v_dot2_f32_bf16 v166, v95, v142, v166
v_dot2_f32_bf16 v167, v95, v143, v167
s_waitcnt vmcnt(7)
v_dot2_f32_bf16 v168, v96, v144, v168
v_dot2_f32_bf16 v169, v96, v145, v169
v_dot2_f32_bf16 v170, v97, v144, v170
v_dot2_f32_bf16 v171, v97, v145, v171
v_dot2_f32_bf16 v172, v98, v144, v172
v_dot2_f32_bf16 v173, v98, v145, v173
v_dot2_f32_bf16 v174, v99, v144, v174
v_dot2_f32_bf16 v175, v99, v145, v175
s_waitcnt vmcnt(6)
v_dot2_f32_bf16 v168, v100, v146, v168
v_dot2_f32_bf16 v169, v100, v147, v169
v_dot2_f32_bf16 v170, v101, v146, v170
v_dot2_f32_bf16 v171, v101, v147, v171
v_dot2_f32_bf16 v172, v102, v146, v172
v_dot2_f32_bf16 v173, v102, v147, v173
v_dot2_f32_bf16 v174, v103, v146, v174
v_dot2_f32_bf16 v175, v103, v147, v175
s_waitcnt vmcnt(5)
v_dot2_f32_bf16 v168, v104, v148, v168
v_dot2_f32_bf16 v169, v104, v149, v169
v_dot2_f32_bf16 v170, v105, v148, v170
v_dot2_f32_bf16 v171, v105, v149, v171
v_dot2_f32_bf16 v172, v106, v148, v172
v_dot2_f32_bf16 v173, v106, v149, v173
v_dot2_f32_bf16 v174, v107, v148, v174
v_dot2_f32_bf16 v175, v107, v149, v175
s_waitcnt vmcnt(4)
v_dot2_f32_bf16 v168, v108, v150, v168
v_dot2_f32_bf16 v169, v108, v151, v169
v_dot2_f32_bf16 v170, v109, v150, v170
v_dot2_f32_bf16 v171, v109, v151, v171
v_dot2_f32_bf16 v172, v110, v150, v172
v_dot2_f32_bf16 v173, v110, v151, v173
v_dot2_f32_bf16 v174, v111, v150, v174
v_dot2_f32_bf16 v175, v111, v151, v175
s_waitcnt vmcnt(3)
v_dot2_f32_bf16 v168, v112, v152, v168
v_dot2_f32_bf16 v169, v112, v153, v169
v_dot2_f32_bf16 v170, v113, v152, v170
v_dot2_f32_bf16 v171, v113, v153, v171
v_dot2_f32_bf16 v172, v114, v152, v172
v_dot2_f32_bf16 v173, v114, v153, v173
v_dot2_f32_bf16 v174, v115, v152, v174
v_dot2_f32_bf16 v175, v115, v153, v175
s_waitcnt vmcnt(2)
v_dot2_f32_bf16 v168, v116, v154, v168
v_dot2_f32_bf16 v169, v116, v155, v169
v_dot2_f32_bf16 v170, v117, v154, v170
v_dot2_f32_bf16 v171, v117, v155, v171
v_dot2_f32_bf16 v172, v118, v154, v172
v_dot2_f32_bf16 v173, v118, v155, v173
v_dot2_f32_bf16 v174, v119, v154, v174
v_dot2_f32_bf16 v175, v119, v155, v175
s_waitcnt vmcnt(1)
v_dot2_f32_bf16 v168, v120, v156, v168
v_dot2_f32_bf16 v169, v120, v157, v169
v_dot2_f32_bf16 v170, v121, v156, v170
v_dot2_f32_bf16 v171, v121, v157, v171
v_dot2_f32_bf16 v172, v122, v156, v172
v_dot2_f32_bf16 v173, v122, v157, v173
v_dot2_f32_bf16 v174, v123, v156, v174
v_dot2_f32_bf16 v175, v123, v157, v175
s_waitcnt vmcnt(0)
v_dot2_f32_bf16 v168, v124, v158, v168
v_dot2_f32_bf16 v169, v124, v159, v169
v_dot2_f32_bf16 v170, v125, v158, v170
v_dot2_f32_bf16 v171, v125, v159, v171
v_dot2_f32_bf16 v172, v126, v158, v172
v_dot2_f32_bf16 v173, v126, v159, v173
v_dot2_f32_bf16 v174, v127, v158, v174
v_dot2_f32_bf16 v175, v127, v159, v175
v_lshlrev_b32 v29, 5, v0
s_nop 2
ds_write_b128 v29, v[160:163] offset:4096
ds_write_b128 v29, v[164:167] offset:4112
ds_write_b128 v29, v[168:171] offset:12288
ds_write_b128 v29, v[172:175] offset:12304
s_waitcnt lgkmcnt(0)
s_barrier
v_and_b32 v20, 63, v0
v_lshlrev_b32 v20, 2, v20
v_lshrrev_b32 v21, 6, v0
v_lshlrev_b32 v22, 11, v21
v_add_u32 v29, v20, v22
ds_read_b32 v128, v29 offset:4096
ds_read_b32 v129, v29 offset:4352
ds_read_b32 v130, v29 offset:4608
ds_read_b32 v131, v29 offset:4864
ds_read_b32 v132, v29 offset:5120
ds_read_b32 v133, v29 offset:5376
ds_read_b32 v134, v29 offset:5632
ds_read_b32 v135, v29 offset:5888
ds_read_b32 v144, v29 offset:12288
ds_read_b32 v145, v29 offset:12544
ds_read_b32 v146, v29 offset:12800
ds_read_b32 v147, v29 offset:13056
ds_read_b32 v148, v29 offset:13312
ds_read_b32 v149, v29 offset:13568
ds_read_b32 v150, v29 offset:13824
ds_read_b32 v151, v29 offset:14080
s_waitcnt lgkmcnt(0)
v_add_f32 v128, v128, v129
v_add_f32 v130, v130, v131
v_add_f32 v132, v132, v133
v_add_f32 v134, v134, v135
v_add_f32 v128, v128, v130
v_add_f32 v132, v132, v134
v_add_f32 v128, v128, v132
v_add_f32 v144, v144, v145
v_add_f32 v146, v146, v147
v_add_f32 v148, v148, v149
v_add_f32 v150, v150, v151
v_add_f32 v144, v144, v146
v_add_f32 v148, v148, v150
v_add_f32 v144, v144, v148
v_lshlrev_b32 v22, 8, v21
v_add_u32 v29, v20, v22
ds_write_b32 v29, v128 offset:20480
ds_write_b32 v29, v144 offset:21504
s_waitcnt lgkmcnt(0)
s_barrier
ds_read_b32 v128, v20 offset:20480
ds_read_b32 v129, v20 offset:20736
ds_read_b32 v130, v20 offset:20992
ds_read_b32 v131, v20 offset:21248
ds_read_b32 v144, v20 offset:21504
ds_read_b32 v145, v20 offset:21760
ds_read_b32 v146, v20 offset:22016
ds_read_b32 v147, v20 offset:22272
s_waitcnt lgkmcnt(0)
s_cmp_lg_u32 s24, 0
s_cbranch_scc1 L_m2s2
v_add_f32 v128, v128, v129
v_add_f32 v130, v130, v131
v_add_f32 v128, v128, v130
s_add_u32 s30, s69, 0
s_mul_i32 s30, s30, 24576
s_lshl_b32 s31, s68, 8
s_add_u32 s30, s30, s31
s_add_u32 s30, s30, 8192
buffer_store_dword v128, v20, s[56:59], s30 offen sc1
v_add_f32 v144, v144, v145
v_add_f32 v146, v146, v147
v_add_f32 v144, v144, v146
s_add_u32 s30, s69, 1
s_mul_i32 s30, s30, 24576
s_lshl_b32 s31, s68, 8
s_add_u32 s30, s30, s31
s_add_u32 s30, s30, 8192
buffer_store_dword v144, v20, s[56:59], s30 offen sc1
L_m2s2:
s_waitcnt vmcnt(0)
s_barrier
s_cmp_lg_u32 s24, 0
s_cbranch_scc1 L_sig3
s_mov_b32 s33, 49152
v_mov_b32 v2, s33
v_mov_b32 v3, 1
s_mov_b64 exec, 1
global_atomic_add v2, v3, s[34:35]
s_mov_b64 exec, -1
L_sig3:
s_mov_b32 s56, s10
s_mov_b32 s57, s11
s_mov_b32 s58, 8388608
s_mov_b32 s59, 0x20000
s_lshl_b32 s30, s67, 2
s_add_u32 s30, s30, s24
s_mul_i32 s30, s30, 16384
v_lshlrev_b32 v20, 7, v1
buffer_load_dword a255, v20, s[56:59], s30 offen
s_add_u32 s30, s30, 8192
buffer_load_dword a255, v20, s[56:59], s30 offen
L_m21:
s_lshl_b32 s71, s25, 5
s_add_u32 s71, s71, s28
v_lshrrev_b32 v20, 6, v0
v_lshlrev_b32 v20, 18, v20
v_bfe_u32 v21, v0, 5, 1
v_lshlrev_b32 v21, 10, v21
v_bfe_u32 v22, v0, 3, 2
v_lshlrev_b32 v22, 8, v22
v_and_b32 v23, 7, v0
v_lshlrev_b32 v24, 4, v23
v_add3_u32 v28, v20, v21, v22
v_add_u32 v28, v28, v24
s_lshr_b32 s30, s71, 1
s_lshl_b32 s30, s30, 11
s_and_b32 s31, s71, 1
s_lshl_b32 s31, s31, 7
s_add_u32 s30, s30, s31
v_add_u32 v28, s30, v28
v_lshrrev_b32 v20, 5, v0
v_lshlrev_b32 v20, 5, v20
v_lshrrev_b32 v22, 6, v22
v_add_u32 v20, v20, v22
v_lshlrev_b32 v30, 2, v20
s_lshl_b32 s30, s71, 14
v_lshlrev_b32 v23, 11, v23
v_lshlrev_b32 v20, 1, v20
v_add3_u32 v29, v23, v20, s30
s_mov_b32 s48, s4
s_mov_b32 s49, s5
s_mov_b32 s50, 4194304
s_mov_b32 s51, 0x20000
s_add_u32 s52, s22, 76546048
s_addc_u32 s53, s23, 0
s_mov_b32 s54, 98304
s_mov_b32 s55, 0x20000
s_mov_b32 s60, s22
s_mov_b32 s61, s23
s_mov_b32 s62, 4194304
s_mov_b32 s63, 0x20000
s_mov_b32 s67, 0
s_mov_b32 s68, 1048576
s_mov_b32 s69, 2097152
s_mov_b32 s70, 3145728
buffer_load_dwordx2 v[64:65], v29, s[48:51], 0 offen offset:0
buffer_load_dwordx2 v[66:67], v29, s[48:51], 0 offen offset:32
buffer_load_dwordx2 v[68:69], v29, s[48:51], 0 offen offset:512
buffer_load_dwordx2 v[70:71], v29, s[48:51], 0 offen offset:544
buffer_load_dwordx2 v[72:73], v29, s[48:51], 0 offen offset:1024
buffer_load_dwordx2 v[74:75], v29, s[48:51], 0 offen offset:1056
buffer_load_dwordx2 v[76:77], v29, s[48:51], 0 offen offset:1536
buffer_load_dwordx2 v[78:79], v29, s[48:51], 0 offen offset:1568
v_lshlrev_b32 v20, 4, v0
s_mov_b32 s31, 4096
buffer_load_dwordx4 v[144:147], v20, s[52:55], s31 offen
s_mov_b32 s31, 28672
buffer_load_dwordx4 v[148:151], v20, s[52:55], s31 offen
s_mov_b32 s31, 53248
buffer_load_dwordx4 v[152:155], v20, s[52:55], s31 offen
s_mov_b32 s31, 77824
buffer_load_dwordx4 v[156:159], v20, s[52:55], s31 offen
s_mov_b32 s31, 0
buffer_load_dwordx4 v[160:163], v20, s[52:55], s31 offen
s_mov_b32 s31, 24576
buffer_load_dwordx4 v[164:167], v20, s[52:55], s31 offen
s_mov_b32 s31, 49152
buffer_load_dwordx4 v[168:171], v20, s[52:55], s31 offen
s_mov_b32 s31, 73728
buffer_load_dwordx4 v[172:175], v20, s[52:55], s31 offen
s_lshl_b32 s31, s28, 8
s_mov_b32 s32, 0
v_lshrrev_b32 v16, 4, v1
v_mul_u32_u24 v17, 131072, v16
v_and_b32 v18, 15, v1
v_lshlrev_b32 v18, 4, v18
v_add3_u32 v4, v17, v18, s31
s_lshl_b32 s30, s24, 2
s_add_u32 s30, s30, s32
s_mul_i32 s64, s30, 8192
s_mul_i32 s65, s24, 4224
s_add_u32 s65, s65, 66560
v_lshrrev_b32 v16, 2, v1
v_mul_u32_u24 v11, 1056, v16
v_and_b32 v16, 3, v1
v_lshlrev_b32 v16, 3, v16
v_add_u32 v11, v11, v16
v_add_u32 v11, 66560, v11
s_mov_b32 s40, s10
s_mov_b32 s41, s11
s_mov_b32 s42, 8388608
s_mov_b32 s43, 0x20000
s_add_u32 m0, s65, 0
s_nop 0
buffer_load_dwordx4 v4, s[40:43], s64 offen lds
s_add_u32 s64, s64, 8192
s_add_u32 m0, s65, 1056
s_nop 0
buffer_load_dwordx4 v4, s[40:43], s64 offen lds
s_add_u32 s64, s64, 8192
s_add_u32 m0, s65, 2112
s_nop 0
buffer_load_dwordx4 v4, s[40:43], s64 offen lds
s_add_u32 s64, s64, 8192
s_add_u32 m0, s65, 3168
s_nop 0
buffer_load_dwordx4 v4, s[40:43], s64 offen lds
s_add_u32 s64, s64, 499712
s_add_u32 m0, s65, 16896
s_nop 0
buffer_load_dwordx4 v4, s[40:43], s64 offen lds
s_add_u32 s64, s64, 8192
s_add_u32 m0, s65, 17952
s_nop 0
buffer_load_dwordx4 v4, s[40:43], s64 offen lds
s_add_u32 s64, s64, 8192
s_add_u32 m0, s65, 19008
s_nop 0
buffer_load_dwordx4 v4, s[40:43], s64 offen lds
s_add_u32 s64, s64, 8192
s_add_u32 m0, s65, 20064
s_nop 0
buffer_load_dwordx4 v4, s[40:43], s64 offen lds
s_waitcnt vmcnt(8)
v_lshlrev_b32 v20, 4, v0
v_pk_add_f32 v[144:145], v[144:145], v[148:149]
v_pk_add_f32 v[146:147], v[146:147], v[150:151]
v_pk_add_f32 v[144:145], v[144:145], v[152:153]
v_pk_add_f32 v[146:147], v[146:147], v[154:155]
v_pk_add_f32 v[144:145], v[144:145], v[156:157]
v_pk_add_f32 v[146:147], v[146:147], v[158:159]
ds_write_b128 v20, v[144:147] offset:0
v_pk_add_f32 v[160:161], v[160:161], v[164:165]
v_pk_add_f32 v[162:163], v[162:163], v[166:167]
v_pk_add_f32 v[160:161], v[160:161], v[168:169]
v_pk_add_f32 v[162:163], v[162:163], v[170:171]
v_pk_add_f32 v[160:161], v[160:161], v[172:173]
v_pk_add_f32 v[162:163], v[162:163], v[174:175]
ds_write_b128 v20, v[160:163] offset:4096
s_waitcnt lgkmcnt(0)
s_barrier
ds_read_b128 v[80:83], v30 offset:0
ds_read_b128 v[84:87], v30 offset:64
ds_read_b128 v[88:91], v30 offset:1024
ds_read_b128 v[92:95], v30 offset:1088
ds_read_b128 v[96:99], v30 offset:2048
ds_read_b128 v[100:103], v30 offset:2112
ds_read_b128 v[104:107], v30 offset:3072
ds_read_b128 v[108:111], v30 offset:3136
ds_read_b128 v[112:115], v30 offset:4096
ds_read_b128 v[116:119], v30 offset:4160
ds_read_b128 v[120:123], v30 offset:5120
ds_read_b128 v[124:127], v30 offset:5184
ds_read_b128 v[128:131], v30 offset:6144
ds_read_b128 v[132:135], v30 offset:6208
ds_read_b128 v[136:139], v30 offset:7168
ds_read_b128 v[140:143], v30 offset:7232
s_waitcnt lgkmcnt(0)
v_pk_add_f32 v[80:81], v[80:81], 1.0 op_sel_hi:[1,0]
v_pk_add_f32 v[82:83], v[82:83], 1.0 op_sel_hi:[1,0]
v_pk_add_f32 v[84:85], v[84:85], 1.0 op_sel_hi:[1,0]
v_pk_add_f32 v[86:87], v[86:87], 1.0 op_sel_hi:[1,0]
v_pk_add_f32 v[88:89], v[88:89], 1.0 op_sel_hi:[1,0]
v_pk_add_f32 v[90:91], v[90:91], 1.0 op_sel_hi:[1,0]
v_pk_add_f32 v[92:93], v[92:93], 1.0 op_sel_hi:[1,0]
v_pk_add_f32 v[94:95], v[94:95], 1.0 op_sel_hi:[1,0]
v_pk_add_f32 v[96:97], v[96:97], 1.0 op_sel_hi:[1,0]
v_pk_add_f32 v[98:99], v[98:99], 1.0 op_sel_hi:[1,0]
v_pk_add_f32 v[100:101], v[100:101], 1.0 op_sel_hi:[1,0]
v_pk_add_f32 v[102:103], v[102:103], 1.0 op_sel_hi:[1,0]
v_pk_add_f32 v[104:105], v[104:105], 1.0 op_sel_hi:[1,0]
v_pk_add_f32 v[106:107], v[106:107], 1.0 op_sel_hi:[1,0]
v_pk_add_f32 v[108:109], v[108:109], 1.0 op_sel_hi:[1,0]
v_pk_add_f32 v[110:111], v[110:111], 1.0 op_sel_hi:[1,0]
v_mul_f32 v112, 0x3e0293ee, v112
v_mul_f32 v113, 0x3e0293ee, v113
v_mul_f32 v114, 0x3e0293ee, v114
v_mul_f32 v115, 0x3e0293ee, v115
v_mul_f32 v116, 0x3e0293ee, v116
v_mul_f32 v117, 0x3e0293ee, v117
v_mul_f32 v118, 0x3e0293ee, v118
v_mul_f32 v119, 0x3e0293ee, v119
v_mul_f32 v120, 0x3e0293ee, v120
v_mul_f32 v121, 0x3e0293ee, v121
v_mul_f32 v122, 0x3e0293ee, v122
v_mul_f32 v123, 0x3e0293ee, v123
v_mul_f32 v124, 0x3e0293ee, v124
v_mul_f32 v125, 0x3e0293ee, v125
v_mul_f32 v126, 0x3e0293ee, v126
v_mul_f32 v127, 0x3e0293ee, v127
v_mul_f32 v128, 0x3e0293ee, v128
v_mul_f32 v129, 0x3e0293ee, v129
v_mul_f32 v130, 0x3e0293ee, v130
v_mul_f32 v131, 0x3e0293ee, v131
v_mul_f32 v132, 0x3e0293ee, v132
v_mul_f32 v133, 0x3e0293ee, v133
v_mul_f32 v134, 0x3e0293ee, v134
v_mul_f32 v135, 0x3e0293ee, v135
v_mul_f32 v136, 0x3e0293ee, v136
v_mul_f32 v137, 0x3e0293ee, v137
v_mul_f32 v138, 0x3e0293ee, v138
v_mul_f32 v139, 0x3e0293ee, v139
v_mul_f32 v140, 0x3e0293ee, v140
v_mul_f32 v141, 0x3e0293ee, v141
v_mul_f32 v142, 0x3e0293ee, v142
v_mul_f32 v143, 0x3e0293ee, v143
s_mov_b32 s72, 0x00003f80
s_mov_b32 s73, 0x3f800000
s_waitcnt vmcnt(16)
v_lshlrev_b32 v32, 16, v64
v_and_b32 v33, 0xffff0000, v64
v_lshlrev_b32 v34, 16, v65
v_and_b32 v35, 0xffff0000, v65
v_lshlrev_b32 v36, 16, v66
v_and_b32 v37, 0xffff0000, v66
v_lshlrev_b32 v38, 16, v67
v_and_b32 v39, 0xffff0000, v67
v_lshlrev_b32 v40, 16, v68
v_and_b32 v41, 0xffff0000, v68
v_lshlrev_b32 v42, 16, v69
v_and_b32 v43, 0xffff0000, v69
v_lshlrev_b32 v44, 16, v70
v_and_b32 v45, 0xffff0000, v70
v_lshlrev_b32 v46, 16, v71
v_and_b32 v47, 0xffff0000, v71
v_lshlrev_b32 v48, 16, v72
v_and_b32 v49, 0xffff0000, v72
v_lshlrev_b32 v50, 16, v73
v_and_b32 v51, 0xffff0000, v73
v_lshlrev_b32 v52, 16, v74
v_and_b32 v53, 0xffff0000, v74
v_lshlrev_b32 v54, 16, v75
v_and_b32 v55, 0xffff0000, v75
v_lshlrev_b32 v56, 16, v76
v_and_b32 v57, 0xffff0000, v76
v_lshlrev_b32 v58, 16, v77
v_and_b32 v59, 0xffff0000, v77
v_lshlrev_b32 v60, 16, v78
v_and_b32 v61, 0xffff0000, v78
v_lshlrev_b32 v62, 16, v79
v_and_b32 v63, 0xffff0000, v79
v_lshrrev_b32 v26, 6, v0
v_lshlrev_b32 v26, 5, v26
v_and_b32 v27, 7, v0
v_lshlrev_b32 v27, 2, v27
v_add_u32 v27, 134144, v27
v_add_u32 v26, v26, v27
v_pk_add_f32 v[24:25], v[32:33], v[34:35]
v_pk_add_f32 v[24:25], v[24:25], v[36:37]
v_pk_add_f32 v[24:25], v[24:25], v[38:39]
v_pk_add_f32 v[24:25], v[24:25], v[40:41]
v_pk_add_f32 v[24:25], v[24:25], v[42:43]
v_pk_add_f32 v[24:25], v[24:25], v[44:45]
v_pk_add_f32 v[24:25], v[24:25], v[46:47]
v_pk_add_f32 v[24:25], v[24:25], v[48:49]
v_pk_add_f32 v[24:25], v[24:25], v[50:51]
v_pk_add_f32 v[24:25], v[24:25], v[52:53]
v_pk_add_f32 v[24:25], v[24:25], v[54:55]
v_pk_add_f32 v[24:25], v[24:25], v[56:57]
v_pk_add_f32 v[24:25], v[24:25], v[58:59]
v_pk_add_f32 v[24:25], v[24:25], v[60:61]
v_pk_add_f32 v[24:25], v[24:25], v[62:63]
v_add_f32 v24, v24, v25
s_nop 1
v_add_f32_dpp v24, v24, v24 row_ror:8 row_mask:0xf bank_mask:0xf
v_mov_b32 v25, v24
s_nop 1
v_permlane16_swap_b32 v24, v25
s_nop 1
v_add_f32 v24, v24, v25
v_mov_b32 v25, v24
s_nop 1
v_permlane32_swap_b32 v24, v25
s_nop 1
v_add_f32 v24, v24, v25
ds_write_b32 v26, v24 offset:0
s_waitcnt lgkmcnt(0)
s_barrier
ds_read_b32 v20, v27 offset:0
ds_read_b32 v21, v27 offset:32
ds_read_b32 v22, v27 offset:64
ds_read_b32 v23, v27 offset:96
s_waitcnt lgkmcnt(0)
v_add_f32 v20, v20, v21
v_add_f32 v22, v22, v23
v_add_f32 v24, v20, v22
v_mul_f32 v24, 0xba800000, v24
v_pk_add_f32 v[32:33], v[32:33], v[24:25] op_sel_hi:[1,0]
v_pk_add_f32 v[34:35], v[34:35], v[24:25] op_sel_hi:[1,0]
v_pk_add_f32 v[36:37], v[36:37], v[24:25] op_sel_hi:[1,0]
v_pk_add_f32 v[38:39], v[38:39], v[24:25] op_sel_hi:[1,0]
v_pk_add_f32 v[40:41], v[40:41], v[24:25] op_sel_hi:[1,0]
v_pk_add_f32 v[42:43], v[42:43], v[24:25] op_sel_hi:[1,0]
v_pk_add_f32 v[44:45], v[44:45], v[24:25] op_sel_hi:[1,0]
v_pk_add_f32 v[46:47], v[46:47], v[24:25] op_sel_hi:[1,0]
v_pk_add_f32 v[48:49], v[48:49], v[24:25] op_sel_hi:[1,0]
v_pk_add_f32 v[50:51], v[50:51], v[24:25] op_sel_hi:[1,0]
v_pk_add_f32 v[52:53], v[52:53], v[24:25] op_sel_hi:[1,0]
v_pk_add_f32 v[54:55], v[54:55], v[24:25] op_sel_hi:[1,0]
v_pk_add_f32 v[56:57], v[56:57], v[24:25] op_sel_hi:[1,0]
v_pk_add_f32 v[58:59], v[58:59], v[24:25] op_sel_hi:[1,0]
v_pk_add_f32 v[60:61], v[60:61], v[24:25] op_sel_hi:[1,0]
v_pk_add_f32 v[62:63], v[62:63], v[24:25] op_sel_hi:[1,0]
v_pk_mul_f32 v[24:25], v[32:33], v[32:33]
v_pk_fma_f32 v[24:25], v[34:35], v[34:35], v[24:25]
v_pk_fma_f32 v[24:25], v[36:37], v[36:37], v[24:25]
v_pk_fma_f32 v[24:25], v[38:39], v[38:39], v[24:25]
v_pk_fma_f32 v[24:25], v[40:41], v[40:41], v[24:25]
v_pk_fma_f32 v[24:25], v[42:43], v[42:43], v[24:25]
v_pk_fma_f32 v[24:25], v[44:45], v[44:45], v[24:25]
v_pk_fma_f32 v[24:25], v[46:47], v[46:47], v[24:25]
v_pk_fma_f32 v[24:25], v[48:49], v[48:49], v[24:25]
v_pk_fma_f32 v[24:25], v[50:51], v[50:51], v[24:25]
v_pk_fma_f32 v[24:25], v[52:53], v[52:53], v[24:25]
v_pk_fma_f32 v[24:25], v[54:55], v[54:55], v[24:25]
v_pk_fma_f32 v[24:25], v[56:57], v[56:57], v[24:25]
v_pk_fma_f32 v[24:25], v[58:59], v[58:59], v[24:25]
v_pk_fma_f32 v[24:25], v[60:61], v[60:61], v[24:25]
v_pk_fma_f32 v[24:25], v[62:63], v[62:63], v[24:25]
v_add_f32 v24, v24, v25
s_nop 1
v_add_f32_dpp v24, v24, v24 row_ror:8 row_mask:0xf bank_mask:0xf
v_mov_b32 v25, v24
s_nop 1
v_permlane16_swap_b32 v24, v25
s_nop 1
v_add_f32 v24, v24, v25
v_mov_b32 v25, v24
s_nop 1
v_permlane32_swap_b32 v24, v25
s_nop 1
v_add_f32 v24, v24, v25
ds_write_b32 v26, v24 offset:128
s_waitcnt lgkmcnt(0)
s_barrier
ds_read_b32 v20, v27 offset:128
ds_read_b32 v21, v27 offset:160
ds_read_b32 v22, v27 offset:192
ds_read_b32 v23, v27 offset:224
s_waitcnt lgkmcnt(0)
v_add_f32 v20, v20, v21
v_add_f32 v22, v22, v23
v_add_f32 v24, v20, v22
v_mov_b32 v25, 0x3727c5ac
v_fmac_f32 v25, 0x3a800000, v24
v_rsq_f32 v24, v25
s_nop 0
v_mul_f32 v24, 0x3e0293ee, v24
v_pk_mul_f32 v[32:33], v[32:33], v[24:25] op_sel_hi:[1,0]
v_pk_mul_f32 v[34:35], v[34:35], v[24:25] op_sel_hi:[1,0]
v_pk_mul_f32 v[36:37], v[36:37], v[24:25] op_sel_hi:[1,0]
v_pk_mul_f32 v[38:39], v[38:39], v[24:25] op_sel_hi:[1,0]
v_pk_mul_f32 v[40:41], v[40:41], v[24:25] op_sel_hi:[1,0]
v_pk_mul_f32 v[42:43], v[42:43], v[24:25] op_sel_hi:[1,0]
v_pk_mul_f32 v[44:45], v[44:45], v[24:25] op_sel_hi:[1,0]
v_pk_mul_f32 v[46:47], v[46:47], v[24:25] op_sel_hi:[1,0]
v_pk_mul_f32 v[48:49], v[48:49], v[24:25] op_sel_hi:[1,0]
v_pk_mul_f32 v[50:51], v[50:51], v[24:25] op_sel_hi:[1,0]
v_pk_mul_f32 v[52:53], v[52:53], v[24:25] op_sel_hi:[1,0]
v_pk_mul_f32 v[54:55], v[54:55], v[24:25] op_sel_hi:[1,0]
v_pk_mul_f32 v[56:57], v[56:57], v[24:25] op_sel_hi:[1,0]
v_pk_mul_f32 v[58:59], v[58:59], v[24:25] op_sel_hi:[1,0]
v_pk_mul_f32 v[60:61], v[60:61], v[24:25] op_sel_hi:[1,0]
v_pk_mul_f32 v[62:63], v[62:63], v[24:25] op_sel_hi:[1,0]
v_pk_fma_f32 v[32:33], v[32:33], v[80:81], v[112:113]
v_pk_fma_f32 v[34:35], v[34:35], v[82:83], v[114:115]
v_pk_fma_f32 v[36:37], v[36:37], v[84:85], v[116:117]
v_pk_fma_f32 v[38:39], v[38:39], v[86:87], v[118:119]
v_cvt_pk_bf16_f32 v64, v32, v33
v_cvt_pk_bf16_f32 v65, v34, v35
v_cvt_pk_bf16_f32 v66, v36, v37
v_cvt_pk_bf16_f32 v67, v38, v39
buffer_store_dwordx4 v[64:67], v28, s[60:63], s67 offen sc1
v_pk_fma_f32 v[40:41], v[40:41], v[88:89], v[120:121]
v_pk_fma_f32 v[42:43], v[42:43], v[90:91], v[122:123]
v_pk_fma_f32 v[44:45], v[44:45], v[92:93], v[124:125]
v_pk_fma_f32 v[46:47], v[46:47], v[94:95], v[126:127]
v_cvt_pk_bf16_f32 v68, v40, v41
v_cvt_pk_bf16_f32 v69, v42, v43
v_cvt_pk_bf16_f32 v70, v44, v45
v_cvt_pk_bf16_f32 v71, v46, v47
buffer_store_dwordx4 v[68:71], v28, s[60:63], s68 offen sc1
v_pk_fma_f32 v[48:49], v[48:49], v[96:97], v[128:129]
v_pk_fma_f32 v[50:51], v[50:51], v[98:99], v[130:131]
v_pk_fma_f32 v[52:53], v[52:53], v[100:101], v[132:133]
v_pk_fma_f32 v[54:55], v[54:55], v[102:103], v[134:135]
v_cvt_pk_bf16_f32 v72, v48, v49
v_cvt_pk_bf16_f32 v73, v50, v51
v_cvt_pk_bf16_f32 v74, v52, v53
v_cvt_pk_bf16_f32 v75, v54, v55
buffer_store_dwordx4 v[72:75], v28, s[60:63], s69 offen sc1
v_pk_fma_f32 v[56:57], v[56:57], v[104:105], v[136:137]
v_pk_fma_f32 v[58:59], v[58:59], v[106:107], v[138:139]
v_pk_fma_f32 v[60:61], v[60:61], v[108:109], v[140:141]
v_pk_fma_f32 v[62:63], v[62:63], v[110:111], v[142:143]
v_cvt_pk_bf16_f32 v76, v56, v57
v_cvt_pk_bf16_f32 v77, v58, v59
v_cvt_pk_bf16_f32 v78, v60, v61
v_cvt_pk_bf16_f32 v79, v62, v63
buffer_store_dwordx4 v[76:79], v28, s[60:63], s70 offen sc1
s_waitcnt vmcnt(0)
s_barrier
s_cmp_lg_u32 s24, 0
s_cbranch_scc1 L_sig4
s_lshl_b32 s33, s25, 3
s_add_u32 s33, s33, 0
s_lshl_b32 s33, s33, 7
v_mov_b32 v2, s33
v_mov_b32 v3, 1
s_mov_b64 exec, 1
global_atomic_add v2, v3, s[34:35]
s_mov_b64 exec, -1
L_sig4:
v_lshrrev_b32 v16, 4, v1
v_lshlrev_b32 v17, 12, v16
v_and_b32 v18, 15, v1
v_lshlrev_b32 v18, 4, v18
v_add_u32 v20, v17, v18
v_add_u32 v5, 4096, v20
v_add_u32 v9, 4096, v20
v_add_u32 v6, 3312, v20
v_add_u32 v10, 3296, v20
v_add_u32 v7, 2528, v20
v_add_u32 v12, 2496, v20
v_add_u32 v8, 1744, v20
v_add_u32 v13, 1696, v20
s_mul_i32 s69, s24, 4160
s_mul_i32 s70, s24, 4224
s_add_u32 s70, s70, 66560
s_lshl_b32 s71, s69, 1
s_add_u32 s71, s71, 33280
s_lshl_b32 s72, s70, 1
s_add_u32 s72, s72, 33792
s_lshr_b32 s30, s28, 3
s_lshl_b32 s30, s30, 11
s_lshl_b32 s31, s24, 2
s_add_u32 s30, s30, s31
s_add_u32 s30, s30, 1536
s_lshl_b32 s67, s30, 8
s_mov_b32 s68, s67
v_lshrrev_b32 v16, 2, v1
v_mul_u32_u24 v23, 1056, v16
v_and_b32 v16, 3, v1
v_lshlrev_b32 v16, 3, v16
v_add_u32 v23, v23, v16
v_add_u32 v23, 66560, v23
v_add_u32 v24, 33792, v23
v_and_b32 v16, 15, v1
v_mul_u32_u24 v22, 1040, v16
v_lshrrev_b32 v16, 4, v1
v_lshlrev_b32 v16, 3, v16
v_add_u32 v22, v22, v16
v_add_u32 v21, 33280, v22
s_sub_u32 s48, s6, 4096
s_subb_u32 s49, s7, 0
s_mov_b32 s51, 0x20000
s_sub_u32 s52, s8, 4096
s_subb_u32 s53, s9, 0
s_mov_b32 s55, 0x20000
s_lshr_b32 s30, s28, 3
s_add_u32 s30, s30, 1
s_lshl_b32 s30, s30, 19
s_add_u32 s50, s30, 4096
s_mov_b32 s54, s50
s_add_u32 s56, s22, 4194304
s_addc_u32 s57, s23, 0
s_mov_b32 s58, 16777216
s_mov_b32 s59, 0x20000
s_mov_b32 s44, s22
s_mov_b32 s45, s23
s_mov_b32 s46, 4194304
s_mov_b32 s47, 0x20000
s_mov_b32 s66, 0
v_mov_b32 v64, 0
v_mov_b32 v65, 0
v_mov_b32 v66, 0
v_mov_b32 v67, 0
v_mov_b32 v68, 0
v_mov_b32 v69, 0
v_mov_b32 v70, 0
v_mov_b32 v71, 0
v_mov_b32 v72, 0
v_mov_b32 v73, 0
v_mov_b32 v74, 0
v_mov_b32 v75, 0
v_mov_b32 v76, 0
v_mov_b32 v77, 0
v_mov_b32 v78, 0
v_mov_b32 v79, 0
v_mov_b32 v80, 0
v_mov_b32 v81, 0
v_mov_b32 v82, 0
v_mov_b32 v83, 0
v_mov_b32 v84, 0
v_mov_b32 v85, 0
v_mov_b32 v86, 0
v_mov_b32 v87, 0
v_mov_b32 v88, 0
v_mov_b32 v89, 0
v_mov_b32 v90, 0
v_mov_b32 v91, 0
v_mov_b32 v92, 0
v_mov_b32 v93, 0
v_mov_b32 v94, 0
v_mov_b32 v95, 0
v_mov_b32 v96, 0
v_mov_b32 v97, 0
v_mov_b32 v98, 0
v_mov_b32 v99, 0
v_mov_b32 v100, 0
v_mov_b32 v101, 0
v_mov_b32 v102, 0
v_mov_b32 v103, 0
v_mov_b32 v104, 0
v_mov_b32 v105, 0
v_mov_b32 v106, 0
v_mov_b32 v107, 0
v_mov_b32 v108, 0
v_mov_b32 v109, 0
v_mov_b32 v110, 0
v_mov_b32 v111, 0
v_mov_b32 v112, 0
v_mov_b32 v113, 0
v_mov_b32 v114, 0
v_mov_b32 v115, 0
v_mov_b32 v116, 0
v_mov_b32 v117, 0
v_mov_b32 v118, 0
v_mov_b32 v119, 0
v_mov_b32 v120, 0
v_mov_b32 v121, 0
v_mov_b32 v122, 0
v_mov_b32 v123, 0
v_mov_b32 v124, 0
v_mov_b32 v125, 0
v_mov_b32 v126, 0
v_mov_b32 v127, 0
v_mov_b32 v128, 0
v_mov_b32 v129, 0
v_mov_b32 v130, 0
v_mov_b32 v131, 0
v_mov_b32 v132, 0
v_mov_b32 v133, 0
v_mov_b32 v134, 0
v_mov_b32 v135, 0
v_mov_b32 v136, 0
v_mov_b32 v137, 0
v_mov_b32 v138, 0
v_mov_b32 v139, 0
v_mov_b32 v140, 0
v_mov_b32 v141, 0
v_mov_b32 v142, 0
v_mov_b32 v143, 0
v_mov_b32 v144, 0
v_mov_b32 v145, 0
v_mov_b32 v146, 0
v_mov_b32 v147, 0
v_mov_b32 v148, 0
v_mov_b32 v149, 0
v_mov_b32 v150, 0
v_mov_b32 v151, 0
v_mov_b32 v152, 0
v_mov_b32 v153, 0
v_mov_b32 v154, 0
v_mov_b32 v155, 0
v_mov_b32 v156, 0
v_mov_b32 v157, 0
v_mov_b32 v158, 0
v_mov_b32 v159, 0
v_mov_b32 v160, 0
v_mov_b32 v161, 0
v_mov_b32 v162, 0
v_mov_b32 v163, 0
v_mov_b32 v164, 0
v_mov_b32 v165, 0
v_mov_b32 v166, 0
v_mov_b32 v167, 0
v_mov_b32 v168, 0
v_mov_b32 v169, 0
v_mov_b32 v170, 0
v_mov_b32 v171, 0
v_mov_b32 v172, 0
v_mov_b32 v173, 0
v_mov_b32 v174, 0
v_mov_b32 v175, 0
v_mov_b32 v176, 0
v_mov_b32 v177, 0
v_mov_b32 v178, 0
v_mov_b32 v179, 0
v_mov_b32 v180, 0
v_mov_b32 v181, 0
v_mov_b32 v182, 0
v_mov_b32 v183, 0
v_mov_b32 v184, 0
v_mov_b32 v185, 0
v_mov_b32 v186, 0
v_mov_b32 v187, 0
v_mov_b32 v188, 0
v_mov_b32 v189, 0
v_mov_b32 v190, 0
v_mov_b32 v191, 0
s_waitcnt vmcnt(8)
s_barrier
ds_read_b64_tr_b16 a[192:193], v11 offset:0
ds_read_b64_tr_b16 a[194:195], v11 offset:256
ds_read_b64_tr_b16 a[196:197], v11 offset:32
ds_read_b64_tr_b16 a[198:199], v11 offset:288
ds_read_b64_tr_b16 a[200:201], v11 offset:64
ds_read_b64_tr_b16 a[202:203], v11 offset:320
ds_read_b64_tr_b16 a[204:205], v11 offset:96
ds_read_b64_tr_b16 a[206:207], v11 offset:352
ds_read_b64_tr_b16 a[208:209], v11 offset:128
ds_read_b64_tr_b16 a[210:211], v11 offset:384
ds_read_b64_tr_b16 a[212:213], v11 offset:160
ds_read_b64_tr_b16 a[214:215], v11 offset:416
s_cmp_lg_u32 s24, 0
s_cbranch_scc1 L_wt5
s_lshl_b32 s33, s25, 3
s_add_u32 s33, s33, 0
s_lshl_b32 s33, s33, 7
v_mov_b32 v2, s33
s_mov_b32 s32, 1048576
L_poll6:
global_load_dword v3, v2, s[34:35] sc1
s_waitcnt vmcnt(0)
v_readfirstlane_b32 s31, v3
s_nop 0
s_cmp_ge_u32 s31, 32
s_cbranch_scc1 L_pd7
s_sub_u32 s32, s32, 1
s_cmp_eq_u32 s32, 0
s_cbranch_scc1 L_pd7
s_sleep 2
s_branch L_poll6
L_pd7:
L_wt5:
s_barrier
buffer_load_dwordx4 a[128:131], v14, s[44:47], s66 offen offset:0 sc1
buffer_load_dwordx4 a[132:135], v14, s[44:47], s66 offen offset:2048 sc1
buffer_load_dwordx4 a[136:139], v15, s[44:47], s66 offen offset:0 sc1
buffer_load_dwordx4 a[140:143], v15, s[44:47], s66 offen offset:2048 sc1
buffer_load_dwordx4 a[144:147], v14, s[44:47], s66 offen offset:1024 sc1
buffer_load_dwordx4 a[148:151], v14, s[44:47], s66 offen offset:3072 sc1
buffer_load_dwordx4 a[152:155], v15, s[44:47], s66 offen offset:1024 sc1
buffer_load_dwordx4 a[156:159], v15, s[44:47], s66 offen offset:3072 sc1
s_add_u32 s66, s66, 262144
buffer_load_dwordx4 a[160:163], v14, s[44:47], s66 offen offset:0 sc1
buffer_load_dwordx4 a[164:167], v14, s[44:47], s66 offen offset:2048 sc1
buffer_load_dwordx4 a[168:171], v15, s[44:47], s66 offen offset:0 sc1
buffer_load_dwordx4 a[172:175], v15, s[44:47], s66 offen offset:2048 sc1
s_mov_b32 s29, 3
L_loop_q:
s_waitcnt vmcnt(8)
s_waitcnt lgkmcnt(8)
v_mfma_f32_16x16x32_bf16 v[64:67], a[192:195], a[128:131], v[64:67]
ds_read_b64_tr_b16 a[216:217], v11 offset:192
v_mfma_f32_16x16x32_bf16 v[96:99], a[192:195], a[132:135], v[96:99]
s_add_u32 s64, s64, 499712
s_add_u32 m0, s65, 33792
v_mfma_f32_16x16x32_bf16 v[128:131], a[192:195], a[136:139], v[128:131]
ds_read_b64_tr_b16 a[218:219], v11 offset:448
v_mfma_f32_16x16x32_bf16 v[160:163], a[192:195], a[140:143], v[160:163]
buffer_load_dwordx4 v4, s[40:43], s64 offen lds
v_mfma_f32_16x16x32_bf16 v[164:167], a[196:199], a[140:143], v[164:167]
ds_read_b64_tr_b16 a[220:221], v11 offset:224
v_mfma_f32_16x16x32_bf16 v[132:135], a[196:199], a[136:139], v[132:135]
v_mfma_f32_16x16x32_bf16 v[100:103], a[196:199], a[132:135], v[100:103]
ds_read_b64_tr_b16 a[222:223], v11 offset:480
v_mfma_f32_16x16x32_bf16 v[68:71], a[196:199], a[128:131], v[68:71]
s_add_u32 s64, s64, 8192
s_add_u32 m0, s65, 34848
s_waitcnt lgkmcnt(8)
v_mfma_f32_16x16x32_bf16 v[72:75], a[200:203], a[128:131], v[72:75]
ds_read_b64_tr_b16 a[192:193], v11 offset:512
v_mfma_f32_16x16x32_bf16 v[104:107], a[200:203], a[132:135], v[104:107]
buffer_load_dwordx4 v4, s[40:43], s64 offen lds
v_mfma_f32_16x16x32_bf16 v[136:139], a[200:203], a[136:139], v[136:139]
ds_read_b64_tr_b16 a[194:195], v11 offset:768
v_mfma_f32_16x16x32_bf16 v[168:171], a[200:203], a[140:143], v[168:171]
v_mfma_f32_16x16x32_bf16 v[172:175], a[204:207], a[140:143], v[172:175]
ds_read_b64_tr_b16 a[196:197], v11 offset:544
v_mfma_f32_16x16x32_bf16 v[140:143], a[204:207], a[136:139], v[140:143]
buffer_load_dwordx4 a[176:179], v14, s[44:47], s66 offen offset:1024 sc1
v_mfma_f32_16x16x32_bf16 v[108:111], a[204:207], a[132:135], v[108:111]
ds_read_b64_tr_b16 a[198:199], v11 offset:800
v_mfma_f32_16x16x32_bf16 v[76:79], a[204:207], a[128:131], v[76:79]
s_waitcnt lgkmcnt(8)
v_mfma_f32_16x16x32_bf16 v[80:83], a[208:211], a[128:131], v[80:83]
ds_read_b64_tr_b16 a[200:201], v11 offset:576
v_mfma_f32_16x16x32_bf16 v[112:115], a[208:211], a[132:135], v[112:115]
buffer_load_dwordx4 a[180:183], v14, s[44:47], s66 offen offset:3072 sc1
v_mfma_f32_16x16x32_bf16 v[144:147], a[208:211], a[136:139], v[144:147]
ds_read_b64_tr_b16 a[202:203], v11 offset:832
v_mfma_f32_16x16x32_bf16 v[176:179], a[208:211], a[140:143], v[176:179]
v_mfma_f32_16x16x32_bf16 v[180:183], a[212:215], a[140:143], v[180:183]
ds_read_b64_tr_b16 a[204:205], v11 offset:608
v_mfma_f32_16x16x32_bf16 v[148:151], a[212:215], a[136:139], v[148:151]
v_mfma_f32_16x16x32_bf16 v[116:119], a[212:215], a[132:135], v[116:119]
ds_read_b64_tr_b16 a[206:207], v11 offset:864
v_mfma_f32_16x16x32_bf16 v[84:87], a[212:215], a[128:131], v[84:87]
buffer_load_dwordx4 a[184:187], v15, s[44:47], s66 offen offset:1024 sc1
s_waitcnt lgkmcnt(8)
v_mfma_f32_16x16x32_bf16 v[88:91], a[216:219], a[128:131], v[88:91]
ds_read_b64_tr_b16 a[208:209], v11 offset:640
v_mfma_f32_16x16x32_bf16 v[120:123], a[216:219], a[132:135], v[120:123]
v_mfma_f32_16x16x32_bf16 v[152:155], a[216:219], a[136:139], v[152:155]
ds_read_b64_tr_b16 a[210:211], v11 offset:896
v_mfma_f32_16x16x32_bf16 v[184:187], a[216:219], a[140:143], v[184:187]
v_mfma_f32_16x16x32_bf16 v[188:191], a[220:223], a[140:143], v[188:191]
ds_read_b64_tr_b16 a[212:213], v11 offset:672
v_mfma_f32_16x16x32_bf16 v[156:159], a[220:223], a[136:139], v[156:159]
buffer_load_dwordx4 a[188:191], v15, s[44:47], s66 offen offset:3072 sc1
v_mfma_f32_16x16x32_bf16 v[124:127], a[220:223], a[132:135], v[124:127]
ds_read_b64_tr_b16 a[214:215], v11 offset:928
v_mfma_f32_16x16x32_bf16 v[92:95], a[220:223], a[128:131], v[92:95]
s_waitcnt vmcnt(10)
s_waitcnt lgkmcnt(8)
v_mfma_f32_16x16x32_bf16 v[64:67], a[192:195], a[144:147], v[64:67]
ds_read_b64_tr_b16 a[216:217], v11 offset:704
v_mfma_f32_16x16x32_bf16 v[96:99], a[192:195], a[148:151], v[96:99]
s_add_u32 s64, s64, 8192
s_add_u32 m0, s65, 35904
v_mfma_f32_16x16x32_bf16 v[128:131], a[192:195], a[152:155], v[128:131]
ds_read_b64_tr_b16 a[218:219], v11 offset:960
v_mfma_f32_16x16x32_bf16 v[160:163], a[192:195], a[156:159], v[160:163]
buffer_load_dwordx4 v4, s[40:43], s64 offen lds
v_mfma_f32_16x16x32_bf16 v[164:167], a[196:199], a[156:159], v[164:167]
ds_read_b64_tr_b16 a[220:221], v11 offset:736
v_mfma_f32_16x16x32_bf16 v[132:135], a[196:199], a[152:155], v[132:135]
v_mfma_f32_16x16x32_bf16 v[100:103], a[196:199], a[148:151], v[100:103]
ds_read_b64_tr_b16 a[222:223], v11 offset:992
v_mfma_f32_16x16x32_bf16 v[68:71], a[196:199], a[144:147], v[68:71]
s_add_u32 s64, s64, 8192
s_add_u32 m0, s65, 36960
s_waitcnt lgkmcnt(8)
s_waitcnt vmcnt(11)
s_barrier
v_mfma_f32_16x16x32_bf16 v[72:75], a[200:203], a[144:147], v[72:75]
ds_read_b64_tr_b16 a[192:193], v11 offset:16896
v_mfma_f32_16x16x32_bf16 v[104:107], a[200:203], a[148:151], v[104:107]
buffer_load_dwordx4 v4, s[40:43], s64 offen lds
v_mfma_f32_16x16x32_bf16 v[136:139], a[200:203], a[152:155], v[136:139]
ds_read_b64_tr_b16 a[194:195], v11 offset:17152
v_mfma_f32_16x16x32_bf16 v[168:171], a[200:203], a[156:159], v[168:171]
v_mfma_f32_16x16x32_bf16 v[172:175], a[204:207], a[156:159], v[172:175]
ds_read_b64_tr_b16 a[196:197], v11 offset:16928
v_mfma_f32_16x16x32_bf16 v[140:143], a[204:207], a[152:155], v[140:143]
s_add_u32 s66, s66, 262144
v_mfma_f32_16x16x32_bf16 v[108:111], a[204:207], a[148:151], v[108:111]
ds_read_b64_tr_b16 a[198:199], v11 offset:17184
v_mfma_f32_16x16x32_bf16 v[76:79], a[204:207], a[144:147], v[76:79]
buffer_load_dwordx4 a[128:131], v14, s[44:47], s66 offen offset:0 sc1
s_waitcnt lgkmcnt(8)
v_mfma_f32_16x16x32_bf16 v[80:83], a[208:211], a[144:147], v[80:83]
ds_read_b64_tr_b16 a[200:201], v11 offset:16960
v_mfma_f32_16x16x32_bf16 v[112:115], a[208:211], a[148:151], v[112:115]
buffer_load_dwordx4 a[132:135], v14, s[44:47], s66 offen offset:2048 sc1
v_mfma_f32_16x16x32_bf16 v[144:147], a[208:211], a[152:155], v[144:147]
ds_read_b64_tr_b16 a[202:203], v11 offset:17216
v_mfma_f32_16x16x32_bf16 v[176:179], a[208:211], a[156:159], v[176:179]
v_mfma_f32_16x16x32_bf16 v[180:183], a[212:215], a[156:159], v[180:183]
ds_read_b64_tr_b16 a[204:205], v11 offset:16992
v_mfma_f32_16x16x32_bf16 v[148:151], a[212:215], a[152:155], v[148:151]
v_mfma_f32_16x16x32_bf16 v[116:119], a[212:215], a[148:151], v[116:119]
ds_read_b64_tr_b16 a[206:207], v11 offset:17248
v_mfma_f32_16x16x32_bf16 v[84:87], a[212:215], a[144:147], v[84:87]
buffer_load_dwordx4 a[136:139], v15, s[44:47], s66 offen offset:0 sc1
s_waitcnt lgkmcnt(8)
v_mfma_f32_16x16x32_bf16 v[88:91], a[216:219], a[144:147], v[88:91]
ds_read_b64_tr_b16 a[208:209], v11 offset:17024
v_mfma_f32_16x16x32_bf16 v[120:123], a[216:219], a[148:151], v[120:123]
v_mfma_f32_16x16x32_bf16 v[152:155], a[216:219], a[152:155], v[152:155]
ds_read_b64_tr_b16 a[210:211], v11 offset:17280
v_mfma_f32_16x16x32_bf16 v[184:187], a[216:219], a[156:159], v[184:187]
v_mfma_f32_16x16x32_bf16 v[188:191], a[220:223], a[156:159], v[188:191]
ds_read_b64_tr_b16 a[212:213], v11 offset:17056
v_mfma_f32_16x16x32_bf16 v[156:159], a[220:223], a[152:155], v[156:159]
buffer_load_dwordx4 a[140:143], v15, s[44:47], s66 offen offset:2048 sc1
v_mfma_f32_16x16x32_bf16 v[124:127], a[220:223], a[148:151], v[124:127]
ds_read_b64_tr_b16 a[214:215], v11 offset:17312
v_mfma_f32_16x16x32_bf16 v[92:95], a[220:223], a[144:147], v[92:95]
s_waitcnt vmcnt(12)
s_waitcnt lgkmcnt(8)
v_mfma_f32_16x16x32_bf16 v[64:67], a[192:195], a[160:163], v[64:67]
ds_read_b64_tr_b16 a[216:217], v11 offset:17088
v_mfma_f32_16x16x32_bf16 v[96:99], a[192:195], a[164:167], v[96:99]
s_add_u32 s64, s64, 499712
s_add_u32 m0, s65, 50688
v_mfma_f32_16x16x32_bf16 v[128:131], a[192:195], a[168:171], v[128:131]
ds_read_b64_tr_b16 a[218:219], v11 offset:17344
v_mfma_f32_16x16x32_bf16 v[160:163], a[192:195], a[172:175], v[160:163]
buffer_load_dwordx4 v4, s[40:43], s64 offen lds
v_mfma_f32_16x16x32_bf16 v[164:167], a[196:199], a[172:175], v[164:167]
ds_read_b64_tr_b16 a[220:221], v11 offset:17120
v_mfma_f32_16x16x32_bf16 v[132:135], a[196:199], a[168:171], v[132:135]
v_mfma_f32_16x16x32_bf16 v[100:103], a[196:199], a[164:167], v[100:103]
ds_read_b64_tr_b16 a[222:223], v11 offset:17376
v_mfma_f32_16x16x32_bf16 v[68:71], a[196:199], a[160:163], v[68:71]
s_add_u32 s64, s64, 8192
s_add_u32 m0, s65, 51744
s_waitcnt lgkmcnt(8)
v_mfma_f32_16x16x32_bf16 v[72:75], a[200:203], a[160:163], v[72:75]
ds_read_b64_tr_b16 a[192:193], v11 offset:17408
v_mfma_f32_16x16x32_bf16 v[104:107], a[200:203], a[164:167], v[104:107]
buffer_load_dwordx4 v4, s[40:43], s64 offen lds
v_mfma_f32_16x16x32_bf16 v[136:139], a[200:203], a[168:171], v[136:139]
ds_read_b64_tr_b16 a[194:195], v11 offset:17664
v_mfma_f32_16x16x32_bf16 v[168:171], a[200:203], a[172:175], v[168:171]
v_mfma_f32_16x16x32_bf16 v[172:175], a[204:207], a[172:175], v[172:175]
ds_read_b64_tr_b16 a[196:197], v11 offset:17440
v_mfma_f32_16x16x32_bf16 v[140:143], a[204:207], a[168:171], v[140:143]
buffer_load_dwordx4 a[144:147], v14, s[44:47], s66 offen offset:1024 sc1
v_mfma_f32_16x16x32_bf16 v[108:111], a[204:207], a[164:167], v[108:111]
ds_read_b64_tr_b16 a[198:199], v11 offset:17696
v_mfma_f32_16x16x32_bf16 v[76:79], a[204:207], a[160:163], v[76:79]
s_waitcnt lgkmcnt(8)
v_mfma_f32_16x16x32_bf16 v[80:83], a[208:211], a[160:163], v[80:83]
ds_read_b64_tr_b16 a[200:201], v11 offset:17472
v_mfma_f32_16x16x32_bf16 v[112:115], a[208:211], a[164:167], v[112:115]
buffer_load_dwordx4 a[148:151], v14, s[44:47], s66 offen offset:3072 sc1
v_mfma_f32_16x16x32_bf16 v[144:147], a[208:211], a[168:171], v[144:147]
ds_read_b64_tr_b16 a[202:203], v11 offset:17728
v_mfma_f32_16x16x32_bf16 v[176:179], a[208:211], a[172:175], v[176:179]
v_mfma_f32_16x16x32_bf16 v[180:183], a[212:215], a[172:175], v[180:183]
ds_read_b64_tr_b16 a[204:205], v11 offset:17504
v_mfma_f32_16x16x32_bf16 v[148:151], a[212:215], a[168:171], v[148:151]
v_mfma_f32_16x16x32_bf16 v[116:119], a[212:215], a[164:167], v[116:119]
ds_read_b64_tr_b16 a[206:207], v11 offset:17760
v_mfma_f32_16x16x32_bf16 v[84:87], a[212:215], a[160:163], v[84:87]
buffer_load_dwordx4 a[152:155], v15, s[44:47], s66 offen offset:1024 sc1
s_waitcnt lgkmcnt(8)
v_mfma_f32_16x16x32_bf16 v[88:91], a[216:219], a[160:163], v[88:91]
ds_read_b64_tr_b16 a[208:209], v11 offset:17536
v_mfma_f32_16x16x32_bf16 v[120:123], a[216:219], a[164:167], v[120:123]
v_mfma_f32_16x16x32_bf16 v[152:155], a[216:219], a[168:171], v[152:155]
ds_read_b64_tr_b16 a[210:211], v11 offset:17792
v_mfma_f32_16x16x32_bf16 v[184:187], a[216:219], a[172:175], v[184:187]
v_mfma_f32_16x16x32_bf16 v[188:191], a[220:223], a[172:175], v[188:191]
ds_read_b64_tr_b16 a[212:213], v11 offset:17568
v_mfma_f32_16x16x32_bf16 v[156:159], a[220:223], a[168:171], v[156:159]
buffer_load_dwordx4 a[156:159], v15, s[44:47], s66 offen offset:3072 sc1
v_mfma_f32_16x16x32_bf16 v[124:127], a[220:223], a[164:167], v[124:127]
ds_read_b64_tr_b16 a[214:215], v11 offset:17824
v_mfma_f32_16x16x32_bf16 v[92:95], a[220:223], a[160:163], v[92:95]
s_waitcnt vmcnt(12)
s_waitcnt lgkmcnt(8)
v_mfma_f32_16x16x32_bf16 v[64:67], a[192:195], a[176:179], v[64:67]
ds_read_b64_tr_b16 a[216:217], v11 offset:17600
v_mfma_f32_16x16x32_bf16 v[96:99], a[192:195], a[180:183], v[96:99]
s_add_u32 s64, s64, 8192
s_add_u32 m0, s65, 52800
v_mfma_f32_16x16x32_bf16 v[128:131], a[192:195], a[184:187], v[128:131]
ds_read_b64_tr_b16 a[218:219], v11 offset:17856
v_mfma_f32_16x16x32_bf16 v[160:163], a[192:195], a[188:191], v[160:163]
buffer_load_dwordx4 v4, s[40:43], s64 offen lds
v_mfma_f32_16x16x32_bf16 v[164:167], a[196:199], a[188:191], v[164:167]
ds_read_b64_tr_b16 a[220:221], v11 offset:17632
v_mfma_f32_16x16x32_bf16 v[132:135], a[196:199], a[184:187], v[132:135]
v_mfma_f32_16x16x32_bf16 v[100:103], a[196:199], a[180:183], v[100:103]
ds_read_b64_tr_b16 a[222:223], v11 offset:17888
v_mfma_f32_16x16x32_bf16 v[68:71], a[196:199], a[176:179], v[68:71]
s_add_u32 s64, s64, 8192
s_add_u32 m0, s65, 53856
s_waitcnt lgkmcnt(8)
s_waitcnt vmcnt(11)
s_barrier
v_mfma_f32_16x16x32_bf16 v[72:75], a[200:203], a[176:179], v[72:75]
ds_read_b64_tr_b16 a[192:193], v11 offset:33792
v_mfma_f32_16x16x32_bf16 v[104:107], a[200:203], a[180:183], v[104:107]
buffer_load_dwordx4 v4, s[40:43], s64 offen lds
v_mfma_f32_16x16x32_bf16 v[136:139], a[200:203], a[184:187], v[136:139]
ds_read_b64_tr_b16 a[194:195], v11 offset:34048
v_mfma_f32_16x16x32_bf16 v[168:171], a[200:203], a[188:191], v[168:171]
v_mfma_f32_16x16x32_bf16 v[172:175], a[204:207], a[188:191], v[172:175]
ds_read_b64_tr_b16 a[196:197], v11 offset:33824
v_mfma_f32_16x16x32_bf16 v[140:143], a[204:207], a[184:187], v[140:143]
s_add_u32 s66, s66, 262144
v_mfma_f32_16x16x32_bf16 v[108:111], a[204:207], a[180:183], v[108:111]
ds_read_b64_tr_b16 a[198:199], v11 offset:34080
v_mfma_f32_16x16x32_bf16 v[76:79], a[204:207], a[176:179], v[76:79]
buffer_load_dwordx4 a[160:163], v14, s[44:47], s66 offen offset:0 sc1
s_waitcnt lgkmcnt(8)
v_mfma_f32_16x16x32_bf16 v[80:83], a[208:211], a[176:179], v[80:83]
ds_read_b64_tr_b16 a[200:201], v11 offset:33856
v_mfma_f32_16x16x32_bf16 v[112:115], a[208:211], a[180:183], v[112:115]
buffer_load_dwordx4 a[164:167], v14, s[44:47], s66 offen offset:2048 sc1
v_mfma_f32_16x16x32_bf16 v[144:147], a[208:211], a[184:187], v[144:147]
ds_read_b64_tr_b16 a[202:203], v11 offset:34112
v_mfma_f32_16x16x32_bf16 v[176:179], a[208:211], a[188:191], v[176:179]
v_mfma_f32_16x16x32_bf16 v[180:183], a[212:215], a[188:191], v[180:183]
ds_read_b64_tr_b16 a[204:205], v11 offset:33888
v_mfma_f32_16x16x32_bf16 v[148:151], a[212:215], a[184:187], v[148:151]
v_mfma_f32_16x16x32_bf16 v[116:119], a[212:215], a[180:183], v[116:119]
ds_read_b64_tr_b16 a[206:207], v11 offset:34144
v_mfma_f32_16x16x32_bf16 v[84:87], a[212:215], a[176:179], v[84:87]
buffer_load_dwordx4 a[168:171], v15, s[44:47], s66 offen offset:0 sc1
s_waitcnt lgkmcnt(8)
v_mfma_f32_16x16x32_bf16 v[88:91], a[216:219], a[176:179], v[88:91]
ds_read_b64_tr_b16 a[208:209], v11 offset:33920
v_mfma_f32_16x16x32_bf16 v[120:123], a[216:219], a[180:183], v[120:123]
v_mfma_f32_16x16x32_bf16 v[152:155], a[216:219], a[184:187], v[152:155]
ds_read_b64_tr_b16 a[210:211], v11 offset:34176
v_mfma_f32_16x16x32_bf16 v[184:187], a[216:219], a[188:191], v[184:187]
v_mfma_f32_16x16x32_bf16 v[188:191], a[220:223], a[188:191], v[188:191]
ds_read_b64_tr_b16 a[212:213], v11 offset:33952
v_mfma_f32_16x16x32_bf16 v[156:159], a[220:223], a[184:187], v[156:159]
buffer_load_dwordx4 a[172:175], v15, s[44:47], s66 offen offset:2048 sc1
v_mfma_f32_16x16x32_bf16 v[124:127], a[220:223], a[180:183], v[124:127]
ds_read_b64_tr_b16 a[214:215], v11 offset:34208
v_mfma_f32_16x16x32_bf16 v[92:95], a[220:223], a[176:179], v[92:95]
s_waitcnt vmcnt(12)
s_waitcnt lgkmcnt(8)
v_mfma_f32_16x16x32_bf16 v[64:67], a[192:195], a[128:131], v[64:67]
ds_read_b64_tr_b16 a[216:217], v11 offset:33984
v_mfma_f32_16x16x32_bf16 v[96:99], a[192:195], a[132:135], v[96:99]
s_add_u32 s64, s64, 499712
s_add_u32 m0, s65, 0
v_mfma_f32_16x16x32_bf16 v[128:131], a[192:195], a[136:139], v[128:131]
ds_read_b64_tr_b16 a[218:219], v11 offset:34240
v_mfma_f32_16x16x32_bf16 v[160:163], a[192:195], a[140:143], v[160:163]
buffer_load_dwordx4 v4, s[40:43], s64 offen lds
v_mfma_f32_16x16x32_bf16 v[164:167], a[196:199], a[140:143], v[164:167]
ds_read_b64_tr_b16 a[220:221], v11 offset:34016
v_mfma_f32_16x16x32_bf16 v[132:135], a[196:199], a[136:139], v[132:135]
v_mfma_f32_16x16x32_bf16 v[100:103], a[196:199], a[132:135], v[100:103]
ds_read_b64_tr_b16 a[222:223], v11 offset:34272
v_mfma_f32_16x16x32_bf16 v[68:71], a[196:199], a[128:131], v[68:71]
s_add_u32 s64, s64, 8192
s_add_u32 m0, s65, 1056
s_waitcnt lgkmcnt(8)
v_mfma_f32_16x16x32_bf16 v[72:75], a[200:203], a[128:131], v[72:75]
ds_read_b64_tr_b16 a[192:193], v11 offset:34304
v_mfma_f32_16x16x32_bf16 v[104:107], a[200:203], a[132:135], v[104:107]
buffer_load_dwordx4 v4, s[40:43], s64 offen lds
v_mfma_f32_16x16x32_bf16 v[136:139], a[200:203], a[136:139], v[136:139]
ds_read_b64_tr_b16 a[194:195], v11 offset:34560
v_mfma_f32_16x16x32_bf16 v[168:171], a[200:203], a[140:143], v[168:171]
v_mfma_f32_16x16x32_bf16 v[172:175], a[204:207], a[140:143], v[172:175]
ds_read_b64_tr_b16 a[196:197], v11 offset:34336
v_mfma_f32_16x16x32_bf16 v[140:143], a[204:207], a[136:139], v[140:143]
buffer_load_dwordx4 a[176:179], v14, s[44:47], s66 offen offset:1024 sc1
v_mfma_f32_16x16x32_bf16 v[108:111], a[204:207], a[132:135], v[108:111]
ds_read_b64_tr_b16 a[198:199], v11 offset:34592
v_mfma_f32_16x16x32_bf16 v[76:79], a[204:207], a[128:131], v[76:79]
s_waitcnt lgkmcnt(8)
v_mfma_f32_16x16x32_bf16 v[80:83], a[208:211], a[128:131], v[80:83]
ds_read_b64_tr_b16 a[200:201], v11 offset:34368
v_mfma_f32_16x16x32_bf16 v[112:115], a[208:211], a[132:135], v[112:115]
buffer_load_dwordx4 a[180:183], v14, s[44:47], s66 offen offset:3072 sc1
v_mfma_f32_16x16x32_bf16 v[144:147], a[208:211], a[136:139], v[144:147]
ds_read_b64_tr_b16 a[202:203], v11 offset:34624
v_mfma_f32_16x16x32_bf16 v[176:179], a[208:211], a[140:143], v[176:179]
v_mfma_f32_16x16x32_bf16 v[180:183], a[212:215], a[140:143], v[180:183]
ds_read_b64_tr_b16 a[204:205], v11 offset:34400
v_mfma_f32_16x16x32_bf16 v[148:151], a[212:215], a[136:139], v[148:151]
v_mfma_f32_16x16x32_bf16 v[116:119], a[212:215], a[132:135], v[116:119]
ds_read_b64_tr_b16 a[206:207], v11 offset:34656
v_mfma_f32_16x16x32_bf16 v[84:87], a[212:215], a[128:131], v[84:87]
buffer_load_dwordx4 a[184:187], v15, s[44:47], s66 offen offset:1024 sc1
s_waitcnt lgkmcnt(8)
v_mfma_f32_16x16x32_bf16 v[88:91], a[216:219], a[128:131], v[88:91]
ds_read_b64_tr_b16 a[208:209], v11 offset:34432
v_mfma_f32_16x16x32_bf16 v[120:123], a[216:219], a[132:135], v[120:123]
v_mfma_f32_16x16x32_bf16 v[152:155], a[216:219], a[136:139], v[152:155]
ds_read_b64_tr_b16 a[210:211], v11 offset:34688
v_mfma_f32_16x16x32_bf16 v[184:187], a[216:219], a[140:143], v[184:187]
v_mfma_f32_16x16x32_bf16 v[188:191], a[220:223], a[140:143], v[188:191]
ds_read_b64_tr_b16 a[212:213], v11 offset:34464
v_mfma_f32_16x16x32_bf16 v[156:159], a[220:223], a[136:139], v[156:159]
buffer_load_dwordx4 a[188:191], v15, s[44:47], s66 offen offset:3072 sc1
v_mfma_f32_16x16x32_bf16 v[124:127], a[220:223], a[132:135], v[124:127]
ds_read_b64_tr_b16 a[214:215], v11 offset:34720
v_mfma_f32_16x16x32_bf16 v[92:95], a[220:223], a[128:131], v[92:95]
s_waitcnt vmcnt(12)
s_waitcnt lgkmcnt(8)
v_mfma_f32_16x16x32_bf16 v[64:67], a[192:195], a[144:147], v[64:67]
ds_read_b64_tr_b16 a[216:217], v11 offset:34496
v_mfma_f32_16x16x32_bf16 v[96:99], a[192:195], a[148:151], v[96:99]
s_add_u32 s64, s64, 8192
s_add_u32 m0, s65, 2112
v_mfma_f32_16x16x32_bf16 v[128:131], a[192:195], a[152:155], v[128:131]
ds_read_b64_tr_b16 a[218:219], v11 offset:34752
v_mfma_f32_16x16x32_bf16 v[160:163], a[192:195], a[156:159], v[160:163]
buffer_load_dwordx4 v4, s[40:43], s64 offen lds
v_mfma_f32_16x16x32_bf16 v[164:167], a[196:199], a[156:159], v[164:167]
ds_read_b64_tr_b16 a[220:221], v11 offset:34528
v_mfma_f32_16x16x32_bf16 v[132:135], a[196:199], a[152:155], v[132:135]
v_mfma_f32_16x16x32_bf16 v[100:103], a[196:199], a[148:151], v[100:103]
ds_read_b64_tr_b16 a[222:223], v11 offset:34784
v_mfma_f32_16x16x32_bf16 v[68:71], a[196:199], a[144:147], v[68:71]
s_add_u32 s64, s64, 8192
s_add_u32 m0, s65, 3168
s_waitcnt lgkmcnt(8)
s_waitcnt vmcnt(11)
s_barrier
v_mfma_f32_16x16x32_bf16 v[72:75], a[200:203], a[144:147], v[72:75]
ds_read_b64_tr_b16 a[192:193], v11 offset:50688
v_mfma_f32_16x16x32_bf16 v[104:107], a[200:203], a[148:151], v[104:107]
buffer_load_dwordx4 v4, s[40:43], s64 offen lds
v_mfma_f32_16x16x32_bf16 v[136:139], a[200:203], a[152:155], v[136:139]
ds_read_b64_tr_b16 a[194:195], v11 offset:50944
v_mfma_f32_16x16x32_bf16 v[168:171], a[200:203], a[156:159], v[168:171]
v_mfma_f32_16x16x32_bf16 v[172:175], a[204:207], a[156:159], v[172:175]
ds_read_b64_tr_b16 a[196:197], v11 offset:50720
v_mfma_f32_16x16x32_bf16 v[140:143], a[204:207], a[152:155], v[140:143]
s_add_u32 s66, s66, 262144
v_mfma_f32_16x16x32_bf16 v[108:111], a[204:207], a[148:151], v[108:111]
ds_read_b64_tr_b16 a[198:199], v11 offset:50976
v_mfma_f32_16x16x32_bf16 v[76:79], a[204:207], a[144:147], v[76:79]
buffer_load_dwordx4 a[128:131], v14, s[44:47], s66 offen offset:0 sc1
s_waitcnt lgkmcnt(8)
v_mfma_f32_16x16x32_bf16 v[80:83], a[208:211], a[144:147], v[80:83]
ds_read_b64_tr_b16 a[200:201], v11 offset:50752
v_mfma_f32_16x16x32_bf16 v[112:115], a[208:211], a[148:151], v[112:115]
buffer_load_dwordx4 a[132:135], v14, s[44:47], s66 offen offset:2048 sc1
v_mfma_f32_16x16x32_bf16 v[144:147], a[208:211], a[152:155], v[144:147]
ds_read_b64_tr_b16 a[202:203], v11 offset:51008
v_mfma_f32_16x16x32_bf16 v[176:179], a[208:211], a[156:159], v[176:179]
v_mfma_f32_16x16x32_bf16 v[180:183], a[212:215], a[156:159], v[180:183]
ds_read_b64_tr_b16 a[204:205], v11 offset:50784
v_mfma_f32_16x16x32_bf16 v[148:151], a[212:215], a[152:155], v[148:151]
v_mfma_f32_16x16x32_bf16 v[116:119], a[212:215], a[148:151], v[116:119]
ds_read_b64_tr_b16 a[206:207], v11 offset:51040
v_mfma_f32_16x16x32_bf16 v[84:87], a[212:215], a[144:147], v[84:87]
buffer_load_dwordx4 a[136:139], v15, s[44:47], s66 offen offset:0 sc1
s_waitcnt lgkmcnt(8)
v_mfma_f32_16x16x32_bf16 v[88:91], a[216:219], a[144:147], v[88:91]
ds_read_b64_tr_b16 a[208:209], v11 offset:50816
v_mfma_f32_16x16x32_bf16 v[120:123], a[216:219], a[148:151], v[120:123]
v_mfma_f32_16x16x32_bf16 v[152:155], a[216:219], a[152:155], v[152:155]
ds_read_b64_tr_b16 a[210:211], v11 offset:51072
v_mfma_f32_16x16x32_bf16 v[184:187], a[216:219], a[156:159], v[184:187]
v_mfma_f32_16x16x32_bf16 v[188:191], a[220:223], a[156:159], v[188:191]
ds_read_b64_tr_b16 a[212:213], v11 offset:50848
v_mfma_f32_16x16x32_bf16 v[156:159], a[220:223], a[152:155], v[156:159]
buffer_load_dwordx4 a[140:143], v15, s[44:47], s66 offen offset:2048 sc1
v_mfma_f32_16x16x32_bf16 v[124:127], a[220:223], a[148:151], v[124:127]
ds_read_b64_tr_b16 a[214:215], v11 offset:51104
v_mfma_f32_16x16x32_bf16 v[92:95], a[220:223], a[144:147], v[92:95]
s_waitcnt vmcnt(12)
s_waitcnt lgkmcnt(8)
v_mfma_f32_16x16x32_bf16 v[64:67], a[192:195], a[160:163], v[64:67]
ds_read_b64_tr_b16 a[216:217], v11 offset:50880
v_mfma_f32_16x16x32_bf16 v[96:99], a[192:195], a[164:167], v[96:99]
s_add_u32 s64, s64, 499712
s_add_u32 m0, s65, 16896
v_mfma_f32_16x16x32_bf16 v[128:131], a[192:195], a[168:171], v[128:131]
ds_read_b64_tr_b16 a[218:219], v11 offset:51136
v_mfma_f32_16x16x32_bf16 v[160:163], a[192:195], a[172:175], v[160:163]
buffer_load_dwordx4 v4, s[40:43], s64 offen lds
v_mfma_f32_16x16x32_bf16 v[164:167], a[196:199], a[172:175], v[164:167]
ds_read_b64_tr_b16 a[220:221], v11 offset:50912
v_mfma_f32_16x16x32_bf16 v[132:135], a[196:199], a[168:171], v[132:135]
v_mfma_f32_16x16x32_bf16 v[100:103], a[196:199], a[164:167], v[100:103]
ds_read_b64_tr_b16 a[222:223], v11 offset:51168
v_mfma_f32_16x16x32_bf16 v[68:71], a[196:199], a[160:163], v[68:71]
s_add_u32 s64, s64, 8192
s_add_u32 m0, s65, 17952
s_waitcnt lgkmcnt(8)
v_mfma_f32_16x16x32_bf16 v[72:75], a[200:203], a[160:163], v[72:75]
ds_read_b64_tr_b16 a[192:193], v11 offset:51200
v_mfma_f32_16x16x32_bf16 v[104:107], a[200:203], a[164:167], v[104:107]
buffer_load_dwordx4 v4, s[40:43], s64 offen lds
v_mfma_f32_16x16x32_bf16 v[136:139], a[200:203], a[168:171], v[136:139]
ds_read_b64_tr_b16 a[194:195], v11 offset:51456
v_mfma_f32_16x16x32_bf16 v[168:171], a[200:203], a[172:175], v[168:171]
v_mfma_f32_16x16x32_bf16 v[172:175], a[204:207], a[172:175], v[172:175]
ds_read_b64_tr_b16 a[196:197], v11 offset:51232
v_mfma_f32_16x16x32_bf16 v[140:143], a[204:207], a[168:171], v[140:143]
buffer_load_dwordx4 a[144:147], v14, s[44:47], s66 offen offset:1024 sc1
v_mfma_f32_16x16x32_bf16 v[108:111], a[204:207], a[164:167], v[108:111]
ds_read_b64_tr_b16 a[198:199], v11 offset:51488
v_mfma_f32_16x16x32_bf16 v[76:79], a[204:207], a[160:163], v[76:79]
s_waitcnt lgkmcnt(8)
v_mfma_f32_16x16x32_bf16 v[80:83], a[208:211], a[160:163], v[80:83]
ds_read_b64_tr_b16 a[200:201], v11 offset:51264
v_mfma_f32_16x16x32_bf16 v[112:115], a[208:211], a[164:167], v[112:115]
buffer_load_dwordx4 a[148:151], v14, s[44:47], s66 offen offset:3072 sc1
v_mfma_f32_16x16x32_bf16 v[144:147], a[208:211], a[168:171], v[144:147]
ds_read_b64_tr_b16 a[202:203], v11 offset:51520
v_mfma_f32_16x16x32_bf16 v[176:179], a[208:211], a[172:175], v[176:179]
v_mfma_f32_16x16x32_bf16 v[180:183], a[212:215], a[172:175], v[180:183]
ds_read_b64_tr_b16 a[204:205], v11 offset:51296
v_mfma_f32_16x16x32_bf16 v[148:151], a[212:215], a[168:171], v[148:151]
v_mfma_f32_16x16x32_bf16 v[116:119], a[212:215], a[164:167], v[116:119]
ds_read_b64_tr_b16 a[206:207], v11 offset:51552
v_mfma_f32_16x16x32_bf16 v[84:87], a[212:215], a[160:163], v[84:87]
buffer_load_dwordx4 a[152:155], v15, s[44:47], s66 offen offset:1024 sc1
s_waitcnt lgkmcnt(8)
v_mfma_f32_16x16x32_bf16 v[88:91], a[216:219], a[160:163], v[88:91]
ds_read_b64_tr_b16 a[208:209], v11 offset:51328
v_mfma_f32_16x16x32_bf16 v[120:123], a[216:219], a[164:167], v[120:123]
v_mfma_f32_16x16x32_bf16 v[152:155], a[216:219], a[168:171], v[152:155]
ds_read_b64_tr_b16 a[210:211], v11 offset:51584
v_mfma_f32_16x16x32_bf16 v[184:187], a[216:219], a[172:175], v[184:187]
v_mfma_f32_16x16x32_bf16 v[188:191], a[220:223], a[172:175], v[188:191]
ds_read_b64_tr_b16 a[212:213], v11 offset:51360
v_mfma_f32_16x16x32_bf16 v[156:159], a[220:223], a[168:171], v[156:159]
buffer_load_dwordx4 a[156:159], v15, s[44:47], s66 offen offset:3072 sc1
v_mfma_f32_16x16x32_bf16 v[124:127], a[220:223], a[164:167], v[124:127]
ds_read_b64_tr_b16 a[214:215], v11 offset:51616
v_mfma_f32_16x16x32_bf16 v[92:95], a[220:223], a[160:163], v[92:95]
s_waitcnt vmcnt(12)
s_waitcnt lgkmcnt(8)
v_mfma_f32_16x16x32_bf16 v[64:67], a[192:195], a[176:179], v[64:67]
ds_read_b64_tr_b16 a[216:217], v11 offset:51392
v_mfma_f32_16x16x32_bf16 v[96:99], a[192:195], a[180:183], v[96:99]
s_add_u32 s64, s64, 8192
s_add_u32 m0, s65, 19008
v_mfma_f32_16x16x32_bf16 v[128:131], a[192:195], a[184:187], v[128:131]
ds_read_b64_tr_b16 a[218:219], v11 offset:51648
v_mfma_f32_16x16x32_bf16 v[160:163], a[192:195], a[188:191], v[160:163]
buffer_load_dwordx4 v4, s[40:43], s64 offen lds
v_mfma_f32_16x16x32_bf16 v[164:167], a[196:199], a[188:191], v[164:167]
ds_read_b64_tr_b16 a[220:221], v11 offset:51424
v_mfma_f32_16x16x32_bf16 v[132:135], a[196:199], a[184:187], v[132:135]
v_mfma_f32_16x16x32_bf16 v[100:103], a[196:199], a[180:183], v[100:103]
ds_read_b64_tr_b16 a[222:223], v11 offset:51680
v_mfma_f32_16x16x32_bf16 v[68:71], a[196:199], a[176:179], v[68:71]
s_add_u32 s64, s64, 8192
s_add_u32 m0, s65, 20064
s_waitcnt lgkmcnt(8)
s_waitcnt vmcnt(11)
s_barrier
v_mfma_f32_16x16x32_bf16 v[72:75], a[200:203], a[176:179], v[72:75]
ds_read_b64_tr_b16 a[192:193], v11 offset:0
v_mfma_f32_16x16x32_bf16 v[104:107], a[200:203], a[180:183], v[104:107]
buffer_load_dwordx4 v4, s[40:43], s64 offen lds
v_mfma_f32_16x16x32_bf16 v[136:139], a[200:203], a[184:187], v[136:139]
ds_read_b64_tr_b16 a[194:195], v11 offset:256
v_mfma_f32_16x16x32_bf16 v[168:171], a[200:203], a[188:191], v[168:171]
v_mfma_f32_16x16x32_bf16 v[172:175], a[204:207], a[188:191], v[172:175]
ds_read_b64_tr_b16 a[196:197], v11 offset:32
v_mfma_f32_16x16x32_bf16 v[140:143], a[204:207], a[184:187], v[140:143]
s_add_u32 s66, s66, 262144
v_mfma_f32_16x16x32_bf16 v[108:111], a[204:207], a[180:183], v[108:111]
ds_read_b64_tr_b16 a[198:199], v11 offset:288
v_mfma_f32_16x16x32_bf16 v[76:79], a[204:207], a[176:179], v[76:79]
buffer_load_dwordx4 a[160:163], v14, s[44:47], s66 offen offset:0 sc1
s_waitcnt lgkmcnt(8)
v_mfma_f32_16x16x32_bf16 v[80:83], a[208:211], a[176:179], v[80:83]
ds_read_b64_tr_b16 a[200:201], v11 offset:64
v_mfma_f32_16x16x32_bf16 v[112:115], a[208:211], a[180:183], v[112:115]
buffer_load_dwordx4 a[164:167], v14, s[44:47], s66 offen offset:2048 sc1
v_mfma_f32_16x16x32_bf16 v[144:147], a[208:211], a[184:187], v[144:147]
ds_read_b64_tr_b16 a[202:203], v11 offset:320
v_mfma_f32_16x16x32_bf16 v[176:179], a[208:211], a[188:191], v[176:179]
v_mfma_f32_16x16x32_bf16 v[180:183], a[212:215], a[188:191], v[180:183]
ds_read_b64_tr_b16 a[204:205], v11 offset:96
v_mfma_f32_16x16x32_bf16 v[148:151], a[212:215], a[184:187], v[148:151]
v_mfma_f32_16x16x32_bf16 v[116:119], a[212:215], a[180:183], v[116:119]
ds_read_b64_tr_b16 a[206:207], v11 offset:352
v_mfma_f32_16x16x32_bf16 v[84:87], a[212:215], a[176:179], v[84:87]
buffer_load_dwordx4 a[168:171], v15, s[44:47], s66 offen offset:0 sc1
s_waitcnt lgkmcnt(8)
v_mfma_f32_16x16x32_bf16 v[88:91], a[216:219], a[176:179], v[88:91]
ds_read_b64_tr_b16 a[208:209], v11 offset:128
v_mfma_f32_16x16x32_bf16 v[120:123], a[216:219], a[180:183], v[120:123]
v_mfma_f32_16x16x32_bf16 v[152:155], a[216:219], a[184:187], v[152:155]
ds_read_b64_tr_b16 a[210:211], v11 offset:384
v_mfma_f32_16x16x32_bf16 v[184:187], a[216:219], a[188:191], v[184:187]
v_mfma_f32_16x16x32_bf16 v[188:191], a[220:223], a[188:191], v[188:191]
ds_read_b64_tr_b16 a[212:213], v11 offset:160
v_mfma_f32_16x16x32_bf16 v[156:159], a[220:223], a[184:187], v[156:159]
buffer_load_dwordx4 a[172:175], v15, s[44:47], s66 offen offset:2048 sc1
v_mfma_f32_16x16x32_bf16 v[124:127], a[220:223], a[180:183], v[124:127]
ds_read_b64_tr_b16 a[214:215], v11 offset:416
v_mfma_f32_16x16x32_bf16 v[92:95], a[220:223], a[176:179], v[92:95]
s_sub_u32 s29, s29, 1
s_cmp_lg_u32 s29, 0
s_cbranch_scc1 L_loop_q
s_waitcnt vmcnt(12)
s_waitcnt lgkmcnt(8)
v_mfma_f32_16x16x32_bf16 v[64:67], a[192:195], a[128:131], v[64:67]
ds_read_b64_tr_b16 a[216:217], v11 offset:192
v_accvgpr_write_b32 a0, 0
v_mfma_f32_16x16x32_bf16 v[96:99], a[192:195], a[132:135], v[96:99]
s_add_u32 s64, s64, 499712
s_add_u32 m0, s65, 33792
v_mfma_f32_16x16x32_bf16 v[128:131], a[192:195], a[136:139], v[128:131]
ds_read_b64_tr_b16 a[218:219], v11 offset:448
v_accvgpr_write_b32 a1, 0
v_mfma_f32_16x16x32_bf16 v[160:163], a[192:195], a[140:143], v[160:163]
buffer_load_dwordx4 v4, s[40:43], s64 offen lds
v_mfma_f32_16x16x32_bf16 v[164:167], a[196:199], a[140:143], v[164:167]
ds_read_b64_tr_b16 a[220:221], v11 offset:224
v_mfma_f32_16x16x32_bf16 v[132:135], a[196:199], a[136:139], v[132:135]
v_accvgpr_write_b32 a2, 0
s_add_u32 m0, s69, 0
v_mfma_f32_16x16x32_bf16 v[100:103], a[196:199], a[132:135], v[100:103]
ds_read_b64_tr_b16 a[222:223], v11 offset:480
buffer_load_dwordx4 v5, s[48:51], s67 offen offset:0 lds
v_mfma_f32_16x16x32_bf16 v[68:71], a[196:199], a[128:131], v[68:71]
s_add_u32 s64, s64, 8192
s_add_u32 m0, s65, 34848
v_accvgpr_write_b32 a3, 0
s_waitcnt lgkmcnt(8)
v_mfma_f32_16x16x32_bf16 v[72:75], a[200:203], a[128:131], v[72:75]
ds_read_b64_tr_b16 a[192:193], v11 offset:512
v_accvgpr_write_b32 a4, 0
v_mfma_f32_16x16x32_bf16 v[104:107], a[200:203], a[132:135], v[104:107]
buffer_load_dwordx4 v4, s[40:43], s64 offen lds
v_mfma_f32_16x16x32_bf16 v[136:139], a[200:203], a[136:139], v[136:139]
ds_read_b64_tr_b16 a[194:195], v11 offset:768
v_mfma_f32_16x16x32_bf16 v[168:171], a[200:203], a[140:143], v[168:171]
v_accvgpr_write_b32 a5, 0
s_add_u32 m0, s69, 0
v_mfma_f32_16x16x32_bf16 v[172:175], a[204:207], a[140:143], v[172:175]
ds_read_b64_tr_b16 a[196:197], v11 offset:544
v_accvgpr_write_b32 a6, 0
v_mfma_f32_16x16x32_bf16 v[140:143], a[204:207], a[136:139], v[140:143]
buffer_load_dwordx4 a[176:179], v14, s[44:47], s66 offen offset:1024 sc1
buffer_load_dwordx4 v6, s[48:51], s67 offen offset:1040 lds
v_mfma_f32_16x16x32_bf16 v[108:111], a[204:207], a[132:135], v[108:111]
ds_read_b64_tr_b16 a[198:199], v11 offset:800
v_mfma_f32_16x16x32_bf16 v[76:79], a[204:207], a[128:131], v[76:79]
v_accvgpr_write_b32 a7, 0
s_waitcnt lgkmcnt(8)
v_mfma_f32_16x16x32_bf16 v[80:83], a[208:211], a[128:131], v[80:83]
ds_read_b64_tr_b16 a[200:201], v11 offset:576
v_accvgpr_write_b32 a8, 0
v_mfma_f32_16x16x32_bf16 v[112:115], a[208:211], a[132:135], v[112:115]
buffer_load_dwordx4 a[180:183], v14, s[44:47], s66 offen offset:3072 sc1
v_mfma_f32_16x16x32_bf16 v[144:147], a[208:211], a[136:139], v[144:147]
ds_read_b64_tr_b16 a[202:203], v11 offset:832
v_mfma_f32_16x16x32_bf16 v[176:179], a[208:211], a[140:143], v[176:179]
v_accvgpr_write_b32 a9, 0
v_mfma_f32_16x16x32_bf16 v[180:183], a[212:215], a[140:143], v[180:183]
ds_read_b64_tr_b16 a[204:205], v11 offset:608
v_mfma_f32_16x16x32_bf16 v[148:151], a[212:215], a[136:139], v[148:151]
s_add_u32 m0, s69, 0
s_nop 0
buffer_load_dwordx4 v7, s[48:51], s67 offen offset:2080 lds
v_mfma_f32_16x16x32_bf16 v[116:119], a[212:215], a[132:135], v[116:119]
ds_read_b64_tr_b16 a[206:207], v11 offset:864
v_accvgpr_write_b32 a10, 0
v_mfma_f32_16x16x32_bf16 v[84:87], a[212:215], a[128:131], v[84:87]
buffer_load_dwordx4 a[184:187], v15, s[44:47], s66 offen offset:1024 sc1
v_accvgpr_write_b32 a11, 0
s_waitcnt lgkmcnt(8)
v_mfma_f32_16x16x32_bf16 v[88:91], a[216:219], a[128:131], v[88:91]
ds_read_b64_tr_b16 a[208:209], v11 offset:640
v_mfma_f32_16x16x32_bf16 v[120:123], a[216:219], a[132:135], v[120:123]
v_accvgpr_write_b32 a12, 0
v_mfma_f32_16x16x32_bf16 v[152:155], a[216:219], a[136:139], v[152:155]
ds_read_b64_tr_b16 a[210:211], v11 offset:896
v_mfma_f32_16x16x32_bf16 v[184:187], a[216:219], a[140:143], v[184:187]
s_add_u32 m0, s69, 0
v_accvgpr_write_b32 a13, 0
v_mfma_f32_16x16x32_bf16 v[188:191], a[220:223], a[140:143], v[188:191]
ds_read_b64_tr_b16 a[212:213], v11 offset:672
buffer_load_dwordx4 v8, s[48:51], s67 offen offset:3120 lds
v_mfma_f32_16x16x32_bf16 v[156:159], a[220:223], a[136:139], v[156:159]
buffer_load_dwordx4 a[188:191], v15, s[44:47], s66 offen offset:3072 sc1
v_accvgpr_write_b32 a14, 0
v_mfma_f32_16x16x32_bf16 v[124:127], a[220:223], a[132:135], v[124:127]
ds_read_b64_tr_b16 a[214:215], v11 offset:928
v_mfma_f32_16x16x32_bf16 v[92:95], a[220:223], a[128:131], v[92:95]
v_accvgpr_write_b32 a15, 0
s_waitcnt vmcnt(16)
s_waitcnt lgkmcnt(8)
v_mfma_f32_16x16x32_bf16 v[64:67], a[192:195], a[144:147], v[64:67]
ds_read_b64_tr_b16 a[216:217], v11 offset:704
v_accvgpr_write_b32 a16, 0
v_mfma_f32_16x16x32_bf16 v[96:99], a[192:195], a[148:151], v[96:99]
s_add_u32 s64, s64, 8192
s_add_u32 m0, s65, 35904
v_mfma_f32_16x16x32_bf16 v[128:131], a[192:195], a[152:155], v[128:131]
ds_read_b64_tr_b16 a[218:219], v11 offset:960
v_accvgpr_write_b32 a17, 0
v_mfma_f32_16x16x32_bf16 v[160:163], a[192:195], a[156:159], v[160:163]
buffer_load_dwordx4 v4, s[40:43], s64 offen lds
v_mfma_f32_16x16x32_bf16 v[164:167], a[196:199], a[156:159], v[164:167]
ds_read_b64_tr_b16 a[220:221], v11 offset:736
v_mfma_f32_16x16x32_bf16 v[132:135], a[196:199], a[152:155], v[132:135]
v_accvgpr_write_b32 a18, 0
v_mfma_f32_16x16x32_bf16 v[100:103], a[196:199], a[148:151], v[100:103]
ds_read_b64_tr_b16 a[222:223], v11 offset:992
v_accvgpr_write_b32 a19, 0
v_mfma_f32_16x16x32_bf16 v[68:71], a[196:199], a[144:147], v[68:71]
s_add_u32 s64, s64, 8192
s_add_u32 m0, s65, 36960
s_waitcnt lgkmcnt(8)
s_waitcnt vmcnt(15)
s_barrier
v_mfma_f32_16x16x32_bf16 v[72:75], a[200:203], a[144:147], v[72:75]
ds_read_b64_tr_b16 a[192:193], v11 offset:16896
v_accvgpr_write_b32 a20, 0
v_mfma_f32_16x16x32_bf16 v[104:107], a[200:203], a[148:151], v[104:107]
buffer_load_dwordx4 v4, s[40:43], s64 offen lds
v_mfma_f32_16x16x32_bf16 v[136:139], a[200:203], a[152:155], v[136:139]
ds_read_b64_tr_b16 a[194:195], v11 offset:17152
v_mfma_f32_16x16x32_bf16 v[168:171], a[200:203], a[156:159], v[168:171]
v_accvgpr_write_b32 a21, 0
v_mfma_f32_16x16x32_bf16 v[172:175], a[204:207], a[156:159], v[172:175]
ds_read_b64_tr_b16 a[196:197], v11 offset:16928
v_accvgpr_write_b32 a22, 0
v_mfma_f32_16x16x32_bf16 v[140:143], a[204:207], a[152:155], v[140:143]
s_add_u32 s66, s66, 262144
v_mfma_f32_16x16x32_bf16 v[108:111], a[204:207], a[148:151], v[108:111]
ds_read_b64_tr_b16 a[198:199], v11 offset:17184
v_accvgpr_write_b32 a23, 0
v_mfma_f32_16x16x32_bf16 v[76:79], a[204:207], a[144:147], v[76:79]
buffer_load_dwordx4 a[128:131], v14, s[44:47], s66 offen offset:0 sc1
s_waitcnt lgkmcnt(8)
v_mfma_f32_16x16x32_bf16 v[80:83], a[208:211], a[144:147], v[80:83]
ds_read_b64_tr_b16 a[200:201], v11 offset:16960
v_accvgpr_write_b32 a24, 0
v_mfma_f32_16x16x32_bf16 v[112:115], a[208:211], a[148:151], v[112:115]
buffer_load_dwordx4 a[132:135], v14, s[44:47], s66 offen offset:2048 sc1
v_mfma_f32_16x16x32_bf16 v[144:147], a[208:211], a[152:155], v[144:147]
ds_read_b64_tr_b16 a[202:203], v11 offset:17216
v_mfma_f32_16x16x32_bf16 v[176:179], a[208:211], a[156:159], v[176:179]
v_accvgpr_write_b32 a25, 0
v_mfma_f32_16x16x32_bf16 v[180:183], a[212:215], a[156:159], v[180:183]
ds_read_b64_tr_b16 a[204:205], v11 offset:16992
v_mfma_f32_16x16x32_bf16 v[148:151], a[212:215], a[152:155], v[148:151]
v_accvgpr_write_b32 a26, 0
v_mfma_f32_16x16x32_bf16 v[116:119], a[212:215], a[148:151], v[116:119]
ds_read_b64_tr_b16 a[206:207], v11 offset:17248
v_accvgpr_write_b32 a27, 0
v_mfma_f32_16x16x32_bf16 v[84:87], a[212:215], a[144:147], v[84:87]
buffer_load_dwordx4 a[136:139], v15, s[44:47], s66 offen offset:0 sc1
s_waitcnt lgkmcnt(8)
v_mfma_f32_16x16x32_bf16 v[88:91], a[216:219], a[144:147], v[88:91]
ds_read_b64_tr_b16 a[208:209], v11 offset:17024
v_mfma_f32_16x16x32_bf16 v[120:123], a[216:219], a[148:151], v[120:123]
v_accvgpr_write_b32 a28, 0
v_mfma_f32_16x16x32_bf16 v[152:155], a[216:219], a[152:155], v[152:155]
ds_read_b64_tr_b16 a[210:211], v11 offset:17280
v_mfma_f32_16x16x32_bf16 v[184:187], a[216:219], a[156:159], v[184:187]
v_accvgpr_write_b32 a29, 0
v_mfma_f32_16x16x32_bf16 v[188:191], a[220:223], a[156:159], v[188:191]
ds_read_b64_tr_b16 a[212:213], v11 offset:17056
v_accvgpr_write_b32 a30, 0
v_mfma_f32_16x16x32_bf16 v[156:159], a[220:223], a[152:155], v[156:159]
buffer_load_dwordx4 a[140:143], v15, s[44:47], s66 offen offset:2048 sc1
v_mfma_f32_16x16x32_bf16 v[124:127], a[220:223], a[148:151], v[124:127]
ds_read_b64_tr_b16 a[214:215], v11 offset:17312
v_mfma_f32_16x16x32_bf16 v[92:95], a[220:223], a[144:147], v[92:95]
v_accvgpr_write_b32 a31, 0
s_waitcnt vmcnt(16)
s_waitcnt lgkmcnt(8)
v_mfma_f32_16x16x32_bf16 v[64:67], a[192:195], a[160:163], v[64:67]
ds_read_b64_tr_b16 a[216:217], v11 offset:17088
v_accvgpr_write_b32 a32, 0
v_mfma_f32_16x16x32_bf16 v[96:99], a[192:195], a[164:167], v[96:99]
s_add_u32 s64, s64, 499712
s_add_u32 m0, s65, 50688
v_mfma_f32_16x16x32_bf16 v[128:131], a[192:195], a[168:171], v[128:131]
ds_read_b64_tr_b16 a[218:219], v11 offset:17344
v_accvgpr_write_b32 a33, 0
v_mfma_f32_16x16x32_bf16 v[160:163], a[192:195], a[172:175], v[160:163]
buffer_load_dwordx4 v4, s[40:43], s64 offen lds
v_mfma_f32_16x16x32_bf16 v[164:167], a[196:199], a[172:175], v[164:167]
ds_read_b64_tr_b16 a[220:221], v11 offset:17120
v_mfma_f32_16x16x32_bf16 v[132:135], a[196:199], a[168:171], v[132:135]
v_accvgpr_write_b32 a34, 0
s_add_u32 s67, s67, 16384
s_add_u32 m0, s69, 16640
v_mfma_f32_16x16x32_bf16 v[100:103], a[196:199], a[164:167], v[100:103]
ds_read_b64_tr_b16 a[222:223], v11 offset:17376
buffer_load_dwordx4 v5, s[48:51], s67 offen offset:0 lds
v_mfma_f32_16x16x32_bf16 v[68:71], a[196:199], a[160:163], v[68:71]
s_add_u32 s64, s64, 8192
s_add_u32 m0, s65, 51744
v_accvgpr_write_b32 a35, 0
s_waitcnt lgkmcnt(8)
v_mfma_f32_16x16x32_bf16 v[72:75], a[200:203], a[160:163], v[72:75]
ds_read_b64_tr_b16 a[192:193], v11 offset:17408
v_accvgpr_write_b32 a36, 0
v_mfma_f32_16x16x32_bf16 v[104:107], a[200:203], a[164:167], v[104:107]
buffer_load_dwordx4 v4, s[40:43], s64 offen lds
v_mfma_f32_16x16x32_bf16 v[136:139], a[200:203], a[168:171], v[136:139]
ds_read_b64_tr_b16 a[194:195], v11 offset:17664
v_mfma_f32_16x16x32_bf16 v[168:171], a[200:203], a[172:175], v[168:171]
v_accvgpr_write_b32 a37, 0
s_add_u32 m0, s69, 16640
v_mfma_f32_16x16x32_bf16 v[172:175], a[204:207], a[172:175], v[172:175]
ds_read_b64_tr_b16 a[196:197], v11 offset:17440
v_accvgpr_write_b32 a38, 0
v_mfma_f32_16x16x32_bf16 v[140:143], a[204:207], a[168:171], v[140:143]
buffer_load_dwordx4 a[144:147], v14, s[44:47], s66 offen offset:1024 sc1
buffer_load_dwordx4 v6, s[48:51], s67 offen offset:1040 lds
v_mfma_f32_16x16x32_bf16 v[108:111], a[204:207], a[164:167], v[108:111]
ds_read_b64_tr_b16 a[198:199], v11 offset:17696
v_mfma_f32_16x16x32_bf16 v[76:79], a[204:207], a[160:163], v[76:79]
v_accvgpr_write_b32 a39, 0
s_waitcnt lgkmcnt(8)
v_mfma_f32_16x16x32_bf16 v[80:83], a[208:211], a[160:163], v[80:83]
ds_read_b64_tr_b16 a[200:201], v11 offset:17472
v_accvgpr_write_b32 a40, 0
v_mfma_f32_16x16x32_bf16 v[112:115], a[208:211], a[164:167], v[112:115]
buffer_load_dwordx4 a[148:151], v14, s[44:47], s66 offen offset:3072 sc1
v_mfma_f32_16x16x32_bf16 v[144:147], a[208:211], a[168:171], v[144:147]
ds_read_b64_tr_b16 a[202:203], v11 offset:17728
v_mfma_f32_16x16x32_bf16 v[176:179], a[208:211], a[172:175], v[176:179]
v_accvgpr_write_b32 a41, 0
v_mfma_f32_16x16x32_bf16 v[180:183], a[212:215], a[172:175], v[180:183]
ds_read_b64_tr_b16 a[204:205], v11 offset:17504
v_mfma_f32_16x16x32_bf16 v[148:151], a[212:215], a[168:171], v[148:151]
s_add_u32 m0, s69, 16640
s_nop 0
buffer_load_dwordx4 v7, s[48:51], s67 offen offset:2080 lds
v_mfma_f32_16x16x32_bf16 v[116:119], a[212:215], a[164:167], v[116:119]
ds_read_b64_tr_b16 a[206:207], v11 offset:17760
v_accvgpr_write_b32 a42, 0
v_mfma_f32_16x16x32_bf16 v[84:87], a[212:215], a[160:163], v[84:87]
buffer_load_dwordx4 a[152:155], v15, s[44:47], s66 offen offset:1024 sc1
v_accvgpr_write_b32 a43, 0
s_waitcnt lgkmcnt(8)
v_mfma_f32_16x16x32_bf16 v[88:91], a[216:219], a[160:163], v[88:91]
ds_read_b64_tr_b16 a[208:209], v11 offset:17536
v_mfma_f32_16x16x32_bf16 v[120:123], a[216:219], a[164:167], v[120:123]
v_accvgpr_write_b32 a44, 0
v_mfma_f32_16x16x32_bf16 v[152:155], a[216:219], a[168:171], v[152:155]
ds_read_b64_tr_b16 a[210:211], v11 offset:17792
v_mfma_f32_16x16x32_bf16 v[184:187], a[216:219], a[172:175], v[184:187]
s_add_u32 m0, s69, 16640
v_accvgpr_write_b32 a45, 0
v_mfma_f32_16x16x32_bf16 v[188:191], a[220:223], a[172:175], v[188:191]
ds_read_b64_tr_b16 a[212:213], v11 offset:17568
buffer_load_dwordx4 v8, s[48:51], s67 offen offset:3120 lds
v_mfma_f32_16x16x32_bf16 v[156:159], a[220:223], a[168:171], v[156:159]
buffer_load_dwordx4 a[156:159], v15, s[44:47], s66 offen offset:3072 sc1
v_accvgpr_write_b32 a46, 0
v_mfma_f32_16x16x32_bf16 v[124:127], a[220:223], a[164:167], v[124:127]
ds_read_b64_tr_b16 a[214:215], v11 offset:17824
v_mfma_f32_16x16x32_bf16 v[92:95], a[220:223], a[160:163], v[92:95]
v_accvgpr_write_b32 a47, 0
s_waitcnt vmcnt(16)
s_waitcnt lgkmcnt(8)
v_mfma_f32_16x16x32_bf16 v[64:67], a[192:195], a[176:179], v[64:67]
ds_read_b64_tr_b16 a[216:217], v11 offset:17600
v_accvgpr_write_b32 a48, 0
v_mfma_f32_16x16x32_bf16 v[96:99], a[192:195], a[180:183], v[96:99]
s_add_u32 s64, s64, 8192
s_add_u32 m0, s65, 52800
v_mfma_f32_16x16x32_bf16 v[128:131], a[192:195], a[184:187], v[128:131]
ds_read_b64_tr_b16 a[218:219], v11 offset:17856
v_accvgpr_write_b32 a49, 0
v_mfma_f32_16x16x32_bf16 v[160:163], a[192:195], a[188:191], v[160:163]
buffer_load_dwordx4 v4, s[40:43], s64 offen lds
v_mfma_f32_16x16x32_bf16 v[164:167], a[196:199], a[188:191], v[164:167]
ds_read_b64_tr_b16 a[220:221], v11 offset:17632
v_mfma_f32_16x16x32_bf16 v[132:135], a[196:199], a[184:187], v[132:135]
v_accvgpr_write_b32 a50, 0
v_mfma_f32_16x16x32_bf16 v[100:103], a[196:199], a[180:183], v[100:103]
ds_read_b64_tr_b16 a[222:223], v11 offset:17888
v_accvgpr_write_b32 a51, 0
v_mfma_f32_16x16x32_bf16 v[68:71], a[196:199], a[176:179], v[68:71]
s_add_u32 s64, s64, 8192
s_add_u32 m0, s65, 53856
s_waitcnt lgkmcnt(8)
s_waitcnt vmcnt(15)
s_barrier
v_mfma_f32_16x16x32_bf16 v[72:75], a[200:203], a[176:179], v[72:75]
ds_read_b64_tr_b16 a[192:193], v11 offset:33792
v_accvgpr_write_b32 a52, 0
v_mfma_f32_16x16x32_bf16 v[104:107], a[200:203], a[180:183], v[104:107]
buffer_load_dwordx4 v4, s[40:43], s64 offen lds
v_mfma_f32_16x16x32_bf16 v[136:139], a[200:203], a[184:187], v[136:139]
ds_read_b64_tr_b16 a[194:195], v11 offset:34048
v_mfma_f32_16x16x32_bf16 v[168:171], a[200:203], a[188:191], v[168:171]
v_accvgpr_write_b32 a53, 0
v_mfma_f32_16x16x32_bf16 v[172:175], a[204:207], a[188:191], v[172:175]
ds_read_b64_tr_b16 a[196:197], v11 offset:33824
v_accvgpr_write_b32 a54, 0
v_mfma_f32_16x16x32_bf16 v[140:143], a[204:207], a[184:187], v[140:143]
s_add_u32 s66, s66, 262144
v_mfma_f32_16x16x32_bf16 v[108:111], a[204:207], a[180:183], v[108:111]
ds_read_b64_tr_b16 a[198:199], v11 offset:34080
v_accvgpr_write_b32 a55, 0
v_mfma_f32_16x16x32_bf16 v[76:79], a[204:207], a[176:179], v[76:79]
buffer_load_dwordx4 a[160:163], v14, s[44:47], s66 offen offset:0 sc1
s_waitcnt lgkmcnt(8)
v_mfma_f32_16x16x32_bf16 v[80:83], a[208:211], a[176:179], v[80:83]
ds_read_b64_tr_b16 a[200:201], v11 offset:33856
v_accvgpr_write_b32 a56, 0
v_mfma_f32_16x16x32_bf16 v[112:115], a[208:211], a[180:183], v[112:115]
buffer_load_dwordx4 a[164:167], v14, s[44:47], s66 offen offset:2048 sc1
v_mfma_f32_16x16x32_bf16 v[144:147], a[208:211], a[184:187], v[144:147]
ds_read_b64_tr_b16 a[202:203], v11 offset:34112
v_mfma_f32_16x16x32_bf16 v[176:179], a[208:211], a[188:191], v[176:179]
v_accvgpr_write_b32 a57, 0
v_mfma_f32_16x16x32_bf16 v[180:183], a[212:215], a[188:191], v[180:183]
ds_read_b64_tr_b16 a[204:205], v11 offset:33888
v_mfma_f32_16x16x32_bf16 v[148:151], a[212:215], a[184:187], v[148:151]
v_accvgpr_write_b32 a58, 0
v_mfma_f32_16x16x32_bf16 v[116:119], a[212:215], a[180:183], v[116:119]
ds_read_b64_tr_b16 a[206:207], v11 offset:34144
v_accvgpr_write_b32 a59, 0
v_mfma_f32_16x16x32_bf16 v[84:87], a[212:215], a[176:179], v[84:87]
buffer_load_dwordx4 a[168:171], v15, s[44:47], s66 offen offset:0 sc1
s_waitcnt lgkmcnt(8)
v_mfma_f32_16x16x32_bf16 v[88:91], a[216:219], a[176:179], v[88:91]
ds_read_b64_tr_b16 a[208:209], v11 offset:33920
v_mfma_f32_16x16x32_bf16 v[120:123], a[216:219], a[180:183], v[120:123]
v_accvgpr_write_b32 a60, 0
v_mfma_f32_16x16x32_bf16 v[152:155], a[216:219], a[184:187], v[152:155]
ds_read_b64_tr_b16 a[210:211], v11 offset:34176
v_mfma_f32_16x16x32_bf16 v[184:187], a[216:219], a[188:191], v[184:187]
v_accvgpr_write_b32 a61, 0
v_mfma_f32_16x16x32_bf16 v[188:191], a[220:223], a[188:191], v[188:191]
ds_read_b64_tr_b16 a[212:213], v11 offset:33952
v_accvgpr_write_b32 a62, 0
v_mfma_f32_16x16x32_bf16 v[156:159], a[220:223], a[184:187], v[156:159]
buffer_load_dwordx4 a[172:175], v15, s[44:47], s66 offen offset:2048 sc1
v_mfma_f32_16x16x32_bf16 v[124:127], a[220:223], a[180:183], v[124:127]
ds_read_b64_tr_b16 a[214:215], v11 offset:34208
v_mfma_f32_16x16x32_bf16 v[92:95], a[220:223], a[176:179], v[92:95]
v_accvgpr_write_b32 a63, 0
s_waitcnt vmcnt(16)
s_waitcnt lgkmcnt(8)
v_mfma_f32_16x16x32_bf16 v[64:67], a[192:195], a[128:131], v[64:67]
ds_read_b64_tr_b16 a[216:217], v11 offset:33984
v_mfma_f32_16x16x32_bf16 v[96:99], a[192:195], a[132:135], v[96:99]
v_accvgpr_write_b32 a64, 0
v_mfma_f32_16x16x32_bf16 v[128:131], a[192:195], a[136:139], v[128:131]
ds_read_b64_tr_b16 a[218:219], v11 offset:34240
v_accvgpr_write_b32 a65, 0
v_mfma_f32_16x16x32_bf16 v[160:163], a[192:195], a[140:143], v[160:163]
buffer_load_dwordx4 a[176:179], v14, s[44:47], s66 offen offset:1024 sc1
v_mfma_f32_16x16x32_bf16 v[164:167], a[196:199], a[140:143], v[164:167]
ds_read_b64_tr_b16 a[220:221], v11 offset:34016
v_mfma_f32_16x16x32_bf16 v[132:135], a[196:199], a[136:139], v[132:135]
v_accvgpr_write_b32 a66, 0
v_mfma_f32_16x16x32_bf16 v[100:103], a[196:199], a[132:135], v[100:103]
ds_read_b64_tr_b16 a[222:223], v11 offset:34272
v_mfma_f32_16x16x32_bf16 v[68:71], a[196:199], a[128:131], v[68:71]
s_add_u32 s67, s67, 16384
s_sub_u32 s69, s71, s69
s_add_u32 m0, s69, 0
s_waitcnt lgkmcnt(8)
v_mfma_f32_16x16x32_bf16 v[72:75], a[200:203], a[128:131], v[72:75]
ds_read_b64_tr_b16 a[192:193], v11 offset:34304
v_mfma_f32_16x16x32_bf16 v[104:107], a[200:203], a[132:135], v[104:107]
buffer_load_dwordx4 v5, s[48:51], s67 offen offset:0 lds
v_accvgpr_write_b32 a67, 0
v_mfma_f32_16x16x32_bf16 v[136:139], a[200:203], a[136:139], v[136:139]
ds_read_b64_tr_b16 a[194:195], v11 offset:34560
v_accvgpr_write_b32 a68, 0
v_mfma_f32_16x16x32_bf16 v[168:171], a[200:203], a[140:143], v[168:171]
buffer_load_dwordx4 a[180:183], v14, s[44:47], s66 offen offset:3072 sc1
v_accvgpr_write_b32 a69, 0
v_mfma_f32_16x16x32_bf16 v[172:175], a[204:207], a[140:143], v[172:175]
ds_read_b64_tr_b16 a[196:197], v11 offset:34336
v_mfma_f32_16x16x32_bf16 v[140:143], a[204:207], a[136:139], v[140:143]
s_add_u32 m0, s69, 0
v_mfma_f32_16x16x32_bf16 v[108:111], a[204:207], a[132:135], v[108:111]
ds_read_b64_tr_b16 a[198:199], v11 offset:34592
v_mfma_f32_16x16x32_bf16 v[76:79], a[204:207], a[128:131], v[76:79]
v_accvgpr_write_b32 a70, 0
s_waitcnt lgkmcnt(8)
v_mfma_f32_16x16x32_bf16 v[80:83], a[208:211], a[128:131], v[80:83]
ds_read_b64_tr_b16 a[200:201], v11 offset:34368
v_mfma_f32_16x16x32_bf16 v[112:115], a[208:211], a[132:135], v[112:115]
buffer_load_dwordx4 v6, s[48:51], s67 offen offset:1040 lds
v_accvgpr_write_b32 a71, 0
v_mfma_f32_16x16x32_bf16 v[144:147], a[208:211], a[136:139], v[144:147]
ds_read_b64_tr_b16 a[202:203], v11 offset:34624
v_accvgpr_write_b32 a72, 0
v_mfma_f32_16x16x32_bf16 v[176:179], a[208:211], a[140:143], v[176:179]
buffer_load_dwordx4 a[184:187], v15, s[44:47], s66 offen offset:1024 sc1
v_accvgpr_write_b32 a73, 0
v_mfma_f32_16x16x32_bf16 v[180:183], a[212:215], a[140:143], v[180:183]
ds_read_b64_tr_b16 a[204:205], v11 offset:34400
v_mfma_f32_16x16x32_bf16 v[148:151], a[212:215], a[136:139], v[148:151]
s_add_u32 m0, s69, 0
v_mfma_f32_16x16x32_bf16 v[116:119], a[212:215], a[132:135], v[116:119]
ds_read_b64_tr_b16 a[206:207], v11 offset:34656
v_mfma_f32_16x16x32_bf16 v[84:87], a[212:215], a[128:131], v[84:87]
buffer_load_dwordx4 v7, s[48:51], s67 offen offset:2080 lds
s_waitcnt lgkmcnt(8)
v_mfma_f32_16x16x32_bf16 v[88:91], a[216:219], a[128:131], v[88:91]
ds_read_b64_tr_b16 a[208:209], v11 offset:34432
v_mfma_f32_16x16x32_bf16 v[120:123], a[216:219], a[132:135], v[120:123]
v_accvgpr_write_b32 a74, 0
v_accvgpr_write_b32 a75, 0
v_mfma_f32_16x16x32_bf16 v[152:155], a[216:219], a[136:139], v[152:155]
ds_read_b64_tr_b16 a[210:211], v11 offset:34688
v_accvgpr_write_b32 a76, 0
v_mfma_f32_16x16x32_bf16 v[184:187], a[216:219], a[140:143], v[184:187]
buffer_load_dwordx4 a[188:191], v15, s[44:47], s66 offen offset:3072 sc1
s_add_u32 m0, s69, 0
v_mfma_f32_16x16x32_bf16 v[188:191], a[220:223], a[140:143], v[188:191]
ds_read_b64_tr_b16 a[212:213], v11 offset:34464
v_mfma_f32_16x16x32_bf16 v[156:159], a[220:223], a[136:139], v[156:159]
v_accvgpr_write_b32 a77, 0
v_mfma_f32_16x16x32_bf16 v[124:127], a[220:223], a[132:135], v[124:127]
ds_read_b64_tr_b16 a[214:215], v11 offset:34720
v_mfma_f32_16x16x32_bf16 v[92:95], a[220:223], a[128:131], v[92:95]
buffer_load_dwordx4 v8, s[48:51], s67 offen offset:3120 lds
v_accvgpr_write_b32 a78, 0
v_accvgpr_write_b32 a79, 0
s_waitcnt vmcnt(14)
s_waitcnt lgkmcnt(8)
v_mfma_f32_16x16x32_bf16 v[64:67], a[192:195], a[144:147], v[64:67]
ds_read_b64_tr_b16 a[216:217], v11 offset:34496
v_mfma_f32_16x16x32_bf16 v[96:99], a[192:195], a[148:151], v[96:99]
v_accvgpr_write_b32 a80, 0
v_mfma_f32_16x16x32_bf16 v[128:131], a[192:195], a[152:155], v[128:131]
ds_read_b64_tr_b16 a[218:219], v11 offset:34752
v_mfma_f32_16x16x32_bf16 v[160:163], a[192:195], a[156:159], v[160:163]
v_accvgpr_write_b32 a81, 0
v_mfma_f32_16x16x32_bf16 v[164:167], a[196:199], a[156:159], v[164:167]
ds_read_b64_tr_b16 a[220:221], v11 offset:34528
v_mfma_f32_16x16x32_bf16 v[132:135], a[196:199], a[152:155], v[132:135]
v_accvgpr_write_b32 a82, 0
v_mfma_f32_16x16x32_bf16 v[100:103], a[196:199], a[148:151], v[100:103]
ds_read_b64_tr_b16 a[222:223], v11 offset:34784
v_mfma_f32_16x16x32_bf16 v[68:71], a[196:199], a[144:147], v[68:71]
v_accvgpr_write_b32 a83, 0
s_waitcnt lgkmcnt(8)
s_waitcnt vmcnt(12)
s_barrier
v_mfma_f32_16x16x32_bf16 v[72:75], a[200:203], a[144:147], v[72:75]
ds_read_b64_tr_b16 a[192:193], v11 offset:50688
v_mfma_f32_16x16x32_bf16 v[104:107], a[200:203], a[148:151], v[104:107]
v_accvgpr_write_b32 a84, 0
v_mfma_f32_16x16x32_bf16 v[136:139], a[200:203], a[152:155], v[136:139]
ds_read_b64_tr_b16 a[194:195], v11 offset:50944
v_mfma_f32_16x16x32_bf16 v[168:171], a[200:203], a[156:159], v[168:171]
v_accvgpr_write_b32 a85, 0
v_mfma_f32_16x16x32_bf16 v[172:175], a[204:207], a[156:159], v[172:175]
ds_read_b64_tr_b16 a[196:197], v11 offset:50720
v_mfma_f32_16x16x32_bf16 v[140:143], a[204:207], a[152:155], v[140:143]
v_accvgpr_write_b32 a86, 0
v_mfma_f32_16x16x32_bf16 v[108:111], a[204:207], a[148:151], v[108:111]
ds_read_b64_tr_b16 a[198:199], v11 offset:50976
v_mfma_f32_16x16x32_bf16 v[76:79], a[204:207], a[144:147], v[76:79]
v_accvgpr_write_b32 a87, 0
s_waitcnt lgkmcnt(8)
v_mfma_f32_16x16x32_bf16 v[80:83], a[208:211], a[144:147], v[80:83]
ds_read_b64_tr_b16 a[200:201], v11 offset:50752
v_mfma_f32_16x16x32_bf16 v[112:115], a[208:211], a[148:151], v[112:115]
v_accvgpr_write_b32 a88, 0
v_mfma_f32_16x16x32_bf16 v[144:147], a[208:211], a[152:155], v[144:147]
ds_read_b64_tr_b16 a[202:203], v11 offset:51008
v_mfma_f32_16x16x32_bf16 v[176:179], a[208:211], a[156:159], v[176:179]
v_accvgpr_write_b32 a89, 0
v_mfma_f32_16x16x32_bf16 v[180:183], a[212:215], a[156:159], v[180:183]
ds_read_b64_tr_b16 a[204:205], v11 offset:50784
v_mfma_f32_16x16x32_bf16 v[148:151], a[212:215], a[152:155], v[148:151]
v_accvgpr_write_b32 a90, 0
v_mfma_f32_16x16x32_bf16 v[116:119], a[212:215], a[148:151], v[116:119]
ds_read_b64_tr_b16 a[206:207], v11 offset:51040
v_mfma_f32_16x16x32_bf16 v[84:87], a[212:215], a[144:147], v[84:87]
v_accvgpr_write_b32 a91, 0
s_waitcnt lgkmcnt(8)
v_mfma_f32_16x16x32_bf16 v[88:91], a[216:219], a[144:147], v[88:91]
ds_read_b64_tr_b16 a[208:209], v11 offset:50816
v_mfma_f32_16x16x32_bf16 v[120:123], a[216:219], a[148:151], v[120:123]
v_accvgpr_write_b32 a92, 0
v_mfma_f32_16x16x32_bf16 v[152:155], a[216:219], a[152:155], v[152:155]
ds_read_b64_tr_b16 a[210:211], v11 offset:51072
v_mfma_f32_16x16x32_bf16 v[184:187], a[216:219], a[156:159], v[184:187]
v_accvgpr_write_b32 a93, 0
v_mfma_f32_16x16x32_bf16 v[188:191], a[220:223], a[156:159], v[188:191]
ds_read_b64_tr_b16 a[212:213], v11 offset:50848
v_mfma_f32_16x16x32_bf16 v[156:159], a[220:223], a[152:155], v[156:159]
v_accvgpr_write_b32 a94, 0
v_mfma_f32_16x16x32_bf16 v[124:127], a[220:223], a[148:151], v[124:127]
ds_read_b64_tr_b16 a[214:215], v11 offset:51104
v_mfma_f32_16x16x32_bf16 v[92:95], a[220:223], a[144:147], v[92:95]
v_accvgpr_write_b32 a95, 0
s_waitcnt vmcnt(8)
s_waitcnt lgkmcnt(8)
v_mfma_f32_16x16x32_bf16 v[64:67], a[192:195], a[160:163], v[64:67]
ds_read_b64_tr_b16 a[216:217], v11 offset:50880
v_mfma_f32_16x16x32_bf16 v[96:99], a[192:195], a[164:167], v[96:99]
v_accvgpr_write_b32 a96, 0
v_mfma_f32_16x16x32_bf16 v[128:131], a[192:195], a[168:171], v[128:131]
ds_read_b64_tr_b16 a[218:219], v11 offset:51136
v_mfma_f32_16x16x32_bf16 v[160:163], a[192:195], a[172:175], v[160:163]
v_accvgpr_write_b32 a97, 0
v_mfma_f32_16x16x32_bf16 v[164:167], a[196:199], a[172:175], v[164:167]
ds_read_b64_tr_b16 a[220:221], v11 offset:50912
v_mfma_f32_16x16x32_bf16 v[132:135], a[196:199], a[168:171], v[132:135]
v_accvgpr_write_b32 a98, 0
v_mfma_f32_16x16x32_bf16 v[100:103], a[196:199], a[164:167], v[100:103]
ds_read_b64_tr_b16 a[222:223], v11 offset:51168
v_mfma_f32_16x16x32_bf16 v[68:71], a[196:199], a[160:163], v[68:71]
s_add_u32 s67, s67, 16384
s_add_u32 m0, s69, 16640
s_waitcnt lgkmcnt(8)
v_mfma_f32_16x16x32_bf16 v[72:75], a[200:203], a[160:163], v[72:75]
ds_read_b64_tr_b16 a[192:193], v11 offset:51200
v_mfma_f32_16x16x32_bf16 v[104:107], a[200:203], a[164:167], v[104:107]
buffer_load_dwordx4 v5, s[48:51], s67 offen offset:0 lds
v_mfma_f32_16x16x32_bf16 v[136:139], a[200:203], a[168:171], v[136:139]
ds_read_b64_tr_b16 a[194:195], v11 offset:51456
v_mfma_f32_16x16x32_bf16 v[168:171], a[200:203], a[172:175], v[168:171]
v_accvgpr_write_b32 a99, 0
v_mfma_f32_16x16x32_bf16 v[172:175], a[204:207], a[172:175], v[172:175]
ds_read_b64_tr_b16 a[196:197], v11 offset:51232
v_mfma_f32_16x16x32_bf16 v[140:143], a[204:207], a[168:171], v[140:143]
v_accvgpr_write_b32 a100, 0
v_mfma_f32_16x16x32_bf16 v[108:111], a[204:207], a[164:167], v[108:111]
ds_read_b64_tr_b16 a[198:199], v11 offset:51488
v_mfma_f32_16x16x32_bf16 v[76:79], a[204:207], a[160:163], v[76:79]
v_accvgpr_write_b32 a101, 0
s_waitcnt lgkmcnt(8)
v_mfma_f32_16x16x32_bf16 v[80:83], a[208:211], a[160:163], v[80:83]
ds_read_b64_tr_b16 a[200:201], v11 offset:51264
v_mfma_f32_16x16x32_bf16 v[112:115], a[208:211], a[164:167], v[112:115]
s_add_u32 m0, s69, 16640
v_mfma_f32_16x16x32_bf16 v[144:147], a[208:211], a[168:171], v[144:147]
ds_read_b64_tr_b16 a[202:203], v11 offset:51520
v_mfma_f32_16x16x32_bf16 v[176:179], a[208:211], a[172:175], v[176:179]
v_accvgpr_write_b32 a102, 0
v_mfma_f32_16x16x32_bf16 v[180:183], a[212:215], a[172:175], v[180:183]
ds_read_b64_tr_b16 a[204:205], v11 offset:51296
v_mfma_f32_16x16x32_bf16 v[148:151], a[212:215], a[168:171], v[148:151]
buffer_load_dwordx4 v6, s[48:51], s67 offen offset:1040 lds
v_mfma_f32_16x16x32_bf16 v[116:119], a[212:215], a[164:167], v[116:119]
ds_read_b64_tr_b16 a[206:207], v11 offset:51552
v_mfma_f32_16x16x32_bf16 v[84:87], a[212:215], a[160:163], v[84:87]
v_accvgpr_write_b32 a103, 0
s_waitcnt lgkmcnt(8)
v_mfma_f32_16x16x32_bf16 v[88:91], a[216:219], a[160:163], v[88:91]
ds_read_b64_tr_b16 a[208:209], v11 offset:51328
v_mfma_f32_16x16x32_bf16 v[120:123], a[216:219], a[164:167], v[120:123]
v_accvgpr_write_b32 a104, 0
v_mfma_f32_16x16x32_bf16 v[152:155], a[216:219], a[168:171], v[152:155]
ds_read_b64_tr_b16 a[210:211], v11 offset:51584
v_mfma_f32_16x16x32_bf16 v[184:187], a[216:219], a[172:175], v[184:187]
v_accvgpr_write_b32 a105, 0
v_mfma_f32_16x16x32_bf16 v[188:191], a[220:223], a[172:175], v[188:191]
ds_read_b64_tr_b16 a[212:213], v11 offset:51360
v_mfma_f32_16x16x32_bf16 v[156:159], a[220:223], a[168:171], v[156:159]
s_add_u32 m0, s69, 16640
v_mfma_f32_16x16x32_bf16 v[124:127], a[220:223], a[164:167], v[124:127]
ds_read_b64_tr_b16 a[214:215], v11 offset:51616
v_mfma_f32_16x16x32_bf16 v[92:95], a[220:223], a[160:163], v[92:95]
buffer_load_dwordx4 v7, s[48:51], s67 offen offset:2080 lds
v_accvgpr_write_b32 a106, 0
v_accvgpr_write_b32 a107, 0
v_accvgpr_write_b32 a108, 0
s_add_u32 m0, s69, 16640
v_accvgpr_write_b32 a109, 0
buffer_load_dwordx4 v8, s[48:51], s67 offen offset:3120 lds
v_accvgpr_write_b32 a110, 0
v_accvgpr_write_b32 a111, 0
s_waitcnt vmcnt(5)
s_waitcnt lgkmcnt(8)
v_mfma_f32_16x16x32_bf16 v[64:67], a[192:195], a[176:179], v[64:67]
ds_read_b64_tr_b16 a[216:217], v11 offset:51392
v_mfma_f32_16x16x32_bf16 v[96:99], a[192:195], a[180:183], v[96:99]
v_accvgpr_write_b32 a112, 0
v_mfma_f32_16x16x32_bf16 v[128:131], a[192:195], a[184:187], v[128:131]
ds_read_b64_tr_b16 a[218:219], v11 offset:51648
v_mfma_f32_16x16x32_bf16 v[160:163], a[192:195], a[188:191], v[160:163]
v_accvgpr_write_b32 a113, 0
v_mfma_f32_16x16x32_bf16 v[164:167], a[196:199], a[188:191], v[164:167]
ds_read_b64_tr_b16 a[220:221], v11 offset:51424
v_mfma_f32_16x16x32_bf16 v[132:135], a[196:199], a[184:187], v[132:135]
v_accvgpr_write_b32 a114, 0
v_mfma_f32_16x16x32_bf16 v[100:103], a[196:199], a[180:183], v[100:103]
ds_read_b64_tr_b16 a[222:223], v11 offset:51680
v_mfma_f32_16x16x32_bf16 v[68:71], a[196:199], a[176:179], v[68:71]
v_accvgpr_write_b32 a115, 0
s_waitcnt lgkmcnt(8)
v_mfma_f32_16x16x32_bf16 v[72:75], a[200:203], a[176:179], v[72:75]
v_accvgpr_write_b32 a116, 0
v_mfma_f32_16x16x32_bf16 v[104:107], a[200:203], a[180:183], v[104:107]
v_mfma_f32_16x16x32_bf16 v[136:139], a[200:203], a[184:187], v[136:139]
v_accvgpr_write_b32 a117, 0
v_mfma_f32_16x16x32_bf16 v[168:171], a[200:203], a[188:191], v[168:171]
v_mfma_f32_16x16x32_bf16 v[172:175], a[204:207], a[188:191], v[172:175]
v_accvgpr_write_b32 a118, 0
v_mfma_f32_16x16x32_bf16 v[140:143], a[204:207], a[184:187], v[140:143]
v_mfma_f32_16x16x32_bf16 v[108:111], a[204:207], a[180:183], v[108:111]
v_accvgpr_write_b32 a119, 0
v_mfma_f32_16x16x32_bf16 v[76:79], a[204:207], a[176:179], v[76:79]
s_waitcnt lgkmcnt(4)
v_mfma_f32_16x16x32_bf16 v[80:83], a[208:211], a[176:179], v[80:83]
v_accvgpr_write_b32 a120, 0
v_mfma_f32_16x16x32_bf16 v[112:115], a[208:211], a[180:183], v[112:115]
v_mfma_f32_16x16x32_bf16 v[144:147], a[208:211], a[184:187], v[144:147]
v_accvgpr_write_b32 a121, 0
v_mfma_f32_16x16x32_bf16 v[176:179], a[208:211], a[188:191], v[176:179]
v_mfma_f32_16x16x32_bf16 v[180:183], a[212:215], a[188:191], v[180:183]
v_accvgpr_write_b32 a122, 0
v_mfma_f32_16x16x32_bf16 v[148:151], a[212:215], a[184:187], v[148:151]
v_mfma_f32_16x16x32_bf16 v[116:119], a[212:215], a[180:183], v[116:119]
v_accvgpr_write_b32 a123, 0
v_mfma_f32_16x16x32_bf16 v[84:87], a[212:215], a[176:179], v[84:87]
s_waitcnt lgkmcnt(0)
v_mfma_f32_16x16x32_bf16 v[88:91], a[216:219], a[176:179], v[88:91]
v_accvgpr_write_b32 a124, 0
v_mfma_f32_16x16x32_bf16 v[120:123], a[216:219], a[180:183], v[120:123]
v_mfma_f32_16x16x32_bf16 v[152:155], a[216:219], a[184:187], v[152:155]
v_accvgpr_write_b32 a125, 0
v_mfma_f32_16x16x32_bf16 v[184:187], a[216:219], a[188:191], v[184:187]
v_mfma_f32_16x16x32_bf16 v[188:191], a[220:223], a[188:191], v[188:191]
v_accvgpr_write_b32 a126, 0
v_mfma_f32_16x16x32_bf16 v[156:159], a[220:223], a[184:187], v[156:159]
v_mfma_f32_16x16x32_bf16 v[124:127], a[220:223], a[180:183], v[124:127]
v_accvgpr_write_b32 a127, 0
v_mfma_f32_16x16x32_bf16 v[92:95], a[220:223], a[176:179], v[92:95]
v_cvt_pk_bf16_f32 v56, v64, v65
v_cvt_pk_bf16_f32 v57, v66, v67
v_cvt_pk_bf16_f32 v58, v68, v69
v_cvt_pk_bf16_f32 v59, v70, v71
v_accvgpr_write_b32 a128, v56
v_accvgpr_write_b32 a129, v57
v_accvgpr_write_b32 a130, v58
v_accvgpr_write_b32 a131, v59
v_cvt_pk_bf16_f32 v56, v72, v73
v_cvt_pk_bf16_f32 v57, v74, v75
v_cvt_pk_bf16_f32 v58, v76, v77
v_cvt_pk_bf16_f32 v59, v78, v79
v_accvgpr_write_b32 a132, v56
v_accvgpr_write_b32 a133, v57
v_accvgpr_write_b32 a134, v58
v_accvgpr_write_b32 a135, v59
v_cvt_pk_bf16_f32 v56, v80, v81
v_cvt_pk_bf16_f32 v57, v82, v83
v_cvt_pk_bf16_f32 v58, v84, v85
v_cvt_pk_bf16_f32 v59, v86, v87
v_accvgpr_write_b32 a136, v56
v_accvgpr_write_b32 a137, v57
v_accvgpr_write_b32 a138, v58
v_accvgpr_write_b32 a139, v59
v_cvt_pk_bf16_f32 v56, v88, v89
v_cvt_pk_bf16_f32 v57, v90, v91
v_cvt_pk_bf16_f32 v58, v92, v93
v_cvt_pk_bf16_f32 v59, v94, v95
v_accvgpr_write_b32 a140, v56
v_accvgpr_write_b32 a141, v57
v_accvgpr_write_b32 a142, v58
v_accvgpr_write_b32 a143, v59
v_cvt_pk_bf16_f32 v56, v96, v97
v_cvt_pk_bf16_f32 v57, v98, v99
v_cvt_pk_bf16_f32 v58, v100, v101
v_cvt_pk_bf16_f32 v59, v102, v103
v_accvgpr_write_b32 a144, v56
v_accvgpr_write_b32 a145, v57
v_accvgpr_write_b32 a146, v58
v_accvgpr_write_b32 a147, v59
v_cvt_pk_bf16_f32 v56, v104, v105
v_cvt_pk_bf16_f32 v57, v106, v107
v_cvt_pk_bf16_f32 v58, v108, v109
v_cvt_pk_bf16_f32 v59, v110, v111
v_accvgpr_write_b32 a148, v56
v_accvgpr_write_b32 a149, v57
v_accvgpr_write_b32 a150, v58
v_accvgpr_write_b32 a151, v59
v_cvt_pk_bf16_f32 v56, v112, v113
v_cvt_pk_bf16_f32 v57, v114, v115
v_cvt_pk_bf16_f32 v58, v116, v117
v_cvt_pk_bf16_f32 v59, v118, v119
v_accvgpr_write_b32 a152, v56
v_accvgpr_write_b32 a153, v57
v_accvgpr_write_b32 a154, v58
v_accvgpr_write_b32 a155, v59
v_cvt_pk_bf16_f32 v56, v120, v121
v_cvt_pk_bf16_f32 v57, v122, v123
v_cvt_pk_bf16_f32 v58, v124, v125
v_cvt_pk_bf16_f32 v59, v126, v127
v_accvgpr_write_b32 a156, v56
v_accvgpr_write_b32 a157, v57
v_accvgpr_write_b32 a158, v58
v_accvgpr_write_b32 a159, v59
v_cvt_pk_bf16_f32 v56, v128, v129
v_cvt_pk_bf16_f32 v57, v130, v131
v_cvt_pk_bf16_f32 v58, v132, v133
v_cvt_pk_bf16_f32 v59, v134, v135
v_accvgpr_write_b32 a160, v56
v_accvgpr_write_b32 a161, v57
v_accvgpr_write_b32 a162, v58
v_accvgpr_write_b32 a163, v59
v_cvt_pk_bf16_f32 v56, v136, v137
v_cvt_pk_bf16_f32 v57, v138, v139
v_cvt_pk_bf16_f32 v58, v140, v141
v_cvt_pk_bf16_f32 v59, v142, v143
v_accvgpr_write_b32 a164, v56
v_accvgpr_write_b32 a165, v57
v_accvgpr_write_b32 a166, v58
v_accvgpr_write_b32 a167, v59
v_cvt_pk_bf16_f32 v56, v144, v145
v_cvt_pk_bf16_f32 v57, v146, v147
v_cvt_pk_bf16_f32 v58, v148, v149
v_cvt_pk_bf16_f32 v59, v150, v151
v_accvgpr_write_b32 a168, v56
v_accvgpr_write_b32 a169, v57
v_accvgpr_write_b32 a170, v58
v_accvgpr_write_b32 a171, v59
v_cvt_pk_bf16_f32 v56, v152, v153
v_cvt_pk_bf16_f32 v57, v154, v155
v_cvt_pk_bf16_f32 v58, v156, v157
v_cvt_pk_bf16_f32 v59, v158, v159
v_accvgpr_write_b32 a172, v56
v_accvgpr_write_b32 a173, v57
v_accvgpr_write_b32 a174, v58
v_accvgpr_write_b32 a175, v59
v_cvt_pk_bf16_f32 v56, v160, v161
v_cvt_pk_bf16_f32 v57, v162, v163
v_cvt_pk_bf16_f32 v58, v164, v165
v_cvt_pk_bf16_f32 v59, v166, v167
v_accvgpr_write_b32 a176, v56
v_accvgpr_write_b32 a177, v57
v_accvgpr_write_b32 a178, v58
v_accvgpr_write_b32 a179, v59
v_cvt_pk_bf16_f32 v56, v168, v169
v_cvt_pk_bf16_f32 v57, v170, v171
v_cvt_pk_bf16_f32 v58, v172, v173
v_cvt_pk_bf16_f32 v59, v174, v175
v_accvgpr_write_b32 a180, v56
v_accvgpr_write_b32 a181, v57
v_accvgpr_write_b32 a182, v58
v_accvgpr_write_b32 a183, v59
v_cvt_pk_bf16_f32 v56, v176, v177
v_cvt_pk_bf16_f32 v57, v178, v179
v_cvt_pk_bf16_f32 v58, v180, v181
v_cvt_pk_bf16_f32 v59, v182, v183
v_accvgpr_write_b32 a184, v56
v_accvgpr_write_b32 a185, v57
v_accvgpr_write_b32 a186, v58
v_accvgpr_write_b32 a187, v59
v_cvt_pk_bf16_f32 v56, v184, v185
v_cvt_pk_bf16_f32 v57, v186, v187
v_cvt_pk_bf16_f32 v58, v188, v189
v_cvt_pk_bf16_f32 v59, v190, v191
v_accvgpr_write_b32 a188, v56
v_accvgpr_write_b32 a189, v57
v_accvgpr_write_b32 a190, v58
v_accvgpr_write_b32 a191, v59
v_mov_b32 v32, 0
v_accvgpr_write_b32 a192, 0
v_mov_b32 v33, 0
v_accvgpr_write_b32 a193, 0
v_mov_b32 v34, 0
v_accvgpr_write_b32 a194, 0
v_mov_b32 v35, 0
v_accvgpr_write_b32 a195, 0
v_mov_b32 v36, 0
v_accvgpr_write_b32 a196, 0
v_mov_b32 v37, 0
v_accvgpr_write_b32 a197, 0
v_mov_b32 v38, 0
v_accvgpr_write_b32 a198, 0
v_mov_b32 v39, 0
v_accvgpr_write_b32 a199, 0
v_mov_b32 v40, 0
v_accvgpr_write_b32 a200, 0
v_mov_b32 v41, 0
v_accvgpr_write_b32 a201, 0
v_mov_b32 v42, 0
v_accvgpr_write_b32 a202, 0
v_mov_b32 v43, 0
v_accvgpr_write_b32 a203, 0
v_mov_b32 v44, 0
v_accvgpr_write_b32 a204, 0
v_mov_b32 v45, 0
v_accvgpr_write_b32 a205, 0
v_mov_b32 v46, 0
v_accvgpr_write_b32 a206, 0
v_mov_b32 v47, 0
v_accvgpr_write_b32 a207, 0
v_mov_b32 v48, 0x3f803f80
v_mov_b32 v49, 0x3f803f80
v_mov_b32 v50, 0x3f803f80
v_mov_b32 v51, 0x3f803f80
s_waitcnt vmcnt(19) lgkmcnt(0)
s_barrier
ds_read_b64 a[208:209], v22 offset:0
ds_read_b64 a[210:211], v22 offset:32
ds_read_b64 a[212:213], v22 offset:64
ds_read_b64 a[214:215], v22 offset:96
ds_read_b64 a[216:217], v22 offset:128
ds_read_b64 a[218:219], v22 offset:160
s_waitcnt lgkmcnt(4)
v_mfma_f32_16x16x32_bf16 v[64:67], a[208:211], a[128:131], v[32:35]
ds_read_b64 a[220:221], v22 offset:192
ds_read_b64 a[222:223], v22 offset:224
v_mfma_f32_16x16x32_bf16 v[68:71], a[208:211], a[144:147], v[36:39]
v_mfma_f32_16x16x32_bf16 v[72:75], a[208:211], a[160:163], v[40:43]
v_mfma_f32_16x16x32_bf16 v[76:79], a[208:211], a[176:179], v[44:47]
s_waitcnt lgkmcnt(4)
v_mfma_f32_16x16x32_bf16 v[76:79], a[212:215], a[180:183], v[76:79]
ds_read_b64 a[208:209], v22 offset:256
ds_read_b64 a[210:211], v22 offset:288
v_mfma_f32_16x16x32_bf16 v[72:75], a[212:215], a[164:167], v[72:75]
s_add_u32 m0, s70, 0
s_nop 0
buffer_load_dwordx4 v9, s[52:55], s68 offen offset:0 lds
v_mfma_f32_16x16x32_bf16 v[68:71], a[212:215], a[148:151], v[68:71]
v_mfma_f32_16x16x32_bf16 v[64:67], a[212:215], a[132:135], v[64:67]
s_waitcnt lgkmcnt(4)
v_mfma_f32_16x16x32_bf16 v[64:67], a[216:219], a[136:139], v[64:67]
ds_read_b64 a[212:213], v22 offset:320
ds_read_b64 a[214:215], v22 offset:352
v_mfma_f32_16x16x32_bf16 v[68:71], a[216:219], a[152:155], v[68:71]
v_mfma_f32_16x16x32_bf16 v[72:75], a[216:219], a[168:171], v[72:75]
v_mfma_f32_16x16x32_bf16 v[76:79], a[216:219], a[184:187], v[76:79]
s_waitcnt lgkmcnt(4)
v_mfma_f32_16x16x32_bf16 v[76:79], a[220:223], a[188:191], v[76:79]
ds_read_b64 a[216:217], v22 offset:384
ds_read_b64 a[218:219], v22 offset:416
v_mfma_f32_16x16x32_bf16 v[72:75], a[220:223], a[172:175], v[72:75]
s_add_u32 m0, s70, 0
s_nop 0
buffer_load_dwordx4 v10, s[52:55], s68 offen offset:1056 lds
v_mfma_f32_16x16x32_bf16 v[68:71], a[220:223], a[156:159], v[68:71]
v_mfma_f32_16x16x32_bf16 v[64:67], a[220:223], a[140:143], v[64:67]
s_nop 7
v_max3_f32 v52, v64, v65, v66
v_max3_f32 v53, v68, v69, v70
v_max3_f32 v54, v72, v73, v74
v_max3_f32 v55, v76, v77, v78
v_max_f32 v52, v52, v67
v_max_f32 v53, v53, v71
v_max_f32 v54, v54, v75
v_max_f32 v55, v55, v79
v_mov_b32 v56, v52
v_mov_b32 v57, v53
v_mov_b32 v58, v54
v_mov_b32 v59, v55
v_permlane32_swap_b32 v52, v56
v_permlane32_swap_b32 v53, v57
v_permlane32_swap_b32 v54, v58
v_permlane32_swap_b32 v55, v59
v_max_f32 v52, v52, v56
v_max_f32 v53, v53, v57
v_max_f32 v54, v54, v58
v_max_f32 v55, v55, v59
v_mov_b32 v56, v52
v_mov_b32 v57, v53
v_mov_b32 v58, v54
v_mov_b32 v59, v55
v_permlane16_swap_b32 v52, v56
v_permlane16_swap_b32 v53, v57
v_permlane16_swap_b32 v54, v58
v_permlane16_swap_b32 v55, v59
v_max_f32 v52, v52, v56
v_max_f32 v53, v53, v57
v_max_f32 v54, v54, v58
v_max_f32 v55, v55, v59
v_add_f32 v52, 0x42b40000, v52
v_add_f32 v53, 0x42b40000, v53
v_add_f32 v54, 0x42b40000, v54
v_add_f32 v55, 0x42b40000, v55
v_sub_f32 v32, 0, v52
v_sub_f32 v33, 0, v52
v_sub_f32 v34, 0, v52
v_sub_f32 v35, 0, v52
v_sub_f32 v36, 0, v53
v_sub_f32 v37, 0, v53
v_sub_f32 v38, 0, v53
v_sub_f32 v39, 0, v53
v_sub_f32 v40, 0, v54
v_sub_f32 v41, 0, v54
v_sub_f32 v42, 0, v54
v_sub_f32 v43, 0, v54
v_sub_f32 v44, 0, v55
v_sub_f32 v45, 0, v55
v_sub_f32 v46, 0, v55
v_sub_f32 v47, 0, v55
v_pk_add_f32 v[64:65], v[64:65], v[32:33]
v_pk_add_f32 v[66:67], v[66:67], v[32:33]
v_pk_add_f32 v[68:69], v[68:69], v[36:37]
v_pk_add_f32 v[70:71], v[70:71], v[36:37]
v_pk_add_f32 v[72:73], v[72:73], v[40:41]
v_pk_add_f32 v[74:75], v[74:75], v[40:41]
v_pk_add_f32 v[76:77], v[76:77], v[44:45]
v_pk_add_f32 v[78:79], v[78:79], v[44:45]
s_nop 1
s_waitcnt lgkmcnt(4)
v_mfma_f32_16x16x32_bf16 v[80:83], a[208:211], a[128:131], v[32:35]
ds_read_b64 a[220:221], v22 offset:448
ds_read_b64 a[222:223], v22 offset:480
v_mfma_f32_16x16x32_bf16 v[84:87], a[208:211], a[144:147], v[36:39]
v_mfma_f32_16x16x32_bf16 v[88:91], a[208:211], a[160:163], v[40:43]
v_mfma_f32_16x16x32_bf16 v[92:95], a[208:211], a[176:179], v[44:47]
s_waitcnt lgkmcnt(4)
v_mfma_f32_16x16x32_bf16 v[92:95], a[212:215], a[180:183], v[92:95]
ds_read_b64 a[208:209], v22 offset:512
ds_read_b64 a[210:211], v22 offset:544
v_mfma_f32_16x16x32_bf16 v[88:91], a[212:215], a[164:167], v[88:91]
s_add_u32 m0, s70, 0
s_nop 0
buffer_load_dwordx4 v12, s[52:55], s68 offen offset:2112 lds
v_mfma_f32_16x16x32_bf16 v[84:87], a[212:215], a[148:151], v[84:87]
v_mfma_f32_16x16x32_bf16 v[80:83], a[212:215], a[132:135], v[80:83]
s_waitcnt lgkmcnt(4)
v_mfma_f32_16x16x32_bf16 v[80:83], a[216:219], a[136:139], v[80:83]
ds_read_b64 a[212:213], v22 offset:576
ds_read_b64 a[214:215], v22 offset:608
v_mfma_f32_16x16x32_bf16 v[84:87], a[216:219], a[152:155], v[84:87]
v_mfma_f32_16x16x32_bf16 v[88:91], a[216:219], a[168:171], v[88:91]
v_mfma_f32_16x16x32_bf16 v[92:95], a[216:219], a[184:187], v[92:95]
s_waitcnt lgkmcnt(4)
v_mfma_f32_16x16x32_bf16 v[92:95], a[220:223], a[188:191], v[92:95]
ds_read_b64 a[216:217], v22 offset:640
ds_read_b64 a[218:219], v22 offset:672
v_mfma_f32_16x16x32_bf16 v[88:91], a[220:223], a[172:175], v[88:91]
s_add_u32 m0, s70, 0
s_nop 0
buffer_load_dwordx4 v13, s[52:55], s68 offen offset:3168 lds
v_mfma_f32_16x16x32_bf16 v[84:87], a[220:223], a[156:159], v[84:87]
v_mfma_f32_16x16x32_bf16 v[80:83], a[220:223], a[140:143], v[80:83]
s_waitcnt lgkmcnt(4)
v_mfma_f32_16x16x32_bf16 v[96:99], a[208:211], a[128:131], v[32:35]
ds_read_b64 a[220:221], v22 offset:704
ds_read_b64 a[222:223], v22 offset:736
v_mfma_f32_16x16x32_bf16 v[100:103], a[208:211], a[144:147], v[36:39]
v_mfma_f32_16x16x32_bf16 v[104:107], a[208:211], a[160:163], v[40:43]
v_mfma_f32_16x16x32_bf16 v[108:111], a[208:211], a[176:179], v[44:47]
s_waitcnt lgkmcnt(4)
v_mfma_f32_16x16x32_bf16 v[108:111], a[212:215], a[180:183], v[108:111]
ds_read_b64 a[208:209], v22 offset:768
ds_read_b64 a[210:211], v22 offset:800
v_mfma_f32_16x16x32_bf16 v[104:107], a[212:215], a[164:167], v[104:107]
s_add_u32 s68, s68, 16384
s_add_u32 m0, s70, 16896
s_nop 0
buffer_load_dwordx4 v9, s[52:55], s68 offen offset:0 lds
v_mfma_f32_16x16x32_bf16 v[100:103], a[212:215], a[148:151], v[100:103]
v_mfma_f32_16x16x32_bf16 v[96:99], a[212:215], a[132:135], v[96:99]
s_waitcnt lgkmcnt(4)
v_mfma_f32_16x16x32_bf16 v[96:99], a[216:219], a[136:139], v[96:99]
ds_read_b64 a[212:213], v22 offset:832
ds_read_b64 a[214:215], v22 offset:864
v_mfma_f32_16x16x32_bf16 v[100:103], a[216:219], a[152:155], v[100:103]
v_mfma_f32_16x16x32_bf16 v[104:107], a[216:219], a[168:171], v[104:107]
v_mfma_f32_16x16x32_bf16 v[108:111], a[216:219], a[184:187], v[108:111]
s_waitcnt lgkmcnt(4)
v_mfma_f32_16x16x32_bf16 v[108:111], a[220:223], a[188:191], v[108:111]
ds_read_b64 a[216:217], v22 offset:896
ds_read_b64 a[218:219], v22 offset:928
v_mfma_f32_16x16x32_bf16 v[104:107], a[220:223], a[172:175], v[104:107]
s_add_u32 m0, s70, 16896
s_nop 0
buffer_load_dwordx4 v10, s[52:55], s68 offen offset:1056 lds
v_mfma_f32_16x16x32_bf16 v[100:103], a[220:223], a[156:159], v[100:103]
v_mfma_f32_16x16x32_bf16 v[96:99], a[220:223], a[140:143], v[96:99]
s_waitcnt lgkmcnt(4)
v_mfma_f32_16x16x32_bf16 v[112:115], a[208:211], a[128:131], v[32:35]
ds_read_b64 a[220:221], v22 offset:960
ds_read_b64 a[222:223], v22 offset:992
v_mfma_f32_16x16x32_bf16 v[116:119], a[208:211], a[144:147], v[36:39]
v_mfma_f32_16x16x32_bf16 v[120:123], a[208:211], a[160:163], v[40:43]
v_mfma_f32_16x16x32_bf16 v[124:127], a[208:211], a[176:179], v[44:47]
s_waitcnt lgkmcnt(4)
v_mfma_f32_16x16x32_bf16 v[124:127], a[212:215], a[180:183], v[124:127]
v_mfma_f32_16x16x32_bf16 v[120:123], a[212:215], a[164:167], v[120:123]
s_add_u32 m0, s70, 16896
s_nop 0
buffer_load_dwordx4 v12, s[52:55], s68 offen offset:2112 lds
v_mfma_f32_16x16x32_bf16 v[116:119], a[212:215], a[148:151], v[116:119]
v_mfma_f32_16x16x32_bf16 v[112:115], a[212:215], a[132:135], v[112:115]
s_waitcnt lgkmcnt(2)
v_mfma_f32_16x16x32_bf16 v[112:115], a[216:219], a[136:139], v[112:115]
v_mfma_f32_16x16x32_bf16 v[116:119], a[216:219], a[152:155], v[116:119]
v_mfma_f32_16x16x32_bf16 v[120:123], a[216:219], a[168:171], v[120:123]
v_mfma_f32_16x16x32_bf16 v[124:127], a[216:219], a[184:187], v[124:127]
s_waitcnt lgkmcnt(0)
v_mfma_f32_16x16x32_bf16 v[124:127], a[220:223], a[188:191], v[124:127]
v_mfma_f32_16x16x32_bf16 v[120:123], a[220:223], a[172:175], v[120:123]
s_add_u32 m0, s70, 16896
s_nop 0
buffer_load_dwordx4 v13, s[52:55], s68 offen offset:3168 lds
v_mfma_f32_16x16x32_bf16 v[116:119], a[220:223], a[156:159], v[116:119]
v_mfma_f32_16x16x32_bf16 v[112:115], a[220:223], a[140:143], v[112:115]
ds_read_b64 a[208:209], v22 offset:16640
ds_read_b64 a[210:211], v22 offset:16672
ds_read_b64 a[212:213], v22 offset:16704
ds_read_b64 a[214:215], v22 offset:16736
ds_read_b64 a[216:217], v22 offset:16768
ds_read_b64 a[218:219], v22 offset:16800
s_barrier
s_lshl_b32 s73, s2, 2
s_add_u32 s73, s73, s24
s_lshl_b32 s73, s73, 12
v_lshlrev_b32 v18, 7, v1
s_mov_b32 s63, 0x20000
v_cmp_gt_u32 vcc, 32, v1
v_mov_b32 v19, 0x7fffffff
s_nop 1
v_cndmask_b32 v18, v19, v18, vcc
s_add_u32 s84, s14, 0
s_addc_u32 s85, s15, 0
s_add_u32 s86, s14, 3670016
s_addc_u32 s87, s15, 0
s_add_u32 s88, s16, 0
s_addc_u32 s89, s17, 0
s_add_u32 s90, s16, 3670016
s_addc_u32 s91, s17, 0
s_add_u32 s92, s18, 0
s_addc_u32 s93, s19, 0
s_add_u32 s76, s18, 3670016
s_addc_u32 s77, s19, 0
s_waitcnt lgkmcnt(2)
v_mfma_f32_16x16x32_bf16 v[128:131], a[208:211], a[128:131], v[32:35]
ds_read_b64 a[220:221], v22 offset:16832
v_mfma_f32_16x16x32_bf16 v[132:135], a[208:211], a[144:147], v[36:39]
ds_read_b64 a[222:223], v22 offset:16864
v_mfma_f32_16x16x32_bf16 v[136:139], a[208:211], a[160:163], v[40:43]
v_exp_f32 v56, v64
v_mfma_f32_16x16x32_bf16 v[140:143], a[208:211], a[176:179], v[44:47]
v_exp_f32 v57, v65
v_mfma_f32_16x16x32_bf16 v[140:143], a[212:215], a[180:183], v[140:143]
ds_read_b64 a[208:209], v22 offset:16896
v_cvt_pk_bf16_f32 v192, v56, v57
v_mfma_f32_16x16x32_bf16 v[136:139], a[212:215], a[164:167], v[136:139]
ds_read_b64 a[210:211], v22 offset:16928
s_waitcnt lgkmcnt(2)
v_mfma_f32_16x16x32_bf16 v[132:135], a[212:215], a[148:151], v[132:135]
v_exp_f32 v58, v66
v_mfma_f32_16x16x32_bf16 v[128:131], a[212:215], a[132:135], v[128:131]
v_exp_f32 v59, v67
v_mfma_f32_16x16x32_bf16 v[128:131], a[216:219], a[136:139], v[128:131]
ds_read_b64 a[212:213], v22 offset:16960
s_add_u32 s67, s67, 16384
s_sub_u32 s69, s71, s69
s_add_u32 m0, s69, 0
v_mfma_f32_16x16x32_bf16 v[132:135], a[216:219], a[152:155], v[132:135]
ds_read_b64 a[214:215], v22 offset:16992
buffer_load_dwordx4 v5, s[48:51], s67 offen offset:0 lds
v_mfma_f32_16x16x32_bf16 v[136:139], a[216:219], a[168:171], v[136:139]
v_exp_f32 v60, v80
v_mfma_f32_16x16x32_bf16 v[140:143], a[216:219], a[184:187], v[140:143]
v_exp_f32 v61, v81
v_mfma_f32_16x16x32_bf16 v[140:143], a[220:223], a[188:191], v[140:143]
ds_read_b64 a[216:217], v22 offset:17024
buffer_load_dwordx4 v6, s[48:51], s67 offen offset:1040 lds
v_mfma_f32_16x16x32_bf16 v[136:139], a[220:223], a[172:175], v[136:139]
ds_read_b64 a[218:219], v22 offset:17056
s_waitcnt lgkmcnt(2)
v_mfma_f32_16x16x32_bf16 v[132:135], a[220:223], a[156:159], v[132:135]
v_exp_f32 v62, v82
v_mfma_f32_16x16x32_bf16 v[128:131], a[220:223], a[140:143], v[128:131]
v_exp_f32 v63, v83
v_mfma_f32_16x16x32_bf16 v[144:147], a[208:211], a[128:131], v[32:35]
ds_read_b64 a[220:221], v22 offset:17088
buffer_load_dwordx4 v7, s[48:51], s67 offen offset:2080 lds
v_mfma_f32_16x16x32_bf16 v[148:151], a[208:211], a[144:147], v[36:39]
ds_read_b64 a[222:223], v22 offset:17120
buffer_load_dwordx4 v8, s[48:51], s67 offen offset:3120 lds
v_mfma_f32_16x16x32_bf16 v[152:155], a[208:211], a[160:163], v[40:43]
v_exp_f32 v56, v68
v_mfma_f32_16x16x32_bf16 v[156:159], a[208:211], a[176:179], v[44:47]
v_exp_f32 v57, v69
v_mfma_f32_16x16x32_bf16 v[156:159], a[212:215], a[180:183], v[156:159]
ds_read_b64 a[208:209], v22 offset:17152
s_add_u32 s68, s68, 16384
s_sub_u32 s70, s72, s70
s_add_u32 m0, s70, 0
v_mfma_f32_16x16x32_bf16 v[152:155], a[212:215], a[164:167], v[152:155]
ds_read_b64 a[210:211], v22 offset:17184
s_waitcnt lgkmcnt(2)
v_mfma_f32_16x16x32_bf16 v[148:151], a[212:215], a[148:151], v[148:151]
v_cvt_pk_bf16_f32 v193, v58, v59
v_cvt_pk_bf16_f32 v194, v60, v61
v_mfma_f32_16x16x32_bf16 v[144:147], a[212:215], a[132:135], v[144:147]
v_exp_f32 v58, v70
v_mfma_f32_16x16x32_bf16 v[144:147], a[216:219], a[136:139], v[144:147]
ds_read_b64 a[212:213], v22 offset:17216
buffer_load_dwordx4 v9, s[52:55], s68 offen offset:0 lds
v_mfma_f32_16x16x32_bf16 v[148:151], a[216:219], a[152:155], v[148:151]
ds_read_b64 a[214:215], v22 offset:17248
buffer_load_dwordx4 v10, s[52:55], s68 offen offset:1056 lds
v_mfma_f32_16x16x32_bf16 v[152:155], a[216:219], a[168:171], v[152:155]
v_exp_f32 v59, v71
v_mfma_f32_16x16x32_bf16 v[156:159], a[216:219], a[184:187], v[156:159]
v_exp_f32 v60, v84
v_mfma_f32_16x16x32_bf16 v[156:159], a[220:223], a[188:191], v[156:159]
ds_read_b64 a[216:217], v22 offset:17280
buffer_load_dwordx4 v12, s[52:55], s68 offen offset:2112 lds
v_mfma_f32_16x16x32_bf16 v[152:155], a[220:223], a[172:175], v[152:155]
ds_read_b64 a[218:219], v22 offset:17312
s_waitcnt lgkmcnt(2)
v_mfma_f32_16x16x32_bf16 v[148:151], a[220:223], a[156:159], v[148:151]
v_exp_f32 v61, v85
v_mfma_f32_16x16x32_bf16 v[144:147], a[220:223], a[140:143], v[144:147]
v_cvt_pk_bf16_f32 v195, v62, v63
v_or_b32 v25, v192, v193
v_mfma_f32_16x16x32_bf16 v[160:163], a[208:211], a[128:131], v[32:35]
ds_read_b64 a[220:221], v22 offset:17344
buffer_load_dwordx4 v13, s[52:55], s68 offen offset:3168 lds
v_mfma_f32_16x16x32_bf16 v[164:167], a[208:211], a[144:147], v[36:39]
ds_read_b64 a[222:223], v22 offset:17376
s_add_u32 s60, s12, 0
s_addc_u32 s61, s13, 0
s_mov_b32 s62, 4194304
v_mfma_f32_16x16x32_bf16 v[168:171], a[208:211], a[160:163], v[40:43]
v_exp_f32 v62, v86
v_mfma_f32_16x16x32_bf16 v[172:175], a[208:211], a[176:179], v[44:47]
v_exp_f32 v63, v87
v_mfma_f32_16x16x32_bf16 v[172:175], a[212:215], a[180:183], v[172:175]
ds_read_b64 a[208:209], v22 offset:17408
buffer_load_dword v19, v18, s[60:63], s73 offen
v_mfma_f32_16x16x32_bf16 v[168:171], a[212:215], a[164:167], v[168:171]
ds_read_b64 a[210:211], v22 offset:17440
s_waitcnt lgkmcnt(2)
v_mfma_f32_16x16x32_bf16 v[164:167], a[212:215], a[148:151], v[164:167]
v_or3_b32 v25, v25, v194, v195
v_cvt_pk_bf16_f32 v196, v56, v57
v_mfma_f32_16x16x32_bf16 v[160:163], a[212:215], a[132:135], v[160:163]
v_exp_f32 v56, v72
v_mfma_f32_16x16x32_bf16 v[160:163], a[216:219], a[136:139], v[160:163]
ds_read_b64 a[212:213], v22 offset:17472
s_add_u32 s60, s12, 4194304
s_addc_u32 s61, s13, 0
s_mov_b32 s62, 4194304
v_mfma_f32_16x16x32_bf16 v[164:167], a[216:219], a[152:155], v[164:167]
ds_read_b64 a[214:215], v22 offset:17504
buffer_load_dword v19, v18, s[60:63], s73 offen
v_mfma_f32_16x16x32_bf16 v[168:171], a[216:219], a[168:171], v[168:171]
v_exp_f32 v57, v73
v_mfma_f32_16x16x32_bf16 v[172:175], a[216:219], a[184:187], v[172:175]
v_cvt_pk_bf16_f32 v197, v58, v59
v_cvt_pk_bf16_f32 v198, v60, v61
v_mfma_f32_16x16x32_bf16 v[172:175], a[220:223], a[188:191], v[172:175]
ds_read_b64 a[216:217], v22 offset:17536
s_mov_b32 s62, 3670016
v_mfma_f32_16x16x32_bf16 v[168:171], a[220:223], a[172:175], v[168:171]
ds_read_b64 a[218:219], v22 offset:17568
s_waitcnt lgkmcnt(2)
v_mfma_f32_16x16x32_bf16 v[164:167], a[220:223], a[156:159], v[164:167]
v_exp_f32 v58, v74
v_mfma_f32_16x16x32_bf16 v[160:163], a[220:223], a[140:143], v[160:163]
v_exp_f32 v59, v75
v_mfma_f32_16x16x32_bf16 v[176:179], a[208:211], a[128:131], v[32:35]
ds_read_b64 a[220:221], v22 offset:17600
s_nop 0
v_mfma_f32_16x16x32_bf16 v[180:183], a[208:211], a[144:147], v[36:39]
ds_read_b64 a[222:223], v22 offset:17632
v_cvt_pk_bf16_f32 v199, v62, v63
v_mfma_f32_16x16x32_bf16 v[184:187], a[208:211], a[160:163], v[40:43]
v_exp_f32 v60, v88
v_mfma_f32_16x16x32_bf16 v[188:191], a[208:211], a[176:179], v[44:47]
v_exp_f32 v61, v89
v_mfma_f32_16x16x32_bf16 v[188:191], a[212:215], a[180:183], v[188:191]
v_exp_f32 v62, v90
v_mfma_f32_16x16x32_bf16 v[184:187], a[212:215], a[164:167], v[184:187]
v_exp_f32 v63, v91
v_mfma_f32_16x16x32_bf16 v[180:183], a[212:215], a[148:151], v[180:183]
s_waitcnt lgkmcnt(0)
v_or3_b32 v25, v25, v196, v197
v_mfma_f32_16x16x32_bf16 v[176:179], a[212:215], a[132:135], v[176:179]
s_waitcnt vmcnt(14)
s_barrier
v_mfma_f32_16x16x32_bf16 v[176:179], a[216:219], a[136:139], v[176:179]
ds_read_b64 a[208:209], v21 offset:0
v_or3_b32 v25, v25, v198, v199
v_mfma_f32_16x16x32_bf16 v[180:183], a[216:219], a[152:155], v[180:183]
ds_read_b64 a[210:211], v21 offset:32
v_cvt_pk_bf16_f32 v200, v56, v57
v_mfma_f32_16x16x32_bf16 v[184:187], a[216:219], a[168:171], v[184:187]
ds_read_b64 a[212:213], v21 offset:64
v_cvt_pk_bf16_f32 v201, v58, v59
v_mfma_f32_16x16x32_bf16 v[188:191], a[216:219], a[184:187], v[188:191]
ds_read_b64 a[214:215], v21 offset:96
v_cvt_pk_bf16_f32 v202, v60, v61
v_mfma_f32_16x16x32_bf16 v[188:191], a[220:223], a[188:191], v[188:191]
ds_read_b64 a[216:217], v21 offset:128
v_cvt_pk_bf16_f32 v203, v62, v63
v_mfma_f32_16x16x32_bf16 v[184:187], a[220:223], a[172:175], v[184:187]
ds_read_b64 a[218:219], v21 offset:160
v_or3_b32 v25, v25, v200, v201
v_mfma_f32_16x16x32_bf16 v[180:183], a[220:223], a[156:159], v[180:183]
v_exp_f32 v56, v76
v_or3_b32 v25, v25, v202, v203
v_exp_f32 v57, v77
s_nop 0
v_cvt_pk_bf16_f32 v204, v56, v57
v_exp_f32 v58, v78
v_exp_f32 v59, v79
s_nop 0
v_cvt_pk_bf16_f32 v205, v58, v59
v_exp_f32 v60, v92
v_exp_f32 v61, v93
s_nop 0
v_cvt_pk_bf16_f32 v206, v60, v61
v_exp_f32 v62, v94
v_exp_f32 v63, v95
s_nop 0
v_cvt_pk_bf16_f32 v207, v62, v63
v_or3_b32 v25, v25, v204, v205
v_or3_b32 v25, v25, v206, v207
v_exp_f32 v56, v96
v_exp_f32 v57, v97
s_nop 0
v_cvt_pk_bf16_f32 v208, v56, v57
v_exp_f32 v58, v98
v_exp_f32 v59, v99
s_nop 0
v_cvt_pk_bf16_f32 v209, v58, v59
v_exp_f32 v60, v112
v_exp_f32 v61, v113
s_nop 0
v_cvt_pk_bf16_f32 v210, v60, v61
v_exp_f32 v62, v114
v_exp_f32 v63, v115
s_nop 0
v_cvt_pk_bf16_f32 v211, v62, v63
v_or3_b32 v25, v25, v208, v209
v_or3_b32 v25, v25, v210, v211
v_exp_f32 v56, v100
v_exp_f32 v57, v101
s_nop 0
v_cvt_pk_bf16_f32 v212, v56, v57
v_exp_f32 v58, v102
v_exp_f32 v59, v103
s_nop 0
v_cvt_pk_bf16_f32 v213, v58, v59
v_exp_f32 v60, v116
v_exp_f32 v61, v117
s_nop 0
v_cvt_pk_bf16_f32 v214, v60, v61
v_exp_f32 v62, v118
v_exp_f32 v63, v119
s_nop 0
v_cvt_pk_bf16_f32 v215, v62, v63
v_or3_b32 v25, v25, v212, v213
v_or3_b32 v25, v25, v214, v215
v_exp_f32 v56, v104
v_exp_f32 v57, v105
s_nop 0
v_cvt_pk_bf16_f32 v216, v56, v57
v_exp_f32 v58, v106
v_exp_f32 v59, v107
s_nop 0
v_cvt_pk_bf16_f32 v217, v58, v59
v_exp_f32 v60, v120
v_exp_f32 v61, v121
s_nop 0
v_cvt_pk_bf16_f32 v218, v60, v61
v_exp_f32 v62, v122
v_exp_f32 v63, v123
s_nop 0
v_cvt_pk_bf16_f32 v219, v62, v63
v_or3_b32 v25, v25, v216, v217
v_or3_b32 v25, v25, v218, v219
v_exp_f32 v56, v108
v_exp_f32 v57, v109
s_nop 0
v_cvt_pk_bf16_f32 v220, v56, v57
v_exp_f32 v58, v110
v_exp_f32 v59, v111
s_nop 0
v_cvt_pk_bf16_f32 v221, v58, v59
v_exp_f32 v60, v124
v_exp_f32 v61, v125
s_nop 0
v_cvt_pk_bf16_f32 v222, v60, v61
v_exp_f32 v62, v126
v_exp_f32 v63, v127
s_nop 0
v_cvt_pk_bf16_f32 v223, v62, v63
v_or3_b32 v25, v25, v220, v221
v_or3_b32 v25, v25, v222, v223
v_mfma_f32_16x16x32_bf16 v[176:179], a[220:223], a[140:143], v[176:179]
v_and_b32 v52, 0x40004000, v25
v_cmp_ne_u32 vcc, 0, v52
s_nop 4
s_cbranch_vccz L_backp_main_kernel
s_call_b64 s[36:37], L_rare0_main_kernel
L_backp_main_kernel:
s_mov_b32 s29, 3
L_loop_attn:
s_waitcnt lgkmcnt(2)
v_mfma_f32_16x16x32_bf16 v[64:67], a[208:211], a[128:131], v[32:35]
ds_read_b64 a[220:221], v21 offset:192
v_mfma_f32_16x16x32_bf16 v[68:71], a[208:211], a[144:147], v[36:39]
ds_read_b64 a[222:223], v21 offset:224
v_mfma_f32_16x16x32_bf16 v[72:75], a[208:211], a[160:163], v[40:43]
v_exp_f32 v56, v128
v_mfma_f32_16x16x32_bf16 v[76:79], a[208:211], a[176:179], v[44:47]
v_exp_f32 v57, v129
v_mfma_f32_16x16x32_bf16 v[76:79], a[212:215], a[180:183], v[76:79]
ds_read_b64 a[208:209], v21 offset:256
v_cvt_pk_bf16_f32 v224, v56, v57
v_mfma_f32_16x16x32_bf16 v[72:75], a[212:215], a[164:167], v[72:75]
ds_read_b64 a[210:211], v21 offset:288
s_waitcnt lgkmcnt(2)
v_mfma_f32_16x16x32_bf16 v[68:71], a[212:215], a[148:151], v[68:71]
v_exp_f32 v58, v130
v_mfma_f32_16x16x32_bf16 v[64:67], a[212:215], a[132:135], v[64:67]
v_exp_f32 v59, v131
v_mfma_f32_16x16x32_bf16 v[64:67], a[216:219], a[136:139], v[64:67]
ds_read_b64 a[212:213], v21 offset:320
s_add_u32 s67, s67, 16384
s_add_u32 m0, s69, 16640
v_mfma_f32_16x16x32_bf16 v[68:71], a[216:219], a[152:155], v[68:71]
ds_read_b64 a[214:215], v21 offset:352
buffer_load_dwordx4 v5, s[48:51], s67 offen offset:0 lds
v_mfma_f32_16x16x32_bf16 v[72:75], a[216:219], a[168:171], v[72:75]
v_exp_f32 v60, v144
v_mfma_f32_16x16x32_bf16 v[76:79], a[216:219], a[184:187], v[76:79]
v_exp_f32 v61, v145
v_mfma_f32_16x16x32_bf16 v[76:79], a[220:223], a[188:191], v[76:79]
ds_read_b64 a[216:217], v21 offset:384
v_cvt_pk_bf16_f32 v225, v58, v59
v_mfma_f32_16x16x32_bf16 v[72:75], a[220:223], a[172:175], v[72:75]
ds_read_b64 a[218:219], v21 offset:416
s_waitcnt lgkmcnt(2)
v_mfma_f32_16x16x32_bf16 v[68:71], a[220:223], a[156:159], v[68:71]
v_exp_f32 v62, v146
v_mfma_f32_16x16x32_bf16 v[64:67], a[220:223], a[140:143], v[64:67]
v_exp_f32 v63, v147
v_mfma_f32_16x16x32_bf16 v[80:83], a[208:211], a[128:131], v[32:35]
ds_read_b64 a[220:221], v21 offset:448
v_cvt_pk_bf16_f32 v226, v60, v61
v_mfma_f32_16x16x32_bf16 v[84:87], a[208:211], a[144:147], v[36:39]
ds_read_b64 a[222:223], v21 offset:480
buffer_load_dwordx4 v6, s[48:51], s67 offen offset:1040 lds
v_mfma_f32_16x16x32_bf16 v[88:91], a[208:211], a[160:163], v[40:43]
v_exp_f32 v56, v132
v_mfma_f32_16x16x32_bf16 v[92:95], a[208:211], a[176:179], v[44:47]
v_exp_f32 v57, v133
v_mfma_f32_16x16x32_bf16 v[92:95], a[212:215], a[180:183], v[92:95]
ds_read_b64 a[208:209], v21 offset:512
v_cvt_pk_bf16_f32 v227, v62, v63
v_mfma_f32_16x16x32_bf16 v[88:91], a[212:215], a[164:167], v[88:91]
ds_read_b64 a[210:211], v21 offset:544
s_waitcnt lgkmcnt(2)
v_mfma_f32_16x16x32_bf16 v[84:87], a[212:215], a[148:151], v[84:87]
v_exp_f32 v58, v134
v_mfma_f32_16x16x32_bf16 v[80:83], a[212:215], a[132:135], v[80:83]
v_exp_f32 v59, v135
v_mfma_f32_16x16x32_bf16 v[80:83], a[216:219], a[136:139], v[80:83]
ds_read_b64 a[212:213], v21 offset:576
v_or_b32 v25, v224, v225
v_mfma_f32_16x16x32_bf16 v[84:87], a[216:219], a[152:155], v[84:87]
ds_read_b64 a[214:215], v21 offset:608
v_or3_b32 v25, v25, v226, v227
v_mfma_f32_16x16x32_bf16 v[88:91], a[216:219], a[168:171], v[88:91]
v_exp_f32 v60, v148
v_mfma_f32_16x16x32_bf16 v[92:95], a[216:219], a[184:187], v[92:95]
v_exp_f32 v61, v149
v_mfma_f32_16x16x32_bf16 v[92:95], a[220:223], a[188:191], v[92:95]
ds_read_b64 a[216:217], v21 offset:640
buffer_load_dwordx4 v7, s[48:51], s67 offen offset:2080 lds
v_mfma_f32_16x16x32_bf16 v[88:91], a[220:223], a[172:175], v[88:91]
ds_read_b64 a[218:219], v21 offset:672
s_waitcnt lgkmcnt(2)
v_mfma_f32_16x16x32_bf16 v[84:87], a[220:223], a[156:159], v[84:87]
v_exp_f32 v62, v150
v_mfma_f32_16x16x32_bf16 v[80:83], a[220:223], a[140:143], v[80:83]
v_exp_f32 v63, v151
v_mfma_f32_16x16x32_bf16 v[96:99], a[208:211], a[128:131], v[32:35]
ds_read_b64 a[220:221], v21 offset:704
v_cvt_pk_bf16_f32 v228, v56, v57
v_mfma_f32_16x16x32_bf16 v[100:103], a[208:211], a[144:147], v[36:39]
ds_read_b64 a[222:223], v21 offset:736
v_cvt_pk_bf16_f32 v229, v58, v59
v_mfma_f32_16x16x32_bf16 v[104:107], a[208:211], a[160:163], v[40:43]
v_exp_f32 v56, v136
v_mfma_f32_16x16x32_bf16 v[108:111], a[208:211], a[176:179], v[44:47]
v_exp_f32 v57, v137
v_mfma_f32_16x16x32_bf16 v[108:111], a[212:215], a[180:183], v[108:111]
ds_read_b64 a[208:209], v21 offset:768
v_cvt_pk_bf16_f32 v230, v60, v61
v_mfma_f32_16x16x32_bf16 v[104:107], a[212:215], a[164:167], v[104:107]
ds_read_b64 a[210:211], v21 offset:800
s_waitcnt lgkmcnt(2)
v_mfma_f32_16x16x32_bf16 v[100:103], a[212:215], a[148:151], v[100:103]
v_exp_f32 v58, v138
v_mfma_f32_16x16x32_bf16 v[96:99], a[212:215], a[132:135], v[96:99]
v_exp_f32 v59, v139
v_mfma_f32_16x16x32_bf16 v[96:99], a[216:219], a[136:139], v[96:99]
ds_read_b64 a[212:213], v21 offset:832
buffer_load_dwordx4 v8, s[48:51], s67 offen offset:3120 lds
v_mfma_f32_16x16x32_bf16 v[100:103], a[216:219], a[152:155], v[100:103]
ds_read_b64 a[214:215], v21 offset:864
v_cvt_pk_bf16_f32 v231, v62, v63
v_mfma_f32_16x16x32_bf16 v[104:107], a[216:219], a[168:171], v[104:107]
v_exp_f32 v60, v152
v_mfma_f32_16x16x32_bf16 v[108:111], a[216:219], a[184:187], v[108:111]
v_exp_f32 v61, v153
v_mfma_f32_16x16x32_bf16 v[108:111], a[220:223], a[188:191], v[108:111]
ds_read_b64 a[216:217], v21 offset:896
v_or3_b32 v25, v25, v228, v229
v_mfma_f32_16x16x32_bf16 v[104:107], a[220:223], a[172:175], v[104:107]
ds_read_b64 a[218:219], v21 offset:928
s_waitcnt lgkmcnt(2)
v_mfma_f32_16x16x32_bf16 v[100:103], a[220:223], a[156:159], v[100:103]
v_exp_f32 v62, v154
v_mfma_f32_16x16x32_bf16 v[96:99], a[220:223], a[140:143], v[96:99]
v_exp_f32 v63, v155
v_mfma_f32_16x16x32_bf16 v[112:115], a[208:211], a[128:131], v[32:35]
ds_read_b64 a[220:221], v21 offset:960
v_or3_b32 v25, v25, v230, v231
v_mfma_f32_16x16x32_bf16 v[116:119], a[208:211], a[144:147], v[36:39]
ds_read_b64 a[222:223], v21 offset:992
v_cvt_pk_bf16_f32 v232, v56, v57
v_mfma_f32_16x16x32_bf16 v[120:123], a[208:211], a[160:163], v[40:43]
v_exp_f32 v56, v140
v_mfma_f32_16x16x32_bf16 v[124:127], a[208:211], a[176:179], v[44:47]
v_exp_f32 v57, v141
v_mfma_f32_16x16x32_bf16 v[124:127], a[212:215], a[180:183], v[124:127]
ds_read_b64_tr_b16 a[224:225], v23 offset:0
s_add_u32 s68, s68, 16384
s_add_u32 m0, s70, 16896
v_mfma_f32_16x16x32_bf16 v[120:123], a[212:215], a[164:167], v[120:123]
ds_read_b64_tr_b16 a[226:227], v23 offset:256
buffer_load_dwordx4 v9, s[52:55], s68 offen offset:0 lds
v_mfma_f32_16x16x32_bf16 v[116:119], a[212:215], a[148:151], v[116:119]
ds_read_b64_tr_b16 a[228:229], v23 offset:32
v_cvt_pk_bf16_f32 v233, v58, v59
v_mfma_f32_16x16x32_bf16 v[112:115], a[212:215], a[132:135], v[112:115]
ds_read_b64_tr_b16 a[230:231], v23 offset:288
s_waitcnt lgkmcnt(4)
v_mfma_f32_16x16x32_bf16 v[112:115], a[216:219], a[136:139], v[112:115]
ds_read_b64_tr_b16 a[232:233], v23 offset:64
v_cvt_pk_bf16_f32 v234, v60, v61
v_mfma_f32_16x16x32_bf16 v[116:119], a[216:219], a[152:155], v[116:119]
ds_read_b64_tr_b16 a[234:235], v23 offset:320
v_cvt_pk_bf16_f32 v235, v62, v63
v_mfma_f32_16x16x32_bf16 v[120:123], a[216:219], a[168:171], v[120:123]
ds_read_b64_tr_b16 a[236:237], v23 offset:96
v_or3_b32 v25, v25, v232, v233
v_mfma_f32_16x16x32_bf16 v[124:127], a[216:219], a[184:187], v[124:127]
ds_read_b64_tr_b16 a[238:239], v23 offset:352
v_or3_b32 v25, v25, v234, v235
v_mfma_f32_16x16x32_bf16 v[124:127], a[220:223], a[188:191], v[124:127]
ds_read_b64_tr_b16 a[240:241], v23 offset:128
v_cvt_pk_bf16_f32 v236, v56, v57
v_mfma_f32_16x16x32_bf16 v[120:123], a[220:223], a[172:175], v[120:123]
ds_read_b64_tr_b16 a[242:243], v23 offset:384
buffer_load_dwordx4 v10, s[52:55], s68 offen offset:1056 lds
v_mfma_f32_16x16x32_bf16 v[116:119], a[220:223], a[156:159], v[116:119]
ds_read_b64_tr_b16 a[244:245], v23 offset:160
v_mfma_f32_16x16x32_bf16 v[112:115], a[220:223], a[140:143], v[112:115]
ds_read_b64_tr_b16 a[246:247], v23 offset:416
s_waitcnt lgkmcnt(4)
v_mfma_f32_16x16x32_bf16 a[0:3], a[224:227], v[192:195], a[0:3]
ds_read_b64_tr_b16 a[248:249], v23 offset:192
v_mfma_f32_16x16x32_bf16 a[4:7], a[224:227], v[196:199], a[4:7]
ds_read_b64_tr_b16 a[250:251], v23 offset:448
v_mfma_f32_16x16x32_bf16 a[8:11], a[224:227], v[200:203], a[8:11]
v_exp_f32 v58, v142
v_mfma_f32_16x16x32_bf16 a[12:15], a[224:227], v[204:207], a[12:15]
v_exp_f32 v59, v143
v_mfma_f32_16x16x32_bf16 a[28:31], a[228:231], v[204:207], a[28:31]
ds_read_b64_tr_b16 a[252:253], v23 offset:224
v_cvt_pk_bf16_f32 v237, v58, v59
v_mfma_f32_16x16x32_bf16 a[24:27], a[228:231], v[200:203], a[24:27]
ds_read_b64_tr_b16 a[254:255], v23 offset:480
v_or3_b32 v25, v25, v236, v237
v_mfma_f32_16x16x32_bf16 a[20:23], a[228:231], v[196:199], a[20:23]
v_exp_f32 v60, v156
v_mfma_f32_16x16x32_bf16 a[16:19], a[228:231], v[192:195], a[16:19]
v_exp_f32 v61, v157
v_mfma_f32_16x16x32_bf16 a[32:35], a[232:235], v[192:195], a[32:35]
ds_read_b64_tr_b16 a[224:225], v23 offset:512
buffer_load_dwordx4 v12, s[52:55], s68 offen offset:2112 lds
v_mfma_f32_16x16x32_bf16 a[36:39], a[232:235], v[196:199], a[36:39]
ds_read_b64_tr_b16 a[226:227], v23 offset:768
v_cvt_pk_bf16_f32 v238, v60, v61
v_mfma_f32_16x16x32_bf16 a[40:43], a[232:235], v[200:203], a[40:43]
v_exp_f32 v62, v158
v_mfma_f32_16x16x32_bf16 a[44:47], a[232:235], v[204:207], a[44:47]
v_exp_f32 v63, v159
v_mfma_f32_16x16x32_bf16 a[60:63], a[236:239], v[204:207], a[60:63]
ds_read_b64_tr_b16 a[228:229], v23 offset:544
v_cvt_pk_bf16_f32 v239, v62, v63
v_mfma_f32_16x16x32_bf16 a[56:59], a[236:239], v[200:203], a[56:59]
ds_read_b64_tr_b16 a[230:231], v23 offset:800
s_waitcnt lgkmcnt(4)
v_mfma_f32_16x16x32_bf16 a[52:55], a[236:239], v[196:199], a[52:55]
v_exp_f32 v56, v160
v_mfma_f32_16x16x32_bf16 a[48:51], a[236:239], v[192:195], a[48:51]
v_exp_f32 v57, v161
v_mfma_f32_16x16x32_bf16 a[64:67], a[240:243], v[192:195], a[64:67]
ds_read_b64_tr_b16 a[232:233], v23 offset:576
v_or3_b32 v25, v25, v238, v239
v_mfma_f32_16x16x32_bf16 a[68:71], a[240:243], v[196:199], a[68:71]
ds_read_b64_tr_b16 a[234:235], v23 offset:832
v_cvt_pk_bf16_f32 v240, v56, v57
v_mfma_f32_16x16x32_bf16 a[72:75], a[240:243], v[200:203], a[72:75]
v_exp_f32 v58, v162
v_mfma_f32_16x16x32_bf16 a[76:79], a[240:243], v[204:207], a[76:79]
v_exp_f32 v59, v163
v_mfma_f32_16x16x32_bf16 a[92:95], a[244:247], v[204:207], a[92:95]
ds_read_b64_tr_b16 a[236:237], v23 offset:608
buffer_load_dwordx4 v13, s[52:55], s68 offen offset:3168 lds
v_mfma_f32_16x16x32_bf16 a[88:91], a[244:247], v[200:203], a[88:91]
ds_read_b64_tr_b16 a[238:239], v23 offset:864
v_cvt_pk_bf16_f32 v241, v58, v59
v_mfma_f32_16x16x32_bf16 a[84:87], a[244:247], v[196:199], a[84:87]
v_exp_f32 v60, v176
v_mfma_f32_16x16x32_bf16 a[80:83], a[244:247], v[192:195], a[80:83]
v_exp_f32 v61, v177
v_mfma_f32_16x16x32_bf16 a[96:99], a[248:251], v[192:195], a[96:99]
ds_read_b64_tr_b16 a[240:241], v23 offset:640
v_cvt_pk_bf16_f32 v242, v60, v61
v_mfma_f32_16x16x32_bf16 a[100:103], a[248:251], v[196:199], a[100:103]
ds_read_b64_tr_b16 a[242:243], v23 offset:896
v_or3_b32 v25, v25, v240, v241
v_mfma_f32_16x16x32_bf16 a[104:107], a[248:251], v[200:203], a[104:107]
v_exp_f32 v62, v178
v_mfma_f32_16x16x32_bf16 a[108:111], a[248:251], v[204:207], a[108:111]
v_exp_f32 v63, v179
v_mfma_f32_16x16x32_bf16 a[124:127], a[252:255], v[204:207], a[124:127]
ds_read_b64_tr_b16 a[244:245], v23 offset:672
v_cvt_pk_bf16_f32 v243, v62, v63
v_mfma_f32_16x16x32_bf16 a[120:123], a[252:255], v[200:203], a[120:123]
ds_read_b64_tr_b16 a[246:247], v23 offset:928
v_or3_b32 v25, v25, v242, v243
v_mfma_f32_16x16x32_bf16 a[116:119], a[252:255], v[196:199], a[116:119]
v_exp_f32 v56, v164
v_mfma_f32_16x16x32_bf16 a[112:115], a[252:255], v[192:195], a[112:115]
v_exp_f32 v57, v165
v_mfma_f32_16x16x32_bf16 a[192:195], v[48:51], v[192:195], a[192:195]
v_exp_f32 v58, v166
v_mfma_f32_16x16x32_bf16 a[196:199], v[48:51], v[196:199], a[196:199]
v_exp_f32 v59, v167
v_mfma_f32_16x16x32_bf16 a[200:203], v[48:51], v[200:203], a[200:203]
v_exp_f32 v60, v180
v_mfma_f32_16x16x32_bf16 a[204:207], v[48:51], v[204:207], a[204:207]
s_waitcnt lgkmcnt(4)
s_mov_b64 s[60:61], s[84:85]
v_mfma_f32_16x16x32_bf16 a[0:3], a[224:227], v[208:211], a[0:3]
ds_read_b64_tr_b16 a[248:249], v23 offset:704
buffer_load_dword v19, v18, s[60:63], s73 offen
v_mfma_f32_16x16x32_bf16 a[4:7], a[224:227], v[212:215], a[4:7]
ds_read_b64_tr_b16 a[250:251], v23 offset:960
v_cvt_pk_bf16_f32 v244, v56, v57
v_mfma_f32_16x16x32_bf16 a[8:11], a[224:227], v[216:219], a[8:11]
v_exp_f32 v61, v181
v_mfma_f32_16x16x32_bf16 a[12:15], a[224:227], v[220:223], a[12:15]
v_exp_f32 v62, v182
v_mfma_f32_16x16x32_bf16 a[28:31], a[228:231], v[220:223], a[28:31]
ds_read_b64_tr_b16 a[252:253], v23 offset:736
v_cvt_pk_bf16_f32 v245, v58, v59
v_mfma_f32_16x16x32_bf16 a[24:27], a[228:231], v[216:219], a[24:27]
ds_read_b64_tr_b16 a[254:255], v23 offset:992
v_cvt_pk_bf16_f32 v246, v60, v61
v_mfma_f32_16x16x32_bf16 a[20:23], a[228:231], v[212:215], a[20:23]
v_exp_f32 v63, v183
v_mfma_f32_16x16x32_bf16 a[16:19], a[228:231], v[208:211], a[16:19]
v_exp_f32 v56, v168
v_mfma_f32_16x16x32_bf16 a[32:35], a[232:235], v[208:211], a[32:35]
v_exp_f32 v57, v169
v_mfma_f32_16x16x32_bf16 a[36:39], a[232:235], v[212:215], a[36:39]
v_exp_f32 v58, v170
v_mfma_f32_16x16x32_bf16 a[40:43], a[232:235], v[216:219], a[40:43]
v_exp_f32 v59, v171
v_mfma_f32_16x16x32_bf16 a[44:47], a[232:235], v[220:223], a[44:47]
v_exp_f32 v60, v184
v_mfma_f32_16x16x32_bf16 a[60:63], a[236:239], v[220:223], a[60:63]
v_exp_f32 v61, v185
v_mfma_f32_16x16x32_bf16 a[56:59], a[236:239], v[216:219], a[56:59]
v_cvt_pk_bf16_f32 v247, v62, v63
v_or3_b32 v25, v25, v244, v245
v_mfma_f32_16x16x32_bf16 a[52:55], a[236:239], v[212:215], a[52:55]
v_exp_f32 v62, v186
v_mfma_f32_16x16x32_bf16 a[48:51], a[236:239], v[208:211], a[48:51]
s_waitcnt lgkmcnt(0)
v_or3_b32 v25, v25, v246, v247
v_mfma_f32_16x16x32_bf16 a[64:67], a[240:243], v[208:211], a[64:67]
v_exp_f32 v63, v187
v_mfma_f32_16x16x32_bf16 a[68:71], a[240:243], v[212:215], a[68:71]
v_cvt_pk_bf16_f32 v248, v56, v57
v_cvt_pk_bf16_f32 v249, v58, v59
v_mfma_f32_16x16x32_bf16 a[72:75], a[240:243], v[216:219], a[72:75]
v_exp_f32 v56, v172
v_mfma_f32_16x16x32_bf16 a[76:79], a[240:243], v[220:223], a[76:79]
v_exp_f32 v57, v173
v_mfma_f32_16x16x32_bf16 a[92:95], a[244:247], v[220:223], a[92:95]
v_exp_f32 v58, v174
v_mfma_f32_16x16x32_bf16 a[88:91], a[244:247], v[216:219], a[88:91]
v_exp_f32 v59, v175
v_mfma_f32_16x16x32_bf16 a[84:87], a[244:247], v[212:215], a[84:87]
v_cvt_pk_bf16_f32 v250, v60, v61
v_cvt_pk_bf16_f32 v251, v62, v63
v_mfma_f32_16x16x32_bf16 a[80:83], a[244:247], v[208:211], a[80:83]
v_exp_f32 v60, v188
v_mfma_f32_16x16x32_bf16 a[96:99], a[248:251], v[208:211], a[96:99]
v_exp_f32 v61, v189
v_mfma_f32_16x16x32_bf16 a[100:103], a[248:251], v[212:215], a[100:103]
v_exp_f32 v62, v190
v_mfma_f32_16x16x32_bf16 a[104:107], a[248:251], v[216:219], a[104:107]
v_exp_f32 v63, v191
v_mfma_f32_16x16x32_bf16 a[108:111], a[248:251], v[220:223], a[108:111]
s_waitcnt vmcnt(19)
s_barrier
v_mfma_f32_16x16x32_bf16 a[124:127], a[252:255], v[220:223], a[124:127]
ds_read_b64 a[208:209], v21 offset:16640
v_or3_b32 v25, v25, v248, v249
v_mfma_f32_16x16x32_bf16 a[120:123], a[252:255], v[216:219], a[120:123]
ds_read_b64 a[210:211], v21 offset:16672
v_or3_b32 v25, v25, v250, v251
v_mfma_f32_16x16x32_bf16 a[116:119], a[252:255], v[212:215], a[116:119]
ds_read_b64 a[212:213], v21 offset:16704
v_cvt_pk_bf16_f32 v252, v56, v57
v_mfma_f32_16x16x32_bf16 a[112:115], a[252:255], v[208:211], a[112:115]
ds_read_b64 a[214:215], v21 offset:16736
v_cvt_pk_bf16_f32 v253, v58, v59
v_mfma_f32_16x16x32_bf16 a[192:195], v[48:51], v[208:211], a[192:195]
ds_read_b64 a[216:217], v21 offset:16768
v_cvt_pk_bf16_f32 v254, v60, v61
v_mfma_f32_16x16x32_bf16 a[196:199], v[48:51], v[212:215], a[196:199]
ds_read_b64 a[218:219], v21 offset:16800
v_cvt_pk_bf16_f32 v255, v62, v63
v_mfma_f32_16x16x32_bf16 a[200:203], v[48:51], v[216:219], a[200:203]
v_or3_b32 v25, v25, v252, v253
v_or3_b32 v25, v25, v254, v255
v_mfma_f32_16x16x32_bf16 a[204:207], v[48:51], v[220:223], a[204:207]
v_and_b32 v52, 0x40004000, v25
v_cmp_ne_u32 vcc, 0, v52
s_nop 4
s_cbranch_vccz L_backa_main_kernel
s_call_b64 s[36:37], L_rare1_main_kernel
L_backa_main_kernel:
s_waitcnt lgkmcnt(2)
v_mfma_f32_16x16x32_bf16 v[128:131], a[208:211], a[128:131], v[32:35]
ds_read_b64 a[220:221], v21 offset:16832
v_mfma_f32_16x16x32_bf16 v[132:135], a[208:211], a[144:147], v[36:39]
ds_read_b64 a[222:223], v21 offset:16864
v_mfma_f32_16x16x32_bf16 v[136:139], a[208:211], a[160:163], v[40:43]
v_exp_f32 v56, v64
v_mfma_f32_16x16x32_bf16 v[140:143], a[208:211], a[176:179], v[44:47]
v_exp_f32 v57, v65
v_mfma_f32_16x16x32_bf16 v[140:143], a[212:215], a[180:183], v[140:143]
ds_read_b64 a[208:209], v21 offset:16896
v_cvt_pk_bf16_f32 v192, v56, v57
v_mfma_f32_16x16x32_bf16 v[136:139], a[212:215], a[164:167], v[136:139]
ds_read_b64 a[210:211], v21 offset:16928
s_waitcnt lgkmcnt(2)
v_mfma_f32_16x16x32_bf16 v[132:135], a[212:215], a[148:151], v[132:135]
v_exp_f32 v58, v66
v_mfma_f32_16x16x32_bf16 v[128:131], a[212:215], a[132:135], v[128:131]
v_exp_f32 v59, v67
v_mfma_f32_16x16x32_bf16 v[128:131], a[216:219], a[136:139], v[128:131]
ds_read_b64 a[212:213], v21 offset:16960
s_add_u32 s67, s67, 16384
s_sub_u32 s69, s71, s69
s_add_u32 m0, s69, 0
v_mfma_f32_16x16x32_bf16 v[132:135], a[216:219], a[152:155], v[132:135]
ds_read_b64 a[214:215], v21 offset:16992
buffer_load_dwordx4 v5, s[48:51], s67 offen offset:0 lds
v_mfma_f32_16x16x32_bf16 v[136:139], a[216:219], a[168:171], v[136:139]
v_exp_f32 v60, v80
v_mfma_f32_16x16x32_bf16 v[140:143], a[216:219], a[184:187], v[140:143]
v_exp_f32 v61, v81
v_mfma_f32_16x16x32_bf16 v[140:143], a[220:223], a[188:191], v[140:143]
ds_read_b64 a[216:217], v21 offset:17024
v_cvt_pk_bf16_f32 v193, v58, v59
v_mfma_f32_16x16x32_bf16 v[136:139], a[220:223], a[172:175], v[136:139]
ds_read_b64 a[218:219], v21 offset:17056
s_waitcnt lgkmcnt(2)
v_mfma_f32_16x16x32_bf16 v[132:135], a[220:223], a[156:159], v[132:135]
v_exp_f32 v62, v82
v_mfma_f32_16x16x32_bf16 v[128:131], a[220:223], a[140:143], v[128:131]
v_exp_f32 v63, v83
v_mfma_f32_16x16x32_bf16 v[144:147], a[208:211], a[128:131], v[32:35]
ds_read_b64 a[220:221], v21 offset:17088
v_cvt_pk_bf16_f32 v194, v60, v61
v_mfma_f32_16x16x32_bf16 v[148:151], a[208:211], a[144:147], v[36:39]
ds_read_b64 a[222:223], v21 offset:17120
buffer_load_dwordx4 v6, s[48:51], s67 offen offset:1040 lds
v_mfma_f32_16x16x32_bf16 v[152:155], a[208:211], a[160:163], v[40:43]
v_exp_f32 v56, v68
v_mfma_f32_16x16x32_bf16 v[156:159], a[208:211], a[176:179], v[44:47]
v_exp_f32 v57, v69
v_mfma_f32_16x16x32_bf16 v[156:159], a[212:215], a[180:183], v[156:159]
ds_read_b64 a[208:209], v21 offset:17152
v_cvt_pk_bf16_f32 v195, v62, v63
v_mfma_f32_16x16x32_bf16 v[152:155], a[212:215], a[164:167], v[152:155]
ds_read_b64 a[210:211], v21 offset:17184
s_waitcnt lgkmcnt(2)
v_mfma_f32_16x16x32_bf16 v[148:151], a[212:215], a[148:151], v[148:151]
v_exp_f32 v58, v70
v_mfma_f32_16x16x32_bf16 v[144:147], a[212:215], a[132:135], v[144:147]
v_exp_f32 v59, v71
v_mfma_f32_16x16x32_bf16 v[144:147], a[216:219], a[136:139], v[144:147]
ds_read_b64 a[212:213], v21 offset:17216
v_or_b32 v25, v192, v193
v_mfma_f32_16x16x32_bf16 v[148:151], a[216:219], a[152:155], v[148:151]
ds_read_b64 a[214:215], v21 offset:17248
v_or3_b32 v25, v25, v194, v195
v_mfma_f32_16x16x32_bf16 v[152:155], a[216:219], a[168:171], v[152:155]
v_exp_f32 v60, v84
v_mfma_f32_16x16x32_bf16 v[156:159], a[216:219], a[184:187], v[156:159]
v_exp_f32 v61, v85
v_mfma_f32_16x16x32_bf16 v[156:159], a[220:223], a[188:191], v[156:159]
ds_read_b64 a[216:217], v21 offset:17280
buffer_load_dwordx4 v7, s[48:51], s67 offen offset:2080 lds
v_mfma_f32_16x16x32_bf16 v[152:155], a[220:223], a[172:175], v[152:155]
ds_read_b64 a[218:219], v21 offset:17312
s_waitcnt lgkmcnt(2)
v_mfma_f32_16x16x32_bf16 v[148:151], a[220:223], a[156:159], v[148:151]
v_exp_f32 v62, v86
v_mfma_f32_16x16x32_bf16 v[144:147], a[220:223], a[140:143], v[144:147]
v_exp_f32 v63, v87
v_mfma_f32_16x16x32_bf16 v[160:163], a[208:211], a[128:131], v[32:35]
ds_read_b64 a[220:221], v21 offset:17344
v_cvt_pk_bf16_f32 v196, v56, v57
v_mfma_f32_16x16x32_bf16 v[164:167], a[208:211], a[144:147], v[36:39]
ds_read_b64 a[222:223], v21 offset:17376
v_cvt_pk_bf16_f32 v197, v58, v59
v_mfma_f32_16x16x32_bf16 v[168:171], a[208:211], a[160:163], v[40:43]
v_exp_f32 v56, v72
v_mfma_f32_16x16x32_bf16 v[172:175], a[208:211], a[176:179], v[44:47]
v_exp_f32 v57, v73
v_mfma_f32_16x16x32_bf16 v[172:175], a[212:215], a[180:183], v[172:175]
ds_read_b64 a[208:209], v21 offset:17408
v_cvt_pk_bf16_f32 v198, v60, v61
v_mfma_f32_16x16x32_bf16 v[168:171], a[212:215], a[164:167], v[168:171]
ds_read_b64 a[210:211], v21 offset:17440
s_waitcnt lgkmcnt(2)
v_mfma_f32_16x16x32_bf16 v[164:167], a[212:215], a[148:151], v[164:167]
v_exp_f32 v58, v74
v_mfma_f32_16x16x32_bf16 v[160:163], a[212:215], a[132:135], v[160:163]
v_exp_f32 v59, v75
v_mfma_f32_16x16x32_bf16 v[160:163], a[216:219], a[136:139], v[160:163]
ds_read_b64 a[212:213], v21 offset:17472
buffer_load_dwordx4 v8, s[48:51], s67 offen offset:3120 lds
v_mfma_f32_16x16x32_bf16 v[164:167], a[216:219], a[152:155], v[164:167]
ds_read_b64 a[214:215], v21 offset:17504
v_cvt_pk_bf16_f32 v199, v62, v63
v_mfma_f32_16x16x32_bf16 v[168:171], a[216:219], a[168:171], v[168:171]
v_exp_f32 v60, v88
v_mfma_f32_16x16x32_bf16 v[172:175], a[216:219], a[184:187], v[172:175]
v_exp_f32 v61, v89
v_mfma_f32_16x16x32_bf16 v[172:175], a[220:223], a[188:191], v[172:175]
ds_read_b64 a[216:217], v21 offset:17536
v_or3_b32 v25, v25, v196, v197
v_mfma_f32_16x16x32_bf16 v[168:171], a[220:223], a[172:175], v[168:171]
ds_read_b64 a[218:219], v21 offset:17568
s_waitcnt lgkmcnt(2)
v_mfma_f32_16x16x32_bf16 v[164:167], a[220:223], a[156:159], v[164:167]
v_exp_f32 v62, v90
v_mfma_f32_16x16x32_bf16 v[160:163], a[220:223], a[140:143], v[160:163]
v_exp_f32 v63, v91
v_mfma_f32_16x16x32_bf16 v[176:179], a[208:211], a[128:131], v[32:35]
ds_read_b64 a[220:221], v21 offset:17600
v_or3_b32 v25, v25, v198, v199
v_mfma_f32_16x16x32_bf16 v[180:183], a[208:211], a[144:147], v[36:39]
ds_read_b64 a[222:223], v21 offset:17632
v_cvt_pk_bf16_f32 v200, v56, v57
v_mfma_f32_16x16x32_bf16 v[184:187], a[208:211], a[160:163], v[40:43]
v_exp_f32 v56, v76
v_mfma_f32_16x16x32_bf16 v[188:191], a[208:211], a[176:179], v[44:47]
v_exp_f32 v57, v77
v_mfma_f32_16x16x32_bf16 v[188:191], a[212:215], a[180:183], v[188:191]
ds_read_b64_tr_b16 a[224:225], v23 offset:16896
s_add_u32 s68, s68, 16384
s_sub_u32 s70, s72, s70
s_add_u32 m0, s70, 0
v_mfma_f32_16x16x32_bf16 v[184:187], a[212:215], a[164:167], v[184:187]
ds_read_b64_tr_b16 a[226:227], v23 offset:17152
buffer_load_dwordx4 v9, s[52:55], s68 offen offset:0 lds
v_mfma_f32_16x16x32_bf16 v[180:183], a[212:215], a[148:151], v[180:183]
ds_read_b64_tr_b16 a[228:229], v23 offset:16928
v_cvt_pk_bf16_f32 v201, v58, v59
v_mfma_f32_16x16x32_bf16 v[176:179], a[212:215], a[132:135], v[176:179]
ds_read_b64_tr_b16 a[230:231], v23 offset:17184
s_waitcnt lgkmcnt(4)
v_mfma_f32_16x16x32_bf16 v[176:179], a[216:219], a[136:139], v[176:179]
ds_read_b64_tr_b16 a[232:233], v23 offset:16960
v_cvt_pk_bf16_f32 v202, v60, v61
v_mfma_f32_16x16x32_bf16 v[180:183], a[216:219], a[152:155], v[180:183]
ds_read_b64_tr_b16 a[234:235], v23 offset:17216
v_cvt_pk_bf16_f32 v203, v62, v63
v_mfma_f32_16x16x32_bf16 v[184:187], a[216:219], a[168:171], v[184:187]
ds_read_b64_tr_b16 a[236:237], v23 offset:16992
v_or3_b32 v25, v25, v200, v201
v_mfma_f32_16x16x32_bf16 v[188:191], a[216:219], a[184:187], v[188:191]
ds_read_b64_tr_b16 a[238:239], v23 offset:17248
v_or3_b32 v25, v25, v202, v203
v_mfma_f32_16x16x32_bf16 v[188:191], a[220:223], a[188:191], v[188:191]
ds_read_b64_tr_b16 a[240:241], v23 offset:17024
v_cvt_pk_bf16_f32 v204, v56, v57
v_mfma_f32_16x16x32_bf16 v[184:187], a[220:223], a[172:175], v[184:187]
ds_read_b64_tr_b16 a[242:243], v23 offset:17280
buffer_load_dwordx4 v10, s[52:55], s68 offen offset:1056 lds
v_mfma_f32_16x16x32_bf16 v[180:183], a[220:223], a[156:159], v[180:183]
ds_read_b64_tr_b16 a[244:245], v23 offset:17056
v_mfma_f32_16x16x32_bf16 v[176:179], a[220:223], a[140:143], v[176:179]
ds_read_b64_tr_b16 a[246:247], v23 offset:17312
s_waitcnt lgkmcnt(4)
v_mfma_f32_16x16x32_bf16 a[0:3], a[224:227], v[224:227], a[0:3]
ds_read_b64_tr_b16 a[248:249], v23 offset:17088
v_mfma_f32_16x16x32_bf16 a[4:7], a[224:227], v[228:231], a[4:7]
ds_read_b64_tr_b16 a[250:251], v23 offset:17344
v_mfma_f32_16x16x32_bf16 a[8:11], a[224:227], v[232:235], a[8:11]
v_exp_f32 v58, v78
v_mfma_f32_16x16x32_bf16 a[12:15], a[224:227], v[236:239], a[12:15]
v_exp_f32 v59, v79
v_mfma_f32_16x16x32_bf16 a[28:31], a[228:231], v[236:239], a[28:31]
ds_read_b64_tr_b16 a[252:253], v23 offset:17120
v_cvt_pk_bf16_f32 v205, v58, v59
v_mfma_f32_16x16x32_bf16 a[24:27], a[228:231], v[232:235], a[24:27]
ds_read_b64_tr_b16 a[254:255], v23 offset:17376
v_or3_b32 v25, v25, v204, v205
v_mfma_f32_16x16x32_bf16 a[20:23], a[228:231], v[228:231], a[20:23]
v_exp_f32 v60, v92
v_mfma_f32_16x16x32_bf16 a[16:19], a[228:231], v[224:227], a[16:19]
v_exp_f32 v61, v93
v_mfma_f32_16x16x32_bf16 a[32:35], a[232:235], v[224:227], a[32:35]
ds_read_b64_tr_b16 a[224:225], v23 offset:17408
buffer_load_dwordx4 v12, s[52:55], s68 offen offset:2112 lds
v_mfma_f32_16x16x32_bf16 a[36:39], a[232:235], v[228:231], a[36:39]
ds_read_b64_tr_b16 a[226:227], v23 offset:17664
v_cvt_pk_bf16_f32 v206, v60, v61
v_mfma_f32_16x16x32_bf16 a[40:43], a[232:235], v[232:235], a[40:43]
v_exp_f32 v62, v94
v_mfma_f32_16x16x32_bf16 a[44:47], a[232:235], v[236:239], a[44:47]
v_exp_f32 v63, v95
v_mfma_f32_16x16x32_bf16 a[60:63], a[236:239], v[236:239], a[60:63]
ds_read_b64_tr_b16 a[228:229], v23 offset:17440
v_cvt_pk_bf16_f32 v207, v62, v63
v_mfma_f32_16x16x32_bf16 a[56:59], a[236:239], v[232:235], a[56:59]
ds_read_b64_tr_b16 a[230:231], v23 offset:17696
s_waitcnt lgkmcnt(4)
v_mfma_f32_16x16x32_bf16 a[52:55], a[236:239], v[228:231], a[52:55]
v_exp_f32 v56, v96
v_mfma_f32_16x16x32_bf16 a[48:51], a[236:239], v[224:227], a[48:51]
v_exp_f32 v57, v97
v_mfma_f32_16x16x32_bf16 a[64:67], a[240:243], v[224:227], a[64:67]
ds_read_b64_tr_b16 a[232:233], v23 offset:17472
v_or3_b32 v25, v25, v206, v207
v_mfma_f32_16x16x32_bf16 a[68:71], a[240:243], v[228:231], a[68:71]
ds_read_b64_tr_b16 a[234:235], v23 offset:17728
v_cvt_pk_bf16_f32 v208, v56, v57
v_mfma_f32_16x16x32_bf16 a[72:75], a[240:243], v[232:235], a[72:75]
v_exp_f32 v58, v98
v_mfma_f32_16x16x32_bf16 a[76:79], a[240:243], v[236:239], a[76:79]
v_exp_f32 v59, v99
v_mfma_f32_16x16x32_bf16 a[92:95], a[244:247], v[236:239], a[92:95]
ds_read_b64_tr_b16 a[236:237], v23 offset:17504
buffer_load_dwordx4 v13, s[52:55], s68 offen offset:3168 lds
v_mfma_f32_16x16x32_bf16 a[88:91], a[244:247], v[232:235], a[88:91]
ds_read_b64_tr_b16 a[238:239], v23 offset:17760
v_cvt_pk_bf16_f32 v209, v58, v59
v_mfma_f32_16x16x32_bf16 a[84:87], a[244:247], v[228:231], a[84:87]
v_exp_f32 v60, v112
v_mfma_f32_16x16x32_bf16 a[80:83], a[244:247], v[224:227], a[80:83]
v_exp_f32 v61, v113
v_mfma_f32_16x16x32_bf16 a[96:99], a[248:251], v[224:227], a[96:99]
ds_read_b64_tr_b16 a[240:241], v23 offset:17536
v_cvt_pk_bf16_f32 v210, v60, v61
v_mfma_f32_16x16x32_bf16 a[100:103], a[248:251], v[228:231], a[100:103]
ds_read_b64_tr_b16 a[242:243], v23 offset:17792
v_or3_b32 v25, v25, v208, v209
v_mfma_f32_16x16x32_bf16 a[104:107], a[248:251], v[232:235], a[104:107]
v_exp_f32 v62, v114
v_mfma_f32_16x16x32_bf16 a[108:111], a[248:251], v[236:239], a[108:111]
v_exp_f32 v63, v115
v_mfma_f32_16x16x32_bf16 a[124:127], a[252:255], v[236:239], a[124:127]
ds_read_b64_tr_b16 a[244:245], v23 offset:17568
v_cvt_pk_bf16_f32 v211, v62, v63
v_mfma_f32_16x16x32_bf16 a[120:123], a[252:255], v[232:235], a[120:123]
ds_read_b64_tr_b16 a[246:247], v23 offset:17824
v_or3_b32 v25, v25, v210, v211
v_mfma_f32_16x16x32_bf16 a[116:119], a[252:255], v[228:231], a[116:119]
v_exp_f32 v56, v100
v_mfma_f32_16x16x32_bf16 a[112:115], a[252:255], v[224:227], a[112:115]
v_exp_f32 v57, v101
v_mfma_f32_16x16x32_bf16 a[192:195], v[48:51], v[224:227], a[192:195]
v_exp_f32 v58, v102
v_mfma_f32_16x16x32_bf16 a[196:199], v[48:51], v[228:231], a[196:199]
v_exp_f32 v59, v103
v_mfma_f32_16x16x32_bf16 a[200:203], v[48:51], v[232:235], a[200:203]
v_exp_f32 v60, v116
v_mfma_f32_16x16x32_bf16 a[204:207], v[48:51], v[236:239], a[204:207]
s_waitcnt lgkmcnt(4)
s_mov_b64 s[60:61], s[86:87]
v_mfma_f32_16x16x32_bf16 a[0:3], a[224:227], v[240:243], a[0:3]
ds_read_b64_tr_b16 a[248:249], v23 offset:17600
buffer_load_dword v19, v18, s[60:63], s73 offen
v_mfma_f32_16x16x32_bf16 a[4:7], a[224:227], v[244:247], a[4:7]
ds_read_b64_tr_b16 a[250:251], v23 offset:17856
v_cvt_pk_bf16_f32 v212, v56, v57
v_mfma_f32_16x16x32_bf16 a[8:11], a[224:227], v[248:251], a[8:11]
v_exp_f32 v61, v117
v_mfma_f32_16x16x32_bf16 a[12:15], a[224:227], v[252:255], a[12:15]
v_exp_f32 v62, v118
v_mfma_f32_16x16x32_bf16 a[28:31], a[228:231], v[252:255], a[28:31]
ds_read_b64_tr_b16 a[252:253], v23 offset:17632
v_cvt_pk_bf16_f32 v213, v58, v59
v_mfma_f32_16x16x32_bf16 a[24:27], a[228:231], v[248:251], a[24:27]
ds_read_b64_tr_b16 a[254:255], v23 offset:17888
v_cvt_pk_bf16_f32 v214, v60, v61
v_mfma_f32_16x16x32_bf16 a[20:23], a[228:231], v[244:247], a[20:23]
v_exp_f32 v63, v119
v_mfma_f32_16x16x32_bf16 a[16:19], a[228:231], v[240:243], a[16:19]
v_exp_f32 v56, v104
v_mfma_f32_16x16x32_bf16 a[32:35], a[232:235], v[240:243], a[32:35]
v_exp_f32 v57, v105
v_mfma_f32_16x16x32_bf16 a[36:39], a[232:235], v[244:247], a[36:39]
v_exp_f32 v58, v106
v_mfma_f32_16x16x32_bf16 a[40:43], a[232:235], v[248:251], a[40:43]
v_exp_f32 v59, v107
v_mfma_f32_16x16x32_bf16 a[44:47], a[232:235], v[252:255], a[44:47]
v_exp_f32 v60, v120
v_mfma_f32_16x16x32_bf16 a[60:63], a[236:239], v[252:255], a[60:63]
v_exp_f32 v61, v121
v_mfma_f32_16x16x32_bf16 a[56:59], a[236:239], v[248:251], a[56:59]
v_cvt_pk_bf16_f32 v215, v62, v63
v_or3_b32 v25, v25, v212, v213
v_mfma_f32_16x16x32_bf16 a[52:55], a[236:239], v[244:247], a[52:55]
v_exp_f32 v62, v122
v_mfma_f32_16x16x32_bf16 a[48:51], a[236:239], v[240:243], a[48:51]
s_waitcnt lgkmcnt(0)
v_or3_b32 v25, v25, v214, v215
v_mfma_f32_16x16x32_bf16 a[64:67], a[240:243], v[240:243], a[64:67]
v_exp_f32 v63, v123
v_mfma_f32_16x16x32_bf16 a[68:71], a[240:243], v[244:247], a[68:71]
v_cvt_pk_bf16_f32 v216, v56, v57
v_cvt_pk_bf16_f32 v217, v58, v59
v_mfma_f32_16x16x32_bf16 a[72:75], a[240:243], v[248:251], a[72:75]
v_exp_f32 v56, v108
v_mfma_f32_16x16x32_bf16 a[76:79], a[240:243], v[252:255], a[76:79]
v_exp_f32 v57, v109
v_mfma_f32_16x16x32_bf16 a[92:95], a[244:247], v[252:255], a[92:95]
v_exp_f32 v58, v110
v_mfma_f32_16x16x32_bf16 a[88:91], a[244:247], v[248:251], a[88:91]
v_exp_f32 v59, v111
v_mfma_f32_16x16x32_bf16 a[84:87], a[244:247], v[244:247], a[84:87]
v_cvt_pk_bf16_f32 v218, v60, v61
v_cvt_pk_bf16_f32 v219, v62, v63
v_mfma_f32_16x16x32_bf16 a[80:83], a[244:247], v[240:243], a[80:83]
v_exp_f32 v60, v124
v_mfma_f32_16x16x32_bf16 a[96:99], a[248:251], v[240:243], a[96:99]
v_exp_f32 v61, v125
v_mfma_f32_16x16x32_bf16 a[100:103], a[248:251], v[244:247], a[100:103]
v_exp_f32 v62, v126
v_mfma_f32_16x16x32_bf16 a[104:107], a[248:251], v[248:251], a[104:107]
v_exp_f32 v63, v127
v_mfma_f32_16x16x32_bf16 a[108:111], a[248:251], v[252:255], a[108:111]
s_waitcnt vmcnt(19)
s_barrier
v_mfma_f32_16x16x32_bf16 a[124:127], a[252:255], v[252:255], a[124:127]
ds_read_b64 a[208:209], v22 offset:0
v_or3_b32 v25, v25, v216, v217
v_mfma_f32_16x16x32_bf16 a[120:123], a[252:255], v[248:251], a[120:123]
ds_read_b64 a[210:211], v22 offset:32
v_or3_b32 v25, v25, v218, v219
v_mfma_f32_16x16x32_bf16 a[116:119], a[252:255], v[244:247], a[116:119]
ds_read_b64 a[212:213], v22 offset:64
v_cvt_pk_bf16_f32 v220, v56, v57
v_mfma_f32_16x16x32_bf16 a[112:115], a[252:255], v[240:243], a[112:115]
ds_read_b64 a[214:215], v22 offset:96
v_cvt_pk_bf16_f32 v221, v58, v59
v_mfma_f32_16x16x32_bf16 a[192:195], v[48:51], v[240:243], a[192:195]
ds_read_b64 a[216:217], v22 offset:128
v_cvt_pk_bf16_f32 v222, v60, v61
v_mfma_f32_16x16x32_bf16 a[196:199], v[48:51], v[244:247], a[196:199]
ds_read_b64 a[218:219], v22 offset:160
v_cvt_pk_bf16_f32 v223, v62, v63
v_mfma_f32_16x16x32_bf16 a[200:203], v[48:51], v[248:251], a[200:203]
v_or3_b32 v25, v25, v220, v221
v_or3_b32 v25, v25, v222, v223
v_mfma_f32_16x16x32_bf16 a[204:207], v[48:51], v[252:255], a[204:207]
v_and_b32 v52, 0x40004000, v25
v_cmp_ne_u32 vcc, 0, v52
s_nop 4
s_cbranch_vccz L_backb_main_kernel
s_call_b64 s[36:37], L_rare0_main_kernel
L_backb_main_kernel:
v_swap_b32 v21, v22
v_swap_b32 v23, v24
s_mov_b64 s[84:85], s[88:89]
s_mov_b64 s[86:87], s[90:91]
s_mov_b64 s[88:89], s[92:93]
s_mov_b64 s[90:91], s[76:77]
s_sub_u32 s29, s29, 1
s_cmp_lg_u32 s29, 0
s_cbranch_scc1 L_loop_attn
ds_read_b64_tr_b16 a[224:225], v23 offset:0
ds_read_b64_tr_b16 a[226:227], v23 offset:256
ds_read_b64_tr_b16 a[228:229], v23 offset:32
ds_read_b64_tr_b16 a[230:231], v23 offset:288
ds_read_b64_tr_b16 a[232:233], v23 offset:64
ds_read_b64_tr_b16 a[234:235], v23 offset:320
ds_read_b64_tr_b16 a[236:237], v23 offset:96
ds_read_b64_tr_b16 a[238:239], v23 offset:352
ds_read_b64_tr_b16 a[240:241], v23 offset:128
ds_read_b64_tr_b16 a[242:243], v23 offset:384
ds_read_b64_tr_b16 a[244:245], v23 offset:160
ds_read_b64_tr_b16 a[246:247], v23 offset:416
s_waitcnt lgkmcnt(4)
v_mfma_f32_16x16x32_bf16 a[0:3], a[224:227], v[192:195], a[0:3]
ds_read_b64_tr_b16 a[248:249], v23 offset:192
v_mfma_f32_16x16x32_bf16 a[4:7], a[224:227], v[196:199], a[4:7]
ds_read_b64_tr_b16 a[250:251], v23 offset:448
v_mfma_f32_16x16x32_bf16 a[8:11], a[224:227], v[200:203], a[8:11]
v_exp_f32 v56, v128
v_mfma_f32_16x16x32_bf16 a[12:15], a[224:227], v[204:207], a[12:15]
v_exp_f32 v57, v129
v_mfma_f32_16x16x32_bf16 a[28:31], a[228:231], v[204:207], a[28:31]
ds_read_b64_tr_b16 a[252:253], v23 offset:224
v_cvt_pk_bf16_f32 v224, v56, v57
v_mfma_f32_16x16x32_bf16 a[24:27], a[228:231], v[200:203], a[24:27]
ds_read_b64_tr_b16 a[254:255], v23 offset:480
v_mfma_f32_16x16x32_bf16 a[20:23], a[228:231], v[196:199], a[20:23]
v_exp_f32 v58, v130
v_mfma_f32_16x16x32_bf16 a[16:19], a[228:231], v[192:195], a[16:19]
v_exp_f32 v59, v131
v_mfma_f32_16x16x32_bf16 a[32:35], a[232:235], v[192:195], a[32:35]
ds_read_b64_tr_b16 a[224:225], v23 offset:512
v_cvt_pk_bf16_f32 v225, v58, v59
v_mfma_f32_16x16x32_bf16 a[36:39], a[232:235], v[196:199], a[36:39]
ds_read_b64_tr_b16 a[226:227], v23 offset:768
v_or_b32 v25, v224, v225
v_mfma_f32_16x16x32_bf16 a[40:43], a[232:235], v[200:203], a[40:43]
v_exp_f32 v60, v144
v_mfma_f32_16x16x32_bf16 a[44:47], a[232:235], v[204:207], a[44:47]
v_exp_f32 v61, v145
v_mfma_f32_16x16x32_bf16 a[60:63], a[236:239], v[204:207], a[60:63]
ds_read_b64_tr_b16 a[228:229], v23 offset:544
v_cvt_pk_bf16_f32 v226, v60, v61
v_mfma_f32_16x16x32_bf16 a[56:59], a[236:239], v[200:203], a[56:59]
ds_read_b64_tr_b16 a[230:231], v23 offset:800
s_waitcnt lgkmcnt(4)
v_mfma_f32_16x16x32_bf16 a[52:55], a[236:239], v[196:199], a[52:55]
v_exp_f32 v62, v146
v_mfma_f32_16x16x32_bf16 a[48:51], a[236:239], v[192:195], a[48:51]
v_exp_f32 v63, v147
v_mfma_f32_16x16x32_bf16 a[64:67], a[240:243], v[192:195], a[64:67]
ds_read_b64_tr_b16 a[232:233], v23 offset:576
v_cvt_pk_bf16_f32 v227, v62, v63
v_mfma_f32_16x16x32_bf16 a[68:71], a[240:243], v[196:199], a[68:71]
ds_read_b64_tr_b16 a[234:235], v23 offset:832
v_or3_b32 v25, v25, v226, v227
v_mfma_f32_16x16x32_bf16 a[72:75], a[240:243], v[200:203], a[72:75]
v_exp_f32 v56, v132
v_mfma_f32_16x16x32_bf16 a[76:79], a[240:243], v[204:207], a[76:79]
v_exp_f32 v57, v133
v_mfma_f32_16x16x32_bf16 a[92:95], a[244:247], v[204:207], a[92:95]
ds_read_b64_tr_b16 a[236:237], v23 offset:608
v_cvt_pk_bf16_f32 v228, v56, v57
v_mfma_f32_16x16x32_bf16 a[88:91], a[244:247], v[200:203], a[88:91]
ds_read_b64_tr_b16 a[238:239], v23 offset:864
v_mfma_f32_16x16x32_bf16 a[84:87], a[244:247], v[196:199], a[84:87]
v_exp_f32 v58, v134
v_mfma_f32_16x16x32_bf16 a[80:83], a[244:247], v[192:195], a[80:83]
v_exp_f32 v59, v135
v_mfma_f32_16x16x32_bf16 a[96:99], a[248:251], v[192:195], a[96:99]
ds_read_b64_tr_b16 a[240:241], v23 offset:640
v_cvt_pk_bf16_f32 v229, v58, v59
v_mfma_f32_16x16x32_bf16 a[100:103], a[248:251], v[196:199], a[100:103]
ds_read_b64_tr_b16 a[242:243], v23 offset:896
v_or3_b32 v25, v25, v228, v229
v_mfma_f32_16x16x32_bf16 a[104:107], a[248:251], v[200:203], a[104:107]
v_exp_f32 v60, v148
v_mfma_f32_16x16x32_bf16 a[108:111], a[248:251], v[204:207], a[108:111]
v_exp_f32 v61, v149
v_mfma_f32_16x16x32_bf16 a[124:127], a[252:255], v[204:207], a[124:127]
ds_read_b64_tr_b16 a[244:245], v23 offset:672
v_cvt_pk_bf16_f32 v230, v60, v61
v_mfma_f32_16x16x32_bf16 a[120:123], a[252:255], v[200:203], a[120:123]
ds_read_b64_tr_b16 a[246:247], v23 offset:928
v_mfma_f32_16x16x32_bf16 a[116:119], a[252:255], v[196:199], a[116:119]
v_exp_f32 v62, v150
v_mfma_f32_16x16x32_bf16 a[112:115], a[252:255], v[192:195], a[112:115]
v_exp_f32 v63, v151
v_mfma_f32_16x16x32_bf16 a[192:195], v[48:51], v[192:195], a[192:195]
v_exp_f32 v56, v136
v_mfma_f32_16x16x32_bf16 a[196:199], v[48:51], v[196:199], a[196:199]
v_exp_f32 v57, v137
v_mfma_f32_16x16x32_bf16 a[200:203], v[48:51], v[200:203], a[200:203]
v_exp_f32 v58, v138
v_mfma_f32_16x16x32_bf16 a[204:207], v[48:51], v[204:207], a[204:207]
s_waitcnt lgkmcnt(4)
v_cvt_pk_bf16_f32 v231, v62, v63
v_mfma_f32_16x16x32_bf16 a[0:3], a[224:227], v[208:211], a[0:3]
ds_read_b64_tr_b16 a[248:249], v23 offset:704
v_or3_b32 v25, v25, v230, v231
v_mfma_f32_16x16x32_bf16 a[4:7], a[224:227], v[212:215], a[4:7]
ds_read_b64_tr_b16 a[250:251], v23 offset:960
v_cvt_pk_bf16_f32 v232, v56, v57
v_mfma_f32_16x16x32_bf16 a[8:11], a[224:227], v[216:219], a[8:11]
v_exp_f32 v59, v139
v_mfma_f32_16x16x32_bf16 a[12:15], a[224:227], v[220:223], a[12:15]
v_exp_f32 v60, v152
v_mfma_f32_16x16x32_bf16 a[28:31], a[228:231], v[220:223], a[28:31]
ds_read_b64_tr_b16 a[252:253], v23 offset:736
v_cvt_pk_bf16_f32 v233, v58, v59
v_mfma_f32_16x16x32_bf16 a[24:27], a[228:231], v[216:219], a[24:27]
ds_read_b64_tr_b16 a[254:255], v23 offset:992
v_or3_b32 v25, v25, v232, v233
v_mfma_f32_16x16x32_bf16 a[20:23], a[228:231], v[212:215], a[20:23]
v_exp_f32 v61, v153
v_mfma_f32_16x16x32_bf16 a[16:19], a[228:231], v[208:211], a[16:19]
v_exp_f32 v62, v154
v_mfma_f32_16x16x32_bf16 a[32:35], a[232:235], v[208:211], a[32:35]
v_exp_f32 v63, v155
v_mfma_f32_16x16x32_bf16 a[36:39], a[232:235], v[212:215], a[36:39]
v_exp_f32 v56, v140
v_mfma_f32_16x16x32_bf16 a[40:43], a[232:235], v[216:219], a[40:43]
v_exp_f32 v57, v141
v_mfma_f32_16x16x32_bf16 a[44:47], a[232:235], v[220:223], a[44:47]
v_exp_f32 v58, v142
v_mfma_f32_16x16x32_bf16 a[60:63], a[236:239], v[220:223], a[60:63]
v_exp_f32 v59, v143
v_mfma_f32_16x16x32_bf16 a[56:59], a[236:239], v[216:219], a[56:59]
v_cvt_pk_bf16_f32 v234, v60, v61
v_cvt_pk_bf16_f32 v235, v62, v63
v_mfma_f32_16x16x32_bf16 a[52:55], a[236:239], v[212:215], a[52:55]
v_exp_f32 v60, v156
v_mfma_f32_16x16x32_bf16 a[48:51], a[236:239], v[208:211], a[48:51]
s_waitcnt lgkmcnt(0)
v_or3_b32 v25, v25, v234, v235
v_mfma_f32_16x16x32_bf16 a[64:67], a[240:243], v[208:211], a[64:67]
v_exp_f32 v61, v157
v_mfma_f32_16x16x32_bf16 a[68:71], a[240:243], v[212:215], a[68:71]
v_exp_f32 v62, v158
v_mfma_f32_16x16x32_bf16 a[72:75], a[240:243], v[216:219], a[72:75]
v_exp_f32 v63, v159
v_mfma_f32_16x16x32_bf16 a[76:79], a[240:243], v[220:223], a[76:79]
v_cvt_pk_bf16_f32 v236, v56, v57
v_cvt_pk_bf16_f32 v237, v58, v59
v_mfma_f32_16x16x32_bf16 a[92:95], a[244:247], v[220:223], a[92:95]
v_exp_f32 v56, v160
v_mfma_f32_16x16x32_bf16 a[88:91], a[244:247], v[216:219], a[88:91]
s_waitcnt vmcnt(10)
s_barrier
v_mfma_f32_16x16x32_bf16 a[84:87], a[244:247], v[212:215], a[84:87]
ds_read_b64_tr_b16 a[224:225], v23 offset:16896
v_cvt_pk_bf16_f32 v238, v60, v61
v_mfma_f32_16x16x32_bf16 a[80:83], a[244:247], v[208:211], a[80:83]
ds_read_b64_tr_b16 a[226:227], v23 offset:17152
v_cvt_pk_bf16_f32 v239, v62, v63
v_mfma_f32_16x16x32_bf16 a[96:99], a[248:251], v[208:211], a[96:99]
ds_read_b64_tr_b16 a[228:229], v23 offset:16928
v_or3_b32 v25, v25, v236, v237
v_mfma_f32_16x16x32_bf16 a[100:103], a[248:251], v[212:215], a[100:103]
ds_read_b64_tr_b16 a[230:231], v23 offset:17184
v_or3_b32 v25, v25, v238, v239
v_mfma_f32_16x16x32_bf16 a[104:107], a[248:251], v[216:219], a[104:107]
ds_read_b64_tr_b16 a[232:233], v23 offset:16960
v_mfma_f32_16x16x32_bf16 a[108:111], a[248:251], v[220:223], a[108:111]
ds_read_b64_tr_b16 a[234:235], v23 offset:17216
v_mfma_f32_16x16x32_bf16 a[124:127], a[252:255], v[220:223], a[124:127]
ds_read_b64_tr_b16 a[236:237], v23 offset:16992
v_mfma_f32_16x16x32_bf16 a[120:123], a[252:255], v[216:219], a[120:123]
ds_read_b64_tr_b16 a[238:239], v23 offset:17248
v_mfma_f32_16x16x32_bf16 a[116:119], a[252:255], v[212:215], a[116:119]
ds_read_b64_tr_b16 a[240:241], v23 offset:17024
v_mfma_f32_16x16x32_bf16 a[112:115], a[252:255], v[208:211], a[112:115]
ds_read_b64_tr_b16 a[242:243], v23 offset:17280
v_mfma_f32_16x16x32_bf16 a[192:195], v[48:51], v[208:211], a[192:195]
ds_read_b64_tr_b16 a[244:245], v23 offset:17056
v_mfma_f32_16x16x32_bf16 a[196:199], v[48:51], v[212:215], a[196:199]
ds_read_b64_tr_b16 a[246:247], v23 offset:17312
v_mfma_f32_16x16x32_bf16 a[200:203], v[48:51], v[216:219], a[200:203]
v_exp_f32 v57, v161
s_nop 0
v_cvt_pk_bf16_f32 v240, v56, v57
v_exp_f32 v58, v162
v_exp_f32 v59, v163
s_nop 0
v_cvt_pk_bf16_f32 v241, v58, v59
v_exp_f32 v60, v176
v_exp_f32 v61, v177
s_nop 0
v_cvt_pk_bf16_f32 v242, v60, v61
v_exp_f32 v62, v178
v_exp_f32 v63, v179
s_nop 0
v_cvt_pk_bf16_f32 v243, v62, v63
v_or3_b32 v25, v25, v240, v241
v_or3_b32 v25, v25, v242, v243
v_exp_f32 v56, v164
v_exp_f32 v57, v165
s_nop 0
v_cvt_pk_bf16_f32 v244, v56, v57
v_exp_f32 v58, v166
v_exp_f32 v59, v167
s_nop 0
v_cvt_pk_bf16_f32 v245, v58, v59
v_exp_f32 v60, v180
v_exp_f32 v61, v181
s_nop 0
v_cvt_pk_bf16_f32 v246, v60, v61
v_exp_f32 v62, v182
v_exp_f32 v63, v183
s_nop 0
v_cvt_pk_bf16_f32 v247, v62, v63
v_or3_b32 v25, v25, v244, v245
v_or3_b32 v25, v25, v246, v247
v_exp_f32 v56, v168
v_exp_f32 v57, v169
s_nop 0
v_cvt_pk_bf16_f32 v248, v56, v57
v_exp_f32 v58, v170
v_exp_f32 v59, v171
s_nop 0
v_cvt_pk_bf16_f32 v249, v58, v59
v_exp_f32 v60, v184
v_exp_f32 v61, v185
s_nop 0
v_cvt_pk_bf16_f32 v250, v60, v61
v_exp_f32 v62, v186
v_exp_f32 v63, v187
s_nop 0
v_cvt_pk_bf16_f32 v251, v62, v63
v_or3_b32 v25, v25, v248, v249
v_or3_b32 v25, v25, v250, v251
v_exp_f32 v56, v172
v_exp_f32 v57, v173
s_nop 0
v_cvt_pk_bf16_f32 v252, v56, v57
v_exp_f32 v58, v174
v_exp_f32 v59, v175
s_nop 0
v_cvt_pk_bf16_f32 v253, v58, v59
v_exp_f32 v60, v188
v_exp_f32 v61, v189
s_nop 0
v_cvt_pk_bf16_f32 v254, v60, v61
v_exp_f32 v62, v190
v_exp_f32 v63, v191
s_nop 0
v_cvt_pk_bf16_f32 v255, v62, v63
v_or3_b32 v25, v25, v252, v253
v_or3_b32 v25, v25, v254, v255
v_mfma_f32_16x16x32_bf16 a[204:207], v[48:51], v[220:223], a[204:207]
v_and_b32 v52, 0x40004000, v25
v_cmp_ne_u32 vcc, 0, v52
s_nop 4
s_cbranch_vccz L_backc_main_kernel
s_call_b64 s[36:37], L_rare1_main_kernel
L_backc_main_kernel:
s_waitcnt lgkmcnt(4)
v_mfma_f32_16x16x32_bf16 a[0:3], a[224:227], v[224:227], a[0:3]
ds_read_b64_tr_b16 a[248:249], v23 offset:17088
v_mfma_f32_16x16x32_bf16 a[4:7], a[224:227], v[228:231], a[4:7]
ds_read_b64_tr_b16 a[250:251], v23 offset:17344
v_mfma_f32_16x16x32_bf16 a[8:11], a[224:227], v[232:235], a[8:11]
v_mfma_f32_16x16x32_bf16 a[12:15], a[224:227], v[236:239], a[12:15]
v_mfma_f32_16x16x32_bf16 a[28:31], a[228:231], v[236:239], a[28:31]
ds_read_b64_tr_b16 a[252:253], v23 offset:17120
v_mfma_f32_16x16x32_bf16 a[24:27], a[228:231], v[232:235], a[24:27]
ds_read_b64_tr_b16 a[254:255], v23 offset:17376
v_mfma_f32_16x16x32_bf16 a[20:23], a[228:231], v[228:231], a[20:23]
v_mfma_f32_16x16x32_bf16 a[16:19], a[228:231], v[224:227], a[16:19]
v_mfma_f32_16x16x32_bf16 a[32:35], a[232:235], v[224:227], a[32:35]
ds_read_b64_tr_b16 a[224:225], v23 offset:17408
v_mfma_f32_16x16x32_bf16 a[36:39], a[232:235], v[228:231], a[36:39]
ds_read_b64_tr_b16 a[226:227], v23 offset:17664
v_mfma_f32_16x16x32_bf16 a[40:43], a[232:235], v[232:235], a[40:43]
v_mfma_f32_16x16x32_bf16 a[44:47], a[232:235], v[236:239], a[44:47]
v_mfma_f32_16x16x32_bf16 a[60:63], a[236:239], v[236:239], a[60:63]
ds_read_b64_tr_b16 a[228:229], v23 offset:17440
v_mfma_f32_16x16x32_bf16 a[56:59], a[236:239], v[232:235], a[56:59]
ds_read_b64_tr_b16 a[230:231], v23 offset:17696
s_waitcnt lgkmcnt(4)
v_mfma_f32_16x16x32_bf16 a[52:55], a[236:239], v[228:231], a[52:55]
v_mfma_f32_16x16x32_bf16 a[48:51], a[236:239], v[224:227], a[48:51]
v_mfma_f32_16x16x32_bf16 a[64:67], a[240:243], v[224:227], a[64:67]
ds_read_b64_tr_b16 a[232:233], v23 offset:17472
v_mfma_f32_16x16x32_bf16 a[68:71], a[240:243], v[228:231], a[68:71]
ds_read_b64_tr_b16 a[234:235], v23 offset:17728
v_mfma_f32_16x16x32_bf16 a[72:75], a[240:243], v[232:235], a[72:75]
v_mfma_f32_16x16x32_bf16 a[76:79], a[240:243], v[236:239], a[76:79]
v_mfma_f32_16x16x32_bf16 a[92:95], a[244:247], v[236:239], a[92:95]
ds_read_b64_tr_b16 a[236:237], v23 offset:17504
v_mfma_f32_16x16x32_bf16 a[88:91], a[244:247], v[232:235], a[88:91]
ds_read_b64_tr_b16 a[238:239], v23 offset:17760
v_mfma_f32_16x16x32_bf16 a[84:87], a[244:247], v[228:231], a[84:87]
v_mfma_f32_16x16x32_bf16 a[80:83], a[244:247], v[224:227], a[80:83]
v_mfma_f32_16x16x32_bf16 a[96:99], a[248:251], v[224:227], a[96:99]
ds_read_b64_tr_b16 a[240:241], v23 offset:17536
v_mfma_f32_16x16x32_bf16 a[100:103], a[248:251], v[228:231], a[100:103]
ds_read_b64_tr_b16 a[242:243], v23 offset:17792
v_mfma_f32_16x16x32_bf16 a[104:107], a[248:251], v[232:235], a[104:107]
v_mfma_f32_16x16x32_bf16 a[108:111], a[248:251], v[236:239], a[108:111]
v_mfma_f32_16x16x32_bf16 a[124:127], a[252:255], v[236:239], a[124:127]
ds_read_b64_tr_b16 a[244:245], v23 offset:17568
v_mfma_f32_16x16x32_bf16 a[120:123], a[252:255], v[232:235], a[120:123]
ds_read_b64_tr_b16 a[246:247], v23 offset:17824
v_mfma_f32_16x16x32_bf16 a[116:119], a[252:255], v[228:231], a[116:119]
v_mfma_f32_16x16x32_bf16 a[112:115], a[252:255], v[224:227], a[112:115]
v_mfma_f32_16x16x32_bf16 a[192:195], v[48:51], v[224:227], a[192:195]
v_mfma_f32_16x16x32_bf16 a[196:199], v[48:51], v[228:231], a[196:199]
v_mfma_f32_16x16x32_bf16 a[200:203], v[48:51], v[232:235], a[200:203]
v_mfma_f32_16x16x32_bf16 a[204:207], v[48:51], v[236:239], a[204:207]
s_waitcnt lgkmcnt(4)
v_mfma_f32_16x16x32_bf16 a[0:3], a[224:227], v[240:243], a[0:3]
ds_read_b64_tr_b16 a[248:249], v23 offset:17600
v_mfma_f32_16x16x32_bf16 a[4:7], a[224:227], v[244:247], a[4:7]
ds_read_b64_tr_b16 a[250:251], v23 offset:17856
v_mfma_f32_16x16x32_bf16 a[8:11], a[224:227], v[248:251], a[8:11]
v_mfma_f32_16x16x32_bf16 a[12:15], a[224:227], v[252:255], a[12:15]
v_mfma_f32_16x16x32_bf16 a[28:31], a[228:231], v[252:255], a[28:31]
ds_read_b64_tr_b16 a[252:253], v23 offset:17632
v_mfma_f32_16x16x32_bf16 a[24:27], a[228:231], v[248:251], a[24:27]
ds_read_b64_tr_b16 a[254:255], v23 offset:17888
v_mfma_f32_16x16x32_bf16 a[20:23], a[228:231], v[244:247], a[20:23]
v_mfma_f32_16x16x32_bf16 a[16:19], a[228:231], v[240:243], a[16:19]
v_mfma_f32_16x16x32_bf16 a[32:35], a[232:235], v[240:243], a[32:35]
v_mfma_f32_16x16x32_bf16 a[36:39], a[232:235], v[244:247], a[36:39]
v_mfma_f32_16x16x32_bf16 a[40:43], a[232:235], v[248:251], a[40:43]
v_mfma_f32_16x16x32_bf16 a[44:47], a[232:235], v[252:255], a[44:47]
v_mfma_f32_16x16x32_bf16 a[60:63], a[236:239], v[252:255], a[60:63]
v_mfma_f32_16x16x32_bf16 a[56:59], a[236:239], v[248:251], a[56:59]
v_mfma_f32_16x16x32_bf16 a[52:55], a[236:239], v[244:247], a[52:55]
v_mfma_f32_16x16x32_bf16 a[48:51], a[236:239], v[240:243], a[48:51]
s_waitcnt lgkmcnt(0)
v_mfma_f32_16x16x32_bf16 a[64:67], a[240:243], v[240:243], a[64:67]
v_mfma_f32_16x16x32_bf16 a[68:71], a[240:243], v[244:247], a[68:71]
v_mfma_f32_16x16x32_bf16 a[72:75], a[240:243], v[248:251], a[72:75]
v_mfma_f32_16x16x32_bf16 a[76:79], a[240:243], v[252:255], a[76:79]
v_mfma_f32_16x16x32_bf16 a[92:95], a[244:247], v[252:255], a[92:95]
v_mfma_f32_16x16x32_bf16 a[88:91], a[244:247], v[248:251], a[88:91]
v_mfma_f32_16x16x32_bf16 a[84:87], a[244:247], v[244:247], a[84:87]
v_mfma_f32_16x16x32_bf16 a[80:83], a[244:247], v[240:243], a[80:83]
v_mfma_f32_16x16x32_bf16 a[96:99], a[248:251], v[240:243], a[96:99]
v_mfma_f32_16x16x32_bf16 a[100:103], a[248:251], v[244:247], a[100:103]
v_mfma_f32_16x16x32_bf16 a[104:107], a[248:251], v[248:251], a[104:107]
v_mfma_f32_16x16x32_bf16 a[108:111], a[248:251], v[252:255], a[108:111]
v_mfma_f32_16x16x32_bf16 a[124:127], a[252:255], v[252:255], a[124:127]
v_mfma_f32_16x16x32_bf16 a[120:123], a[252:255], v[248:251], a[120:123]
v_mfma_f32_16x16x32_bf16 a[116:119], a[252:255], v[244:247], a[116:119]
v_mfma_f32_16x16x32_bf16 a[112:115], a[252:255], v[240:243], a[112:115]
v_mfma_f32_16x16x32_bf16 a[192:195], v[48:51], v[240:243], a[192:195]
v_mfma_f32_16x16x32_bf16 a[196:199], v[48:51], v[244:247], a[196:199]
v_mfma_f32_16x16x32_bf16 a[200:203], v[48:51], v[248:251], a[200:203]
v_mfma_f32_16x16x32_bf16 a[204:207], v[48:51], v[252:255], a[204:207]
s_lshl_b32 s30, s28, 19
s_nop 7
v_accvgpr_read_b32 v52, a192
s_nop 0
v_rcp_f32 v52, v52
v_accvgpr_read_b32 v64, a0
v_accvgpr_read_b32 v65, a1
v_accvgpr_read_b32 v66, a2
v_accvgpr_read_b32 v67, a3
v_accvgpr_read_b32 v68, a16
v_accvgpr_read_b32 v69, a17
v_accvgpr_read_b32 v70, a18
v_accvgpr_read_b32 v71, a19
v_pk_mul_f32 v[64:65], v[64:65], v[52:53] op_sel_hi:[1,0]
v_pk_mul_f32 v[66:67], v[66:67], v[52:53] op_sel_hi:[1,0]
v_pk_mul_f32 v[68:69], v[68:69], v[52:53] op_sel_hi:[1,0]
v_pk_mul_f32 v[70:71], v[70:71], v[52:53] op_sel_hi:[1,0]
v_cvt_pk_bf16_f32 v64, v64, v65
v_cvt_pk_bf16_f32 v65, v66, v67
v_cvt_pk_bf16_f32 v66, v68, v69
v_cvt_pk_bf16_f32 v67, v70, v71
s_add_u32 s31, s30, 0
buffer_store_dwordx4 v[64:67], v14, s[56:59], s31 offen offset:0 sc1
v_accvgpr_read_b32 v72, a32
v_accvgpr_read_b32 v73, a33
v_accvgpr_read_b32 v74, a34
v_accvgpr_read_b32 v75, a35
v_accvgpr_read_b32 v76, a48
v_accvgpr_read_b32 v77, a49
v_accvgpr_read_b32 v78, a50
v_accvgpr_read_b32 v79, a51
v_pk_mul_f32 v[72:73], v[72:73], v[52:53] op_sel_hi:[1,0]
v_pk_mul_f32 v[74:75], v[74:75], v[52:53] op_sel_hi:[1,0]
v_pk_mul_f32 v[76:77], v[76:77], v[52:53] op_sel_hi:[1,0]
v_pk_mul_f32 v[78:79], v[78:79], v[52:53] op_sel_hi:[1,0]
v_cvt_pk_bf16_f32 v72, v72, v73
v_cvt_pk_bf16_f32 v73, v74, v75
v_cvt_pk_bf16_f32 v74, v76, v77
v_cvt_pk_bf16_f32 v75, v78, v79
s_add_u32 s31, s30, 0
buffer_store_dwordx4 v[72:75], v14, s[56:59], s31 offen offset:1024 sc1
v_accvgpr_read_b32 v80, a64
v_accvgpr_read_b32 v81, a65
v_accvgpr_read_b32 v82, a66
v_accvgpr_read_b32 v83, a67
v_accvgpr_read_b32 v84, a80
v_accvgpr_read_b32 v85, a81
v_accvgpr_read_b32 v86, a82
v_accvgpr_read_b32 v87, a83
v_pk_mul_f32 v[80:81], v[80:81], v[52:53] op_sel_hi:[1,0]
v_pk_mul_f32 v[82:83], v[82:83], v[52:53] op_sel_hi:[1,0]
v_pk_mul_f32 v[84:85], v[84:85], v[52:53] op_sel_hi:[1,0]
v_pk_mul_f32 v[86:87], v[86:87], v[52:53] op_sel_hi:[1,0]
v_cvt_pk_bf16_f32 v80, v80, v81
v_cvt_pk_bf16_f32 v81, v82, v83
v_cvt_pk_bf16_f32 v82, v84, v85
v_cvt_pk_bf16_f32 v83, v86, v87
s_add_u32 s31, s30, 262144
buffer_store_dwordx4 v[80:83], v14, s[56:59], s31 offen offset:0 sc1
v_accvgpr_read_b32 v88, a96
v_accvgpr_read_b32 v89, a97
v_accvgpr_read_b32 v90, a98
v_accvgpr_read_b32 v91, a99
v_accvgpr_read_b32 v92, a112
v_accvgpr_read_b32 v93, a113
v_accvgpr_read_b32 v94, a114
v_accvgpr_read_b32 v95, a115
v_pk_mul_f32 v[88:89], v[88:89], v[52:53] op_sel_hi:[1,0]
v_pk_mul_f32 v[90:91], v[90:91], v[52:53] op_sel_hi:[1,0]
v_pk_mul_f32 v[92:93], v[92:93], v[52:53] op_sel_hi:[1,0]
v_pk_mul_f32 v[94:95], v[94:95], v[52:53] op_sel_hi:[1,0]
v_cvt_pk_bf16_f32 v88, v88, v89
v_cvt_pk_bf16_f32 v89, v90, v91
v_cvt_pk_bf16_f32 v90, v92, v93
v_cvt_pk_bf16_f32 v91, v94, v95
s_add_u32 s31, s30, 262144
buffer_store_dwordx4 v[88:91], v14, s[56:59], s31 offen offset:1024 sc1
v_accvgpr_read_b32 v52, a196
s_nop 0
v_rcp_f32 v52, v52
v_accvgpr_read_b32 v96, a4
v_accvgpr_read_b32 v97, a5
v_accvgpr_read_b32 v98, a6
v_accvgpr_read_b32 v99, a7
v_accvgpr_read_b32 v100, a20
v_accvgpr_read_b32 v101, a21
v_accvgpr_read_b32 v102, a22
v_accvgpr_read_b32 v103, a23
v_pk_mul_f32 v[96:97], v[96:97], v[52:53] op_sel_hi:[1,0]
v_pk_mul_f32 v[98:99], v[98:99], v[52:53] op_sel_hi:[1,0]
v_pk_mul_f32 v[100:101], v[100:101], v[52:53] op_sel_hi:[1,0]
v_pk_mul_f32 v[102:103], v[102:103], v[52:53] op_sel_hi:[1,0]
v_cvt_pk_bf16_f32 v96, v96, v97
v_cvt_pk_bf16_f32 v97, v98, v99
v_cvt_pk_bf16_f32 v98, v100, v101
v_cvt_pk_bf16_f32 v99, v102, v103
s_add_u32 s31, s30, 0
buffer_store_dwordx4 v[96:99], v14, s[56:59], s31 offen offset:2048 sc1
v_accvgpr_read_b32 v104, a36
v_accvgpr_read_b32 v105, a37
v_accvgpr_read_b32 v106, a38
v_accvgpr_read_b32 v107, a39
v_accvgpr_read_b32 v108, a52
v_accvgpr_read_b32 v109, a53
v_accvgpr_read_b32 v110, a54
v_accvgpr_read_b32 v111, a55
v_pk_mul_f32 v[104:105], v[104:105], v[52:53] op_sel_hi:[1,0]
v_pk_mul_f32 v[106:107], v[106:107], v[52:53] op_sel_hi:[1,0]
v_pk_mul_f32 v[108:109], v[108:109], v[52:53] op_sel_hi:[1,0]
v_pk_mul_f32 v[110:111], v[110:111], v[52:53] op_sel_hi:[1,0]
v_cvt_pk_bf16_f32 v104, v104, v105
v_cvt_pk_bf16_f32 v105, v106, v107
v_cvt_pk_bf16_f32 v106, v108, v109
v_cvt_pk_bf16_f32 v107, v110, v111
s_add_u32 s31, s30, 0
buffer_store_dwordx4 v[104:107], v14, s[56:59], s31 offen offset:3072 sc1
v_accvgpr_read_b32 v112, a68
v_accvgpr_read_b32 v113, a69
v_accvgpr_read_b32 v114, a70
v_accvgpr_read_b32 v115, a71
v_accvgpr_read_b32 v116, a84
v_accvgpr_read_b32 v117, a85
v_accvgpr_read_b32 v118, a86
v_accvgpr_read_b32 v119, a87
v_pk_mul_f32 v[112:113], v[112:113], v[52:53] op_sel_hi:[1,0]
v_pk_mul_f32 v[114:115], v[114:115], v[52:53] op_sel_hi:[1,0]
v_pk_mul_f32 v[116:117], v[116:117], v[52:53] op_sel_hi:[1,0]
v_pk_mul_f32 v[118:119], v[118:119], v[52:53] op_sel_hi:[1,0]
v_cvt_pk_bf16_f32 v112, v112, v113
v_cvt_pk_bf16_f32 v113, v114, v115
v_cvt_pk_bf16_f32 v114, v116, v117
v_cvt_pk_bf16_f32 v115, v118, v119
s_add_u32 s31, s30, 262144
buffer_store_dwordx4 v[112:115], v14, s[56:59], s31 offen offset:2048 sc1
v_accvgpr_read_b32 v120, a100
v_accvgpr_read_b32 v121, a101
v_accvgpr_read_b32 v122, a102
v_accvgpr_read_b32 v123, a103
v_accvgpr_read_b32 v124, a116
v_accvgpr_read_b32 v125, a117
v_accvgpr_read_b32 v126, a118
v_accvgpr_read_b32 v127, a119
v_pk_mul_f32 v[120:121], v[120:121], v[52:53] op_sel_hi:[1,0]
v_pk_mul_f32 v[122:123], v[122:123], v[52:53] op_sel_hi:[1,0]
v_pk_mul_f32 v[124:125], v[124:125], v[52:53] op_sel_hi:[1,0]
v_pk_mul_f32 v[126:127], v[126:127], v[52:53] op_sel_hi:[1,0]
v_cvt_pk_bf16_f32 v120, v120, v121
v_cvt_pk_bf16_f32 v121, v122, v123
v_cvt_pk_bf16_f32 v122, v124, v125
v_cvt_pk_bf16_f32 v123, v126, v127
s_add_u32 s31, s30, 262144
buffer_store_dwordx4 v[120:123], v14, s[56:59], s31 offen offset:3072 sc1
v_accvgpr_read_b32 v52, a200
s_nop 0
v_rcp_f32 v52, v52
v_accvgpr_read_b32 v64, a8
v_accvgpr_read_b32 v65, a9
v_accvgpr_read_b32 v66, a10
v_accvgpr_read_b32 v67, a11
v_accvgpr_read_b32 v68, a24
v_accvgpr_read_b32 v69, a25
v_accvgpr_read_b32 v70, a26
v_accvgpr_read_b32 v71, a27
v_pk_mul_f32 v[64:65], v[64:65], v[52:53] op_sel_hi:[1,0]
v_pk_mul_f32 v[66:67], v[66:67], v[52:53] op_sel_hi:[1,0]
v_pk_mul_f32 v[68:69], v[68:69], v[52:53] op_sel_hi:[1,0]
v_pk_mul_f32 v[70:71], v[70:71], v[52:53] op_sel_hi:[1,0]
v_cvt_pk_bf16_f32 v64, v64, v65
v_cvt_pk_bf16_f32 v65, v66, v67
v_cvt_pk_bf16_f32 v66, v68, v69
v_cvt_pk_bf16_f32 v67, v70, v71
s_add_u32 s31, s30, 0
buffer_store_dwordx4 v[64:67], v15, s[56:59], s31 offen offset:0 sc1
v_accvgpr_read_b32 v72, a40
v_accvgpr_read_b32 v73, a41
v_accvgpr_read_b32 v74, a42
v_accvgpr_read_b32 v75, a43
v_accvgpr_read_b32 v76, a56
v_accvgpr_read_b32 v77, a57
v_accvgpr_read_b32 v78, a58
v_accvgpr_read_b32 v79, a59
v_pk_mul_f32 v[72:73], v[72:73], v[52:53] op_sel_hi:[1,0]
v_pk_mul_f32 v[74:75], v[74:75], v[52:53] op_sel_hi:[1,0]
v_pk_mul_f32 v[76:77], v[76:77], v[52:53] op_sel_hi:[1,0]
v_pk_mul_f32 v[78:79], v[78:79], v[52:53] op_sel_hi:[1,0]
v_cvt_pk_bf16_f32 v72, v72, v73
v_cvt_pk_bf16_f32 v73, v74, v75
v_cvt_pk_bf16_f32 v74, v76, v77
v_cvt_pk_bf16_f32 v75, v78, v79
s_add_u32 s31, s30, 0
buffer_store_dwordx4 v[72:75], v15, s[56:59], s31 offen offset:1024 sc1
v_accvgpr_read_b32 v80, a72
v_accvgpr_read_b32 v81, a73
v_accvgpr_read_b32 v82, a74
v_accvgpr_read_b32 v83, a75
v_accvgpr_read_b32 v84, a88
v_accvgpr_read_b32 v85, a89
v_accvgpr_read_b32 v86, a90
v_accvgpr_read_b32 v87, a91
v_pk_mul_f32 v[80:81], v[80:81], v[52:53] op_sel_hi:[1,0]
v_pk_mul_f32 v[82:83], v[82:83], v[52:53] op_sel_hi:[1,0]
v_pk_mul_f32 v[84:85], v[84:85], v[52:53] op_sel_hi:[1,0]
v_pk_mul_f32 v[86:87], v[86:87], v[52:53] op_sel_hi:[1,0]
v_cvt_pk_bf16_f32 v80, v80, v81
v_cvt_pk_bf16_f32 v81, v82, v83
v_cvt_pk_bf16_f32 v82, v84, v85
v_cvt_pk_bf16_f32 v83, v86, v87
s_add_u32 s31, s30, 262144
buffer_store_dwordx4 v[80:83], v15, s[56:59], s31 offen offset:0 sc1
v_accvgpr_read_b32 v88, a104
v_accvgpr_read_b32 v89, a105
v_accvgpr_read_b32 v90, a106
v_accvgpr_read_b32 v91, a107
v_accvgpr_read_b32 v92, a120
v_accvgpr_read_b32 v93, a121
v_accvgpr_read_b32 v94, a122
v_accvgpr_read_b32 v95, a123
v_pk_mul_f32 v[88:89], v[88:89], v[52:53] op_sel_hi:[1,0]
v_pk_mul_f32 v[90:91], v[90:91], v[52:53] op_sel_hi:[1,0]
v_pk_mul_f32 v[92:93], v[92:93], v[52:53] op_sel_hi:[1,0]
v_pk_mul_f32 v[94:95], v[94:95], v[52:53] op_sel_hi:[1,0]
v_cvt_pk_bf16_f32 v88, v88, v89
v_cvt_pk_bf16_f32 v89, v90, v91
v_cvt_pk_bf16_f32 v90, v92, v93
v_cvt_pk_bf16_f32 v91, v94, v95
s_add_u32 s31, s30, 262144
buffer_store_dwordx4 v[88:91], v15, s[56:59], s31 offen offset:1024 sc1
v_accvgpr_read_b32 v52, a204
s_nop 0
v_rcp_f32 v52, v52
v_accvgpr_read_b32 v96, a12
v_accvgpr_read_b32 v97, a13
v_accvgpr_read_b32 v98, a14
v_accvgpr_read_b32 v99, a15
v_accvgpr_read_b32 v100, a28
v_accvgpr_read_b32 v101, a29
v_accvgpr_read_b32 v102, a30
v_accvgpr_read_b32 v103, a31
v_pk_mul_f32 v[96:97], v[96:97], v[52:53] op_sel_hi:[1,0]
v_pk_mul_f32 v[98:99], v[98:99], v[52:53] op_sel_hi:[1,0]
v_pk_mul_f32 v[100:101], v[100:101], v[52:53] op_sel_hi:[1,0]
v_pk_mul_f32 v[102:103], v[102:103], v[52:53] op_sel_hi:[1,0]
v_cvt_pk_bf16_f32 v96, v96, v97
v_cvt_pk_bf16_f32 v97, v98, v99
v_cvt_pk_bf16_f32 v98, v100, v101
v_cvt_pk_bf16_f32 v99, v102, v103
s_add_u32 s31, s30, 0
buffer_store_dwordx4 v[96:99], v15, s[56:59], s31 offen offset:2048 sc1
v_accvgpr_read_b32 v104, a44
v_accvgpr_read_b32 v105, a45
v_accvgpr_read_b32 v106, a46
v_accvgpr_read_b32 v107, a47
v_accvgpr_read_b32 v108, a60
v_accvgpr_read_b32 v109, a61
v_accvgpr_read_b32 v110, a62
v_accvgpr_read_b32 v111, a63
v_pk_mul_f32 v[104:105], v[104:105], v[52:53] op_sel_hi:[1,0]
v_pk_mul_f32 v[106:107], v[106:107], v[52:53] op_sel_hi:[1,0]
v_pk_mul_f32 v[108:109], v[108:109], v[52:53] op_sel_hi:[1,0]
v_pk_mul_f32 v[110:111], v[110:111], v[52:53] op_sel_hi:[1,0]
v_cvt_pk_bf16_f32 v104, v104, v105
v_cvt_pk_bf16_f32 v105, v106, v107
v_cvt_pk_bf16_f32 v106, v108, v109
v_cvt_pk_bf16_f32 v107, v110, v111
s_add_u32 s31, s30, 0
buffer_store_dwordx4 v[104:107], v15, s[56:59], s31 offen offset:3072 sc1
v_accvgpr_read_b32 v112, a76
v_accvgpr_read_b32 v113, a77
v_accvgpr_read_b32 v114, a78
v_accvgpr_read_b32 v115, a79
v_accvgpr_read_b32 v116, a92
v_accvgpr_read_b32 v117, a93
v_accvgpr_read_b32 v118, a94
v_accvgpr_read_b32 v119, a95
v_pk_mul_f32 v[112:113], v[112:113], v[52:53] op_sel_hi:[1,0]
v_pk_mul_f32 v[114:115], v[114:115], v[52:53] op_sel_hi:[1,0]
v_pk_mul_f32 v[116:117], v[116:117], v[52:53] op_sel_hi:[1,0]
v_pk_mul_f32 v[118:119], v[118:119], v[52:53] op_sel_hi:[1,0]
v_cvt_pk_bf16_f32 v112, v112, v113
v_cvt_pk_bf16_f32 v113, v114, v115
v_cvt_pk_bf16_f32 v114, v116, v117
v_cvt_pk_bf16_f32 v115, v118, v119
s_add_u32 s31, s30, 262144
buffer_store_dwordx4 v[112:115], v15, s[56:59], s31 offen offset:2048 sc1
v_accvgpr_read_b32 v120, a108
v_accvgpr_read_b32 v121, a109
v_accvgpr_read_b32 v122, a110
v_accvgpr_read_b32 v123, a111
v_accvgpr_read_b32 v124, a124
v_accvgpr_read_b32 v125, a125
v_accvgpr_read_b32 v126, a126
v_accvgpr_read_b32 v127, a127
v_pk_mul_f32 v[120:121], v[120:121], v[52:53] op_sel_hi:[1,0]
v_pk_mul_f32 v[122:123], v[122:123], v[52:53] op_sel_hi:[1,0]
v_pk_mul_f32 v[124:125], v[124:125], v[52:53] op_sel_hi:[1,0]
v_pk_mul_f32 v[126:127], v[126:127], v[52:53] op_sel_hi:[1,0]
v_cvt_pk_bf16_f32 v120, v120, v121
v_cvt_pk_bf16_f32 v121, v122, v123
v_cvt_pk_bf16_f32 v122, v124, v125
v_cvt_pk_bf16_f32 v123, v126, v127
s_add_u32 s31, s30, 262144
buffer_store_dwordx4 v[120:123], v15, s[56:59], s31 offen offset:3072 sc1
s_lshr_b32 s77, s28, 3
s_waitcnt vmcnt(0)
s_barrier
s_cmp_lg_u32 s24, 0
s_cbranch_scc1 L_sig8
s_lshl_b32 s33, s25, 3
s_add_u32 s33, s33, 64
s_add_u32 s33, s33, s77
s_lshl_b32 s33, s33, 7
v_mov_b32 v2, s33
v_mov_b32 v3, 1
s_mov_b64 exec, 1
global_atomic_add v2, v3, s[34:35]
s_mov_b64 exec, -1
L_sig8:
s_and_b32 s31, s26, 1
s_lshl_b32 s31, s31, 2
s_add_u32 s31, s31, s27
s_lshl_b32 s31, s31, 8
s_lshr_b32 s32, s26, 1
s_mul_i32 s32, s32, 1024
v_lshrrev_b32 v16, 4, v1
v_mul_u32_u24 v17, 32768, v16
v_and_b32 v18, 15, v1
v_lshlrev_b32 v18, 4, v18
v_add3_u32 v4, v17, v18, s31
s_lshl_b32 s30, s24, 2
s_add_u32 s30, s30, s32
s_mul_i32 s64, s30, 2048
s_mul_i32 s65, s24, 4224
s_add_u32 s65, s65, 0
v_lshrrev_b32 v16, 2, v1
v_mul_u32_u24 v11, 1056, v16
v_and_b32 v16, 3, v1
v_lshlrev_b32 v16, 3, v16
v_add_u32 v11, v11, v16
s_mov_b32 s40, s12
s_mov_b32 s41, s13
s_mov_b32 s42, 8388608
s_mov_b32 s43, 0x20000
s_add_u32 m0, s65, 0
s_nop 0
buffer_load_dwordx4 v4, s[40:43], s64 offen lds
s_add_u32 s64, s64, 2048
s_add_u32 m0, s65, 1056
s_nop 0
buffer_load_dwordx4 v4, s[40:43], s64 offen lds
s_add_u32 s64, s64, 2048
s_add_u32 m0, s65, 2112
s_nop 0
buffer_load_dwordx4 v4, s[40:43], s64 offen lds
s_add_u32 s64, s64, 2048
s_add_u32 m0, s65, 3168
s_nop 0
buffer_load_dwordx4 v4, s[40:43], s64 offen lds
s_add_u32 s64, s64, 124928
s_add_u32 m0, s65, 16896
s_nop 0
buffer_load_dwordx4 v4, s[40:43], s64 offen lds
s_add_u32 s64, s64, 2048
s_add_u32 m0, s65, 17952
s_nop 0
buffer_load_dwordx4 v4, s[40:43], s64 offen lds
s_add_u32 s64, s64, 2048
s_add_u32 m0, s65, 19008
s_nop 0
buffer_load_dwordx4 v4, s[40:43], s64 offen lds
s_add_u32 s64, s64, 2048
s_add_u32 m0, s65, 20064
s_nop 0
buffer_load_dwordx4 v4, s[40:43], s64 offen lds
s_add_u32 s44, s22, 4194304
s_addc_u32 s45, s23, 0
s_mov_b32 s46, 16777216
s_mov_b32 s47, 0x20000
s_lshr_b32 s66, s26, 1
s_mul_i32 s66, s66, 4194304
v_mov_b32 v64, 0
v_mov_b32 v65, 0
v_mov_b32 v66, 0
v_mov_b32 v67, 0
v_mov_b32 v68, 0
v_mov_b32 v69, 0
v_mov_b32 v70, 0
v_mov_b32 v71, 0
v_mov_b32 v72, 0
v_mov_b32 v73, 0
v_mov_b32 v74, 0
v_mov_b32 v75, 0
v_mov_b32 v76, 0
v_mov_b32 v77, 0
v_mov_b32 v78, 0
v_mov_b32 v79, 0
v_mov_b32 v80, 0
v_mov_b32 v81, 0
v_mov_b32 v82, 0
v_mov_b32 v83, 0
v_mov_b32 v84, 0
v_mov_b32 v85, 0
v_mov_b32 v86, 0
v_mov_b32 v87, 0
v_mov_b32 v88, 0
v_mov_b32 v89, 0
v_mov_b32 v90, 0
v_mov_b32 v91, 0
v_mov_b32 v92, 0
v_mov_b32 v93, 0
v_mov_b32 v94, 0
v_mov_b32 v95, 0
v_mov_b32 v96, 0
v_mov_b32 v97, 0
v_mov_b32 v98, 0
v_mov_b32 v99, 0
v_mov_b32 v100, 0
v_mov_b32 v101, 0
v_mov_b32 v102, 0
v_mov_b32 v103, 0
v_mov_b32 v104, 0
v_mov_b32 v105, 0
v_mov_b32 v106, 0
v_mov_b32 v107, 0
v_mov_b32 v108, 0
v_mov_b32 v109, 0
v_mov_b32 v110, 0
v_mov_b32 v111, 0
v_mov_b32 v112, 0
v_mov_b32 v113, 0
v_mov_b32 v114, 0
v_mov_b32 v115, 0
v_mov_b32 v116, 0
v_mov_b32 v117, 0
v_mov_b32 v118, 0
v_mov_b32 v119, 0
v_mov_b32 v120, 0
v_mov_b32 v121, 0
v_mov_b32 v122, 0
v_mov_b32 v123, 0
v_mov_b32 v124, 0
v_mov_b32 v125, 0
v_mov_b32 v126, 0
v_mov_b32 v127, 0
v_mov_b32 v128, 0
v_mov_b32 v129, 0
v_mov_b32 v130, 0
v_mov_b32 v131, 0
v_mov_b32 v132, 0
v_mov_b32 v133, 0
v_mov_b32 v134, 0
v_mov_b32 v135, 0
v_mov_b32 v136, 0
v_mov_b32 v137, 0
v_mov_b32 v138, 0
v_mov_b32 v139, 0
v_mov_b32 v140, 0
v_mov_b32 v141, 0
v_mov_b32 v142, 0
v_mov_b32 v143, 0
v_mov_b32 v144, 0
v_mov_b32 v145, 0
v_mov_b32 v146, 0
v_mov_b32 v147, 0
v_mov_b32 v148, 0
v_mov_b32 v149, 0
v_mov_b32 v150, 0
v_mov_b32 v151, 0
v_mov_b32 v152, 0
v_mov_b32 v153, 0
v_mov_b32 v154, 0
v_mov_b32 v155, 0
v_mov_b32 v156, 0
v_mov_b32 v157, 0
v_mov_b32 v158, 0
v_mov_b32 v159, 0
v_mov_b32 v160, 0
v_mov_b32 v161, 0
v_mov_b32 v162, 0
v_mov_b32 v163, 0
v_mov_b32 v164, 0
v_mov_b32 v165, 0
v_mov_b32 v166, 0
v_mov_b32 v167, 0
v_mov_b32 v168, 0
v_mov_b32 v169, 0
v_mov_b32 v170, 0
v_mov_b32 v171, 0
v_mov_b32 v172, 0
v_mov_b32 v173, 0
v_mov_b32 v174, 0
v_mov_b32 v175, 0
v_mov_b32 v176, 0
v_mov_b32 v177, 0
v_mov_b32 v178, 0
v_mov_b32 v179, 0
v_mov_b32 v180, 0
v_mov_b32 v181, 0
v_mov_b32 v182, 0
v_mov_b32 v183, 0
v_mov_b32 v184, 0
v_mov_b32 v185, 0
v_mov_b32 v186, 0
v_mov_b32 v187, 0
v_mov_b32 v188, 0
v_mov_b32 v189, 0
v_mov_b32 v190, 0
v_mov_b32 v191, 0
s_waitcnt vmcnt(4)
s_barrier
ds_read_b64_tr_b16 a[128:129], v11 offset:0
ds_read_b64_tr_b16 a[130:131], v11 offset:256
ds_read_b64_tr_b16 a[132:133], v11 offset:32
ds_read_b64_tr_b16 a[134:135], v11 offset:288
ds_read_b64_tr_b16 a[136:137], v11 offset:64
ds_read_b64_tr_b16 a[138:139], v11 offset:320
ds_read_b64_tr_b16 a[140:141], v11 offset:96
ds_read_b64_tr_b16 a[142:143], v11 offset:352
ds_read_b64_tr_b16 a[144:145], v11 offset:128
ds_read_b64_tr_b16 a[146:147], v11 offset:384
ds_read_b64_tr_b16 a[148:149], v11 offset:160
ds_read_b64_tr_b16 a[150:151], v11 offset:416
s_lshr_b32 s77, s26, 1
s_cmp_lg_u32 s24, 0
s_cbranch_scc1 L_wt9
s_lshl_b32 s33, s25, 3
s_add_u32 s33, s33, 64
s_add_u32 s33, s33, s77
s_lshl_b32 s33, s33, 7
v_mov_b32 v2, s33
s_mov_b32 s32, 1048576
L_poll10:
global_load_dword v3, v2, s[34:35] sc1
s_waitcnt vmcnt(0)
v_readfirstlane_b32 s31, v3
s_nop 0
s_cmp_ge_u32 s31, 8
s_cbranch_scc1 L_pd11
s_sub_u32 s32, s32, 1
s_cmp_eq_u32 s32, 0
s_cbranch_scc1 L_pd11
s_sleep 2
s_branch L_poll10
L_pd11:
L_wt9:
s_barrier
s_add_u32 s48, s22, 20971520
s_addc_u32 s49, s23, 0
s_mov_b32 s50, 16777216
s_mov_b32 s51, 0x20000
s_lshr_b32 s30, s26, 1
s_lshl_b32 s30, s30, 22
s_and_b32 s31, s26, 1
s_lshl_b32 s31, s31, 2
s_add_u32 s31, s31, s27
s_lshl_b32 s31, s31, 19
s_add_u32 s75, s30, s31
s_add_u32 s76, s75, 262144
buffer_load_dwordx4 a[0:3], v14, s[44:47], s66 offen offset:0 sc1
buffer_load_dwordx4 a[4:7], v14, s[44:47], s66 offen offset:2048 sc1
buffer_load_dwordx4 a[8:11], v15, s[44:47], s66 offen offset:0 sc1
buffer_load_dwordx4 a[12:15], v15, s[44:47], s66 offen offset:2048 sc1
buffer_load_dwordx4 a[16:19], v14, s[44:47], s66 offen offset:1024 sc1
buffer_load_dwordx4 a[20:23], v14, s[44:47], s66 offen offset:3072 sc1
buffer_load_dwordx4 a[24:27], v15, s[44:47], s66 offen offset:1024 sc1
buffer_load_dwordx4 a[28:31], v15, s[44:47], s66 offen offset:3072 sc1
s_add_u32 s66, s66, 262144
buffer_load_dwordx4 a[32:35], v14, s[44:47], s66 offen offset:0 sc1
buffer_load_dwordx4 a[36:39], v14, s[44:47], s66 offen offset:2048 sc1
buffer_load_dwordx4 a[40:43], v15, s[44:47], s66 offen offset:0 sc1
buffer_load_dwordx4 a[44:47], v15, s[44:47], s66 offen offset:2048 sc1
s_mov_b32 s29, 3
L_loop_o:
s_waitcnt vmcnt(8)
s_waitcnt lgkmcnt(8)
v_mfma_f32_16x16x32_bf16 v[64:67], a[128:131], a[0:3], v[64:67]
ds_read_b64_tr_b16 a[152:153], v11 offset:192
v_mfma_f32_16x16x32_bf16 v[96:99], a[128:131], a[4:7], v[96:99]
s_add_u32 s64, s64, 124928
s_add_u32 m0, s65, 33792
v_mfma_f32_16x16x32_bf16 v[128:131], a[128:131], a[8:11], v[128:131]
ds_read_b64_tr_b16 a[154:155], v11 offset:448
v_mfma_f32_16x16x32_bf16 v[160:163], a[128:131], a[12:15], v[160:163]
buffer_load_dwordx4 v4, s[40:43], s64 offen lds
v_mfma_f32_16x16x32_bf16 v[164:167], a[132:135], a[12:15], v[164:167]
ds_read_b64_tr_b16 a[156:157], v11 offset:224
v_mfma_f32_16x16x32_bf16 v[132:135], a[132:135], a[8:11], v[132:135]
v_mfma_f32_16x16x32_bf16 v[100:103], a[132:135], a[4:7], v[100:103]
ds_read_b64_tr_b16 a[158:159], v11 offset:480
v_mfma_f32_16x16x32_bf16 v[68:71], a[132:135], a[0:3], v[68:71]
s_add_u32 s64, s64, 2048
s_add_u32 m0, s65, 34848
s_waitcnt lgkmcnt(8)
v_mfma_f32_16x16x32_bf16 v[72:75], a[136:139], a[0:3], v[72:75]
ds_read_b64_tr_b16 a[128:129], v11 offset:512
v_mfma_f32_16x16x32_bf16 v[104:107], a[136:139], a[4:7], v[104:107]
buffer_load_dwordx4 v4, s[40:43], s64 offen lds
v_mfma_f32_16x16x32_bf16 v[136:139], a[136:139], a[8:11], v[136:139]
ds_read_b64_tr_b16 a[130:131], v11 offset:768
v_mfma_f32_16x16x32_bf16 v[168:171], a[136:139], a[12:15], v[168:171]
v_mfma_f32_16x16x32_bf16 v[172:175], a[140:143], a[12:15], v[172:175]
ds_read_b64_tr_b16 a[132:133], v11 offset:544
v_mfma_f32_16x16x32_bf16 v[140:143], a[140:143], a[8:11], v[140:143]
buffer_load_dwordx4 a[48:51], v14, s[44:47], s66 offen offset:1024 sc1
v_mfma_f32_16x16x32_bf16 v[108:111], a[140:143], a[4:7], v[108:111]
ds_read_b64_tr_b16 a[134:135], v11 offset:800
v_mfma_f32_16x16x32_bf16 v[76:79], a[140:143], a[0:3], v[76:79]
s_waitcnt lgkmcnt(8)
v_mfma_f32_16x16x32_bf16 v[80:83], a[144:147], a[0:3], v[80:83]
ds_read_b64_tr_b16 a[136:137], v11 offset:576
v_mfma_f32_16x16x32_bf16 v[112:115], a[144:147], a[4:7], v[112:115]
buffer_load_dwordx4 a[52:55], v14, s[44:47], s66 offen offset:3072 sc1
v_mfma_f32_16x16x32_bf16 v[144:147], a[144:147], a[8:11], v[144:147]
ds_read_b64_tr_b16 a[138:139], v11 offset:832
v_mfma_f32_16x16x32_bf16 v[176:179], a[144:147], a[12:15], v[176:179]
v_mfma_f32_16x16x32_bf16 v[180:183], a[148:151], a[12:15], v[180:183]
ds_read_b64_tr_b16 a[140:141], v11 offset:608
v_mfma_f32_16x16x32_bf16 v[148:151], a[148:151], a[8:11], v[148:151]
v_mfma_f32_16x16x32_bf16 v[116:119], a[148:151], a[4:7], v[116:119]
ds_read_b64_tr_b16 a[142:143], v11 offset:864
v_mfma_f32_16x16x32_bf16 v[84:87], a[148:151], a[0:3], v[84:87]
buffer_load_dwordx4 a[56:59], v15, s[44:47], s66 offen offset:1024 sc1
s_waitcnt lgkmcnt(8)
v_mfma_f32_16x16x32_bf16 v[88:91], a[152:155], a[0:3], v[88:91]
ds_read_b64_tr_b16 a[144:145], v11 offset:640
v_mfma_f32_16x16x32_bf16 v[120:123], a[152:155], a[4:7], v[120:123]
v_mfma_f32_16x16x32_bf16 v[152:155], a[152:155], a[8:11], v[152:155]
ds_read_b64_tr_b16 a[146:147], v11 offset:896
v_mfma_f32_16x16x32_bf16 v[184:187], a[152:155], a[12:15], v[184:187]
v_mfma_f32_16x16x32_bf16 v[188:191], a[156:159], a[12:15], v[188:191]
ds_read_b64_tr_b16 a[148:149], v11 offset:672
v_mfma_f32_16x16x32_bf16 v[156:159], a[156:159], a[8:11], v[156:159]
buffer_load_dwordx4 a[60:63], v15, s[44:47], s66 offen offset:3072 sc1
v_mfma_f32_16x16x32_bf16 v[124:127], a[156:159], a[4:7], v[124:127]
ds_read_b64_tr_b16 a[150:151], v11 offset:928
v_mfma_f32_16x16x32_bf16 v[92:95], a[156:159], a[0:3], v[92:95]
s_waitcnt vmcnt(10)
s_waitcnt lgkmcnt(8)
v_mfma_f32_16x16x32_bf16 v[64:67], a[128:131], a[16:19], v[64:67]
ds_read_b64_tr_b16 a[152:153], v11 offset:704
v_mfma_f32_16x16x32_bf16 v[96:99], a[128:131], a[20:23], v[96:99]
s_add_u32 s64, s64, 2048
s_add_u32 m0, s65, 35904
v_mfma_f32_16x16x32_bf16 v[128:131], a[128:131], a[24:27], v[128:131]
ds_read_b64_tr_b16 a[154:155], v11 offset:960
v_mfma_f32_16x16x32_bf16 v[160:163], a[128:131], a[28:31], v[160:163]
buffer_load_dwordx4 v4, s[40:43], s64 offen lds
v_mfma_f32_16x16x32_bf16 v[164:167], a[132:135], a[28:31], v[164:167]
ds_read_b64_tr_b16 a[156:157], v11 offset:736
v_mfma_f32_16x16x32_bf16 v[132:135], a[132:135], a[24:27], v[132:135]
v_mfma_f32_16x16x32_bf16 v[100:103], a[132:135], a[20:23], v[100:103]
ds_read_b64_tr_b16 a[158:159], v11 offset:992
v_mfma_f32_16x16x32_bf16 v[68:71], a[132:135], a[16:19], v[68:71]
s_add_u32 s64, s64, 2048
s_add_u32 m0, s65, 36960
s_waitcnt lgkmcnt(8)
s_waitcnt vmcnt(11)
s_barrier
v_mfma_f32_16x16x32_bf16 v[72:75], a[136:139], a[16:19], v[72:75]
ds_read_b64_tr_b16 a[128:129], v11 offset:16896
v_mfma_f32_16x16x32_bf16 v[104:107], a[136:139], a[20:23], v[104:107]
buffer_load_dwordx4 v4, s[40:43], s64 offen lds
v_mfma_f32_16x16x32_bf16 v[136:139], a[136:139], a[24:27], v[136:139]
ds_read_b64_tr_b16 a[130:131], v11 offset:17152
v_mfma_f32_16x16x32_bf16 v[168:171], a[136:139], a[28:31], v[168:171]
v_mfma_f32_16x16x32_bf16 v[172:175], a[140:143], a[28:31], v[172:175]
ds_read_b64_tr_b16 a[132:133], v11 offset:16928
v_mfma_f32_16x16x32_bf16 v[140:143], a[140:143], a[24:27], v[140:143]
s_add_u32 s66, s66, 262144
v_mfma_f32_16x16x32_bf16 v[108:111], a[140:143], a[20:23], v[108:111]
ds_read_b64_tr_b16 a[134:135], v11 offset:17184
v_mfma_f32_16x16x32_bf16 v[76:79], a[140:143], a[16:19], v[76:79]
buffer_load_dwordx4 a[0:3], v14, s[44:47], s66 offen offset:0 sc1
s_waitcnt lgkmcnt(8)
v_mfma_f32_16x16x32_bf16 v[80:83], a[144:147], a[16:19], v[80:83]
ds_read_b64_tr_b16 a[136:137], v11 offset:16960
v_mfma_f32_16x16x32_bf16 v[112:115], a[144:147], a[20:23], v[112:115]
buffer_load_dwordx4 a[4:7], v14, s[44:47], s66 offen offset:2048 sc1
v_mfma_f32_16x16x32_bf16 v[144:147], a[144:147], a[24:27], v[144:147]
ds_read_b64_tr_b16 a[138:139], v11 offset:17216
v_mfma_f32_16x16x32_bf16 v[176:179], a[144:147], a[28:31], v[176:179]
v_mfma_f32_16x16x32_bf16 v[180:183], a[148:151], a[28:31], v[180:183]
ds_read_b64_tr_b16 a[140:141], v11 offset:16992
v_mfma_f32_16x16x32_bf16 v[148:151], a[148:151], a[24:27], v[148:151]
v_mfma_f32_16x16x32_bf16 v[116:119], a[148:151], a[20:23], v[116:119]
ds_read_b64_tr_b16 a[142:143], v11 offset:17248
v_mfma_f32_16x16x32_bf16 v[84:87], a[148:151], a[16:19], v[84:87]
buffer_load_dwordx4 a[8:11], v15, s[44:47], s66 offen offset:0 sc1
s_waitcnt lgkmcnt(8)
v_mfma_f32_16x16x32_bf16 v[88:91], a[152:155], a[16:19], v[88:91]
ds_read_b64_tr_b16 a[144:145], v11 offset:17024
v_mfma_f32_16x16x32_bf16 v[120:123], a[152:155], a[20:23], v[120:123]
v_mfma_f32_16x16x32_bf16 v[152:155], a[152:155], a[24:27], v[152:155]
ds_read_b64_tr_b16 a[146:147], v11 offset:17280
v_mfma_f32_16x16x32_bf16 v[184:187], a[152:155], a[28:31], v[184:187]
v_mfma_f32_16x16x32_bf16 v[188:191], a[156:159], a[28:31], v[188:191]
ds_read_b64_tr_b16 a[148:149], v11 offset:17056
v_mfma_f32_16x16x32_bf16 v[156:159], a[156:159], a[24:27], v[156:159]
buffer_load_dwordx4 a[12:15], v15, s[44:47], s66 offen offset:2048 sc1
v_mfma_f32_16x16x32_bf16 v[124:127], a[156:159], a[20:23], v[124:127]
ds_read_b64_tr_b16 a[150:151], v11 offset:17312
v_mfma_f32_16x16x32_bf16 v[92:95], a[156:159], a[16:19], v[92:95]
s_waitcnt vmcnt(12)
s_waitcnt lgkmcnt(8)
v_mfma_f32_16x16x32_bf16 v[64:67], a[128:131], a[32:35], v[64:67]
ds_read_b64_tr_b16 a[152:153], v11 offset:17088
v_mfma_f32_16x16x32_bf16 v[96:99], a[128:131], a[36:39], v[96:99]
s_add_u32 s64, s64, 124928
s_add_u32 m0, s65, 50688
v_mfma_f32_16x16x32_bf16 v[128:131], a[128:131], a[40:43], v[128:131]
ds_read_b64_tr_b16 a[154:155], v11 offset:17344
v_mfma_f32_16x16x32_bf16 v[160:163], a[128:131], a[44:47], v[160:163]
buffer_load_dwordx4 v4, s[40:43], s64 offen lds
v_mfma_f32_16x16x32_bf16 v[164:167], a[132:135], a[44:47], v[164:167]
ds_read_b64_tr_b16 a[156:157], v11 offset:17120
v_mfma_f32_16x16x32_bf16 v[132:135], a[132:135], a[40:43], v[132:135]
v_mfma_f32_16x16x32_bf16 v[100:103], a[132:135], a[36:39], v[100:103]
ds_read_b64_tr_b16 a[158:159], v11 offset:17376
v_mfma_f32_16x16x32_bf16 v[68:71], a[132:135], a[32:35], v[68:71]
s_add_u32 s64, s64, 2048
s_add_u32 m0, s65, 51744
s_waitcnt lgkmcnt(8)
v_mfma_f32_16x16x32_bf16 v[72:75], a[136:139], a[32:35], v[72:75]
ds_read_b64_tr_b16 a[128:129], v11 offset:17408
v_mfma_f32_16x16x32_bf16 v[104:107], a[136:139], a[36:39], v[104:107]
buffer_load_dwordx4 v4, s[40:43], s64 offen lds
v_mfma_f32_16x16x32_bf16 v[136:139], a[136:139], a[40:43], v[136:139]
ds_read_b64_tr_b16 a[130:131], v11 offset:17664
v_mfma_f32_16x16x32_bf16 v[168:171], a[136:139], a[44:47], v[168:171]
v_mfma_f32_16x16x32_bf16 v[172:175], a[140:143], a[44:47], v[172:175]
ds_read_b64_tr_b16 a[132:133], v11 offset:17440
v_mfma_f32_16x16x32_bf16 v[140:143], a[140:143], a[40:43], v[140:143]
buffer_load_dwordx4 a[16:19], v14, s[44:47], s66 offen offset:1024 sc1
v_mfma_f32_16x16x32_bf16 v[108:111], a[140:143], a[36:39], v[108:111]
ds_read_b64_tr_b16 a[134:135], v11 offset:17696
v_mfma_f32_16x16x32_bf16 v[76:79], a[140:143], a[32:35], v[76:79]
s_waitcnt lgkmcnt(8)
v_mfma_f32_16x16x32_bf16 v[80:83], a[144:147], a[32:35], v[80:83]
ds_read_b64_tr_b16 a[136:137], v11 offset:17472
v_mfma_f32_16x16x32_bf16 v[112:115], a[144:147], a[36:39], v[112:115]
buffer_load_dwordx4 a[20:23], v14, s[44:47], s66 offen offset:3072 sc1
v_mfma_f32_16x16x32_bf16 v[144:147], a[144:147], a[40:43], v[144:147]
ds_read_b64_tr_b16 a[138:139], v11 offset:17728
v_mfma_f32_16x16x32_bf16 v[176:179], a[144:147], a[44:47], v[176:179]
v_mfma_f32_16x16x32_bf16 v[180:183], a[148:151], a[44:47], v[180:183]
ds_read_b64_tr_b16 a[140:141], v11 offset:17504
v_mfma_f32_16x16x32_bf16 v[148:151], a[148:151], a[40:43], v[148:151]
v_mfma_f32_16x16x32_bf16 v[116:119], a[148:151], a[36:39], v[116:119]
ds_read_b64_tr_b16 a[142:143], v11 offset:17760
v_mfma_f32_16x16x32_bf16 v[84:87], a[148:151], a[32:35], v[84:87]
buffer_load_dwordx4 a[24:27], v15, s[44:47], s66 offen offset:1024 sc1
s_waitcnt lgkmcnt(8)
v_mfma_f32_16x16x32_bf16 v[88:91], a[152:155], a[32:35], v[88:91]
ds_read_b64_tr_b16 a[144:145], v11 offset:17536
v_mfma_f32_16x16x32_bf16 v[120:123], a[152:155], a[36:39], v[120:123]
v_mfma_f32_16x16x32_bf16 v[152:155], a[152:155], a[40:43], v[152:155]
ds_read_b64_tr_b16 a[146:147], v11 offset:17792
v_mfma_f32_16x16x32_bf16 v[184:187], a[152:155], a[44:47], v[184:187]
v_mfma_f32_16x16x32_bf16 v[188:191], a[156:159], a[44:47], v[188:191]
ds_read_b64_tr_b16 a[148:149], v11 offset:17568
v_mfma_f32_16x16x32_bf16 v[156:159], a[156:159], a[40:43], v[156:159]
buffer_load_dwordx4 a[28:31], v15, s[44:47], s66 offen offset:3072 sc1
v_mfma_f32_16x16x32_bf16 v[124:127], a[156:159], a[36:39], v[124:127]
ds_read_b64_tr_b16 a[150:151], v11 offset:17824
v_mfma_f32_16x16x32_bf16 v[92:95], a[156:159], a[32:35], v[92:95]
s_waitcnt vmcnt(12)
s_waitcnt lgkmcnt(8)
v_mfma_f32_16x16x32_bf16 v[64:67], a[128:131], a[48:51], v[64:67]
ds_read_b64_tr_b16 a[152:153], v11 offset:17600
v_mfma_f32_16x16x32_bf16 v[96:99], a[128:131], a[52:55], v[96:99]
s_add_u32 s64, s64, 2048
s_add_u32 m0, s65, 52800
v_mfma_f32_16x16x32_bf16 v[128:131], a[128:131], a[56:59], v[128:131]
ds_read_b64_tr_b16 a[154:155], v11 offset:17856
v_mfma_f32_16x16x32_bf16 v[160:163], a[128:131], a[60:63], v[160:163]
buffer_load_dwordx4 v4, s[40:43], s64 offen lds
v_mfma_f32_16x16x32_bf16 v[164:167], a[132:135], a[60:63], v[164:167]
ds_read_b64_tr_b16 a[156:157], v11 offset:17632
v_mfma_f32_16x16x32_bf16 v[132:135], a[132:135], a[56:59], v[132:135]
v_mfma_f32_16x16x32_bf16 v[100:103], a[132:135], a[52:55], v[100:103]
ds_read_b64_tr_b16 a[158:159], v11 offset:17888
v_mfma_f32_16x16x32_bf16 v[68:71], a[132:135], a[48:51], v[68:71]
s_add_u32 s64, s64, 2048
s_add_u32 m0, s65, 53856
s_waitcnt lgkmcnt(8)
s_waitcnt vmcnt(11)
s_barrier
v_mfma_f32_16x16x32_bf16 v[72:75], a[136:139], a[48:51], v[72:75]
ds_read_b64_tr_b16 a[128:129], v11 offset:33792
v_mfma_f32_16x16x32_bf16 v[104:107], a[136:139], a[52:55], v[104:107]
buffer_load_dwordx4 v4, s[40:43], s64 offen lds
v_mfma_f32_16x16x32_bf16 v[136:139], a[136:139], a[56:59], v[136:139]
ds_read_b64_tr_b16 a[130:131], v11 offset:34048
v_mfma_f32_16x16x32_bf16 v[168:171], a[136:139], a[60:63], v[168:171]
v_mfma_f32_16x16x32_bf16 v[172:175], a[140:143], a[60:63], v[172:175]
ds_read_b64_tr_b16 a[132:133], v11 offset:33824
v_mfma_f32_16x16x32_bf16 v[140:143], a[140:143], a[56:59], v[140:143]
s_add_u32 s66, s66, 262144
v_mfma_f32_16x16x32_bf16 v[108:111], a[140:143], a[52:55], v[108:111]
ds_read_b64_tr_b16 a[134:135], v11 offset:34080
v_mfma_f32_16x16x32_bf16 v[76:79], a[140:143], a[48:51], v[76:79]
buffer_load_dwordx4 a[32:35], v14, s[44:47], s66 offen offset:0 sc1
s_waitcnt lgkmcnt(8)
v_mfma_f32_16x16x32_bf16 v[80:83], a[144:147], a[48:51], v[80:83]
ds_read_b64_tr_b16 a[136:137], v11 offset:33856
v_mfma_f32_16x16x32_bf16 v[112:115], a[144:147], a[52:55], v[112:115]
buffer_load_dwordx4 a[36:39], v14, s[44:47], s66 offen offset:2048 sc1
v_mfma_f32_16x16x32_bf16 v[144:147], a[144:147], a[56:59], v[144:147]
ds_read_b64_tr_b16 a[138:139], v11 offset:34112
v_mfma_f32_16x16x32_bf16 v[176:179], a[144:147], a[60:63], v[176:179]
v_mfma_f32_16x16x32_bf16 v[180:183], a[148:151], a[60:63], v[180:183]
ds_read_b64_tr_b16 a[140:141], v11 offset:33888
v_mfma_f32_16x16x32_bf16 v[148:151], a[148:151], a[56:59], v[148:151]
v_mfma_f32_16x16x32_bf16 v[116:119], a[148:151], a[52:55], v[116:119]
ds_read_b64_tr_b16 a[142:143], v11 offset:34144
v_mfma_f32_16x16x32_bf16 v[84:87], a[148:151], a[48:51], v[84:87]
buffer_load_dwordx4 a[40:43], v15, s[44:47], s66 offen offset:0 sc1
s_waitcnt lgkmcnt(8)
v_mfma_f32_16x16x32_bf16 v[88:91], a[152:155], a[48:51], v[88:91]
ds_read_b64_tr_b16 a[144:145], v11 offset:33920
v_mfma_f32_16x16x32_bf16 v[120:123], a[152:155], a[52:55], v[120:123]
v_mfma_f32_16x16x32_bf16 v[152:155], a[152:155], a[56:59], v[152:155]
ds_read_b64_tr_b16 a[146:147], v11 offset:34176
v_mfma_f32_16x16x32_bf16 v[184:187], a[152:155], a[60:63], v[184:187]
v_mfma_f32_16x16x32_bf16 v[188:191], a[156:159], a[60:63], v[188:191]
ds_read_b64_tr_b16 a[148:149], v11 offset:33952
v_mfma_f32_16x16x32_bf16 v[156:159], a[156:159], a[56:59], v[156:159]
buffer_load_dwordx4 a[44:47], v15, s[44:47], s66 offen offset:2048 sc1
v_mfma_f32_16x16x32_bf16 v[124:127], a[156:159], a[52:55], v[124:127]
ds_read_b64_tr_b16 a[150:151], v11 offset:34208
v_mfma_f32_16x16x32_bf16 v[92:95], a[156:159], a[48:51], v[92:95]
s_waitcnt vmcnt(12)
s_waitcnt lgkmcnt(8)
v_mfma_f32_16x16x32_bf16 v[64:67], a[128:131], a[0:3], v[64:67]
ds_read_b64_tr_b16 a[152:153], v11 offset:33984
v_mfma_f32_16x16x32_bf16 v[96:99], a[128:131], a[4:7], v[96:99]
s_add_u32 s64, s64, 124928
s_add_u32 m0, s65, 0
v_mfma_f32_16x16x32_bf16 v[128:131], a[128:131], a[8:11], v[128:131]
ds_read_b64_tr_b16 a[154:155], v11 offset:34240
v_mfma_f32_16x16x32_bf16 v[160:163], a[128:131], a[12:15], v[160:163]
buffer_load_dwordx4 v4, s[40:43], s64 offen lds
v_mfma_f32_16x16x32_bf16 v[164:167], a[132:135], a[12:15], v[164:167]
ds_read_b64_tr_b16 a[156:157], v11 offset:34016
v_mfma_f32_16x16x32_bf16 v[132:135], a[132:135], a[8:11], v[132:135]
v_mfma_f32_16x16x32_bf16 v[100:103], a[132:135], a[4:7], v[100:103]
ds_read_b64_tr_b16 a[158:159], v11 offset:34272
v_mfma_f32_16x16x32_bf16 v[68:71], a[132:135], a[0:3], v[68:71]
s_add_u32 s64, s64, 2048
s_add_u32 m0, s65, 1056
s_waitcnt lgkmcnt(8)
v_mfma_f32_16x16x32_bf16 v[72:75], a[136:139], a[0:3], v[72:75]
ds_read_b64_tr_b16 a[128:129], v11 offset:34304
v_mfma_f32_16x16x32_bf16 v[104:107], a[136:139], a[4:7], v[104:107]
buffer_load_dwordx4 v4, s[40:43], s64 offen lds
v_mfma_f32_16x16x32_bf16 v[136:139], a[136:139], a[8:11], v[136:139]
ds_read_b64_tr_b16 a[130:131], v11 offset:34560
v_mfma_f32_16x16x32_bf16 v[168:171], a[136:139], a[12:15], v[168:171]
v_mfma_f32_16x16x32_bf16 v[172:175], a[140:143], a[12:15], v[172:175]
ds_read_b64_tr_b16 a[132:133], v11 offset:34336
v_mfma_f32_16x16x32_bf16 v[140:143], a[140:143], a[8:11], v[140:143]
buffer_load_dwordx4 a[48:51], v14, s[44:47], s66 offen offset:1024 sc1
v_mfma_f32_16x16x32_bf16 v[108:111], a[140:143], a[4:7], v[108:111]
ds_read_b64_tr_b16 a[134:135], v11 offset:34592
v_mfma_f32_16x16x32_bf16 v[76:79], a[140:143], a[0:3], v[76:79]
s_waitcnt lgkmcnt(8)
v_mfma_f32_16x16x32_bf16 v[80:83], a[144:147], a[0:3], v[80:83]
ds_read_b64_tr_b16 a[136:137], v11 offset:34368
v_mfma_f32_16x16x32_bf16 v[112:115], a[144:147], a[4:7], v[112:115]
buffer_load_dwordx4 a[52:55], v14, s[44:47], s66 offen offset:3072 sc1
v_mfma_f32_16x16x32_bf16 v[144:147], a[144:147], a[8:11], v[144:147]
ds_read_b64_tr_b16 a[138:139], v11 offset:34624
v_mfma_f32_16x16x32_bf16 v[176:179], a[144:147], a[12:15], v[176:179]
v_mfma_f32_16x16x32_bf16 v[180:183], a[148:151], a[12:15], v[180:183]
ds_read_b64_tr_b16 a[140:141], v11 offset:34400
v_mfma_f32_16x16x32_bf16 v[148:151], a[148:151], a[8:11], v[148:151]
v_mfma_f32_16x16x32_bf16 v[116:119], a[148:151], a[4:7], v[116:119]
ds_read_b64_tr_b16 a[142:143], v11 offset:34656
v_mfma_f32_16x16x32_bf16 v[84:87], a[148:151], a[0:3], v[84:87]
buffer_load_dwordx4 a[56:59], v15, s[44:47], s66 offen offset:1024 sc1
s_waitcnt lgkmcnt(8)
v_mfma_f32_16x16x32_bf16 v[88:91], a[152:155], a[0:3], v[88:91]
ds_read_b64_tr_b16 a[144:145], v11 offset:34432
v_mfma_f32_16x16x32_bf16 v[120:123], a[152:155], a[4:7], v[120:123]
v_mfma_f32_16x16x32_bf16 v[152:155], a[152:155], a[8:11], v[152:155]
ds_read_b64_tr_b16 a[146:147], v11 offset:34688
v_mfma_f32_16x16x32_bf16 v[184:187], a[152:155], a[12:15], v[184:187]
v_mfma_f32_16x16x32_bf16 v[188:191], a[156:159], a[12:15], v[188:191]
ds_read_b64_tr_b16 a[148:149], v11 offset:34464
v_mfma_f32_16x16x32_bf16 v[156:159], a[156:159], a[8:11], v[156:159]
buffer_load_dwordx4 a[60:63], v15, s[44:47], s66 offen offset:3072 sc1
v_mfma_f32_16x16x32_bf16 v[124:127], a[156:159], a[4:7], v[124:127]
ds_read_b64_tr_b16 a[150:151], v11 offset:34720
v_mfma_f32_16x16x32_bf16 v[92:95], a[156:159], a[0:3], v[92:95]
s_waitcnt vmcnt(12)
s_waitcnt lgkmcnt(8)
v_mfma_f32_16x16x32_bf16 v[64:67], a[128:131], a[16:19], v[64:67]
ds_read_b64_tr_b16 a[152:153], v11 offset:34496
v_mfma_f32_16x16x32_bf16 v[96:99], a[128:131], a[20:23], v[96:99]
s_add_u32 s64, s64, 2048
s_add_u32 m0, s65, 2112
v_mfma_f32_16x16x32_bf16 v[128:131], a[128:131], a[24:27], v[128:131]
ds_read_b64_tr_b16 a[154:155], v11 offset:34752
v_mfma_f32_16x16x32_bf16 v[160:163], a[128:131], a[28:31], v[160:163]
buffer_load_dwordx4 v4, s[40:43], s64 offen lds
v_mfma_f32_16x16x32_bf16 v[164:167], a[132:135], a[28:31], v[164:167]
ds_read_b64_tr_b16 a[156:157], v11 offset:34528
v_mfma_f32_16x16x32_bf16 v[132:135], a[132:135], a[24:27], v[132:135]
v_mfma_f32_16x16x32_bf16 v[100:103], a[132:135], a[20:23], v[100:103]
ds_read_b64_tr_b16 a[158:159], v11 offset:34784
v_mfma_f32_16x16x32_bf16 v[68:71], a[132:135], a[16:19], v[68:71]
s_add_u32 s64, s64, 2048
s_add_u32 m0, s65, 3168
s_waitcnt lgkmcnt(8)
s_waitcnt vmcnt(11)
s_barrier
v_mfma_f32_16x16x32_bf16 v[72:75], a[136:139], a[16:19], v[72:75]
ds_read_b64_tr_b16 a[128:129], v11 offset:50688
v_mfma_f32_16x16x32_bf16 v[104:107], a[136:139], a[20:23], v[104:107]
buffer_load_dwordx4 v4, s[40:43], s64 offen lds
v_mfma_f32_16x16x32_bf16 v[136:139], a[136:139], a[24:27], v[136:139]
ds_read_b64_tr_b16 a[130:131], v11 offset:50944
v_mfma_f32_16x16x32_bf16 v[168:171], a[136:139], a[28:31], v[168:171]
v_mfma_f32_16x16x32_bf16 v[172:175], a[140:143], a[28:31], v[172:175]
ds_read_b64_tr_b16 a[132:133], v11 offset:50720
v_mfma_f32_16x16x32_bf16 v[140:143], a[140:143], a[24:27], v[140:143]
s_add_u32 s66, s66, 262144
v_mfma_f32_16x16x32_bf16 v[108:111], a[140:143], a[20:23], v[108:111]
ds_read_b64_tr_b16 a[134:135], v11 offset:50976
v_mfma_f32_16x16x32_bf16 v[76:79], a[140:143], a[16:19], v[76:79]
buffer_load_dwordx4 a[0:3], v14, s[44:47], s66 offen offset:0 sc1
s_waitcnt lgkmcnt(8)
v_mfma_f32_16x16x32_bf16 v[80:83], a[144:147], a[16:19], v[80:83]
ds_read_b64_tr_b16 a[136:137], v11 offset:50752
v_mfma_f32_16x16x32_bf16 v[112:115], a[144:147], a[20:23], v[112:115]
buffer_load_dwordx4 a[4:7], v14, s[44:47], s66 offen offset:2048 sc1
v_mfma_f32_16x16x32_bf16 v[144:147], a[144:147], a[24:27], v[144:147]
ds_read_b64_tr_b16 a[138:139], v11 offset:51008
v_mfma_f32_16x16x32_bf16 v[176:179], a[144:147], a[28:31], v[176:179]
v_mfma_f32_16x16x32_bf16 v[180:183], a[148:151], a[28:31], v[180:183]
ds_read_b64_tr_b16 a[140:141], v11 offset:50784
v_mfma_f32_16x16x32_bf16 v[148:151], a[148:151], a[24:27], v[148:151]
v_mfma_f32_16x16x32_bf16 v[116:119], a[148:151], a[20:23], v[116:119]
ds_read_b64_tr_b16 a[142:143], v11 offset:51040
v_mfma_f32_16x16x32_bf16 v[84:87], a[148:151], a[16:19], v[84:87]
buffer_load_dwordx4 a[8:11], v15, s[44:47], s66 offen offset:0 sc1
s_waitcnt lgkmcnt(8)
v_mfma_f32_16x16x32_bf16 v[88:91], a[152:155], a[16:19], v[88:91]
ds_read_b64_tr_b16 a[144:145], v11 offset:50816
v_mfma_f32_16x16x32_bf16 v[120:123], a[152:155], a[20:23], v[120:123]
v_mfma_f32_16x16x32_bf16 v[152:155], a[152:155], a[24:27], v[152:155]
ds_read_b64_tr_b16 a[146:147], v11 offset:51072
v_mfma_f32_16x16x32_bf16 v[184:187], a[152:155], a[28:31], v[184:187]
v_mfma_f32_16x16x32_bf16 v[188:191], a[156:159], a[28:31], v[188:191]
ds_read_b64_tr_b16 a[148:149], v11 offset:50848
v_mfma_f32_16x16x32_bf16 v[156:159], a[156:159], a[24:27], v[156:159]
buffer_load_dwordx4 a[12:15], v15, s[44:47], s66 offen offset:2048 sc1
v_mfma_f32_16x16x32_bf16 v[124:127], a[156:159], a[20:23], v[124:127]
ds_read_b64_tr_b16 a[150:151], v11 offset:51104
v_mfma_f32_16x16x32_bf16 v[92:95], a[156:159], a[16:19], v[92:95]
s_waitcnt vmcnt(12)
s_waitcnt lgkmcnt(8)
v_mfma_f32_16x16x32_bf16 v[64:67], a[128:131], a[32:35], v[64:67]
ds_read_b64_tr_b16 a[152:153], v11 offset:50880
v_mfma_f32_16x16x32_bf16 v[96:99], a[128:131], a[36:39], v[96:99]
s_add_u32 s64, s64, 124928
s_add_u32 m0, s65, 16896
v_mfma_f32_16x16x32_bf16 v[128:131], a[128:131], a[40:43], v[128:131]
ds_read_b64_tr_b16 a[154:155], v11 offset:51136
v_mfma_f32_16x16x32_bf16 v[160:163], a[128:131], a[44:47], v[160:163]
buffer_load_dwordx4 v4, s[40:43], s64 offen lds
v_mfma_f32_16x16x32_bf16 v[164:167], a[132:135], a[44:47], v[164:167]
ds_read_b64_tr_b16 a[156:157], v11 offset:50912
v_mfma_f32_16x16x32_bf16 v[132:135], a[132:135], a[40:43], v[132:135]
v_mfma_f32_16x16x32_bf16 v[100:103], a[132:135], a[36:39], v[100:103]
ds_read_b64_tr_b16 a[158:159], v11 offset:51168
v_mfma_f32_16x16x32_bf16 v[68:71], a[132:135], a[32:35], v[68:71]
s_add_u32 s64, s64, 2048
s_add_u32 m0, s65, 17952
s_waitcnt lgkmcnt(8)
v_mfma_f32_16x16x32_bf16 v[72:75], a[136:139], a[32:35], v[72:75]
ds_read_b64_tr_b16 a[128:129], v11 offset:51200
v_mfma_f32_16x16x32_bf16 v[104:107], a[136:139], a[36:39], v[104:107]
buffer_load_dwordx4 v4, s[40:43], s64 offen lds
v_mfma_f32_16x16x32_bf16 v[136:139], a[136:139], a[40:43], v[136:139]
ds_read_b64_tr_b16 a[130:131], v11 offset:51456
v_mfma_f32_16x16x32_bf16 v[168:171], a[136:139], a[44:47], v[168:171]
v_mfma_f32_16x16x32_bf16 v[172:175], a[140:143], a[44:47], v[172:175]
ds_read_b64_tr_b16 a[132:133], v11 offset:51232
v_mfma_f32_16x16x32_bf16 v[140:143], a[140:143], a[40:43], v[140:143]
buffer_load_dwordx4 a[16:19], v14, s[44:47], s66 offen offset:1024 sc1
v_mfma_f32_16x16x32_bf16 v[108:111], a[140:143], a[36:39], v[108:111]
ds_read_b64_tr_b16 a[134:135], v11 offset:51488
v_mfma_f32_16x16x32_bf16 v[76:79], a[140:143], a[32:35], v[76:79]
s_waitcnt lgkmcnt(8)
v_mfma_f32_16x16x32_bf16 v[80:83], a[144:147], a[32:35], v[80:83]
ds_read_b64_tr_b16 a[136:137], v11 offset:51264
v_mfma_f32_16x16x32_bf16 v[112:115], a[144:147], a[36:39], v[112:115]
buffer_load_dwordx4 a[20:23], v14, s[44:47], s66 offen offset:3072 sc1
v_mfma_f32_16x16x32_bf16 v[144:147], a[144:147], a[40:43], v[144:147]
ds_read_b64_tr_b16 a[138:139], v11 offset:51520
v_mfma_f32_16x16x32_bf16 v[176:179], a[144:147], a[44:47], v[176:179]
v_mfma_f32_16x16x32_bf16 v[180:183], a[148:151], a[44:47], v[180:183]
ds_read_b64_tr_b16 a[140:141], v11 offset:51296
v_mfma_f32_16x16x32_bf16 v[148:151], a[148:151], a[40:43], v[148:151]
v_mfma_f32_16x16x32_bf16 v[116:119], a[148:151], a[36:39], v[116:119]
ds_read_b64_tr_b16 a[142:143], v11 offset:51552
v_mfma_f32_16x16x32_bf16 v[84:87], a[148:151], a[32:35], v[84:87]
buffer_load_dwordx4 a[24:27], v15, s[44:47], s66 offen offset:1024 sc1
s_waitcnt lgkmcnt(8)
v_mfma_f32_16x16x32_bf16 v[88:91], a[152:155], a[32:35], v[88:91]
ds_read_b64_tr_b16 a[144:145], v11 offset:51328
v_mfma_f32_16x16x32_bf16 v[120:123], a[152:155], a[36:39], v[120:123]
v_mfma_f32_16x16x32_bf16 v[152:155], a[152:155], a[40:43], v[152:155]
ds_read_b64_tr_b16 a[146:147], v11 offset:51584
v_mfma_f32_16x16x32_bf16 v[184:187], a[152:155], a[44:47], v[184:187]
v_mfma_f32_16x16x32_bf16 v[188:191], a[156:159], a[44:47], v[188:191]
ds_read_b64_tr_b16 a[148:149], v11 offset:51360
v_mfma_f32_16x16x32_bf16 v[156:159], a[156:159], a[40:43], v[156:159]
buffer_load_dwordx4 a[28:31], v15, s[44:47], s66 offen offset:3072 sc1
v_mfma_f32_16x16x32_bf16 v[124:127], a[156:159], a[36:39], v[124:127]
ds_read_b64_tr_b16 a[150:151], v11 offset:51616
v_mfma_f32_16x16x32_bf16 v[92:95], a[156:159], a[32:35], v[92:95]
s_waitcnt vmcnt(12)
s_waitcnt lgkmcnt(8)
v_mfma_f32_16x16x32_bf16 v[64:67], a[128:131], a[48:51], v[64:67]
ds_read_b64_tr_b16 a[152:153], v11 offset:51392
v_mfma_f32_16x16x32_bf16 v[96:99], a[128:131], a[52:55], v[96:99]
s_add_u32 s64, s64, 2048
s_add_u32 m0, s65, 19008
v_mfma_f32_16x16x32_bf16 v[128:131], a[128:131], a[56:59], v[128:131]
ds_read_b64_tr_b16 a[154:155], v11 offset:51648
v_mfma_f32_16x16x32_bf16 v[160:163], a[128:131], a[60:63], v[160:163]
buffer_load_dwordx4 v4, s[40:43], s64 offen lds
v_mfma_f32_16x16x32_bf16 v[164:167], a[132:135], a[60:63], v[164:167]
ds_read_b64_tr_b16 a[156:157], v11 offset:51424
v_mfma_f32_16x16x32_bf16 v[132:135], a[132:135], a[56:59], v[132:135]
v_mfma_f32_16x16x32_bf16 v[100:103], a[132:135], a[52:55], v[100:103]
ds_read_b64_tr_b16 a[158:159], v11 offset:51680
v_mfma_f32_16x16x32_bf16 v[68:71], a[132:135], a[48:51], v[68:71]
s_add_u32 s64, s64, 2048
s_add_u32 m0, s65, 20064
s_waitcnt lgkmcnt(8)
s_waitcnt vmcnt(11)
s_barrier
v_mfma_f32_16x16x32_bf16 v[72:75], a[136:139], a[48:51], v[72:75]
ds_read_b64_tr_b16 a[128:129], v11 offset:0
v_mfma_f32_16x16x32_bf16 v[104:107], a[136:139], a[52:55], v[104:107]
buffer_load_dwordx4 v4, s[40:43], s64 offen lds
v_mfma_f32_16x16x32_bf16 v[136:139], a[136:139], a[56:59], v[136:139]
ds_read_b64_tr_b16 a[130:131], v11 offset:256
v_mfma_f32_16x16x32_bf16 v[168:171], a[136:139], a[60:63], v[168:171]
v_mfma_f32_16x16x32_bf16 v[172:175], a[140:143], a[60:63], v[172:175]
ds_read_b64_tr_b16 a[132:133], v11 offset:32
v_mfma_f32_16x16x32_bf16 v[140:143], a[140:143], a[56:59], v[140:143]
s_add_u32 s66, s66, 262144
v_mfma_f32_16x16x32_bf16 v[108:111], a[140:143], a[52:55], v[108:111]
ds_read_b64_tr_b16 a[134:135], v11 offset:288
v_mfma_f32_16x16x32_bf16 v[76:79], a[140:143], a[48:51], v[76:79]
buffer_load_dwordx4 a[32:35], v14, s[44:47], s66 offen offset:0 sc1
s_waitcnt lgkmcnt(8)
v_mfma_f32_16x16x32_bf16 v[80:83], a[144:147], a[48:51], v[80:83]
ds_read_b64_tr_b16 a[136:137], v11 offset:64
v_mfma_f32_16x16x32_bf16 v[112:115], a[144:147], a[52:55], v[112:115]
buffer_load_dwordx4 a[36:39], v14, s[44:47], s66 offen offset:2048 sc1
v_mfma_f32_16x16x32_bf16 v[144:147], a[144:147], a[56:59], v[144:147]
ds_read_b64_tr_b16 a[138:139], v11 offset:320
v_mfma_f32_16x16x32_bf16 v[176:179], a[144:147], a[60:63], v[176:179]
v_mfma_f32_16x16x32_bf16 v[180:183], a[148:151], a[60:63], v[180:183]
ds_read_b64_tr_b16 a[140:141], v11 offset:96
v_mfma_f32_16x16x32_bf16 v[148:151], a[148:151], a[56:59], v[148:151]
v_mfma_f32_16x16x32_bf16 v[116:119], a[148:151], a[52:55], v[116:119]
ds_read_b64_tr_b16 a[142:143], v11 offset:352
v_mfma_f32_16x16x32_bf16 v[84:87], a[148:151], a[48:51], v[84:87]
buffer_load_dwordx4 a[40:43], v15, s[44:47], s66 offen offset:0 sc1
s_waitcnt lgkmcnt(8)
v_mfma_f32_16x16x32_bf16 v[88:91], a[152:155], a[48:51], v[88:91]
ds_read_b64_tr_b16 a[144:145], v11 offset:128
v_mfma_f32_16x16x32_bf16 v[120:123], a[152:155], a[52:55], v[120:123]
v_mfma_f32_16x16x32_bf16 v[152:155], a[152:155], a[56:59], v[152:155]
ds_read_b64_tr_b16 a[146:147], v11 offset:384
v_mfma_f32_16x16x32_bf16 v[184:187], a[152:155], a[60:63], v[184:187]
v_mfma_f32_16x16x32_bf16 v[188:191], a[156:159], a[60:63], v[188:191]
ds_read_b64_tr_b16 a[148:149], v11 offset:160
v_mfma_f32_16x16x32_bf16 v[156:159], a[156:159], a[56:59], v[156:159]
buffer_load_dwordx4 a[44:47], v15, s[44:47], s66 offen offset:2048 sc1
v_mfma_f32_16x16x32_bf16 v[124:127], a[156:159], a[52:55], v[124:127]
ds_read_b64_tr_b16 a[150:151], v11 offset:416
v_mfma_f32_16x16x32_bf16 v[92:95], a[156:159], a[48:51], v[92:95]
s_sub_u32 s29, s29, 1
s_cmp_lg_u32 s29, 0
s_cbranch_scc1 L_loop_o
s_waitcnt vmcnt(12)
s_waitcnt lgkmcnt(8)
v_mfma_f32_16x16x32_bf16 v[64:67], a[128:131], a[0:3], v[64:67]
ds_read_b64_tr_b16 a[152:153], v11 offset:192
v_mfma_f32_16x16x32_bf16 v[96:99], a[128:131], a[4:7], v[96:99]
s_add_u32 s64, s64, 124928
s_add_u32 m0, s65, 33792
v_mfma_f32_16x16x32_bf16 v[128:131], a[128:131], a[8:11], v[128:131]
ds_read_b64_tr_b16 a[154:155], v11 offset:448
v_mfma_f32_16x16x32_bf16 v[160:163], a[128:131], a[12:15], v[160:163]
buffer_load_dwordx4 v4, s[40:43], s64 offen lds
v_mfma_f32_16x16x32_bf16 v[164:167], a[132:135], a[12:15], v[164:167]
ds_read_b64_tr_b16 a[156:157], v11 offset:224
v_mfma_f32_16x16x32_bf16 v[132:135], a[132:135], a[8:11], v[132:135]
v_mfma_f32_16x16x32_bf16 v[100:103], a[132:135], a[4:7], v[100:103]
ds_read_b64_tr_b16 a[158:159], v11 offset:480
v_mfma_f32_16x16x32_bf16 v[68:71], a[132:135], a[0:3], v[68:71]
s_add_u32 s64, s64, 2048
s_add_u32 m0, s65, 34848
s_waitcnt lgkmcnt(8)
v_mfma_f32_16x16x32_bf16 v[72:75], a[136:139], a[0:3], v[72:75]
ds_read_b64_tr_b16 a[128:129], v11 offset:512
v_mfma_f32_16x16x32_bf16 v[104:107], a[136:139], a[4:7], v[104:107]
buffer_load_dwordx4 v4, s[40:43], s64 offen lds
v_mfma_f32_16x16x32_bf16 v[136:139], a[136:139], a[8:11], v[136:139]
ds_read_b64_tr_b16 a[130:131], v11 offset:768
v_mfma_f32_16x16x32_bf16 v[168:171], a[136:139], a[12:15], v[168:171]
v_mfma_f32_16x16x32_bf16 v[172:175], a[140:143], a[12:15], v[172:175]
ds_read_b64_tr_b16 a[132:133], v11 offset:544
v_mfma_f32_16x16x32_bf16 v[140:143], a[140:143], a[8:11], v[140:143]
buffer_load_dwordx4 a[48:51], v14, s[44:47], s66 offen offset:1024 sc1
v_mfma_f32_16x16x32_bf16 v[108:111], a[140:143], a[4:7], v[108:111]
ds_read_b64_tr_b16 a[134:135], v11 offset:800
v_mfma_f32_16x16x32_bf16 v[76:79], a[140:143], a[0:3], v[76:79]
s_waitcnt lgkmcnt(8)
v_mfma_f32_16x16x32_bf16 v[80:83], a[144:147], a[0:3], v[80:83]
ds_read_b64_tr_b16 a[136:137], v11 offset:576
v_mfma_f32_16x16x32_bf16 v[112:115], a[144:147], a[4:7], v[112:115]
buffer_load_dwordx4 a[52:55], v14, s[44:47], s66 offen offset:3072 sc1
v_mfma_f32_16x16x32_bf16 v[144:147], a[144:147], a[8:11], v[144:147]
ds_read_b64_tr_b16 a[138:139], v11 offset:832
v_mfma_f32_16x16x32_bf16 v[176:179], a[144:147], a[12:15], v[176:179]
v_mfma_f32_16x16x32_bf16 v[180:183], a[148:151], a[12:15], v[180:183]
ds_read_b64_tr_b16 a[140:141], v11 offset:608
v_mfma_f32_16x16x32_bf16 v[148:151], a[148:151], a[8:11], v[148:151]
v_mfma_f32_16x16x32_bf16 v[116:119], a[148:151], a[4:7], v[116:119]
ds_read_b64_tr_b16 a[142:143], v11 offset:864
v_mfma_f32_16x16x32_bf16 v[84:87], a[148:151], a[0:3], v[84:87]
buffer_load_dwordx4 a[56:59], v15, s[44:47], s66 offen offset:1024 sc1
s_waitcnt lgkmcnt(8)
v_mfma_f32_16x16x32_bf16 v[88:91], a[152:155], a[0:3], v[88:91]
ds_read_b64_tr_b16 a[144:145], v11 offset:640
v_mfma_f32_16x16x32_bf16 v[120:123], a[152:155], a[4:7], v[120:123]
v_mfma_f32_16x16x32_bf16 v[152:155], a[152:155], a[8:11], v[152:155]
ds_read_b64_tr_b16 a[146:147], v11 offset:896
v_mfma_f32_16x16x32_bf16 v[184:187], a[152:155], a[12:15], v[184:187]
v_mfma_f32_16x16x32_bf16 v[188:191], a[156:159], a[12:15], v[188:191]
ds_read_b64_tr_b16 a[148:149], v11 offset:672
v_mfma_f32_16x16x32_bf16 v[156:159], a[156:159], a[8:11], v[156:159]
buffer_load_dwordx4 a[60:63], v15, s[44:47], s66 offen offset:3072 sc1
v_mfma_f32_16x16x32_bf16 v[124:127], a[156:159], a[4:7], v[124:127]
ds_read_b64_tr_b16 a[150:151], v11 offset:928
v_mfma_f32_16x16x32_bf16 v[92:95], a[156:159], a[0:3], v[92:95]
s_waitcnt vmcnt(12)
s_waitcnt lgkmcnt(8)
v_mfma_f32_16x16x32_bf16 v[64:67], a[128:131], a[16:19], v[64:67]
ds_read_b64_tr_b16 a[152:153], v11 offset:704
v_mfma_f32_16x16x32_bf16 v[96:99], a[128:131], a[20:23], v[96:99]
s_add_u32 s64, s64, 2048
s_add_u32 m0, s65, 35904
v_mfma_f32_16x16x32_bf16 v[128:131], a[128:131], a[24:27], v[128:131]
ds_read_b64_tr_b16 a[154:155], v11 offset:960
v_mfma_f32_16x16x32_bf16 v[160:163], a[128:131], a[28:31], v[160:163]
buffer_load_dwordx4 v4, s[40:43], s64 offen lds
v_mfma_f32_16x16x32_bf16 v[164:167], a[132:135], a[28:31], v[164:167]
ds_read_b64_tr_b16 a[156:157], v11 offset:736
v_mfma_f32_16x16x32_bf16 v[132:135], a[132:135], a[24:27], v[132:135]
v_mfma_f32_16x16x32_bf16 v[100:103], a[132:135], a[20:23], v[100:103]
ds_read_b64_tr_b16 a[158:159], v11 offset:992
v_mfma_f32_16x16x32_bf16 v[68:71], a[132:135], a[16:19], v[68:71]
s_add_u32 s64, s64, 2048
s_add_u32 m0, s65, 36960
s_waitcnt lgkmcnt(8)
s_waitcnt vmcnt(11)
s_barrier
v_mfma_f32_16x16x32_bf16 v[72:75], a[136:139], a[16:19], v[72:75]
ds_read_b64_tr_b16 a[128:129], v11 offset:16896
v_mfma_f32_16x16x32_bf16 v[104:107], a[136:139], a[20:23], v[104:107]
buffer_load_dwordx4 v4, s[40:43], s64 offen lds
v_mfma_f32_16x16x32_bf16 v[136:139], a[136:139], a[24:27], v[136:139]
ds_read_b64_tr_b16 a[130:131], v11 offset:17152
v_mfma_f32_16x16x32_bf16 v[168:171], a[136:139], a[28:31], v[168:171]
v_mfma_f32_16x16x32_bf16 v[172:175], a[140:143], a[28:31], v[172:175]
ds_read_b64_tr_b16 a[132:133], v11 offset:16928
v_mfma_f32_16x16x32_bf16 v[140:143], a[140:143], a[24:27], v[140:143]
s_add_u32 s66, s66, 262144
v_mfma_f32_16x16x32_bf16 v[108:111], a[140:143], a[20:23], v[108:111]
ds_read_b64_tr_b16 a[134:135], v11 offset:17184
v_mfma_f32_16x16x32_bf16 v[76:79], a[140:143], a[16:19], v[76:79]
buffer_load_dwordx4 a[0:3], v14, s[44:47], s66 offen offset:0 sc1
s_waitcnt lgkmcnt(8)
v_mfma_f32_16x16x32_bf16 v[80:83], a[144:147], a[16:19], v[80:83]
ds_read_b64_tr_b16 a[136:137], v11 offset:16960
v_mfma_f32_16x16x32_bf16 v[112:115], a[144:147], a[20:23], v[112:115]
buffer_load_dwordx4 a[4:7], v14, s[44:47], s66 offen offset:2048 sc1
v_mfma_f32_16x16x32_bf16 v[144:147], a[144:147], a[24:27], v[144:147]
ds_read_b64_tr_b16 a[138:139], v11 offset:17216
v_mfma_f32_16x16x32_bf16 v[176:179], a[144:147], a[28:31], v[176:179]
v_mfma_f32_16x16x32_bf16 v[180:183], a[148:151], a[28:31], v[180:183]
ds_read_b64_tr_b16 a[140:141], v11 offset:16992
v_mfma_f32_16x16x32_bf16 v[148:151], a[148:151], a[24:27], v[148:151]
v_mfma_f32_16x16x32_bf16 v[116:119], a[148:151], a[20:23], v[116:119]
ds_read_b64_tr_b16 a[142:143], v11 offset:17248
v_mfma_f32_16x16x32_bf16 v[84:87], a[148:151], a[16:19], v[84:87]
buffer_load_dwordx4 a[8:11], v15, s[44:47], s66 offen offset:0 sc1
s_waitcnt lgkmcnt(8)
v_mfma_f32_16x16x32_bf16 v[88:91], a[152:155], a[16:19], v[88:91]
ds_read_b64_tr_b16 a[144:145], v11 offset:17024
v_mfma_f32_16x16x32_bf16 v[120:123], a[152:155], a[20:23], v[120:123]
v_mfma_f32_16x16x32_bf16 v[152:155], a[152:155], a[24:27], v[152:155]
ds_read_b64_tr_b16 a[146:147], v11 offset:17280
v_mfma_f32_16x16x32_bf16 v[184:187], a[152:155], a[28:31], v[184:187]
v_mfma_f32_16x16x32_bf16 v[188:191], a[156:159], a[28:31], v[188:191]
ds_read_b64_tr_b16 a[148:149], v11 offset:17056
v_mfma_f32_16x16x32_bf16 v[156:159], a[156:159], a[24:27], v[156:159]
buffer_load_dwordx4 a[12:15], v15, s[44:47], s66 offen offset:2048 sc1
v_mfma_f32_16x16x32_bf16 v[124:127], a[156:159], a[20:23], v[124:127]
ds_read_b64_tr_b16 a[150:151], v11 offset:17312
v_mfma_f32_16x16x32_bf16 v[92:95], a[156:159], a[16:19], v[92:95]
s_waitcnt vmcnt(12)
s_waitcnt lgkmcnt(8)
v_mfma_f32_16x16x32_bf16 v[64:67], a[128:131], a[32:35], v[64:67]
ds_read_b64_tr_b16 a[152:153], v11 offset:17088
v_mfma_f32_16x16x32_bf16 v[96:99], a[128:131], a[36:39], v[96:99]
s_add_u32 s64, s64, 124928
s_add_u32 m0, s65, 50688
v_mfma_f32_16x16x32_bf16 v[128:131], a[128:131], a[40:43], v[128:131]
ds_read_b64_tr_b16 a[154:155], v11 offset:17344
v_mfma_f32_16x16x32_bf16 v[160:163], a[128:131], a[44:47], v[160:163]
buffer_load_dwordx4 v4, s[40:43], s64 offen lds
v_mfma_f32_16x16x32_bf16 v[164:167], a[132:135], a[44:47], v[164:167]
ds_read_b64_tr_b16 a[156:157], v11 offset:17120
v_mfma_f32_16x16x32_bf16 v[132:135], a[132:135], a[40:43], v[132:135]
v_mfma_f32_16x16x32_bf16 v[100:103], a[132:135], a[36:39], v[100:103]
ds_read_b64_tr_b16 a[158:159], v11 offset:17376
v_mfma_f32_16x16x32_bf16 v[68:71], a[132:135], a[32:35], v[68:71]
s_add_u32 s64, s64, 2048
s_add_u32 m0, s65, 51744
s_waitcnt lgkmcnt(8)
v_mfma_f32_16x16x32_bf16 v[72:75], a[136:139], a[32:35], v[72:75]
ds_read_b64_tr_b16 a[128:129], v11 offset:17408
v_mfma_f32_16x16x32_bf16 v[104:107], a[136:139], a[36:39], v[104:107]
buffer_load_dwordx4 v4, s[40:43], s64 offen lds
v_mfma_f32_16x16x32_bf16 v[136:139], a[136:139], a[40:43], v[136:139]
ds_read_b64_tr_b16 a[130:131], v11 offset:17664
v_mfma_f32_16x16x32_bf16 v[168:171], a[136:139], a[44:47], v[168:171]
v_mfma_f32_16x16x32_bf16 v[172:175], a[140:143], a[44:47], v[172:175]
ds_read_b64_tr_b16 a[132:133], v11 offset:17440
v_mfma_f32_16x16x32_bf16 v[140:143], a[140:143], a[40:43], v[140:143]
buffer_load_dwordx4 a[16:19], v14, s[44:47], s66 offen offset:1024 sc1
v_mfma_f32_16x16x32_bf16 v[108:111], a[140:143], a[36:39], v[108:111]
ds_read_b64_tr_b16 a[134:135], v11 offset:17696
v_mfma_f32_16x16x32_bf16 v[76:79], a[140:143], a[32:35], v[76:79]
s_waitcnt lgkmcnt(8)
v_mfma_f32_16x16x32_bf16 v[80:83], a[144:147], a[32:35], v[80:83]
ds_read_b64_tr_b16 a[136:137], v11 offset:17472
v_mfma_f32_16x16x32_bf16 v[112:115], a[144:147], a[36:39], v[112:115]
buffer_load_dwordx4 a[20:23], v14, s[44:47], s66 offen offset:3072 sc1
v_mfma_f32_16x16x32_bf16 v[144:147], a[144:147], a[40:43], v[144:147]
ds_read_b64_tr_b16 a[138:139], v11 offset:17728
v_mfma_f32_16x16x32_bf16 v[176:179], a[144:147], a[44:47], v[176:179]
v_mfma_f32_16x16x32_bf16 v[180:183], a[148:151], a[44:47], v[180:183]
ds_read_b64_tr_b16 a[140:141], v11 offset:17504
v_mfma_f32_16x16x32_bf16 v[148:151], a[148:151], a[40:43], v[148:151]
v_mfma_f32_16x16x32_bf16 v[116:119], a[148:151], a[36:39], v[116:119]
ds_read_b64_tr_b16 a[142:143], v11 offset:17760
v_mfma_f32_16x16x32_bf16 v[84:87], a[148:151], a[32:35], v[84:87]
buffer_load_dwordx4 a[24:27], v15, s[44:47], s66 offen offset:1024 sc1
s_waitcnt lgkmcnt(8)
v_mfma_f32_16x16x32_bf16 v[88:91], a[152:155], a[32:35], v[88:91]
ds_read_b64_tr_b16 a[144:145], v11 offset:17536
v_mfma_f32_16x16x32_bf16 v[120:123], a[152:155], a[36:39], v[120:123]
v_mfma_f32_16x16x32_bf16 v[152:155], a[152:155], a[40:43], v[152:155]
ds_read_b64_tr_b16 a[146:147], v11 offset:17792
v_mfma_f32_16x16x32_bf16 v[184:187], a[152:155], a[44:47], v[184:187]
v_mfma_f32_16x16x32_bf16 v[188:191], a[156:159], a[44:47], v[188:191]
ds_read_b64_tr_b16 a[148:149], v11 offset:17568
v_mfma_f32_16x16x32_bf16 v[156:159], a[156:159], a[40:43], v[156:159]
buffer_load_dwordx4 a[28:31], v15, s[44:47], s66 offen offset:3072 sc1
v_mfma_f32_16x16x32_bf16 v[124:127], a[156:159], a[36:39], v[124:127]
ds_read_b64_tr_b16 a[150:151], v11 offset:17824
v_mfma_f32_16x16x32_bf16 v[92:95], a[156:159], a[32:35], v[92:95]
s_waitcnt vmcnt(12)
s_waitcnt lgkmcnt(8)
v_mfma_f32_16x16x32_bf16 v[64:67], a[128:131], a[48:51], v[64:67]
ds_read_b64_tr_b16 a[152:153], v11 offset:17600
v_mfma_f32_16x16x32_bf16 v[96:99], a[128:131], a[52:55], v[96:99]
s_add_u32 s64, s64, 2048
s_add_u32 m0, s65, 52800
v_mfma_f32_16x16x32_bf16 v[128:131], a[128:131], a[56:59], v[128:131]
ds_read_b64_tr_b16 a[154:155], v11 offset:17856
v_mfma_f32_16x16x32_bf16 v[160:163], a[128:131], a[60:63], v[160:163]
buffer_load_dwordx4 v4, s[40:43], s64 offen lds
v_mfma_f32_16x16x32_bf16 v[164:167], a[132:135], a[60:63], v[164:167]
ds_read_b64_tr_b16 a[156:157], v11 offset:17632
v_mfma_f32_16x16x32_bf16 v[132:135], a[132:135], a[56:59], v[132:135]
v_mfma_f32_16x16x32_bf16 v[100:103], a[132:135], a[52:55], v[100:103]
ds_read_b64_tr_b16 a[158:159], v11 offset:17888
v_mfma_f32_16x16x32_bf16 v[68:71], a[132:135], a[48:51], v[68:71]
s_add_u32 s64, s64, 2048
s_add_u32 m0, s65, 53856
s_waitcnt lgkmcnt(8)
s_waitcnt vmcnt(11)
s_barrier
v_mfma_f32_16x16x32_bf16 v[72:75], a[136:139], a[48:51], v[72:75]
ds_read_b64_tr_b16 a[128:129], v11 offset:33792
v_mfma_f32_16x16x32_bf16 v[104:107], a[136:139], a[52:55], v[104:107]
buffer_load_dwordx4 v4, s[40:43], s64 offen lds
v_mfma_f32_16x16x32_bf16 v[136:139], a[136:139], a[56:59], v[136:139]
ds_read_b64_tr_b16 a[130:131], v11 offset:34048
v_mfma_f32_16x16x32_bf16 v[168:171], a[136:139], a[60:63], v[168:171]
v_mfma_f32_16x16x32_bf16 v[172:175], a[140:143], a[60:63], v[172:175]
ds_read_b64_tr_b16 a[132:133], v11 offset:33824
v_mfma_f32_16x16x32_bf16 v[140:143], a[140:143], a[56:59], v[140:143]
s_add_u32 s66, s66, 262144
v_mfma_f32_16x16x32_bf16 v[108:111], a[140:143], a[52:55], v[108:111]
ds_read_b64_tr_b16 a[134:135], v11 offset:34080
v_mfma_f32_16x16x32_bf16 v[76:79], a[140:143], a[48:51], v[76:79]
buffer_load_dwordx4 a[32:35], v14, s[44:47], s66 offen offset:0 sc1
s_waitcnt lgkmcnt(8)
v_mfma_f32_16x16x32_bf16 v[80:83], a[144:147], a[48:51], v[80:83]
ds_read_b64_tr_b16 a[136:137], v11 offset:33856
v_mfma_f32_16x16x32_bf16 v[112:115], a[144:147], a[52:55], v[112:115]
buffer_load_dwordx4 a[36:39], v14, s[44:47], s66 offen offset:2048 sc1
v_mfma_f32_16x16x32_bf16 v[144:147], a[144:147], a[56:59], v[144:147]
ds_read_b64_tr_b16 a[138:139], v11 offset:34112
v_mfma_f32_16x16x32_bf16 v[176:179], a[144:147], a[60:63], v[176:179]
v_mfma_f32_16x16x32_bf16 v[180:183], a[148:151], a[60:63], v[180:183]
ds_read_b64_tr_b16 a[140:141], v11 offset:33888
v_mfma_f32_16x16x32_bf16 v[148:151], a[148:151], a[56:59], v[148:151]
v_mfma_f32_16x16x32_bf16 v[116:119], a[148:151], a[52:55], v[116:119]
ds_read_b64_tr_b16 a[142:143], v11 offset:34144
v_mfma_f32_16x16x32_bf16 v[84:87], a[148:151], a[48:51], v[84:87]
buffer_load_dwordx4 a[40:43], v15, s[44:47], s66 offen offset:0 sc1
s_waitcnt lgkmcnt(8)
v_mfma_f32_16x16x32_bf16 v[88:91], a[152:155], a[48:51], v[88:91]
ds_read_b64_tr_b16 a[144:145], v11 offset:33920
v_mfma_f32_16x16x32_bf16 v[120:123], a[152:155], a[52:55], v[120:123]
v_mfma_f32_16x16x32_bf16 v[152:155], a[152:155], a[56:59], v[152:155]
ds_read_b64_tr_b16 a[146:147], v11 offset:34176
v_mfma_f32_16x16x32_bf16 v[184:187], a[152:155], a[60:63], v[184:187]
v_mfma_f32_16x16x32_bf16 v[188:191], a[156:159], a[60:63], v[188:191]
ds_read_b64_tr_b16 a[148:149], v11 offset:33952
v_mfma_f32_16x16x32_bf16 v[156:159], a[156:159], a[56:59], v[156:159]
buffer_load_dwordx4 a[44:47], v15, s[44:47], s66 offen offset:2048 sc1
v_mfma_f32_16x16x32_bf16 v[124:127], a[156:159], a[52:55], v[124:127]
ds_read_b64_tr_b16 a[150:151], v11 offset:34208
v_mfma_f32_16x16x32_bf16 v[92:95], a[156:159], a[48:51], v[92:95]
s_waitcnt vmcnt(12)
s_waitcnt lgkmcnt(8)
v_mfma_f32_16x16x32_bf16 v[64:67], a[128:131], a[0:3], v[64:67]
ds_read_b64_tr_b16 a[152:153], v11 offset:33984
v_mfma_f32_16x16x32_bf16 v[96:99], a[128:131], a[4:7], v[96:99]
v_mfma_f32_16x16x32_bf16 v[128:131], a[128:131], a[8:11], v[128:131]
ds_read_b64_tr_b16 a[154:155], v11 offset:34240
v_mfma_f32_16x16x32_bf16 v[160:163], a[128:131], a[12:15], v[160:163]
buffer_load_dwordx4 a[48:51], v14, s[44:47], s66 offen offset:1024 sc1
v_mfma_f32_16x16x32_bf16 v[164:167], a[132:135], a[12:15], v[164:167]
ds_read_b64_tr_b16 a[156:157], v11 offset:34016
v_mfma_f32_16x16x32_bf16 v[132:135], a[132:135], a[8:11], v[132:135]
v_mfma_f32_16x16x32_bf16 v[100:103], a[132:135], a[4:7], v[100:103]
ds_read_b64_tr_b16 a[158:159], v11 offset:34272
v_mfma_f32_16x16x32_bf16 v[68:71], a[132:135], a[0:3], v[68:71]
s_waitcnt lgkmcnt(8)
v_mfma_f32_16x16x32_bf16 v[72:75], a[136:139], a[0:3], v[72:75]
ds_read_b64_tr_b16 a[128:129], v11 offset:34304
v_mfma_f32_16x16x32_bf16 v[104:107], a[136:139], a[4:7], v[104:107]
v_mfma_f32_16x16x32_bf16 v[136:139], a[136:139], a[8:11], v[136:139]
ds_read_b64_tr_b16 a[130:131], v11 offset:34560
v_mfma_f32_16x16x32_bf16 v[168:171], a[136:139], a[12:15], v[168:171]
buffer_load_dwordx4 a[52:55], v14, s[44:47], s66 offen offset:3072 sc1
v_mfma_f32_16x16x32_bf16 v[172:175], a[140:143], a[12:15], v[172:175]
ds_read_b64_tr_b16 a[132:133], v11 offset:34336
v_mfma_f32_16x16x32_bf16 v[140:143], a[140:143], a[8:11], v[140:143]
v_mfma_f32_16x16x32_bf16 v[108:111], a[140:143], a[4:7], v[108:111]
ds_read_b64_tr_b16 a[134:135], v11 offset:34592
v_mfma_f32_16x16x32_bf16 v[76:79], a[140:143], a[0:3], v[76:79]
s_waitcnt lgkmcnt(8)
v_mfma_f32_16x16x32_bf16 v[80:83], a[144:147], a[0:3], v[80:83]
ds_read_b64_tr_b16 a[136:137], v11 offset:34368
v_mfma_f32_16x16x32_bf16 v[112:115], a[144:147], a[4:7], v[112:115]
v_mfma_f32_16x16x32_bf16 v[144:147], a[144:147], a[8:11], v[144:147]
ds_read_b64_tr_b16 a[138:139], v11 offset:34624
v_mfma_f32_16x16x32_bf16 v[176:179], a[144:147], a[12:15], v[176:179]
buffer_load_dwordx4 a[56:59], v15, s[44:47], s66 offen offset:1024 sc1
v_mfma_f32_16x16x32_bf16 v[180:183], a[148:151], a[12:15], v[180:183]
ds_read_b64_tr_b16 a[140:141], v11 offset:34400
v_mfma_f32_16x16x32_bf16 v[148:151], a[148:151], a[8:11], v[148:151]
v_mfma_f32_16x16x32_bf16 v[116:119], a[148:151], a[4:7], v[116:119]
ds_read_b64_tr_b16 a[142:143], v11 offset:34656
v_mfma_f32_16x16x32_bf16 v[84:87], a[148:151], a[0:3], v[84:87]
s_waitcnt lgkmcnt(8)
v_mfma_f32_16x16x32_bf16 v[88:91], a[152:155], a[0:3], v[88:91]
ds_read_b64_tr_b16 a[144:145], v11 offset:34432
v_mfma_f32_16x16x32_bf16 v[120:123], a[152:155], a[4:7], v[120:123]
v_mfma_f32_16x16x32_bf16 v[152:155], a[152:155], a[8:11], v[152:155]
ds_read_b64_tr_b16 a[146:147], v11 offset:34688
v_mfma_f32_16x16x32_bf16 v[184:187], a[152:155], a[12:15], v[184:187]
buffer_load_dwordx4 a[60:63], v15, s[44:47], s66 offen offset:3072 sc1
v_mfma_f32_16x16x32_bf16 v[188:191], a[156:159], a[12:15], v[188:191]
ds_read_b64_tr_b16 a[148:149], v11 offset:34464
v_mfma_f32_16x16x32_bf16 v[156:159], a[156:159], a[8:11], v[156:159]
v_mfma_f32_16x16x32_bf16 v[124:127], a[156:159], a[4:7], v[124:127]
ds_read_b64_tr_b16 a[150:151], v11 offset:34720
v_mfma_f32_16x16x32_bf16 v[92:95], a[156:159], a[0:3], v[92:95]
s_waitcnt vmcnt(10)
s_waitcnt lgkmcnt(8)
v_mfma_f32_16x16x32_bf16 v[64:67], a[128:131], a[16:19], v[64:67]
ds_read_b64_tr_b16 a[152:153], v11 offset:34496
v_mfma_f32_16x16x32_bf16 v[96:99], a[128:131], a[20:23], v[96:99]
v_mfma_f32_16x16x32_bf16 v[128:131], a[128:131], a[24:27], v[128:131]
ds_read_b64_tr_b16 a[154:155], v11 offset:34752
v_mfma_f32_16x16x32_bf16 v[160:163], a[128:131], a[28:31], v[160:163]
v_mfma_f32_16x16x32_bf16 v[164:167], a[132:135], a[28:31], v[164:167]
ds_read_b64_tr_b16 a[156:157], v11 offset:34528
v_mfma_f32_16x16x32_bf16 v[132:135], a[132:135], a[24:27], v[132:135]
v_mfma_f32_16x16x32_bf16 v[100:103], a[132:135], a[20:23], v[100:103]
ds_read_b64_tr_b16 a[158:159], v11 offset:34784
v_mfma_f32_16x16x32_bf16 v[68:71], a[132:135], a[16:19], v[68:71]
s_waitcnt lgkmcnt(8)
s_waitcnt vmcnt(8)
s_barrier
v_mfma_f32_16x16x32_bf16 v[72:75], a[136:139], a[16:19], v[72:75]
ds_read_b64_tr_b16 a[128:129], v11 offset:50688
v_mfma_f32_16x16x32_bf16 v[104:107], a[136:139], a[20:23], v[104:107]
v_mfma_f32_16x16x32_bf16 v[136:139], a[136:139], a[24:27], v[136:139]
ds_read_b64_tr_b16 a[130:131], v11 offset:50944
v_mfma_f32_16x16x32_bf16 v[168:171], a[136:139], a[28:31], v[168:171]
v_mfma_f32_16x16x32_bf16 v[172:175], a[140:143], a[28:31], v[172:175]
ds_read_b64_tr_b16 a[132:133], v11 offset:50720
v_mfma_f32_16x16x32_bf16 v[140:143], a[140:143], a[24:27], v[140:143]
v_mfma_f32_16x16x32_bf16 v[108:111], a[140:143], a[20:23], v[108:111]
ds_read_b64_tr_b16 a[134:135], v11 offset:50976
v_mfma_f32_16x16x32_bf16 v[76:79], a[140:143], a[16:19], v[76:79]
s_waitcnt lgkmcnt(8)
v_mfma_f32_16x16x32_bf16 v[80:83], a[144:147], a[16:19], v[80:83]
ds_read_b64_tr_b16 a[136:137], v11 offset:50752
v_mfma_f32_16x16x32_bf16 v[112:115], a[144:147], a[20:23], v[112:115]
v_mfma_f32_16x16x32_bf16 v[144:147], a[144:147], a[24:27], v[144:147]
ds_read_b64_tr_b16 a[138:139], v11 offset:51008
v_mfma_f32_16x16x32_bf16 v[176:179], a[144:147], a[28:31], v[176:179]
v_mfma_f32_16x16x32_bf16 v[180:183], a[148:151], a[28:31], v[180:183]
ds_read_b64_tr_b16 a[140:141], v11 offset:50784
v_mfma_f32_16x16x32_bf16 v[148:151], a[148:151], a[24:27], v[148:151]
v_mfma_f32_16x16x32_bf16 v[116:119], a[148:151], a[20:23], v[116:119]
ds_read_b64_tr_b16 a[142:143], v11 offset:51040
v_mfma_f32_16x16x32_bf16 v[84:87], a[148:151], a[16:19], v[84:87]
s_waitcnt lgkmcnt(8)
v_mfma_f32_16x16x32_bf16 v[88:91], a[152:155], a[16:19], v[88:91]
ds_read_b64_tr_b16 a[144:145], v11 offset:50816
v_mfma_f32_16x16x32_bf16 v[120:123], a[152:155], a[20:23], v[120:123]
v_mfma_f32_16x16x32_bf16 v[152:155], a[152:155], a[24:27], v[152:155]
ds_read_b64_tr_b16 a[146:147], v11 offset:51072
v_mfma_f32_16x16x32_bf16 v[184:187], a[152:155], a[28:31], v[184:187]
v_mfma_f32_16x16x32_bf16 v[188:191], a[156:159], a[28:31], v[188:191]
ds_read_b64_tr_b16 a[148:149], v11 offset:50848
v_mfma_f32_16x16x32_bf16 v[156:159], a[156:159], a[24:27], v[156:159]
v_mfma_f32_16x16x32_bf16 v[124:127], a[156:159], a[20:23], v[124:127]
ds_read_b64_tr_b16 a[150:151], v11 offset:51104
v_mfma_f32_16x16x32_bf16 v[92:95], a[156:159], a[16:19], v[92:95]
s_waitcnt vmcnt(4)
s_waitcnt lgkmcnt(8)
v_mfma_f32_16x16x32_bf16 v[64:67], a[128:131], a[32:35], v[64:67]
ds_read_b64_tr_b16 a[152:153], v11 offset:50880
v_mfma_f32_16x16x32_bf16 v[96:99], a[128:131], a[36:39], v[96:99]
v_mfma_f32_16x16x32_bf16 v[128:131], a[128:131], a[40:43], v[128:131]
ds_read_b64_tr_b16 a[154:155], v11 offset:51136
v_mfma_f32_16x16x32_bf16 v[160:163], a[128:131], a[44:47], v[160:163]
v_mfma_f32_16x16x32_bf16 v[164:167], a[132:135], a[44:47], v[164:167]
ds_read_b64_tr_b16 a[156:157], v11 offset:50912
v_mfma_f32_16x16x32_bf16 v[132:135], a[132:135], a[40:43], v[132:135]
v_mfma_f32_16x16x32_bf16 v[100:103], a[132:135], a[36:39], v[100:103]
ds_read_b64_tr_b16 a[158:159], v11 offset:51168
v_mfma_f32_16x16x32_bf16 v[68:71], a[132:135], a[32:35], v[68:71]
s_waitcnt lgkmcnt(8)
v_mfma_f32_16x16x32_bf16 v[72:75], a[136:139], a[32:35], v[72:75]
ds_read_b64_tr_b16 a[128:129], v11 offset:51200
v_mfma_f32_16x16x32_bf16 v[104:107], a[136:139], a[36:39], v[104:107]
v_mfma_f32_16x16x32_bf16 v[136:139], a[136:139], a[40:43], v[136:139]
ds_read_b64_tr_b16 a[130:131], v11 offset:51456
v_mfma_f32_16x16x32_bf16 v[168:171], a[136:139], a[44:47], v[168:171]
v_mfma_f32_16x16x32_bf16 v[172:175], a[140:143], a[44:47], v[172:175]
ds_read_b64_tr_b16 a[132:133], v11 offset:51232
v_mfma_f32_16x16x32_bf16 v[140:143], a[140:143], a[40:43], v[140:143]
v_mfma_f32_16x16x32_bf16 v[108:111], a[140:143], a[36:39], v[108:111]
ds_read_b64_tr_b16 a[134:135], v11 offset:51488
v_mfma_f32_16x16x32_bf16 v[76:79], a[140:143], a[32:35], v[76:79]
s_waitcnt lgkmcnt(8)
v_mfma_f32_16x16x32_bf16 v[80:83], a[144:147], a[32:35], v[80:83]
ds_read_b64_tr_b16 a[136:137], v11 offset:51264
v_mfma_f32_16x16x32_bf16 v[112:115], a[144:147], a[36:39], v[112:115]
v_mfma_f32_16x16x32_bf16 v[144:147], a[144:147], a[40:43], v[144:147]
ds_read_b64_tr_b16 a[138:139], v11 offset:51520
v_mfma_f32_16x16x32_bf16 v[176:179], a[144:147], a[44:47], v[176:179]
v_mfma_f32_16x16x32_bf16 v[180:183], a[148:151], a[44:47], v[180:183]
ds_read_b64_tr_b16 a[140:141], v11 offset:51296
v_mfma_f32_16x16x32_bf16 v[148:151], a[148:151], a[40:43], v[148:151]
v_mfma_f32_16x16x32_bf16 v[116:119], a[148:151], a[36:39], v[116:119]
ds_read_b64_tr_b16 a[142:143], v11 offset:51552
v_mfma_f32_16x16x32_bf16 v[84:87], a[148:151], a[32:35], v[84:87]
s_waitcnt lgkmcnt(8)
v_mfma_f32_16x16x32_bf16 v[88:91], a[152:155], a[32:35], v[88:91]
ds_read_b64_tr_b16 a[144:145], v11 offset:51328
v_mfma_f32_16x16x32_bf16 v[120:123], a[152:155], a[36:39], v[120:123]
v_mfma_f32_16x16x32_bf16 v[152:155], a[152:155], a[40:43], v[152:155]
ds_read_b64_tr_b16 a[146:147], v11 offset:51584
v_mfma_f32_16x16x32_bf16 v[184:187], a[152:155], a[44:47], v[184:187]
v_mfma_f32_16x16x32_bf16 v[188:191], a[156:159], a[44:47], v[188:191]
ds_read_b64_tr_b16 a[148:149], v11 offset:51360
v_mfma_f32_16x16x32_bf16 v[156:159], a[156:159], a[40:43], v[156:159]
v_mfma_f32_16x16x32_bf16 v[124:127], a[156:159], a[36:39], v[124:127]
ds_read_b64_tr_b16 a[150:151], v11 offset:51616
v_mfma_f32_16x16x32_bf16 v[92:95], a[156:159], a[32:35], v[92:95]
s_waitcnt vmcnt(0)
s_waitcnt lgkmcnt(8)
v_mfma_f32_16x16x32_bf16 v[64:67], a[128:131], a[48:51], v[64:67]
ds_read_b64_tr_b16 a[152:153], v11 offset:51392
v_mfma_f32_16x16x32_bf16 v[96:99], a[128:131], a[52:55], v[96:99]
v_mfma_f32_16x16x32_bf16 v[128:131], a[128:131], a[56:59], v[128:131]
ds_read_b64_tr_b16 a[154:155], v11 offset:51648
v_mfma_f32_16x16x32_bf16 v[160:163], a[128:131], a[60:63], v[160:163]
v_mfma_f32_16x16x32_bf16 v[164:167], a[132:135], a[60:63], v[164:167]
ds_read_b64_tr_b16 a[156:157], v11 offset:51424
v_mfma_f32_16x16x32_bf16 v[132:135], a[132:135], a[56:59], v[132:135]
v_mfma_f32_16x16x32_bf16 v[100:103], a[132:135], a[52:55], v[100:103]
ds_read_b64_tr_b16 a[158:159], v11 offset:51680
v_mfma_f32_16x16x32_bf16 v[68:71], a[132:135], a[48:51], v[68:71]
s_waitcnt lgkmcnt(8)
v_mfma_f32_16x16x32_bf16 v[72:75], a[136:139], a[48:51], v[72:75]
v_mfma_f32_16x16x32_bf16 v[104:107], a[136:139], a[52:55], v[104:107]
v_mfma_f32_16x16x32_bf16 v[136:139], a[136:139], a[56:59], v[136:139]
v_mfma_f32_16x16x32_bf16 v[168:171], a[136:139], a[60:63], v[168:171]
v_mfma_f32_16x16x32_bf16 v[172:175], a[140:143], a[60:63], v[172:175]
v_mfma_f32_16x16x32_bf16 v[140:143], a[140:143], a[56:59], v[140:143]
v_mfma_f32_16x16x32_bf16 v[108:111], a[140:143], a[52:55], v[108:111]
v_mfma_f32_16x16x32_bf16 v[76:79], a[140:143], a[48:51], v[76:79]
s_waitcnt lgkmcnt(4)
v_mfma_f32_16x16x32_bf16 v[80:83], a[144:147], a[48:51], v[80:83]
v_mfma_f32_16x16x32_bf16 v[112:115], a[144:147], a[52:55], v[112:115]
v_mfma_f32_16x16x32_bf16 v[144:147], a[144:147], a[56:59], v[144:147]
v_mfma_f32_16x16x32_bf16 v[176:179], a[144:147], a[60:63], v[176:179]
v_mfma_f32_16x16x32_bf16 v[180:183], a[148:151], a[60:63], v[180:183]
v_mfma_f32_16x16x32_bf16 v[148:151], a[148:151], a[56:59], v[148:151]
v_mfma_f32_16x16x32_bf16 v[116:119], a[148:151], a[52:55], v[116:119]
v_mfma_f32_16x16x32_bf16 v[84:87], a[148:151], a[48:51], v[84:87]
s_waitcnt lgkmcnt(0)
v_mfma_f32_16x16x32_bf16 v[88:91], a[152:155], a[48:51], v[88:91]
v_mfma_f32_16x16x32_bf16 v[120:123], a[152:155], a[52:55], v[120:123]
v_mfma_f32_16x16x32_bf16 v[152:155], a[152:155], a[56:59], v[152:155]
v_mfma_f32_16x16x32_bf16 v[184:187], a[152:155], a[60:63], v[184:187]
v_mfma_f32_16x16x32_bf16 v[188:191], a[156:159], a[60:63], v[188:191]
v_mfma_f32_16x16x32_bf16 v[156:159], a[156:159], a[56:59], v[156:159]
v_mfma_f32_16x16x32_bf16 v[124:127], a[156:159], a[52:55], v[124:127]
v_mfma_f32_16x16x32_bf16 v[92:95], a[156:159], a[48:51], v[92:95]
v_cvt_pk_bf16_f32 v64, v64, v65
v_cvt_pk_bf16_f32 v65, v66, v67
v_cvt_pk_bf16_f32 v66, v68, v69
v_cvt_pk_bf16_f32 v67, v70, v71
buffer_store_dwordx4 v[64:67], v14, s[48:51], s75 offen offset:0 sc1
v_cvt_pk_bf16_f32 v96, v96, v97
v_cvt_pk_bf16_f32 v97, v98, v99
v_cvt_pk_bf16_f32 v98, v100, v101
v_cvt_pk_bf16_f32 v99, v102, v103
buffer_store_dwordx4 v[96:99], v14, s[48:51], s75 offen offset:2048 sc1
v_cvt_pk_bf16_f32 v128, v128, v129
v_cvt_pk_bf16_f32 v129, v130, v131
v_cvt_pk_bf16_f32 v130, v132, v133
v_cvt_pk_bf16_f32 v131, v134, v135
buffer_store_dwordx4 v[128:131], v15, s[48:51], s75 offen offset:0 sc1
v_cvt_pk_bf16_f32 v160, v160, v161
v_cvt_pk_bf16_f32 v161, v162, v163
v_cvt_pk_bf16_f32 v162, v164, v165
v_cvt_pk_bf16_f32 v163, v166, v167
buffer_store_dwordx4 v[160:163], v15, s[48:51], s75 offen offset:2048 sc1
v_cvt_pk_bf16_f32 v72, v72, v73
v_cvt_pk_bf16_f32 v73, v74, v75
v_cvt_pk_bf16_f32 v74, v76, v77
v_cvt_pk_bf16_f32 v75, v78, v79
buffer_store_dwordx4 v[72:75], v14, s[48:51], s75 offen offset:1024 sc1
v_cvt_pk_bf16_f32 v104, v104, v105
v_cvt_pk_bf16_f32 v105, v106, v107
v_cvt_pk_bf16_f32 v106, v108, v109
v_cvt_pk_bf16_f32 v107, v110, v111
buffer_store_dwordx4 v[104:107], v14, s[48:51], s75 offen offset:3072 sc1
v_cvt_pk_bf16_f32 v136, v136, v137
v_cvt_pk_bf16_f32 v137, v138, v139
v_cvt_pk_bf16_f32 v138, v140, v141
v_cvt_pk_bf16_f32 v139, v142, v143
buffer_store_dwordx4 v[136:139], v15, s[48:51], s75 offen offset:1024 sc1
v_cvt_pk_bf16_f32 v168, v168, v169
v_cvt_pk_bf16_f32 v169, v170, v171
v_cvt_pk_bf16_f32 v170, v172, v173
v_cvt_pk_bf16_f32 v171, v174, v175
buffer_store_dwordx4 v[168:171], v15, s[48:51], s75 offen offset:3072 sc1
v_cvt_pk_bf16_f32 v80, v80, v81
v_cvt_pk_bf16_f32 v81, v82, v83
v_cvt_pk_bf16_f32 v82, v84, v85
v_cvt_pk_bf16_f32 v83, v86, v87
buffer_store_dwordx4 v[80:83], v14, s[48:51], s76 offen offset:0 sc1
v_cvt_pk_bf16_f32 v112, v112, v113
v_cvt_pk_bf16_f32 v113, v114, v115
v_cvt_pk_bf16_f32 v114, v116, v117
v_cvt_pk_bf16_f32 v115, v118, v119
buffer_store_dwordx4 v[112:115], v14, s[48:51], s76 offen offset:2048 sc1
v_cvt_pk_bf16_f32 v144, v144, v145
v_cvt_pk_bf16_f32 v145, v146, v147
v_cvt_pk_bf16_f32 v146, v148, v149
v_cvt_pk_bf16_f32 v147, v150, v151
buffer_store_dwordx4 v[144:147], v15, s[48:51], s76 offen offset:0 sc1
v_cvt_pk_bf16_f32 v176, v176, v177
v_cvt_pk_bf16_f32 v177, v178, v179
v_cvt_pk_bf16_f32 v178, v180, v181
v_cvt_pk_bf16_f32 v179, v182, v183
buffer_store_dwordx4 v[176:179], v15, s[48:51], s76 offen offset:2048 sc1
v_cvt_pk_bf16_f32 v88, v88, v89
v_cvt_pk_bf16_f32 v89, v90, v91
v_cvt_pk_bf16_f32 v90, v92, v93
v_cvt_pk_bf16_f32 v91, v94, v95
buffer_store_dwordx4 v[88:91], v14, s[48:51], s76 offen offset:1024 sc1
v_cvt_pk_bf16_f32 v120, v120, v121
v_cvt_pk_bf16_f32 v121, v122, v123
v_cvt_pk_bf16_f32 v122, v124, v125
v_cvt_pk_bf16_f32 v123, v126, v127
buffer_store_dwordx4 v[120:123], v14, s[48:51], s76 offen offset:3072 sc1
v_cvt_pk_bf16_f32 v152, v152, v153
v_cvt_pk_bf16_f32 v153, v154, v155
v_cvt_pk_bf16_f32 v154, v156, v157
v_cvt_pk_bf16_f32 v155, v158, v159
buffer_store_dwordx4 v[152:155], v15, s[48:51], s76 offen offset:1024 sc1
v_cvt_pk_bf16_f32 v184, v184, v185
v_cvt_pk_bf16_f32 v185, v186, v187
v_cvt_pk_bf16_f32 v186, v188, v189
v_cvt_pk_bf16_f32 v187, v190, v191
buffer_store_dwordx4 v[184:187], v15, s[48:51], s76 offen offset:3072 sc1
s_waitcnt vmcnt(0)
s_barrier
s_cmp_lg_u32 s24, 0
s_cbranch_scc1 L_sig12
s_lshl_b32 s33, s25, 3
s_add_u32 s33, s33, 128
s_lshl_b32 s33, s33, 7
v_mov_b32 v2, s33
v_mov_b32 v3, 1
s_mov_b64 exec, 1
global_atomic_add v2, v3, s[34:35]
s_mov_b64 exec, -1
L_sig12:
s_cmp_lg_u32 s24, 0
s_cbranch_scc1 L_wt13
s_mov_b32 s33, 49152
v_mov_b32 v2, s33
s_mov_b32 s32, 1048576
L_poll14:
global_load_dword v3, v2, s[34:35] sc1
s_waitcnt vmcnt(0)
v_readfirstlane_b32 s31, v3
s_nop 0
s_cmp_ge_u32 s31, 128
s_cbranch_scc1 L_pd15
s_sub_u32 s32, s32, 1
s_cmp_eq_u32 s32, 0
s_cbranch_scc1 L_pd15
s_sleep 2
s_branch L_poll14
L_pd15:
L_wt13:
s_barrier
s_lshl_b32 s71, s25, 5
s_add_u32 s71, s71, s28
v_lshrrev_b32 v20, 6, v0
v_lshlrev_b32 v20, 18, v20
v_bfe_u32 v21, v0, 5, 1
v_lshlrev_b32 v21, 10, v21
v_bfe_u32 v22, v0, 3, 2
v_lshlrev_b32 v22, 8, v22
v_and_b32 v23, 7, v0
v_lshlrev_b32 v24, 4, v23
v_add3_u32 v28, v20, v21, v22
v_add_u32 v28, v28, v24
s_lshr_b32 s30, s71, 1
s_lshl_b32 s30, s30, 11
s_and_b32 s31, s71, 1
s_lshl_b32 s31, s31, 7
s_add_u32 s30, s30, s31
v_add_u32 v28, s30, v28
v_lshrrev_b32 v20, 5, v0
v_lshlrev_b32 v20, 5, v20
v_lshrrev_b32 v22, 6, v22
v_add_u32 v20, v20, v22
v_lshlrev_b32 v30, 2, v20
s_lshl_b32 s30, s71, 14
v_lshlrev_b32 v23, 11, v23
v_lshlrev_b32 v20, 1, v20
v_add3_u32 v29, v23, v20, s30
s_mov_b32 s48, s4
s_mov_b32 s49, s5
s_mov_b32 s50, 4194304
s_mov_b32 s51, 0x20000
s_add_u32 s52, s22, 76546048
s_addc_u32 s53, s23, 0
s_mov_b32 s54, 98304
s_mov_b32 s55, 0x20000
s_add_u32 s56, s22, 20971520
s_addc_u32 s57, s23, 0
s_mov_b32 s58, 16777216
s_mov_b32 s59, 0x20000
s_add_u32 s60, s22, 54525952
s_addc_u32 s61, s23, 0
s_mov_b32 s62, 4194304
s_mov_b32 s63, 0x20000
s_mov_b32 s67, 0
s_mov_b32 s68, 1048576
s_mov_b32 s69, 2097152
s_mov_b32 s70, 3145728
buffer_load_dwordx2 v[64:65], v29, s[48:51], 0 offen offset:0
buffer_load_dwordx2 v[66:67], v29, s[48:51], 0 offen offset:32
buffer_load_dwordx2 v[68:69], v29, s[48:51], 0 offen offset:512
buffer_load_dwordx2 v[70:71], v29, s[48:51], 0 offen offset:544
buffer_load_dwordx2 v[72:73], v29, s[48:51], 0 offen offset:1024
buffer_load_dwordx2 v[74:75], v29, s[48:51], 0 offen offset:1056
buffer_load_dwordx2 v[76:77], v29, s[48:51], 0 offen offset:1536
buffer_load_dwordx2 v[78:79], v29, s[48:51], 0 offen offset:1568
v_lshlrev_b32 v20, 4, v0
s_mov_b32 s31, 16384
buffer_load_dwordx4 v[80:83], v20, s[52:55], s31 offen sc1
s_mov_b32 s31, 40960
buffer_load_dwordx4 v[84:87], v20, s[52:55], s31 offen sc1
s_mov_b32 s31, 65536
buffer_load_dwordx4 v[88:91], v20, s[52:55], s31 offen sc1
s_mov_b32 s31, 90112
buffer_load_dwordx4 v[92:95], v20, s[52:55], s31 offen sc1
s_mov_b32 s31, 12288
buffer_load_dwordx4 v[96:99], v20, s[52:55], s31 offen sc1
s_mov_b32 s31, 36864
buffer_load_dwordx4 v[100:103], v20, s[52:55], s31 offen sc1
s_mov_b32 s31, 61440
buffer_load_dwordx4 v[104:107], v20, s[52:55], s31 offen sc1
s_mov_b32 s31, 86016
buffer_load_dwordx4 v[108:111], v20, s[52:55], s31 offen sc1
s_mov_b32 s31, 8192
buffer_load_dwordx4 v[112:115], v20, s[52:55], s31 offen sc1
s_mov_b32 s31, 32768
buffer_load_dwordx4 v[116:119], v20, s[52:55], s31 offen sc1
s_mov_b32 s31, 57344
buffer_load_dwordx4 v[120:123], v20, s[52:55], s31 offen sc1
s_mov_b32 s31, 81920
buffer_load_dwordx4 v[124:127], v20, s[52:55], s31 offen sc1
s_waitcnt vmcnt(0)
v_lshlrev_b32 v20, 4, v0
v_pk_add_f32 v[80:81], v[80:81], v[84:85]
v_pk_add_f32 v[82:83], v[82:83], v[86:87]
v_pk_add_f32 v[80:81], v[80:81], v[88:89]
v_pk_add_f32 v[82:83], v[82:83], v[90:91]
v_pk_add_f32 v[80:81], v[80:81], v[92:93]
v_pk_add_f32 v[82:83], v[82:83], v[94:95]
ds_write_b128 v20, v[80:83] offset:0
v_pk_add_f32 v[96:97], v[96:97], v[100:101]
v_pk_add_f32 v[98:99], v[98:99], v[102:103]
v_pk_add_f32 v[96:97], v[96:97], v[104:105]
v_pk_add_f32 v[98:99], v[98:99], v[106:107]
v_pk_add_f32 v[96:97], v[96:97], v[108:109]
v_pk_add_f32 v[98:99], v[98:99], v[110:111]
ds_write_b128 v20, v[96:99] offset:4096
v_pk_add_f32 v[112:113], v[112:113], v[116:117]
v_pk_add_f32 v[114:115], v[114:115], v[118:119]
v_pk_add_f32 v[112:113], v[112:113], v[120:121]
v_pk_add_f32 v[114:115], v[114:115], v[122:123]
v_pk_add_f32 v[112:113], v[112:113], v[124:125]
v_pk_add_f32 v[114:115], v[114:115], v[126:127]
ds_write_b128 v20, v[112:115] offset:8192
s_waitcnt lgkmcnt(0)
s_barrier
ds_read_b128 v[144:147], v30 offset:0
ds_read_b128 v[148:151], v30 offset:64
ds_read_b128 v[152:155], v30 offset:1024
ds_read_b128 v[156:159], v30 offset:1088
ds_read_b128 v[160:163], v30 offset:2048
ds_read_b128 v[164:167], v30 offset:2112
ds_read_b128 v[168:171], v30 offset:3072
ds_read_b128 v[172:175], v30 offset:3136
ds_read_b128 v[176:179], v30 offset:4096
ds_read_b128 v[180:183], v30 offset:4160
ds_read_b128 v[184:187], v30 offset:5120
ds_read_b128 v[188:191], v30 offset:5184
ds_read_b128 v[192:195], v30 offset:6144
ds_read_b128 v[196:199], v30 offset:6208
ds_read_b128 v[200:203], v30 offset:7168
ds_read_b128 v[204:207], v30 offset:7232
ds_read_b128 v[208:211], v30 offset:8192
ds_read_b128 v[212:215], v30 offset:8256
ds_read_b128 v[216:219], v30 offset:9216
ds_read_b128 v[220:223], v30 offset:9280
ds_read_b128 v[224:227], v30 offset:10240
ds_read_b128 v[228:231], v30 offset:10304
ds_read_b128 v[232:235], v30 offset:11264
ds_read_b128 v[236:239], v30 offset:11328
s_waitcnt lgkmcnt(0)
v_pk_add_f32 v[144:145], v[144:145], 1.0 op_sel_hi:[1,0]
v_pk_add_f32 v[146:147], v[146:147], 1.0 op_sel_hi:[1,0]
v_pk_add_f32 v[148:149], v[148:149], 1.0 op_sel_hi:[1,0]
v_pk_add_f32 v[150:151], v[150:151], 1.0 op_sel_hi:[1,0]
v_pk_add_f32 v[152:153], v[152:153], 1.0 op_sel_hi:[1,0]
v_pk_add_f32 v[154:155], v[154:155], 1.0 op_sel_hi:[1,0]
v_pk_add_f32 v[156:157], v[156:157], 1.0 op_sel_hi:[1,0]
v_pk_add_f32 v[158:159], v[158:159], 1.0 op_sel_hi:[1,0]
v_pk_add_f32 v[160:161], v[160:161], 1.0 op_sel_hi:[1,0]
v_pk_add_f32 v[162:163], v[162:163], 1.0 op_sel_hi:[1,0]
v_pk_add_f32 v[164:165], v[164:165], 1.0 op_sel_hi:[1,0]
v_pk_add_f32 v[166:167], v[166:167], 1.0 op_sel_hi:[1,0]
v_pk_add_f32 v[168:169], v[168:169], 1.0 op_sel_hi:[1,0]
v_pk_add_f32 v[170:171], v[170:171], 1.0 op_sel_hi:[1,0]
v_pk_add_f32 v[172:173], v[172:173], 1.0 op_sel_hi:[1,0]
v_pk_add_f32 v[174:175], v[174:175], 1.0 op_sel_hi:[1,0]
v_mul_f32 v176, 0x3fb8aa3b, v176
v_mul_f32 v177, 0x3fb8aa3b, v177
v_mul_f32 v178, 0x3fb8aa3b, v178
v_mul_f32 v179, 0x3fb8aa3b, v179
v_mul_f32 v180, 0x3fb8aa3b, v180
v_mul_f32 v181, 0x3fb8aa3b, v181
v_mul_f32 v182, 0x3fb8aa3b, v182
v_mul_f32 v183, 0x3fb8aa3b, v183
v_mul_f32 v184, 0x3fb8aa3b, v184
v_mul_f32 v185, 0x3fb8aa3b, v185
v_mul_f32 v186, 0x3fb8aa3b, v186
v_mul_f32 v187, 0x3fb8aa3b, v187
v_mul_f32 v188, 0x3fb8aa3b, v188
v_mul_f32 v189, 0x3fb8aa3b, v189
v_mul_f32 v190, 0x3fb8aa3b, v190
v_mul_f32 v191, 0x3fb8aa3b, v191
v_mul_f32 v192, 0x3fb8aa3b, v192
v_mul_f32 v193, 0x3fb8aa3b, v193
v_mul_f32 v194, 0x3fb8aa3b, v194
v_mul_f32 v195, 0x3fb8aa3b, v195
v_mul_f32 v196, 0x3fb8aa3b, v196
v_mul_f32 v197, 0x3fb8aa3b, v197
v_mul_f32 v198, 0x3fb8aa3b, v198
v_mul_f32 v199, 0x3fb8aa3b, v199
v_mul_f32 v200, 0x3fb8aa3b, v200
v_mul_f32 v201, 0x3fb8aa3b, v201
v_mul_f32 v202, 0x3fb8aa3b, v202
v_mul_f32 v203, 0x3fb8aa3b, v203
v_mul_f32 v204, 0x3fb8aa3b, v204
v_mul_f32 v205, 0x3fb8aa3b, v205
v_mul_f32 v206, 0x3fb8aa3b, v206
v_mul_f32 v207, 0x3fb8aa3b, v207
s_cmp_lg_u32 s24, 0
s_cbranch_scc1 L_wt16
s_lshl_b32 s33, s25, 3
s_add_u32 s33, s33, 128
s_lshl_b32 s33, s33, 7
v_mov_b32 v2, s33
s_mov_b32 s32, 1048576
L_poll17:
global_load_dword v3, v2, s[34:35] sc1
s_waitcnt vmcnt(0)
v_readfirstlane_b32 s31, v3
s_nop 0
s_cmp_ge_u32 s31, 32
s_cbranch_scc1 L_pd18
s_sub_u32 s32, s32, 1
s_cmp_eq_u32 s32, 0
s_cbranch_scc1 L_pd18
s_sleep 2
s_branch L_poll17
L_pd18:
L_wt16:
s_barrier
s_add_u32 s30, s67, 0
buffer_load_dwordx4 v[80:83], v28, s[56:59], s30 offen sc1
s_add_u32 s30, s67, 4194304
buffer_load_dwordx4 v[84:87], v28, s[56:59], s30 offen sc1
s_add_u32 s30, s67, 8388608
buffer_load_dwordx4 v[88:91], v28, s[56:59], s30 offen sc1
s_add_u32 s30, s67, 12582912
buffer_load_dwordx4 v[92:95], v28, s[56:59], s30 offen sc1
s_add_u32 s30, s68, 0
buffer_load_dwordx4 v[96:99], v28, s[56:59], s30 offen sc1
s_add_u32 s30, s68, 4194304
buffer_load_dwordx4 v[100:103], v28, s[56:59], s30 offen sc1
s_add_u32 s30, s68, 8388608
buffer_load_dwordx4 v[104:107], v28, s[56:59], s30 offen sc1
s_add_u32 s30, s68, 12582912
buffer_load_dwordx4 v[108:111], v28, s[56:59], s30 offen sc1
s_add_u32 s30, s69, 0
buffer_load_dwordx4 v[112:115], v28, s[56:59], s30 offen sc1
s_add_u32 s30, s69, 4194304
buffer_load_dwordx4 v[116:119], v28, s[56:59], s30 offen sc1
s_add_u32 s30, s69, 8388608
buffer_load_dwordx4 v[120:123], v28, s[56:59], s30 offen sc1
s_add_u32 s30, s69, 12582912
buffer_load_dwordx4 v[124:127], v28, s[56:59], s30 offen sc1
s_add_u32 s30, s70, 0
buffer_load_dwordx4 v[128:131], v28, s[56:59], s30 offen sc1
s_add_u32 s30, s70, 4194304
buffer_load_dwordx4 v[132:135], v28, s[56:59], s30 offen sc1
s_add_u32 s30, s70, 8388608
buffer_load_dwordx4 v[136:139], v28, s[56:59], s30 offen sc1
s_add_u32 s30, s70, 12582912
buffer_load_dwordx4 v[140:143], v28, s[56:59], s30 offen sc1
s_mov_b32 s72, 0x00003f80
s_mov_b32 s73, 0x3f800000
s_waitcnt vmcnt(28)
v_lshlrev_b32 v32, 16, v64
v_and_b32 v33, 0xffff0000, v64
v_lshlrev_b32 v34, 16, v65
v_and_b32 v35, 0xffff0000, v65
v_lshlrev_b32 v36, 16, v66
v_and_b32 v37, 0xffff0000, v66
v_lshlrev_b32 v38, 16, v67
v_and_b32 v39, 0xffff0000, v67
v_lshlrev_b32 v40, 16, v68
v_and_b32 v41, 0xffff0000, v68
v_lshlrev_b32 v42, 16, v69
v_and_b32 v43, 0xffff0000, v69
v_lshlrev_b32 v44, 16, v70
v_and_b32 v45, 0xffff0000, v70
v_lshlrev_b32 v46, 16, v71
v_and_b32 v47, 0xffff0000, v71
v_lshlrev_b32 v48, 16, v72
v_and_b32 v49, 0xffff0000, v72
v_lshlrev_b32 v50, 16, v73
v_and_b32 v51, 0xffff0000, v73
v_lshlrev_b32 v52, 16, v74
v_and_b32 v53, 0xffff0000, v74
v_lshlrev_b32 v54, 16, v75
v_and_b32 v55, 0xffff0000, v75
v_lshlrev_b32 v56, 16, v76
v_and_b32 v57, 0xffff0000, v76
v_lshlrev_b32 v58, 16, v77
v_and_b32 v59, 0xffff0000, v77
v_lshlrev_b32 v60, 16, v78
v_and_b32 v61, 0xffff0000, v78
v_lshlrev_b32 v62, 16, v79
v_and_b32 v63, 0xffff0000, v79
s_waitcnt vmcnt(12)
v_dot2_f32_bf16 v20, v80, s72, 0
v_dot2_f32_bf16 v21, v80, s73, 0
v_dot2_f32_bf16 v20, v84, s72, v20
v_dot2_f32_bf16 v21, v84, s73, v21
v_dot2_f32_bf16 v20, v88, s72, v20
v_dot2_f32_bf16 v21, v88, s73, v21
v_dot2_f32_bf16 v20, v92, s72, v20
v_dot2_f32_bf16 v21, v92, s73, v21
v_dot2_f32_bf16 v22, v81, s72, 0
v_dot2_f32_bf16 v23, v81, s73, 0
v_dot2_f32_bf16 v22, v85, s72, v22
v_dot2_f32_bf16 v23, v85, s73, v23
v_dot2_f32_bf16 v22, v89, s72, v22
v_dot2_f32_bf16 v23, v89, s73, v23
v_pk_fma_f32 v[32:33], v[20:21], v[208:209], v[32:33]
v_dot2_f32_bf16 v22, v93, s72, v22
v_dot2_f32_bf16 v23, v93, s73, v23
v_dot2_f32_bf16 v20, v82, s72, 0
v_dot2_f32_bf16 v21, v82, s73, 0
v_dot2_f32_bf16 v20, v86, s72, v20
v_dot2_f32_bf16 v21, v86, s73, v21
v_dot2_f32_bf16 v20, v90, s72, v20
v_dot2_f32_bf16 v21, v90, s73, v21
v_pk_fma_f32 v[34:35], v[22:23], v[210:211], v[34:35]
v_dot2_f32_bf16 v20, v94, s72, v20
v_dot2_f32_bf16 v21, v94, s73, v21
v_dot2_f32_bf16 v22, v83, s72, 0
v_dot2_f32_bf16 v23, v83, s73, 0
v_dot2_f32_bf16 v22, v87, s72, v22
v_dot2_f32_bf16 v23, v87, s73, v23
v_dot2_f32_bf16 v22, v91, s72, v22
v_dot2_f32_bf16 v23, v91, s73, v23
v_pk_fma_f32 v[36:37], v[20:21], v[212:213], v[36:37]
v_dot2_f32_bf16 v22, v95, s72, v22
v_dot2_f32_bf16 v23, v95, s73, v23
s_nop 2
v_pk_fma_f32 v[38:39], v[22:23], v[214:215], v[38:39]
s_waitcnt vmcnt(8)
v_dot2_f32_bf16 v20, v96, s72, 0
v_dot2_f32_bf16 v21, v96, s73, 0
v_dot2_f32_bf16 v20, v100, s72, v20
v_dot2_f32_bf16 v21, v100, s73, v21
v_dot2_f32_bf16 v20, v104, s72, v20
v_dot2_f32_bf16 v21, v104, s73, v21
v_dot2_f32_bf16 v20, v108, s72, v20
v_dot2_f32_bf16 v21, v108, s73, v21
v_dot2_f32_bf16 v22, v97, s72, 0
v_dot2_f32_bf16 v23, v97, s73, 0
v_dot2_f32_bf16 v22, v101, s72, v22
v_dot2_f32_bf16 v23, v101, s73, v23
v_dot2_f32_bf16 v22, v105, s72, v22
v_dot2_f32_bf16 v23, v105, s73, v23
v_pk_fma_f32 v[40:41], v[20:21], v[216:217], v[40:41]
v_dot2_f32_bf16 v22, v109, s72, v22
v_dot2_f32_bf16 v23, v109, s73, v23
v_dot2_f32_bf16 v20, v98, s72, 0
v_dot2_f32_bf16 v21, v98, s73, 0
v_dot2_f32_bf16 v20, v102, s72, v20
v_dot2_f32_bf16 v21, v102, s73, v21
v_dot2_f32_bf16 v20, v106, s72, v20
v_dot2_f32_bf16 v21, v106, s73, v21
v_pk_fma_f32 v[42:43], v[22:23], v[218:219], v[42:43]
v_dot2_f32_bf16 v20, v110, s72, v20
v_dot2_f32_bf16 v21, v110, s73, v21
v_dot2_f32_bf16 v22, v99, s72, 0
v_dot2_f32_bf16 v23, v99, s73, 0
v_dot2_f32_bf16 v22, v103, s72, v22
v_dot2_f32_bf16 v23, v103, s73, v23
v_dot2_f32_bf16 v22, v107, s72, v22
v_dot2_f32_bf16 v23, v107, s73, v23
v_pk_fma_f32 v[44:45], v[20:21], v[220:221], v[44:45]
v_dot2_f32_bf16 v22, v111, s72, v22
v_dot2_f32_bf16 v23, v111, s73, v23
s_nop 2
v_pk_fma_f32 v[46:47], v[22:23], v[222:223], v[46:47]
s_waitcnt vmcnt(4)
v_dot2_f32_bf16 v20, v112, s72, 0
v_dot2_f32_bf16 v21, v112, s73, 0
v_dot2_f32_bf16 v20, v116, s72, v20
v_dot2_f32_bf16 v21, v116, s73, v21
v_dot2_f32_bf16 v20, v120, s72, v20
v_dot2_f32_bf16 v21, v120, s73, v21
v_dot2_f32_bf16 v20, v124, s72, v20
v_dot2_f32_bf16 v21, v124, s73, v21
v_dot2_f32_bf16 v22, v113, s72, 0
v_dot2_f32_bf16 v23, v113, s73, 0
v_dot2_f32_bf16 v22, v117, s72, v22
v_dot2_f32_bf16 v23, v117, s73, v23
v_dot2_f32_bf16 v22, v121, s72, v22
v_dot2_f32_bf16 v23, v121, s73, v23
v_pk_fma_f32 v[48:49], v[20:21], v[224:225], v[48:49]
v_dot2_f32_bf16 v22, v125, s72, v22
v_dot2_f32_bf16 v23, v125, s73, v23
v_dot2_f32_bf16 v20, v114, s72, 0
v_dot2_f32_bf16 v21, v114, s73, 0
v_dot2_f32_bf16 v20, v118, s72, v20
v_dot2_f32_bf16 v21, v118, s73, v21
v_dot2_f32_bf16 v20, v122, s72, v20
v_dot2_f32_bf16 v21, v122, s73, v21
v_pk_fma_f32 v[50:51], v[22:23], v[226:227], v[50:51]
v_dot2_f32_bf16 v20, v126, s72, v20
v_dot2_f32_bf16 v21, v126, s73, v21
v_dot2_f32_bf16 v22, v115, s72, 0
v_dot2_f32_bf16 v23, v115, s73, 0
v_dot2_f32_bf16 v22, v119, s72, v22
v_dot2_f32_bf16 v23, v119, s73, v23
v_dot2_f32_bf16 v22, v123, s72, v22
v_dot2_f32_bf16 v23, v123, s73, v23
v_pk_fma_f32 v[52:53], v[20:21], v[228:229], v[52:53]
v_dot2_f32_bf16 v22, v127, s72, v22
v_dot2_f32_bf16 v23, v127, s73, v23
s_nop 2
v_pk_fma_f32 v[54:55], v[22:23], v[230:231], v[54:55]
s_waitcnt vmcnt(0)
v_dot2_f32_bf16 v20, v128, s72, 0
v_dot2_f32_bf16 v21, v128, s73, 0
v_dot2_f32_bf16 v20, v132, s72, v20
v_dot2_f32_bf16 v21, v132, s73, v21
v_dot2_f32_bf16 v20, v136, s72, v20
v_dot2_f32_bf16 v21, v136, s73, v21
v_dot2_f32_bf16 v20, v140, s72, v20
v_dot2_f32_bf16 v21, v140, s73, v21
v_dot2_f32_bf16 v22, v129, s72, 0
v_dot2_f32_bf16 v23, v129, s73, 0
v_dot2_f32_bf16 v22, v133, s72, v22
v_dot2_f32_bf16 v23, v133, s73, v23
v_dot2_f32_bf16 v22, v137, s72, v22
v_dot2_f32_bf16 v23, v137, s73, v23
v_pk_fma_f32 v[56:57], v[20:21], v[232:233], v[56:57]
v_dot2_f32_bf16 v22, v141, s72, v22
v_dot2_f32_bf16 v23, v141, s73, v23
v_dot2_f32_bf16 v20, v130, s72, 0
v_dot2_f32_bf16 v21, v130, s73, 0
v_dot2_f32_bf16 v20, v134, s72, v20
v_dot2_f32_bf16 v21, v134, s73, v21
v_dot2_f32_bf16 v20, v138, s72, v20
v_dot2_f32_bf16 v21, v138, s73, v21
v_pk_fma_f32 v[58:59], v[22:23], v[234:235], v[58:59]
v_dot2_f32_bf16 v20, v142, s72, v20
v_dot2_f32_bf16 v21, v142, s73, v21
v_dot2_f32_bf16 v22, v131, s72, 0
v_dot2_f32_bf16 v23, v131, s73, 0
v_dot2_f32_bf16 v22, v135, s72, v22
v_dot2_f32_bf16 v23, v135, s73, v23
v_dot2_f32_bf16 v22, v139, s72, v22
v_dot2_f32_bf16 v23, v139, s73, v23
v_pk_fma_f32 v[60:61], v[20:21], v[236:237], v[60:61]
v_dot2_f32_bf16 v22, v143, s72, v22
v_dot2_f32_bf16 v23, v143, s73, v23
s_nop 2
v_pk_fma_f32 v[62:63], v[22:23], v[238:239], v[62:63]
v_cvt_pk_bf16_f32 v80, v32, v33
v_cvt_pk_bf16_f32 v81, v34, v35
v_cvt_pk_bf16_f32 v82, v36, v37
v_cvt_pk_bf16_f32 v83, v38, v39
v_accvgpr_write_b32 a224, v80
v_accvgpr_write_b32 a225, v81
v_accvgpr_write_b32 a226, v82
v_accvgpr_write_b32 a227, v83
v_cvt_pk_bf16_f32 v96, v40, v41
v_cvt_pk_bf16_f32 v97, v42, v43
v_cvt_pk_bf16_f32 v98, v44, v45
v_cvt_pk_bf16_f32 v99, v46, v47
v_accvgpr_write_b32 a228, v96
v_accvgpr_write_b32 a229, v97
v_accvgpr_write_b32 a230, v98
v_accvgpr_write_b32 a231, v99
v_cvt_pk_bf16_f32 v112, v48, v49
v_cvt_pk_bf16_f32 v113, v50, v51
v_cvt_pk_bf16_f32 v114, v52, v53
v_cvt_pk_bf16_f32 v115, v54, v55
v_accvgpr_write_b32 a232, v112
v_accvgpr_write_b32 a233, v113
v_accvgpr_write_b32 a234, v114
v_accvgpr_write_b32 a235, v115
v_cvt_pk_bf16_f32 v128, v56, v57
v_cvt_pk_bf16_f32 v129, v58, v59
v_cvt_pk_bf16_f32 v130, v60, v61
v_cvt_pk_bf16_f32 v131, v62, v63
v_accvgpr_write_b32 a236, v128
v_accvgpr_write_b32 a237, v129
v_accvgpr_write_b32 a238, v130
v_accvgpr_write_b32 a239, v131
v_accvgpr_write_b32 a240, v28
v_lshrrev_b32 v26, 6, v0
v_lshlrev_b32 v26, 5, v26
v_and_b32 v27, 7, v0
v_lshlrev_b32 v27, 2, v27
v_add_u32 v27, 134144, v27
v_add_u32 v26, v26, v27
v_pk_add_f32 v[24:25], v[32:33], v[34:35]
v_pk_add_f32 v[24:25], v[24:25], v[36:37]
v_pk_add_f32 v[24:25], v[24:25], v[38:39]
v_pk_add_f32 v[24:25], v[24:25], v[40:41]
v_pk_add_f32 v[24:25], v[24:25], v[42:43]
v_pk_add_f32 v[24:25], v[24:25], v[44:45]
v_pk_add_f32 v[24:25], v[24:25], v[46:47]
v_pk_add_f32 v[24:25], v[24:25], v[48:49]
v_pk_add_f32 v[24:25], v[24:25], v[50:51]
v_pk_add_f32 v[24:25], v[24:25], v[52:53]
v_pk_add_f32 v[24:25], v[24:25], v[54:55]
v_pk_add_f32 v[24:25], v[24:25], v[56:57]
v_pk_add_f32 v[24:25], v[24:25], v[58:59]
v_pk_add_f32 v[24:25], v[24:25], v[60:61]
v_pk_add_f32 v[24:25], v[24:25], v[62:63]
v_add_f32 v24, v24, v25
s_nop 1
v_add_f32_dpp v24, v24, v24 row_ror:8 row_mask:0xf bank_mask:0xf
v_mov_b32 v25, v24
s_nop 1
v_permlane16_swap_b32 v24, v25
s_nop 1
v_add_f32 v24, v24, v25
v_mov_b32 v25, v24
s_nop 1
v_permlane32_swap_b32 v24, v25
s_nop 1
v_add_f32 v24, v24, v25
ds_write_b32 v26, v24 offset:0
s_waitcnt lgkmcnt(0)
s_barrier
ds_read_b32 v20, v27 offset:0
ds_read_b32 v21, v27 offset:32
ds_read_b32 v22, v27 offset:64
ds_read_b32 v23, v27 offset:96
s_waitcnt lgkmcnt(0)
v_add_f32 v20, v20, v21
v_add_f32 v22, v22, v23
v_add_f32 v24, v20, v22
v_mul_f32 v24, 0xba800000, v24
v_pk_add_f32 v[32:33], v[32:33], v[24:25] op_sel_hi:[1,0]
v_pk_add_f32 v[34:35], v[34:35], v[24:25] op_sel_hi:[1,0]
v_pk_add_f32 v[36:37], v[36:37], v[24:25] op_sel_hi:[1,0]
v_pk_add_f32 v[38:39], v[38:39], v[24:25] op_sel_hi:[1,0]
v_pk_add_f32 v[40:41], v[40:41], v[24:25] op_sel_hi:[1,0]
v_pk_add_f32 v[42:43], v[42:43], v[24:25] op_sel_hi:[1,0]
v_pk_add_f32 v[44:45], v[44:45], v[24:25] op_sel_hi:[1,0]
v_pk_add_f32 v[46:47], v[46:47], v[24:25] op_sel_hi:[1,0]
v_pk_add_f32 v[48:49], v[48:49], v[24:25] op_sel_hi:[1,0]
v_pk_add_f32 v[50:51], v[50:51], v[24:25] op_sel_hi:[1,0]
v_pk_add_f32 v[52:53], v[52:53], v[24:25] op_sel_hi:[1,0]
v_pk_add_f32 v[54:55], v[54:55], v[24:25] op_sel_hi:[1,0]
v_pk_add_f32 v[56:57], v[56:57], v[24:25] op_sel_hi:[1,0]
v_pk_add_f32 v[58:59], v[58:59], v[24:25] op_sel_hi:[1,0]
v_pk_add_f32 v[60:61], v[60:61], v[24:25] op_sel_hi:[1,0]
v_pk_add_f32 v[62:63], v[62:63], v[24:25] op_sel_hi:[1,0]
v_pk_mul_f32 v[24:25], v[32:33], v[32:33]
v_pk_fma_f32 v[24:25], v[34:35], v[34:35], v[24:25]
v_pk_fma_f32 v[24:25], v[36:37], v[36:37], v[24:25]
v_pk_fma_f32 v[24:25], v[38:39], v[38:39], v[24:25]
v_pk_fma_f32 v[24:25], v[40:41], v[40:41], v[24:25]
v_pk_fma_f32 v[24:25], v[42:43], v[42:43], v[24:25]
v_pk_fma_f32 v[24:25], v[44:45], v[44:45], v[24:25]
v_pk_fma_f32 v[24:25], v[46:47], v[46:47], v[24:25]
v_pk_fma_f32 v[24:25], v[48:49], v[48:49], v[24:25]
v_pk_fma_f32 v[24:25], v[50:51], v[50:51], v[24:25]
v_pk_fma_f32 v[24:25], v[52:53], v[52:53], v[24:25]
v_pk_fma_f32 v[24:25], v[54:55], v[54:55], v[24:25]
v_pk_fma_f32 v[24:25], v[56:57], v[56:57], v[24:25]
v_pk_fma_f32 v[24:25], v[58:59], v[58:59], v[24:25]
v_pk_fma_f32 v[24:25], v[60:61], v[60:61], v[24:25]
v_pk_fma_f32 v[24:25], v[62:63], v[62:63], v[24:25]
v_add_f32 v24, v24, v25
s_nop 1
v_add_f32_dpp v24, v24, v24 row_ror:8 row_mask:0xf bank_mask:0xf
v_mov_b32 v25, v24
s_nop 1
v_permlane16_swap_b32 v24, v25
s_nop 1
v_add_f32 v24, v24, v25
v_mov_b32 v25, v24
s_nop 1
v_permlane32_swap_b32 v24, v25
s_nop 1
v_add_f32 v24, v24, v25
ds_write_b32 v26, v24 offset:128
s_waitcnt lgkmcnt(0)
s_barrier
ds_read_b32 v20, v27 offset:128
ds_read_b32 v21, v27 offset:160
ds_read_b32 v22, v27 offset:192
ds_read_b32 v23, v27 offset:224
s_waitcnt lgkmcnt(0)
v_add_f32 v20, v20, v21
v_add_f32 v22, v22, v23
v_add_f32 v24, v20, v22
v_mov_b32 v25, 0x3727c5ac
v_fmac_f32 v25, 0x3a800000, v24
v_rsq_f32 v24, v25
s_nop 0
v_mul_f32 v24, 0x3fb8aa3b, v24
v_pk_mul_f32 v[32:33], v[32:33], v[24:25] op_sel_hi:[1,0]
v_pk_mul_f32 v[34:35], v[34:35], v[24:25] op_sel_hi:[1,0]
v_pk_mul_f32 v[36:37], v[36:37], v[24:25] op_sel_hi:[1,0]
v_pk_mul_f32 v[38:39], v[38:39], v[24:25] op_sel_hi:[1,0]
v_pk_mul_f32 v[40:41], v[40:41], v[24:25] op_sel_hi:[1,0]
v_pk_mul_f32 v[42:43], v[42:43], v[24:25] op_sel_hi:[1,0]
v_pk_mul_f32 v[44:45], v[44:45], v[24:25] op_sel_hi:[1,0]
v_pk_mul_f32 v[46:47], v[46:47], v[24:25] op_sel_hi:[1,0]
v_pk_mul_f32 v[48:49], v[48:49], v[24:25] op_sel_hi:[1,0]
v_pk_mul_f32 v[50:51], v[50:51], v[24:25] op_sel_hi:[1,0]
v_pk_mul_f32 v[52:53], v[52:53], v[24:25] op_sel_hi:[1,0]
v_pk_mul_f32 v[54:55], v[54:55], v[24:25] op_sel_hi:[1,0]
v_pk_mul_f32 v[56:57], v[56:57], v[24:25] op_sel_hi:[1,0]
v_pk_mul_f32 v[58:59], v[58:59], v[24:25] op_sel_hi:[1,0]
v_pk_mul_f32 v[60:61], v[60:61], v[24:25] op_sel_hi:[1,0]
v_pk_mul_f32 v[62:63], v[62:63], v[24:25] op_sel_hi:[1,0]
v_pk_fma_f32 v[32:33], v[32:33], v[144:145], v[176:177]
v_pk_fma_f32 v[34:35], v[34:35], v[146:147], v[178:179]
v_pk_fma_f32 v[36:37], v[36:37], v[148:149], v[180:181]
v_pk_fma_f32 v[38:39], v[38:39], v[150:151], v[182:183]
v_cvt_pk_bf16_f32 v64, v32, v33
v_cvt_pk_bf16_f32 v65, v34, v35
v_cvt_pk_bf16_f32 v66, v36, v37
v_cvt_pk_bf16_f32 v67, v38, v39
buffer_store_dwordx4 v[64:67], v28, s[60:63], s67 offen sc1
v_pk_fma_f32 v[40:41], v[40:41], v[152:153], v[184:185]
v_pk_fma_f32 v[42:43], v[42:43], v[154:155], v[186:187]
v_pk_fma_f32 v[44:45], v[44:45], v[156:157], v[188:189]
v_pk_fma_f32 v[46:47], v[46:47], v[158:159], v[190:191]
v_cvt_pk_bf16_f32 v68, v40, v41
v_cvt_pk_bf16_f32 v69, v42, v43
v_cvt_pk_bf16_f32 v70, v44, v45
v_cvt_pk_bf16_f32 v71, v46, v47
buffer_store_dwordx4 v[68:71], v28, s[60:63], s68 offen sc1
v_pk_fma_f32 v[48:49], v[48:49], v[160:161], v[192:193]
v_pk_fma_f32 v[50:51], v[50:51], v[162:163], v[194:195]
v_pk_fma_f32 v[52:53], v[52:53], v[164:165], v[196:197]
v_pk_fma_f32 v[54:55], v[54:55], v[166:167], v[198:199]
v_cvt_pk_bf16_f32 v72, v48, v49
v_cvt_pk_bf16_f32 v73, v50, v51
v_cvt_pk_bf16_f32 v74, v52, v53
v_cvt_pk_bf16_f32 v75, v54, v55
buffer_store_dwordx4 v[72:75], v28, s[60:63], s69 offen sc1
v_pk_fma_f32 v[56:57], v[56:57], v[168:169], v[200:201]
v_pk_fma_f32 v[58:59], v[58:59], v[170:171], v[202:203]
v_pk_fma_f32 v[60:61], v[60:61], v[172:173], v[204:205]
v_pk_fma_f32 v[62:63], v[62:63], v[174:175], v[206:207]
v_cvt_pk_bf16_f32 v76, v56, v57
v_cvt_pk_bf16_f32 v77, v58, v59
v_cvt_pk_bf16_f32 v78, v60, v61
v_cvt_pk_bf16_f32 v79, v62, v63
buffer_store_dwordx4 v[76:79], v28, s[60:63], s70 offen sc1
s_waitcnt vmcnt(0)
s_barrier
s_cmp_lg_u32 s24, 0
s_cbranch_scc1 L_sig19
s_lshl_b32 s33, s25, 3
s_add_u32 s33, s33, 192
s_lshl_b32 s33, s33, 7
v_mov_b32 v2, s33
v_mov_b32 v3, 1
s_mov_b64 exec, 1
global_atomic_add v2, v3, s[34:35]
s_mov_b64 exec, -1
L_sig19:
s_add_u32 s56, s22, 46137344
s_addc_u32 s57, s23, 0
s_mov_b32 s58, 4194304
s_mov_b32 s59, 0x20000
v_accvgpr_read_b32 v19, a240
s_mov_b32 s30, 0
buffer_store_dwordx4 a[224:227], v19, s[56:59], s30 offen sc1
s_mov_b32 s30, 1048576
buffer_store_dwordx4 a[228:231], v19, s[56:59], s30 offen sc1
s_mov_b32 s30, 2097152
buffer_store_dwordx4 a[232:235], v19, s[56:59], s30 offen sc1
s_mov_b32 s30, 3145728
buffer_store_dwordx4 a[236:239], v19, s[56:59], s30 offen sc1
s_and_b32 s30, s24, 1
s_mul_i32 s30, s30, 448
s_mul_i32 s31, s28, 224
s_and_b32 s32, s28, 1
s_lshl_b32 s32, s32, 1
v_add_u32 v16, s30, v1
v_mul_u32_u24 v17, 4682, v16
v_lshrrev_b32 v17, 16, v17
v_mul_u32_u24 v18, 14, v17
v_sub_u32 v18, v16, v18
v_add_u32 v18, s32, v18
v_subrev_u32 v19, 14, v18
v_cmp_gt_u32 vcc, 14, v18
s_nop 1
v_cndmask_b32 v18, v19, v18, vcc
v_mul_u32_u24 v17, 7168, v17
v_lshlrev_b32 v18, 4, v18
v_add3_u32 v4, v17, v18, s31
v_add_u32 v16, s30, v1
v_add_u32 v16, 64, v16
v_mul_u32_u24 v17, 4682, v16
v_lshrrev_b32 v17, 16, v17
v_mul_u32_u24 v18, 14, v17
v_sub_u32 v18, v16, v18
v_add_u32 v18, s32, v18
v_subrev_u32 v19, 14, v18
v_cmp_gt_u32 vcc, 14, v18
s_nop 1
v_cndmask_b32 v18, v19, v18, vcc
v_mul_u32_u24 v17, 7168, v17
v_lshlrev_b32 v18, 4, v18
v_add3_u32 v5, v17, v18, s31
v_add_u32 v16, s30, v1
v_add_u32 v16, 128, v16
v_mul_u32_u24 v17, 4682, v16
v_lshrrev_b32 v17, 16, v17
v_mul_u32_u24 v18, 14, v17
v_sub_u32 v18, v16, v18
v_add_u32 v18, s32, v18
v_subrev_u32 v19, 14, v18
v_cmp_gt_u32 vcc, 14, v18
s_nop 1
v_cndmask_b32 v18, v19, v18, vcc
v_mul_u32_u24 v17, 7168, v17
v_lshlrev_b32 v18, 4, v18
v_add3_u32 v6, v17, v18, s31
v_add_u32 v16, s30, v1
v_add_u32 v16, 192, v16
v_mul_u32_u24 v17, 4682, v16
v_lshrrev_b32 v17, 16, v17
v_mul_u32_u24 v18, 14, v17
v_sub_u32 v18, v16, v18
v_add_u32 v18, s32, v18
v_subrev_u32 v19, 14, v18
v_cmp_gt_u32 vcc, 14, v18
s_nop 1
v_cndmask_b32 v18, v19, v18, vcc
v_mul_u32_u24 v17, 7168, v17
v_lshlrev_b32 v18, 4, v18
v_add3_u32 v7, v17, v18, s31
v_add_u32 v16, s30, v1
v_add_u32 v16, 256, v16
v_mul_u32_u24 v17, 4682, v16
v_lshrrev_b32 v17, 16, v17
v_mul_u32_u24 v18, 14, v17
v_sub_u32 v18, v16, v18
v_add_u32 v18, s32, v18
v_subrev_u32 v19, 14, v18
v_cmp_gt_u32 vcc, 14, v18
s_nop 1
v_cndmask_b32 v18, v19, v18, vcc
v_mul_u32_u24 v17, 7168, v17
v_lshlrev_b32 v18, 4, v18
v_add3_u32 v8, v17, v18, s31
v_add_u32 v16, s30, v1
v_add_u32 v16, 320, v16
v_mul_u32_u24 v17, 4682, v16
v_lshrrev_b32 v17, 16, v17
v_mul_u32_u24 v18, 14, v17
v_sub_u32 v18, v16, v18
v_add_u32 v18, s32, v18
v_subrev_u32 v19, 14, v18
v_cmp_gt_u32 vcc, 14, v18
s_nop 1
v_cndmask_b32 v18, v19, v18, vcc
v_mul_u32_u24 v17, 7168, v17
v_lshlrev_b32 v18, 4, v18
v_add3_u32 v9, v17, v18, s31
v_add_u32 v16, s30, v1
v_add_u32 v16, 384, v16
v_mul_u32_u24 v17, 4682, v16
v_lshrrev_b32 v17, 16, v17
v_mul_u32_u24 v18, 14, v17
v_sub_u32 v18, v16, v18
v_add_u32 v18, s32, v18
v_subrev_u32 v19, 14, v18
v_cmp_gt_u32 vcc, 14, v18
s_nop 1
v_cndmask_b32 v18, v19, v18, vcc
v_mul_u32_u24 v17, 7168, v17
v_lshlrev_b32 v18, 4, v18
v_add3_u32 v10, v17, v18, s31
s_lshr_b32 s30, s24, 1
s_mul_i32 s30, s30, 14336
s_and_b32 s31, s24, 1
s_mul_i32 s31, s31, 7168
s_add_u32 s65, s30, s31
v_lshrrev_b32 v16, 2, v1
v_mul_u32_u24 v11, 224, v16
v_and_b32 v16, 3, v1
v_lshlrev_b32 v16, 3, v16
v_add_u32 v11, v11, v16
v_add_u32 v12, 57344, v11
s_cmp_ge_u32 s24, 2
s_cselect_b32 s40, s16, s14
s_cselect_b32 s41, s17, s15
s_mov_b32 s42, 7340032
s_mov_b32 s43, 0x20000
s_mov_b32 s64, 0
s_add_u32 m0, s65, 0
s_nop 0
buffer_load_dwordx4 v4, s[40:43], s64 offen lds
s_add_u32 m0, s65, 1024
s_nop 0
buffer_load_dwordx4 v5, s[40:43], s64 offen lds
s_add_u32 m0, s65, 2048
s_nop 0
buffer_load_dwordx4 v6, s[40:43], s64 offen lds
s_add_u32 m0, s65, 3072
s_nop 0
buffer_load_dwordx4 v7, s[40:43], s64 offen lds
s_add_u32 m0, s65, 4096
s_nop 0
buffer_load_dwordx4 v8, s[40:43], s64 offen lds
s_add_u32 m0, s65, 5120
s_nop 0
buffer_load_dwordx4 v9, s[40:43], s64 offen lds
s_add_u32 m0, s65, 6144
s_nop 0
buffer_load_dwordx4 v10, s[40:43], s64 offen lds
s_add_u32 s64, s64, 458752
s_add_u32 m0, s65, 28672
s_nop 0
buffer_load_dwordx4 v4, s[40:43], s64 offen lds
s_add_u32 m0, s65, 29696
s_nop 0
buffer_load_dwordx4 v5, s[40:43], s64 offen lds
s_add_u32 m0, s65, 30720
s_nop 0
buffer_load_dwordx4 v6, s[40:43], s64 offen lds
s_add_u32 m0, s65, 31744
s_nop 0
buffer_load_dwordx4 v7, s[40:43], s64 offen lds
s_add_u32 m0, s65, 32768
s_nop 0
buffer_load_dwordx4 v8, s[40:43], s64 offen lds
s_add_u32 m0, s65, 33792
s_nop 0
buffer_load_dwordx4 v9, s[40:43], s64 offen lds
s_add_u32 m0, s65, 34816
s_nop 0
buffer_load_dwordx4 v10, s[40:43], s64 offen lds
s_add_u32 s44, s22, 54525952
s_addc_u32 s45, s23, 0
s_mov_b32 s46, 4194304
s_mov_b32 s47, 0x20000
s_mov_b32 s66, 0
v_mov_b32 v32, 0
v_mov_b32 v33, 0
v_mov_b32 v34, 0
v_mov_b32 v35, 0
v_mov_b32 v36, 0
v_mov_b32 v37, 0
v_mov_b32 v38, 0
v_mov_b32 v39, 0
v_mov_b32 v40, 0
v_mov_b32 v41, 0
v_mov_b32 v42, 0
v_mov_b32 v43, 0
v_mov_b32 v44, 0
v_mov_b32 v45, 0
v_mov_b32 v46, 0
v_mov_b32 v47, 0
v_mov_b32 v48, 0
v_mov_b32 v49, 0
v_mov_b32 v50, 0
v_mov_b32 v51, 0
v_mov_b32 v52, 0
v_mov_b32 v53, 0
v_mov_b32 v54, 0
v_mov_b32 v55, 0
v_mov_b32 v56, 0
v_mov_b32 v57, 0
v_mov_b32 v58, 0
v_mov_b32 v59, 0
v_mov_b32 v60, 0
v_mov_b32 v61, 0
v_mov_b32 v62, 0
v_mov_b32 v63, 0
v_mov_b32 v64, 0
v_mov_b32 v65, 0
v_mov_b32 v66, 0
v_mov_b32 v67, 0
v_mov_b32 v68, 0
v_mov_b32 v69, 0
v_mov_b32 v70, 0
v_mov_b32 v71, 0
v_mov_b32 v72, 0
v_mov_b32 v73, 0
v_mov_b32 v74, 0
v_mov_b32 v75, 0
v_mov_b32 v76, 0
v_mov_b32 v77, 0
v_mov_b32 v78, 0
v_mov_b32 v79, 0
v_mov_b32 v80, 0
v_mov_b32 v81, 0
v_mov_b32 v82, 0
v_mov_b32 v83, 0
v_mov_b32 v84, 0
v_mov_b32 v85, 0
v_mov_b32 v86, 0
v_mov_b32 v87, 0
v_mov_b32 v88, 0
v_mov_b32 v89, 0
v_mov_b32 v90, 0
v_mov_b32 v91, 0
v_mov_b32 v92, 0
v_mov_b32 v93, 0
v_mov_b32 v94, 0
v_mov_b32 v95, 0
v_mov_b32 v96, 0
v_mov_b32 v97, 0
v_mov_b32 v98, 0
v_mov_b32 v99, 0
v_mov_b32 v100, 0
v_mov_b32 v101, 0
v_mov_b32 v102, 0
v_mov_b32 v103, 0
v_mov_b32 v104, 0
v_mov_b32 v105, 0
v_mov_b32 v106, 0
v_mov_b32 v107, 0
v_mov_b32 v108, 0
v_mov_b32 v109, 0
v_mov_b32 v110, 0
v_mov_b32 v111, 0
v_mov_b32 v112, 0
v_mov_b32 v113, 0
v_mov_b32 v114, 0
v_mov_b32 v115, 0
v_mov_b32 v116, 0
v_mov_b32 v117, 0
v_mov_b32 v118, 0
v_mov_b32 v119, 0
v_mov_b32 v120, 0
v_mov_b32 v121, 0
v_mov_b32 v122, 0
v_mov_b32 v123, 0
v_mov_b32 v124, 0
v_mov_b32 v125, 0
v_mov_b32 v126, 0
v_mov_b32 v127, 0
v_mov_b32 v128, 0
v_mov_b32 v129, 0
v_mov_b32 v130, 0
v_mov_b32 v131, 0
v_mov_b32 v132, 0
v_mov_b32 v133, 0
v_mov_b32 v134, 0
v_mov_b32 v135, 0
v_mov_b32 v136, 0
v_mov_b32 v137, 0
v_mov_b32 v138, 0
v_mov_b32 v139, 0
v_mov_b32 v140, 0
v_mov_b32 v141, 0
v_mov_b32 v142, 0
v_mov_b32 v143, 0
v_mov_b32 v144, 0
v_mov_b32 v145, 0
v_mov_b32 v146, 0
v_mov_b32 v147, 0
v_mov_b32 v148, 0
v_mov_b32 v149, 0
v_mov_b32 v150, 0
v_mov_b32 v151, 0
v_mov_b32 v152, 0
v_mov_b32 v153, 0
v_mov_b32 v154, 0
v_mov_b32 v155, 0
v_mov_b32 v156, 0
v_mov_b32 v157, 0
v_mov_b32 v158, 0
v_mov_b32 v159, 0
v_mov_b32 v160, 0
v_mov_b32 v161, 0
v_mov_b32 v162, 0
v_mov_b32 v163, 0
v_mov_b32 v164, 0
v_mov_b32 v165, 0
v_mov_b32 v166, 0
v_mov_b32 v167, 0
v_mov_b32 v168, 0
v_mov_b32 v169, 0
v_mov_b32 v170, 0
v_mov_b32 v171, 0
v_mov_b32 v172, 0
v_mov_b32 v173, 0
v_mov_b32 v174, 0
v_mov_b32 v175, 0
v_mov_b32 v176, 0
v_mov_b32 v177, 0
v_mov_b32 v178, 0
v_mov_b32 v179, 0
v_mov_b32 v180, 0
v_mov_b32 v181, 0
v_mov_b32 v182, 0
v_mov_b32 v183, 0
v_mov_b32 v184, 0
v_mov_b32 v185, 0
v_mov_b32 v186, 0
v_mov_b32 v187, 0
v_mov_b32 v188, 0
v_mov_b32 v189, 0
v_mov_b32 v190, 0
v_mov_b32 v191, 0
v_mov_b32 v192, 0
v_mov_b32 v193, 0
v_mov_b32 v194, 0
v_mov_b32 v195, 0
v_mov_b32 v196, 0
v_mov_b32 v197, 0
v_mov_b32 v198, 0
v_mov_b32 v199, 0
v_mov_b32 v200, 0
v_mov_b32 v201, 0
v_mov_b32 v202, 0
v_mov_b32 v203, 0
v_mov_b32 v204, 0
v_mov_b32 v205, 0
v_mov_b32 v206, 0
v_mov_b32 v207, 0
v_mov_b32 v208, 0
v_mov_b32 v209, 0
v_mov_b32 v210, 0
v_mov_b32 v211, 0
v_mov_b32 v212, 0
v_mov_b32 v213, 0
v_mov_b32 v214, 0
v_mov_b32 v215, 0
v_mov_b32 v216, 0
v_mov_b32 v217, 0
v_mov_b32 v218, 0
v_mov_b32 v219, 0
v_mov_b32 v220, 0
v_mov_b32 v221, 0
v_mov_b32 v222, 0
v_mov_b32 v223, 0
v_mov_b32 v224, 0
v_mov_b32 v225, 0
v_mov_b32 v226, 0
v_mov_b32 v227, 0
v_mov_b32 v228, 0
v_mov_b32 v229, 0
v_mov_b32 v230, 0
v_mov_b32 v231, 0
v_mov_b32 v232, 0
v_mov_b32 v233, 0
v_mov_b32 v234, 0
v_mov_b32 v235, 0
v_mov_b32 v236, 0
v_mov_b32 v237, 0
v_mov_b32 v238, 0
v_mov_b32 v239, 0
v_mov_b32 v240, 0
v_mov_b32 v241, 0
v_mov_b32 v242, 0
v_mov_b32 v243, 0
v_mov_b32 v244, 0
v_mov_b32 v245, 0
v_mov_b32 v246, 0
v_mov_b32 v247, 0
v_mov_b32 v248, 0
v_mov_b32 v249, 0
v_mov_b32 v250, 0
v_mov_b32 v251, 0
v_mov_b32 v252, 0
v_mov_b32 v253, 0
v_mov_b32 v254, 0
v_mov_b32 v255, 0
s_waitcnt vmcnt(7)
s_barrier
ds_read_b64_tr_b16 a[128:129], v11 offset:0
ds_read_b64_tr_b16 a[130:131], v11 offset:3584
ds_read_b64_tr_b16 a[132:133], v11 offset:14336
ds_read_b64_tr_b16 a[134:135], v11 offset:17920
ds_read_b64_tr_b16 a[136:137], v11 offset:32
ds_read_b64_tr_b16 a[138:139], v11 offset:3616
ds_read_b64_tr_b16 a[140:141], v11 offset:14368
ds_read_b64_tr_b16 a[142:143], v11 offset:17952
ds_read_b64_tr_b16 a[144:145], v11 offset:64
ds_read_b64_tr_b16 a[146:147], v11 offset:3648
ds_read_b64_tr_b16 a[148:149], v11 offset:14400
ds_read_b64_tr_b16 a[150:151], v11 offset:17984
s_cmp_lg_u32 s24, 0
s_cbranch_scc1 L_wt20
s_lshl_b32 s33, s25, 3
s_add_u32 s33, s33, 192
s_lshl_b32 s33, s33, 7
v_mov_b32 v2, s33
s_mov_b32 s32, 1048576
L_poll21:
global_load_dword v3, v2, s[34:35] sc1
s_waitcnt vmcnt(0)
v_readfirstlane_b32 s31, v3
s_nop 0
s_cmp_ge_u32 s31, 32
s_cbranch_scc1 L_pd22
s_sub_u32 s32, s32, 1
s_cmp_eq_u32 s32, 0
s_cbranch_scc1 L_pd22
s_sleep 2
s_branch L_poll21
L_pd22:
L_wt20:
s_barrier
s_add_u32 s48, s22, 58720256
s_addc_u32 s49, s23, 0
s_mov_b32 s50, 14680064
s_mov_b32 s51, 0x20000
s_and_b32 s67, s28, 1
s_mul_i32 s68, s28, 7
s_add_u32 s68, s68, s67
s_lshr_b32 s68, s68, 1
s_add_u32 s30, s68, 0
s_lshr_b32 s69, s30, 1
s_lshl_b32 s69, s69, 18
s_and_b32 s30, s30, 1
s_lshl_b32 s30, s30, 10
s_add_u32 s69, s69, s30
s_add_u32 s30, s68, 1
s_lshr_b32 s70, s30, 1
s_lshl_b32 s70, s70, 18
s_and_b32 s30, s30, 1
s_lshl_b32 s30, s30, 10
s_add_u32 s70, s70, s30
s_add_u32 s30, s68, 2
s_lshr_b32 s71, s30, 1
s_lshl_b32 s71, s71, 18
s_and_b32 s30, s30, 1
s_lshl_b32 s30, s30, 10
s_add_u32 s71, s71, s30
s_mul_i32 s30, s28, 7
s_add_u32 s31, s30, 6
s_cmp_eq_u32 s67, 0
s_cselect_b32 s30, s31, s30
s_lshr_b32 s31, s30, 2
s_lshl_b32 s72, s31, 18
s_bfe_u32 s31, s30, 0x10001
s_lshl_b32 s31, s31, 10
s_add_u32 s72, s72, s31
s_and_b32 s30, s30, 1
s_lshl_b32 s30, s30, 3
s_add_u32 s72, s72, s30
buffer_load_dwordx4 a[0:3], v14, s[44:47], s66 offen offset:0 sc1
buffer_load_dwordx4 a[4:7], v14, s[44:47], s66 offen offset:2048 sc1
buffer_load_dwordx4 a[8:11], v15, s[44:47], s66 offen offset:0 sc1
buffer_load_dwordx4 a[12:15], v15, s[44:47], s66 offen offset:2048 sc1
buffer_load_dwordx4 a[16:19], v14, s[44:47], s66 offen offset:1024 sc1
buffer_load_dwordx4 a[20:23], v14, s[44:47], s66 offen offset:3072 sc1
buffer_load_dwordx4 a[24:27], v15, s[44:47], s66 offen offset:1024 sc1
buffer_load_dwordx4 a[28:31], v15, s[44:47], s66 offen offset:3072 sc1
s_add_u32 s66, s66, 262144
buffer_load_dwordx4 a[32:35], v14, s[44:47], s66 offen offset:0 sc1
buffer_load_dwordx4 a[36:39], v14, s[44:47], s66 offen offset:2048 sc1
buffer_load_dwordx4 a[40:43], v15, s[44:47], s66 offen offset:0 sc1
buffer_load_dwordx4 a[44:47], v15, s[44:47], s66 offen offset:2048 sc1
s_mov_b32 s29, 3
L_loop_u:
s_waitcnt vmcnt(8)
s_waitcnt lgkmcnt(8)
v_mfma_f32_16x16x32_bf16 v[32:35], a[128:131], a[0:3], v[32:35]
ds_read_b64_tr_b16 a[152:153], v11 offset:96
v_mfma_f32_16x16x32_bf16 v[88:91], a[128:131], a[4:7], v[88:91]
v_mfma_f32_16x16x32_bf16 v[144:147], a[128:131], a[8:11], v[144:147]
ds_read_b64_tr_b16 a[154:155], v11 offset:3680
v_mfma_f32_16x16x32_bf16 v[200:203], a[128:131], a[12:15], v[200:203]
s_add_u32 s64, s64, 458752
s_add_u32 m0, s65, 57344
v_mfma_f32_16x16x32_bf16 v[204:207], a[132:135], a[12:15], v[204:207]
ds_read_b64_tr_b16 a[156:157], v11 offset:14432
v_mfma_f32_16x16x32_bf16 v[148:151], a[132:135], a[8:11], v[148:151]
buffer_load_dwordx4 v4, s[40:43], s64 offen lds
v_mfma_f32_16x16x32_bf16 v[92:95], a[132:135], a[4:7], v[92:95]
ds_read_b64_tr_b16 a[158:159], v11 offset:18016
v_mfma_f32_16x16x32_bf16 v[36:39], a[132:135], a[0:3], v[36:39]
s_waitcnt lgkmcnt(8)
v_mfma_f32_16x16x32_bf16 v[40:43], a[136:139], a[0:3], v[40:43]
ds_read_b64_tr_b16 a[128:129], v11 offset:128
v_mfma_f32_16x16x32_bf16 v[96:99], a[136:139], a[4:7], v[96:99]
s_add_u32 m0, s65, 58368
v_mfma_f32_16x16x32_bf16 v[152:155], a[136:139], a[8:11], v[152:155]
ds_read_b64_tr_b16 a[130:131], v11 offset:3712
v_mfma_f32_16x16x32_bf16 v[208:211], a[136:139], a[12:15], v[208:211]
buffer_load_dwordx4 v5, s[40:43], s64 offen lds
v_mfma_f32_16x16x32_bf16 v[212:215], a[140:143], a[12:15], v[212:215]
ds_read_b64_tr_b16 a[132:133], v11 offset:14464
v_mfma_f32_16x16x32_bf16 v[156:159], a[140:143], a[8:11], v[156:159]
v_mfma_f32_16x16x32_bf16 v[100:103], a[140:143], a[4:7], v[100:103]
ds_read_b64_tr_b16 a[134:135], v11 offset:18048
v_mfma_f32_16x16x32_bf16 v[44:47], a[140:143], a[0:3], v[44:47]
s_waitcnt lgkmcnt(8)
v_mfma_f32_16x16x32_bf16 v[48:51], a[144:147], a[0:3], v[48:51]
ds_read_b64_tr_b16 a[136:137], v11 offset:160
v_mfma_f32_16x16x32_bf16 v[104:107], a[144:147], a[4:7], v[104:107]
s_add_u32 m0, s65, 59392
v_mfma_f32_16x16x32_bf16 v[160:163], a[144:147], a[8:11], v[160:163]
ds_read_b64_tr_b16 a[138:139], v11 offset:3744
v_mfma_f32_16x16x32_bf16 v[216:219], a[144:147], a[12:15], v[216:219]
buffer_load_dwordx4 v6, s[40:43], s64 offen lds
v_mfma_f32_16x16x32_bf16 v[220:223], a[148:151], a[12:15], v[220:223]
ds_read_b64_tr_b16 a[140:141], v11 offset:14496
v_mfma_f32_16x16x32_bf16 v[164:167], a[148:151], a[8:11], v[164:167]
v_mfma_f32_16x16x32_bf16 v[108:111], a[148:151], a[4:7], v[108:111]
ds_read_b64_tr_b16 a[142:143], v11 offset:18080
v_mfma_f32_16x16x32_bf16 v[52:55], a[148:151], a[0:3], v[52:55]
s_add_u32 m0, s65, 60416
s_waitcnt lgkmcnt(8)
v_mfma_f32_16x16x32_bf16 v[56:59], a[152:155], a[0:3], v[56:59]
ds_read_b64_tr_b16 a[144:145], v11 offset:192
v_mfma_f32_16x16x32_bf16 v[112:115], a[152:155], a[4:7], v[112:115]
buffer_load_dwordx4 v7, s[40:43], s64 offen lds
v_mfma_f32_16x16x32_bf16 v[168:171], a[152:155], a[8:11], v[168:171]
ds_read_b64_tr_b16 a[146:147], v11 offset:3776
v_mfma_f32_16x16x32_bf16 v[224:227], a[152:155], a[12:15], v[224:227]
v_mfma_f32_16x16x32_bf16 v[228:231], a[156:159], a[12:15], v[228:231]
ds_read_b64_tr_b16 a[148:149], v11 offset:14528
v_mfma_f32_16x16x32_bf16 v[172:175], a[156:159], a[8:11], v[172:175]
v_mfma_f32_16x16x32_bf16 v[116:119], a[156:159], a[4:7], v[116:119]
ds_read_b64_tr_b16 a[150:151], v11 offset:18112
v_mfma_f32_16x16x32_bf16 v[60:63], a[156:159], a[0:3], v[60:63]
buffer_load_dwordx4 a[48:51], v14, s[44:47], s66 offen offset:1024 sc1
s_waitcnt lgkmcnt(8)
v_mfma_f32_16x16x32_bf16 v[64:67], a[128:131], a[0:3], v[64:67]
ds_read_b64_tr_b16 a[152:153], v11 offset:7168
v_mfma_f32_16x16x32_bf16 v[120:123], a[128:131], a[4:7], v[120:123]
v_mfma_f32_16x16x32_bf16 v[176:179], a[128:131], a[8:11], v[176:179]
ds_read_b64_tr_b16 a[154:155], v11 offset:10752
v_mfma_f32_16x16x32_bf16 v[232:235], a[128:131], a[12:15], v[232:235]
v_mfma_f32_16x16x32_bf16 v[236:239], a[132:135], a[12:15], v[236:239]
ds_read_b64_tr_b16 a[156:157], v11 offset:21504
v_mfma_f32_16x16x32_bf16 v[180:183], a[132:135], a[8:11], v[180:183]
buffer_load_dwordx4 a[52:55], v14, s[44:47], s66 offen offset:3072 sc1
v_mfma_f32_16x16x32_bf16 v[124:127], a[132:135], a[4:7], v[124:127]
ds_read_b64_tr_b16 a[158:159], v11 offset:25088
v_mfma_f32_16x16x32_bf16 v[68:71], a[132:135], a[0:3], v[68:71]
s_waitcnt lgkmcnt(8)
v_mfma_f32_16x16x32_bf16 v[72:75], a[136:139], a[0:3], v[72:75]
ds_read_b64_tr_b16 a[128:129], v11 offset:7200
v_mfma_f32_16x16x32_bf16 v[128:131], a[136:139], a[4:7], v[128:131]
v_mfma_f32_16x16x32_bf16 v[184:187], a[136:139], a[8:11], v[184:187]
ds_read_b64_tr_b16 a[130:131], v11 offset:10784
v_mfma_f32_16x16x32_bf16 v[240:243], a[136:139], a[12:15], v[240:243]
v_mfma_f32_16x16x32_bf16 v[244:247], a[140:143], a[12:15], v[244:247]
ds_read_b64_tr_b16 a[132:133], v11 offset:21536
v_mfma_f32_16x16x32_bf16 v[188:191], a[140:143], a[8:11], v[188:191]
buffer_load_dwordx4 a[56:59], v15, s[44:47], s66 offen offset:1024 sc1
v_mfma_f32_16x16x32_bf16 v[132:135], a[140:143], a[4:7], v[132:135]
ds_read_b64_tr_b16 a[134:135], v11 offset:25120
v_mfma_f32_16x16x32_bf16 v[76:79], a[140:143], a[0:3], v[76:79]
s_waitcnt lgkmcnt(8)
v_mfma_f32_16x16x32_bf16 v[80:83], a[144:147], a[0:3], v[80:83]
ds_read_b64_tr_b16 a[136:137], v11 offset:7232
v_mfma_f32_16x16x32_bf16 v[136:139], a[144:147], a[4:7], v[136:139]
v_mfma_f32_16x16x32_bf16 v[192:195], a[144:147], a[8:11], v[192:195]
ds_read_b64_tr_b16 a[138:139], v11 offset:10816
v_mfma_f32_16x16x32_bf16 v[248:251], a[144:147], a[12:15], v[248:251]
buffer_load_dwordx4 a[60:63], v15, s[44:47], s66 offen offset:3072 sc1
v_mfma_f32_16x16x32_bf16 v[252:255], a[148:151], a[12:15], v[252:255]
ds_read_b64_tr_b16 a[140:141], v11 offset:21568
v_mfma_f32_16x16x32_bf16 v[196:199], a[148:151], a[8:11], v[196:199]
v_mfma_f32_16x16x32_bf16 v[140:143], a[148:151], a[4:7], v[140:143]
ds_read_b64_tr_b16 a[142:143], v11 offset:25152
v_mfma_f32_16x16x32_bf16 v[84:87], a[148:151], a[0:3], v[84:87]
s_waitcnt vmcnt(12)
s_waitcnt lgkmcnt(8)
v_mfma_f32_16x16x32_bf16 v[32:35], a[152:155], a[16:19], v[32:35]
ds_read_b64_tr_b16 a[144:145], v11 offset:7264
v_mfma_f32_16x16x32_bf16 v[88:91], a[152:155], a[20:23], v[88:91]
v_mfma_f32_16x16x32_bf16 v[144:147], a[152:155], a[24:27], v[144:147]
ds_read_b64_tr_b16 a[146:147], v11 offset:10848
v_mfma_f32_16x16x32_bf16 v[200:203], a[152:155], a[28:31], v[200:203]
s_add_u32 m0, s65, 61440
v_mfma_f32_16x16x32_bf16 v[204:207], a[156:159], a[28:31], v[204:207]
ds_read_b64_tr_b16 a[148:149], v11 offset:21600
v_mfma_f32_16x16x32_bf16 v[148:151], a[156:159], a[24:27], v[148:151]
buffer_load_dwordx4 v8, s[40:43], s64 offen lds
v_mfma_f32_16x16x32_bf16 v[92:95], a[156:159], a[20:23], v[92:95]
ds_read_b64_tr_b16 a[150:151], v11 offset:25184
v_mfma_f32_16x16x32_bf16 v[36:39], a[156:159], a[16:19], v[36:39]
s_waitcnt lgkmcnt(8)
v_mfma_f32_16x16x32_bf16 v[40:43], a[128:131], a[16:19], v[40:43]
ds_read_b64_tr_b16 a[152:153], v11 offset:7296
v_mfma_f32_16x16x32_bf16 v[96:99], a[128:131], a[20:23], v[96:99]
v_mfma_f32_16x16x32_bf16 v[152:155], a[128:131], a[24:27], v[152:155]
ds_read_b64_tr_b16 a[154:155], v11 offset:10880
v_mfma_f32_16x16x32_bf16 v[208:211], a[128:131], a[28:31], v[208:211]
s_add_u32 m0, s65, 62464
v_mfma_f32_16x16x32_bf16 v[212:215], a[132:135], a[28:31], v[212:215]
ds_read_b64_tr_b16 a[156:157], v11 offset:21632
v_mfma_f32_16x16x32_bf16 v[156:159], a[132:135], a[24:27], v[156:159]
buffer_load_dwordx4 v9, s[40:43], s64 offen lds
v_mfma_f32_16x16x32_bf16 v[100:103], a[132:135], a[20:23], v[100:103]
ds_read_b64_tr_b16 a[158:159], v11 offset:25216
v_mfma_f32_16x16x32_bf16 v[44:47], a[132:135], a[16:19], v[44:47]
s_waitcnt lgkmcnt(8)
v_mfma_f32_16x16x32_bf16 v[48:51], a[136:139], a[16:19], v[48:51]
ds_read_b64_tr_b16 a[128:129], v11 offset:7328
v_mfma_f32_16x16x32_bf16 v[104:107], a[136:139], a[20:23], v[104:107]
v_mfma_f32_16x16x32_bf16 v[160:163], a[136:139], a[24:27], v[160:163]
ds_read_b64_tr_b16 a[130:131], v11 offset:10912
v_mfma_f32_16x16x32_bf16 v[216:219], a[136:139], a[28:31], v[216:219]
s_add_u32 m0, s65, 63488
v_mfma_f32_16x16x32_bf16 v[220:223], a[140:143], a[28:31], v[220:223]
ds_read_b64_tr_b16 a[132:133], v11 offset:21664
v_mfma_f32_16x16x32_bf16 v[164:167], a[140:143], a[24:27], v[164:167]
buffer_load_dwordx4 v10, s[40:43], s64 offen lds
v_mfma_f32_16x16x32_bf16 v[108:111], a[140:143], a[20:23], v[108:111]
ds_read_b64_tr_b16 a[134:135], v11 offset:25248
v_mfma_f32_16x16x32_bf16 v[52:55], a[140:143], a[16:19], v[52:55]
s_waitcnt lgkmcnt(8)
v_mfma_f32_16x16x32_bf16 v[56:59], a[144:147], a[16:19], v[56:59]
ds_read_b64_tr_b16 a[136:137], v11 offset:7360
v_mfma_f32_16x16x32_bf16 v[112:115], a[144:147], a[20:23], v[112:115]
v_mfma_f32_16x16x32_bf16 v[168:171], a[144:147], a[24:27], v[168:171]
ds_read_b64_tr_b16 a[138:139], v11 offset:10944
v_mfma_f32_16x16x32_bf16 v[224:227], a[144:147], a[28:31], v[224:227]
s_add_u32 s66, s66, 262144
v_mfma_f32_16x16x32_bf16 v[228:231], a[148:151], a[28:31], v[228:231]
ds_read_b64_tr_b16 a[140:141], v11 offset:21696
v_mfma_f32_16x16x32_bf16 v[172:175], a[148:151], a[24:27], v[172:175]
buffer_load_dwordx4 a[0:3], v14, s[44:47], s66 offen offset:0 sc1
v_mfma_f32_16x16x32_bf16 v[116:119], a[148:151], a[20:23], v[116:119]
ds_read_b64_tr_b16 a[142:143], v11 offset:25280
v_mfma_f32_16x16x32_bf16 v[60:63], a[148:151], a[16:19], v[60:63]
s_waitcnt lgkmcnt(8)
s_waitcnt vmcnt(16)
s_barrier
v_mfma_f32_16x16x32_bf16 v[64:67], a[152:155], a[16:19], v[64:67]
ds_read_b64_tr_b16 a[144:145], v11 offset:28672
v_mfma_f32_16x16x32_bf16 v[120:123], a[152:155], a[20:23], v[120:123]
v_mfma_f32_16x16x32_bf16 v[176:179], a[152:155], a[24:27], v[176:179]
ds_read_b64_tr_b16 a[146:147], v11 offset:32256
v_mfma_f32_16x16x32_bf16 v[232:235], a[152:155], a[28:31], v[232:235]
buffer_load_dwordx4 a[4:7], v14, s[44:47], s66 offen offset:2048 sc1
v_mfma_f32_16x16x32_bf16 v[236:239], a[156:159], a[28:31], v[236:239]
ds_read_b64_tr_b16 a[148:149], v11 offset:43008
v_mfma_f32_16x16x32_bf16 v[180:183], a[156:159], a[24:27], v[180:183]
v_mfma_f32_16x16x32_bf16 v[124:127], a[156:159], a[20:23], v[124:127]
ds_read_b64_tr_b16 a[150:151], v11 offset:46592
v_mfma_f32_16x16x32_bf16 v[68:71], a[156:159], a[16:19], v[68:71]
s_waitcnt lgkmcnt(8)
v_mfma_f32_16x16x32_bf16 v[72:75], a[128:131], a[16:19], v[72:75]
ds_read_b64_tr_b16 a[152:153], v11 offset:28704
v_mfma_f32_16x16x32_bf16 v[128:131], a[128:131], a[20:23], v[128:131]
v_mfma_f32_16x16x32_bf16 v[184:187], a[128:131], a[24:27], v[184:187]
ds_read_b64_tr_b16 a[154:155], v11 offset:32288
v_mfma_f32_16x16x32_bf16 v[240:243], a[128:131], a[28:31], v[240:243]
buffer_load_dwordx4 a[8:11], v15, s[44:47], s66 offen offset:0 sc1
v_mfma_f32_16x16x32_bf16 v[244:247], a[132:135], a[28:31], v[244:247]
ds_read_b64_tr_b16 a[156:157], v11 offset:43040
v_mfma_f32_16x16x32_bf16 v[188:191], a[132:135], a[24:27], v[188:191]
v_mfma_f32_16x16x32_bf16 v[132:135], a[132:135], a[20:23], v[132:135]
ds_read_b64_tr_b16 a[158:159], v11 offset:46624
v_mfma_f32_16x16x32_bf16 v[76:79], a[132:135], a[16:19], v[76:79]
s_waitcnt lgkmcnt(8)
v_mfma_f32_16x16x32_bf16 v[80:83], a[136:139], a[16:19], v[80:83]
ds_read_b64_tr_b16 a[128:129], v11 offset:28736
v_mfma_f32_16x16x32_bf16 v[136:139], a[136:139], a[20:23], v[136:139]
v_mfma_f32_16x16x32_bf16 v[192:195], a[136:139], a[24:27], v[192:195]
ds_read_b64_tr_b16 a[130:131], v11 offset:32320
v_mfma_f32_16x16x32_bf16 v[248:251], a[136:139], a[28:31], v[248:251]
buffer_load_dwordx4 a[12:15], v15, s[44:47], s66 offen offset:2048 sc1
v_mfma_f32_16x16x32_bf16 v[252:255], a[140:143], a[28:31], v[252:255]
ds_read_b64_tr_b16 a[132:133], v11 offset:43072
v_mfma_f32_16x16x32_bf16 v[196:199], a[140:143], a[24:27], v[196:199]
v_mfma_f32_16x16x32_bf16 v[140:143], a[140:143], a[20:23], v[140:143]
ds_read_b64_tr_b16 a[134:135], v11 offset:46656
v_mfma_f32_16x16x32_bf16 v[84:87], a[140:143], a[16:19], v[84:87]
s_waitcnt vmcnt(15)
s_waitcnt lgkmcnt(8)
v_mfma_f32_16x16x32_bf16 v[32:35], a[144:147], a[32:35], v[32:35]
ds_read_b64_tr_b16 a[136:137], v11 offset:28768
v_mfma_f32_16x16x32_bf16 v[88:91], a[144:147], a[36:39], v[88:91]
v_mfma_f32_16x16x32_bf16 v[144:147], a[144:147], a[40:43], v[144:147]
ds_read_b64_tr_b16 a[138:139], v11 offset:32352
v_mfma_f32_16x16x32_bf16 v[200:203], a[144:147], a[44:47], v[200:203]
s_add_u32 s64, s64, 458752
s_add_u32 m0, s65, 86016
v_mfma_f32_16x16x32_bf16 v[204:207], a[148:151], a[44:47], v[204:207]
ds_read_b64_tr_b16 a[140:141], v11 offset:43104
v_mfma_f32_16x16x32_bf16 v[148:151], a[148:151], a[40:43], v[148:151]
buffer_load_dwordx4 v4, s[40:43], s64 offen lds
v_mfma_f32_16x16x32_bf16 v[92:95], a[148:151], a[36:39], v[92:95]
ds_read_b64_tr_b16 a[142:143], v11 offset:46688
v_mfma_f32_16x16x32_bf16 v[36:39], a[148:151], a[32:35], v[36:39]
s_waitcnt lgkmcnt(8)
v_mfma_f32_16x16x32_bf16 v[40:43], a[152:155], a[32:35], v[40:43]
ds_read_b64_tr_b16 a[144:145], v11 offset:28800
v_mfma_f32_16x16x32_bf16 v[96:99], a[152:155], a[36:39], v[96:99]
s_add_u32 m0, s65, 87040
v_mfma_f32_16x16x32_bf16 v[152:155], a[152:155], a[40:43], v[152:155]
ds_read_b64_tr_b16 a[146:147], v11 offset:32384
v_mfma_f32_16x16x32_bf16 v[208:211], a[152:155], a[44:47], v[208:211]
buffer_load_dwordx4 v5, s[40:43], s64 offen lds
v_mfma_f32_16x16x32_bf16 v[212:215], a[156:159], a[44:47], v[212:215]
ds_read_b64_tr_b16 a[148:149], v11 offset:43136
v_mfma_f32_16x16x32_bf16 v[156:159], a[156:159], a[40:43], v[156:159]
v_mfma_f32_16x16x32_bf16 v[100:103], a[156:159], a[36:39], v[100:103]
ds_read_b64_tr_b16 a[150:151], v11 offset:46720
v_mfma_f32_16x16x32_bf16 v[44:47], a[156:159], a[32:35], v[44:47]
s_waitcnt lgkmcnt(8)
v_mfma_f32_16x16x32_bf16 v[48:51], a[128:131], a[32:35], v[48:51]
ds_read_b64_tr_b16 a[152:153], v11 offset:28832
v_mfma_f32_16x16x32_bf16 v[104:107], a[128:131], a[36:39], v[104:107]
s_add_u32 m0, s65, 88064
v_mfma_f32_16x16x32_bf16 v[160:163], a[128:131], a[40:43], v[160:163]
ds_read_b64_tr_b16 a[154:155], v11 offset:32416
v_mfma_f32_16x16x32_bf16 v[216:219], a[128:131], a[44:47], v[216:219]
buffer_load_dwordx4 v6, s[40:43], s64 offen lds
v_mfma_f32_16x16x32_bf16 v[220:223], a[132:135], a[44:47], v[220:223]
ds_read_b64_tr_b16 a[156:157], v11 offset:43168
v_mfma_f32_16x16x32_bf16 v[164:167], a[132:135], a[40:43], v[164:167]
v_mfma_f32_16x16x32_bf16 v[108:111], a[132:135], a[36:39], v[108:111]
ds_read_b64_tr_b16 a[158:159], v11 offset:46752
v_mfma_f32_16x16x32_bf16 v[52:55], a[132:135], a[32:35], v[52:55]
s_add_u32 m0, s65, 89088
s_waitcnt lgkmcnt(8)
v_mfma_f32_16x16x32_bf16 v[56:59], a[136:139], a[32:35], v[56:59]
ds_read_b64_tr_b16 a[128:129], v11 offset:28864
v_mfma_f32_16x16x32_bf16 v[112:115], a[136:139], a[36:39], v[112:115]
buffer_load_dwordx4 v7, s[40:43], s64 offen lds
v_mfma_f32_16x16x32_bf16 v[168:171], a[136:139], a[40:43], v[168:171]
ds_read_b64_tr_b16 a[130:131], v11 offset:32448
v_mfma_f32_16x16x32_bf16 v[224:227], a[136:139], a[44:47], v[224:227]
v_mfma_f32_16x16x32_bf16 v[228:231], a[140:143], a[44:47], v[228:231]
ds_read_b64_tr_b16 a[132:133], v11 offset:43200
v_mfma_f32_16x16x32_bf16 v[172:175], a[140:143], a[40:43], v[172:175]
v_mfma_f32_16x16x32_bf16 v[116:119], a[140:143], a[36:39], v[116:119]
ds_read_b64_tr_b16 a[134:135], v11 offset:46784
v_mfma_f32_16x16x32_bf16 v[60:63], a[140:143], a[32:35], v[60:63]
buffer_load_dwordx4 a[16:19], v14, s[44:47], s66 offen offset:1024 sc1
s_waitcnt lgkmcnt(8)
v_mfma_f32_16x16x32_bf16 v[64:67], a[144:147], a[32:35], v[64:67]
ds_read_b64_tr_b16 a[136:137], v11 offset:35840
v_mfma_f32_16x16x32_bf16 v[120:123], a[144:147], a[36:39], v[120:123]
v_mfma_f32_16x16x32_bf16 v[176:179], a[144:147], a[40:43], v[176:179]
ds_read_b64_tr_b16 a[138:139], v11 offset:39424
v_mfma_f32_16x16x32_bf16 v[232:235], a[144:147], a[44:47], v[232:235]
v_mfma_f32_16x16x32_bf16 v[236:239], a[148:151], a[44:47], v[236:239]
ds_read_b64_tr_b16 a[140:141], v11 offset:50176
v_mfma_f32_16x16x32_bf16 v[180:183], a[148:151], a[40:43], v[180:183]
buffer_load_dwordx4 a[20:23], v14, s[44:47], s66 offen offset:3072 sc1
v_mfma_f32_16x16x32_bf16 v[124:127], a[148:151], a[36:39], v[124:127]
ds_read_b64_tr_b16 a[142:143], v11 offset:53760
v_mfma_f32_16x16x32_bf16 v[68:71], a[148:151], a[32:35], v[68:71]
s_waitcnt lgkmcnt(8)
v_mfma_f32_16x16x32_bf16 v[72:75], a[152:155], a[32:35], v[72:75]
ds_read_b64_tr_b16 a[144:145], v11 offset:35872
v_mfma_f32_16x16x32_bf16 v[128:131], a[152:155], a[36:39], v[128:131]
v_mfma_f32_16x16x32_bf16 v[184:187], a[152:155], a[40:43], v[184:187]
ds_read_b64_tr_b16 a[146:147], v11 offset:39456
v_mfma_f32_16x16x32_bf16 v[240:243], a[152:155], a[44:47], v[240:243]
v_mfma_f32_16x16x32_bf16 v[244:247], a[156:159], a[44:47], v[244:247]
ds_read_b64_tr_b16 a[148:149], v11 offset:50208
v_mfma_f32_16x16x32_bf16 v[188:191], a[156:159], a[40:43], v[188:191]
buffer_load_dwordx4 a[24:27], v15, s[44:47], s66 offen offset:1024 sc1
v_mfma_f32_16x16x32_bf16 v[132:135], a[156:159], a[36:39], v[132:135]
ds_read_b64_tr_b16 a[150:151], v11 offset:53792
v_mfma_f32_16x16x32_bf16 v[76:79], a[156:159], a[32:35], v[76:79]
s_waitcnt lgkmcnt(8)
v_mfma_f32_16x16x32_bf16 v[80:83], a[128:131], a[32:35], v[80:83]
ds_read_b64_tr_b16 a[152:153], v11 offset:35904
v_mfma_f32_16x16x32_bf16 v[136:139], a[128:131], a[36:39], v[136:139]
v_mfma_f32_16x16x32_bf16 v[192:195], a[128:131], a[40:43], v[192:195]
ds_read_b64_tr_b16 a[154:155], v11 offset:39488
v_mfma_f32_16x16x32_bf16 v[248:251], a[128:131], a[44:47], v[248:251]
buffer_load_dwordx4 a[28:31], v15, s[44:47], s66 offen offset:3072 sc1
v_mfma_f32_16x16x32_bf16 v[252:255], a[132:135], a[44:47], v[252:255]
ds_read_b64_tr_b16 a[156:157], v11 offset:50240
v_mfma_f32_16x16x32_bf16 v[196:199], a[132:135], a[40:43], v[196:199]
v_mfma_f32_16x16x32_bf16 v[140:143], a[132:135], a[36:39], v[140:143]
ds_read_b64_tr_b16 a[158:159], v11 offset:53824
v_mfma_f32_16x16x32_bf16 v[84:87], a[132:135], a[32:35], v[84:87]
s_waitcnt vmcnt(15)
s_waitcnt lgkmcnt(8)
v_mfma_f32_16x16x32_bf16 v[32:35], a[136:139], a[48:51], v[32:35]
ds_read_b64_tr_b16 a[128:129], v11 offset:35936
v_mfma_f32_16x16x32_bf16 v[88:91], a[136:139], a[52:55], v[88:91]
v_mfma_f32_16x16x32_bf16 v[144:147], a[136:139], a[56:59], v[144:147]
ds_read_b64_tr_b16 a[130:131], v11 offset:39520
v_mfma_f32_16x16x32_bf16 v[200:203], a[136:139], a[60:63], v[200:203]
s_add_u32 m0, s65, 90112
v_mfma_f32_16x16x32_bf16 v[204:207], a[140:143], a[60:63], v[204:207]
ds_read_b64_tr_b16 a[132:133], v11 offset:50272
v_mfma_f32_16x16x32_bf16 v[148:151], a[140:143], a[56:59], v[148:151]
buffer_load_dwordx4 v8, s[40:43], s64 offen lds
v_mfma_f32_16x16x32_bf16 v[92:95], a[140:143], a[52:55], v[92:95]
ds_read_b64_tr_b16 a[134:135], v11 offset:53856
v_mfma_f32_16x16x32_bf16 v[36:39], a[140:143], a[48:51], v[36:39]
s_waitcnt lgkmcnt(8)
v_mfma_f32_16x16x32_bf16 v[40:43], a[144:147], a[48:51], v[40:43]
ds_read_b64_tr_b16 a[136:137], v11 offset:35968
v_mfma_f32_16x16x32_bf16 v[96:99], a[144:147], a[52:55], v[96:99]
v_mfma_f32_16x16x32_bf16 v[152:155], a[144:147], a[56:59], v[152:155]
ds_read_b64_tr_b16 a[138:139], v11 offset:39552
v_mfma_f32_16x16x32_bf16 v[208:211], a[144:147], a[60:63], v[208:211]
s_add_u32 m0, s65, 91136
v_mfma_f32_16x16x32_bf16 v[212:215], a[148:151], a[60:63], v[212:215]
ds_read_b64_tr_b16 a[140:141], v11 offset:50304
v_mfma_f32_16x16x32_bf16 v[156:159], a[148:151], a[56:59], v[156:159]
buffer_load_dwordx4 v9, s[40:43], s64 offen lds
v_mfma_f32_16x16x32_bf16 v[100:103], a[148:151], a[52:55], v[100:103]
ds_read_b64_tr_b16 a[142:143], v11 offset:53888
v_mfma_f32_16x16x32_bf16 v[44:47], a[148:151], a[48:51], v[44:47]
s_waitcnt lgkmcnt(8)
v_mfma_f32_16x16x32_bf16 v[48:51], a[152:155], a[48:51], v[48:51]
ds_read_b64_tr_b16 a[144:145], v11 offset:36000
v_mfma_f32_16x16x32_bf16 v[104:107], a[152:155], a[52:55], v[104:107]
v_mfma_f32_16x16x32_bf16 v[160:163], a[152:155], a[56:59], v[160:163]
ds_read_b64_tr_b16 a[146:147], v11 offset:39584
v_mfma_f32_16x16x32_bf16 v[216:219], a[152:155], a[60:63], v[216:219]
s_add_u32 m0, s65, 92160
v_mfma_f32_16x16x32_bf16 v[220:223], a[156:159], a[60:63], v[220:223]
ds_read_b64_tr_b16 a[148:149], v11 offset:50336
v_mfma_f32_16x16x32_bf16 v[164:167], a[156:159], a[56:59], v[164:167]
buffer_load_dwordx4 v10, s[40:43], s64 offen lds
v_mfma_f32_16x16x32_bf16 v[108:111], a[156:159], a[52:55], v[108:111]
ds_read_b64_tr_b16 a[150:151], v11 offset:53920
v_mfma_f32_16x16x32_bf16 v[52:55], a[156:159], a[48:51], v[52:55]
s_waitcnt lgkmcnt(8)
v_mfma_f32_16x16x32_bf16 v[56:59], a[128:131], a[48:51], v[56:59]
ds_read_b64_tr_b16 a[152:153], v11 offset:36032
v_mfma_f32_16x16x32_bf16 v[112:115], a[128:131], a[52:55], v[112:115]
v_mfma_f32_16x16x32_bf16 v[168:171], a[128:131], a[56:59], v[168:171]
ds_read_b64_tr_b16 a[154:155], v11 offset:39616
v_mfma_f32_16x16x32_bf16 v[224:227], a[128:131], a[60:63], v[224:227]
s_add_u32 s66, s66, 262144
v_mfma_f32_16x16x32_bf16 v[228:231], a[132:135], a[60:63], v[228:231]
ds_read_b64_tr_b16 a[156:157], v11 offset:50368
v_mfma_f32_16x16x32_bf16 v[172:175], a[132:135], a[56:59], v[172:175]
buffer_load_dwordx4 a[32:35], v14, s[44:47], s66 offen offset:0 sc1
v_mfma_f32_16x16x32_bf16 v[116:119], a[132:135], a[52:55], v[116:119]
ds_read_b64_tr_b16 a[158:159], v11 offset:53952
v_mfma_f32_16x16x32_bf16 v[60:63], a[132:135], a[48:51], v[60:63]
s_waitcnt lgkmcnt(8)
s_waitcnt vmcnt(16)
s_barrier
v_mfma_f32_16x16x32_bf16 v[64:67], a[136:139], a[48:51], v[64:67]
ds_read_b64_tr_b16 a[128:129], v12 offset:0
v_mfma_f32_16x16x32_bf16 v[120:123], a[136:139], a[52:55], v[120:123]
v_mfma_f32_16x16x32_bf16 v[176:179], a[136:139], a[56:59], v[176:179]
ds_read_b64_tr_b16 a[130:131], v12 offset:3584
v_mfma_f32_16x16x32_bf16 v[232:235], a[136:139], a[60:63], v[232:235]
buffer_load_dwordx4 a[36:39], v14, s[44:47], s66 offen offset:2048 sc1
v_mfma_f32_16x16x32_bf16 v[236:239], a[140:143], a[60:63], v[236:239]
ds_read_b64_tr_b16 a[132:133], v12 offset:14336
v_mfma_f32_16x16x32_bf16 v[180:183], a[140:143], a[56:59], v[180:183]
v_mfma_f32_16x16x32_bf16 v[124:127], a[140:143], a[52:55], v[124:127]
ds_read_b64_tr_b16 a[134:135], v12 offset:17920
v_mfma_f32_16x16x32_bf16 v[68:71], a[140:143], a[48:51], v[68:71]
s_waitcnt lgkmcnt(8)
v_mfma_f32_16x16x32_bf16 v[72:75], a[144:147], a[48:51], v[72:75]
ds_read_b64_tr_b16 a[136:137], v12 offset:32
v_mfma_f32_16x16x32_bf16 v[128:131], a[144:147], a[52:55], v[128:131]
v_mfma_f32_16x16x32_bf16 v[184:187], a[144:147], a[56:59], v[184:187]
ds_read_b64_tr_b16 a[138:139], v12 offset:3616
v_mfma_f32_16x16x32_bf16 v[240:243], a[144:147], a[60:63], v[240:243]
buffer_load_dwordx4 a[40:43], v15, s[44:47], s66 offen offset:0 sc1
v_mfma_f32_16x16x32_bf16 v[244:247], a[148:151], a[60:63], v[244:247]
ds_read_b64_tr_b16 a[140:141], v12 offset:14368
v_mfma_f32_16x16x32_bf16 v[188:191], a[148:151], a[56:59], v[188:191]
v_mfma_f32_16x16x32_bf16 v[132:135], a[148:151], a[52:55], v[132:135]
ds_read_b64_tr_b16 a[142:143], v12 offset:17952
v_mfma_f32_16x16x32_bf16 v[76:79], a[148:151], a[48:51], v[76:79]
s_waitcnt lgkmcnt(8)
v_mfma_f32_16x16x32_bf16 v[80:83], a[152:155], a[48:51], v[80:83]
ds_read_b64_tr_b16 a[144:145], v12 offset:64
v_mfma_f32_16x16x32_bf16 v[136:139], a[152:155], a[52:55], v[136:139]
v_mfma_f32_16x16x32_bf16 v[192:195], a[152:155], a[56:59], v[192:195]
ds_read_b64_tr_b16 a[146:147], v12 offset:3648
v_mfma_f32_16x16x32_bf16 v[248:251], a[152:155], a[60:63], v[248:251]
buffer_load_dwordx4 a[44:47], v15, s[44:47], s66 offen offset:2048 sc1
v_mfma_f32_16x16x32_bf16 v[252:255], a[156:159], a[60:63], v[252:255]
ds_read_b64_tr_b16 a[148:149], v12 offset:14400
v_mfma_f32_16x16x32_bf16 v[196:199], a[156:159], a[56:59], v[196:199]
v_mfma_f32_16x16x32_bf16 v[140:143], a[156:159], a[52:55], v[140:143]
ds_read_b64_tr_b16 a[150:151], v12 offset:17984
v_mfma_f32_16x16x32_bf16 v[84:87], a[156:159], a[48:51], v[84:87]
s_waitcnt vmcnt(15)
s_waitcnt lgkmcnt(8)
v_mfma_f32_16x16x32_bf16 v[32:35], a[128:131], a[0:3], v[32:35]
ds_read_b64_tr_b16 a[152:153], v12 offset:96
v_mfma_f32_16x16x32_bf16 v[88:91], a[128:131], a[4:7], v[88:91]
v_mfma_f32_16x16x32_bf16 v[144:147], a[128:131], a[8:11], v[144:147]
ds_read_b64_tr_b16 a[154:155], v12 offset:3680
v_mfma_f32_16x16x32_bf16 v[200:203], a[128:131], a[12:15], v[200:203]
s_add_u32 s64, s64, 458752
s_add_u32 m0, s65, 0
v_mfma_f32_16x16x32_bf16 v[204:207], a[132:135], a[12:15], v[204:207]
ds_read_b64_tr_b16 a[156:157], v12 offset:14432
v_mfma_f32_16x16x32_bf16 v[148:151], a[132:135], a[8:11], v[148:151]
buffer_load_dwordx4 v4, s[40:43], s64 offen lds
v_mfma_f32_16x16x32_bf16 v[92:95], a[132:135], a[4:7], v[92:95]
ds_read_b64_tr_b16 a[158:159], v12 offset:18016
v_mfma_f32_16x16x32_bf16 v[36:39], a[132:135], a[0:3], v[36:39]
s_waitcnt lgkmcnt(8)
v_mfma_f32_16x16x32_bf16 v[40:43], a[136:139], a[0:3], v[40:43]
ds_read_b64_tr_b16 a[128:129], v12 offset:128
v_mfma_f32_16x16x32_bf16 v[96:99], a[136:139], a[4:7], v[96:99]
s_add_u32 m0, s65, 1024
v_mfma_f32_16x16x32_bf16 v[152:155], a[136:139], a[8:11], v[152:155]
ds_read_b64_tr_b16 a[130:131], v12 offset:3712
v_mfma_f32_16x16x32_bf16 v[208:211], a[136:139], a[12:15], v[208:211]
buffer_load_dwordx4 v5, s[40:43], s64 offen lds
v_mfma_f32_16x16x32_bf16 v[212:215], a[140:143], a[12:15], v[212:215]
ds_read_b64_tr_b16 a[132:133], v12 offset:14464
v_mfma_f32_16x16x32_bf16 v[156:159], a[140:143], a[8:11], v[156:159]
v_mfma_f32_16x16x32_bf16 v[100:103], a[140:143], a[4:7], v[100:103]
ds_read_b64_tr_b16 a[134:135], v12 offset:18048
v_mfma_f32_16x16x32_bf16 v[44:47], a[140:143], a[0:3], v[44:47]
s_waitcnt lgkmcnt(8)
v_mfma_f32_16x16x32_bf16 v[48:51], a[144:147], a[0:3], v[48:51]
ds_read_b64_tr_b16 a[136:137], v12 offset:160
v_mfma_f32_16x16x32_bf16 v[104:107], a[144:147], a[4:7], v[104:107]
s_add_u32 m0, s65, 2048
v_mfma_f32_16x16x32_bf16 v[160:163], a[144:147], a[8:11], v[160:163]
ds_read_b64_tr_b16 a[138:139], v12 offset:3744
v_mfma_f32_16x16x32_bf16 v[216:219], a[144:147], a[12:15], v[216:219]
buffer_load_dwordx4 v6, s[40:43], s64 offen lds
v_mfma_f32_16x16x32_bf16 v[220:223], a[148:151], a[12:15], v[220:223]
ds_read_b64_tr_b16 a[140:141], v12 offset:14496
v_mfma_f32_16x16x32_bf16 v[164:167], a[148:151], a[8:11], v[164:167]
v_mfma_f32_16x16x32_bf16 v[108:111], a[148:151], a[4:7], v[108:111]
ds_read_b64_tr_b16 a[142:143], v12 offset:18080
v_mfma_f32_16x16x32_bf16 v[52:55], a[148:151], a[0:3], v[52:55]
s_add_u32 m0, s65, 3072
s_waitcnt lgkmcnt(8)
v_mfma_f32_16x16x32_bf16 v[56:59], a[152:155], a[0:3], v[56:59]
ds_read_b64_tr_b16 a[144:145], v12 offset:192
v_mfma_f32_16x16x32_bf16 v[112:115], a[152:155], a[4:7], v[112:115]
buffer_load_dwordx4 v7, s[40:43], s64 offen lds
v_mfma_f32_16x16x32_bf16 v[168:171], a[152:155], a[8:11], v[168:171]
ds_read_b64_tr_b16 a[146:147], v12 offset:3776
v_mfma_f32_16x16x32_bf16 v[224:227], a[152:155], a[12:15], v[224:227]
v_mfma_f32_16x16x32_bf16 v[228:231], a[156:159], a[12:15], v[228:231]
ds_read_b64_tr_b16 a[148:149], v12 offset:14528
v_mfma_f32_16x16x32_bf16 v[172:175], a[156:159], a[8:11], v[172:175]
v_mfma_f32_16x16x32_bf16 v[116:119], a[156:159], a[4:7], v[116:119]
ds_read_b64_tr_b16 a[150:151], v12 offset:18112
v_mfma_f32_16x16x32_bf16 v[60:63], a[156:159], a[0:3], v[60:63]
buffer_load_dwordx4 a[48:51], v14, s[44:47], s66 offen offset:1024 sc1
s_waitcnt lgkmcnt(8)
v_mfma_f32_16x16x32_bf16 v[64:67], a[128:131], a[0:3], v[64:67]
ds_read_b64_tr_b16 a[152:153], v12 offset:7168
v_mfma_f32_16x16x32_bf16 v[120:123], a[128:131], a[4:7], v[120:123]
v_mfma_f32_16x16x32_bf16 v[176:179], a[128:131], a[8:11], v[176:179]
ds_read_b64_tr_b16 a[154:155], v12 offset:10752
v_mfma_f32_16x16x32_bf16 v[232:235], a[128:131], a[12:15], v[232:235]
v_mfma_f32_16x16x32_bf16 v[236:239], a[132:135], a[12:15], v[236:239]
ds_read_b64_tr_b16 a[156:157], v12 offset:21504
v_mfma_f32_16x16x32_bf16 v[180:183], a[132:135], a[8:11], v[180:183]
buffer_load_dwordx4 a[52:55], v14, s[44:47], s66 offen offset:3072 sc1
v_mfma_f32_16x16x32_bf16 v[124:127], a[132:135], a[4:7], v[124:127]
ds_read_b64_tr_b16 a[158:159], v12 offset:25088
v_mfma_f32_16x16x32_bf16 v[68:71], a[132:135], a[0:3], v[68:71]
s_waitcnt lgkmcnt(8)
v_mfma_f32_16x16x32_bf16 v[72:75], a[136:139], a[0:3], v[72:75]
ds_read_b64_tr_b16 a[128:129], v12 offset:7200
v_mfma_f32_16x16x32_bf16 v[128:131], a[136:139], a[4:7], v[128:131]
v_mfma_f32_16x16x32_bf16 v[184:187], a[136:139], a[8:11], v[184:187]
ds_read_b64_tr_b16 a[130:131], v12 offset:10784
v_mfma_f32_16x16x32_bf16 v[240:243], a[136:139], a[12:15], v[240:243]
v_mfma_f32_16x16x32_bf16 v[244:247], a[140:143], a[12:15], v[244:247]
ds_read_b64_tr_b16 a[132:133], v12 offset:21536
v_mfma_f32_16x16x32_bf16 v[188:191], a[140:143], a[8:11], v[188:191]
buffer_load_dwordx4 a[56:59], v15, s[44:47], s66 offen offset:1024 sc1
v_mfma_f32_16x16x32_bf16 v[132:135], a[140:143], a[4:7], v[132:135]
ds_read_b64_tr_b16 a[134:135], v12 offset:25120
v_mfma_f32_16x16x32_bf16 v[76:79], a[140:143], a[0:3], v[76:79]
s_waitcnt lgkmcnt(8)
v_mfma_f32_16x16x32_bf16 v[80:83], a[144:147], a[0:3], v[80:83]
ds_read_b64_tr_b16 a[136:137], v12 offset:7232
v_mfma_f32_16x16x32_bf16 v[136:139], a[144:147], a[4:7], v[136:139]
v_mfma_f32_16x16x32_bf16 v[192:195], a[144:147], a[8:11], v[192:195]
ds_read_b64_tr_b16 a[138:139], v12 offset:10816
v_mfma_f32_16x16x32_bf16 v[248:251], a[144:147], a[12:15], v[248:251]
buffer_load_dwordx4 a[60:63], v15, s[44:47], s66 offen offset:3072 sc1
v_mfma_f32_16x16x32_bf16 v[252:255], a[148:151], a[12:15], v[252:255]
ds_read_b64_tr_b16 a[140:141], v12 offset:21568
v_mfma_f32_16x16x32_bf16 v[196:199], a[148:151], a[8:11], v[196:199]
v_mfma_f32_16x16x32_bf16 v[140:143], a[148:151], a[4:7], v[140:143]
ds_read_b64_tr_b16 a[142:143], v12 offset:25152
v_mfma_f32_16x16x32_bf16 v[84:87], a[148:151], a[0:3], v[84:87]
s_waitcnt vmcnt(15)
s_waitcnt lgkmcnt(8)
v_mfma_f32_16x16x32_bf16 v[32:35], a[152:155], a[16:19], v[32:35]
ds_read_b64_tr_b16 a[144:145], v12 offset:7264
v_mfma_f32_16x16x32_bf16 v[88:91], a[152:155], a[20:23], v[88:91]
v_mfma_f32_16x16x32_bf16 v[144:147], a[152:155], a[24:27], v[144:147]
ds_read_b64_tr_b16 a[146:147], v12 offset:10848
v_mfma_f32_16x16x32_bf16 v[200:203], a[152:155], a[28:31], v[200:203]
s_add_u32 m0, s65, 4096
v_mfma_f32_16x16x32_bf16 v[204:207], a[156:159], a[28:31], v[204:207]
ds_read_b64_tr_b16 a[148:149], v12 offset:21600
v_mfma_f32_16x16x32_bf16 v[148:151], a[156:159], a[24:27], v[148:151]
buffer_load_dwordx4 v8, s[40:43], s64 offen lds
v_mfma_f32_16x16x32_bf16 v[92:95], a[156:159], a[20:23], v[92:95]
ds_read_b64_tr_b16 a[150:151], v12 offset:25184
v_mfma_f32_16x16x32_bf16 v[36:39], a[156:159], a[16:19], v[36:39]
s_waitcnt lgkmcnt(8)
v_mfma_f32_16x16x32_bf16 v[40:43], a[128:131], a[16:19], v[40:43]
ds_read_b64_tr_b16 a[152:153], v12 offset:7296
v_mfma_f32_16x16x32_bf16 v[96:99], a[128:131], a[20:23], v[96:99]
v_mfma_f32_16x16x32_bf16 v[152:155], a[128:131], a[24:27], v[152:155]
ds_read_b64_tr_b16 a[154:155], v12 offset:10880
v_mfma_f32_16x16x32_bf16 v[208:211], a[128:131], a[28:31], v[208:211]
s_add_u32 m0, s65, 5120
v_mfma_f32_16x16x32_bf16 v[212:215], a[132:135], a[28:31], v[212:215]
ds_read_b64_tr_b16 a[156:157], v12 offset:21632
v_mfma_f32_16x16x32_bf16 v[156:159], a[132:135], a[24:27], v[156:159]
buffer_load_dwordx4 v9, s[40:43], s64 offen lds
v_mfma_f32_16x16x32_bf16 v[100:103], a[132:135], a[20:23], v[100:103]
ds_read_b64_tr_b16 a[158:159], v12 offset:25216
v_mfma_f32_16x16x32_bf16 v[44:47], a[132:135], a[16:19], v[44:47]
s_waitcnt lgkmcnt(8)
v_mfma_f32_16x16x32_bf16 v[48:51], a[136:139], a[16:19], v[48:51]
ds_read_b64_tr_b16 a[128:129], v12 offset:7328
v_mfma_f32_16x16x32_bf16 v[104:107], a[136:139], a[20:23], v[104:107]
v_mfma_f32_16x16x32_bf16 v[160:163], a[136:139], a[24:27], v[160:163]
ds_read_b64_tr_b16 a[130:131], v12 offset:10912
v_mfma_f32_16x16x32_bf16 v[216:219], a[136:139], a[28:31], v[216:219]
s_add_u32 m0, s65, 6144
v_mfma_f32_16x16x32_bf16 v[220:223], a[140:143], a[28:31], v[220:223]
ds_read_b64_tr_b16 a[132:133], v12 offset:21664
v_mfma_f32_16x16x32_bf16 v[164:167], a[140:143], a[24:27], v[164:167]
buffer_load_dwordx4 v10, s[40:43], s64 offen lds
v_mfma_f32_16x16x32_bf16 v[108:111], a[140:143], a[20:23], v[108:111]
ds_read_b64_tr_b16 a[134:135], v12 offset:25248
v_mfma_f32_16x16x32_bf16 v[52:55], a[140:143], a[16:19], v[52:55]
s_waitcnt lgkmcnt(8)
v_mfma_f32_16x16x32_bf16 v[56:59], a[144:147], a[16:19], v[56:59]
ds_read_b64_tr_b16 a[136:137], v12 offset:7360
v_mfma_f32_16x16x32_bf16 v[112:115], a[144:147], a[20:23], v[112:115]
v_mfma_f32_16x16x32_bf16 v[168:171], a[144:147], a[24:27], v[168:171]
ds_read_b64_tr_b16 a[138:139], v12 offset:10944
v_mfma_f32_16x16x32_bf16 v[224:227], a[144:147], a[28:31], v[224:227]
s_add_u32 s66, s66, 262144
v_mfma_f32_16x16x32_bf16 v[228:231], a[148:151], a[28:31], v[228:231]
ds_read_b64_tr_b16 a[140:141], v12 offset:21696
v_mfma_f32_16x16x32_bf16 v[172:175], a[148:151], a[24:27], v[172:175]
buffer_load_dwordx4 a[0:3], v14, s[44:47], s66 offen offset:0 sc1
v_mfma_f32_16x16x32_bf16 v[116:119], a[148:151], a[20:23], v[116:119]
ds_read_b64_tr_b16 a[142:143], v12 offset:25280
v_mfma_f32_16x16x32_bf16 v[60:63], a[148:151], a[16:19], v[60:63]
s_waitcnt lgkmcnt(8)
s_waitcnt vmcnt(16)
s_barrier
v_mfma_f32_16x16x32_bf16 v[64:67], a[152:155], a[16:19], v[64:67]
ds_read_b64_tr_b16 a[144:145], v12 offset:28672
v_mfma_f32_16x16x32_bf16 v[120:123], a[152:155], a[20:23], v[120:123]
v_mfma_f32_16x16x32_bf16 v[176:179], a[152:155], a[24:27], v[176:179]
ds_read_b64_tr_b16 a[146:147], v12 offset:32256
v_mfma_f32_16x16x32_bf16 v[232:235], a[152:155], a[28:31], v[232:235]
buffer_load_dwordx4 a[4:7], v14, s[44:47], s66 offen offset:2048 sc1
v_mfma_f32_16x16x32_bf16 v[236:239], a[156:159], a[28:31], v[236:239]
ds_read_b64_tr_b16 a[148:149], v12 offset:43008
v_mfma_f32_16x16x32_bf16 v[180:183], a[156:159], a[24:27], v[180:183]
v_mfma_f32_16x16x32_bf16 v[124:127], a[156:159], a[20:23], v[124:127]
ds_read_b64_tr_b16 a[150:151], v12 offset:46592
v_mfma_f32_16x16x32_bf16 v[68:71], a[156:159], a[16:19], v[68:71]
s_waitcnt lgkmcnt(8)
v_mfma_f32_16x16x32_bf16 v[72:75], a[128:131], a[16:19], v[72:75]
ds_read_b64_tr_b16 a[152:153], v12 offset:28704
v_mfma_f32_16x16x32_bf16 v[128:131], a[128:131], a[20:23], v[128:131]
v_mfma_f32_16x16x32_bf16 v[184:187], a[128:131], a[24:27], v[184:187]
ds_read_b64_tr_b16 a[154:155], v12 offset:32288
v_mfma_f32_16x16x32_bf16 v[240:243], a[128:131], a[28:31], v[240:243]
buffer_load_dwordx4 a[8:11], v15, s[44:47], s66 offen offset:0 sc1
v_mfma_f32_16x16x32_bf16 v[244:247], a[132:135], a[28:31], v[244:247]
ds_read_b64_tr_b16 a[156:157], v12 offset:43040
v_mfma_f32_16x16x32_bf16 v[188:191], a[132:135], a[24:27], v[188:191]
v_mfma_f32_16x16x32_bf16 v[132:135], a[132:135], a[20:23], v[132:135]
ds_read_b64_tr_b16 a[158:159], v12 offset:46624
v_mfma_f32_16x16x32_bf16 v[76:79], a[132:135], a[16:19], v[76:79]
s_waitcnt lgkmcnt(8)
v_mfma_f32_16x16x32_bf16 v[80:83], a[136:139], a[16:19], v[80:83]
ds_read_b64_tr_b16 a[128:129], v12 offset:28736
v_mfma_f32_16x16x32_bf16 v[136:139], a[136:139], a[20:23], v[136:139]
v_mfma_f32_16x16x32_bf16 v[192:195], a[136:139], a[24:27], v[192:195]
ds_read_b64_tr_b16 a[130:131], v12 offset:32320
v_mfma_f32_16x16x32_bf16 v[248:251], a[136:139], a[28:31], v[248:251]
buffer_load_dwordx4 a[12:15], v15, s[44:47], s66 offen offset:2048 sc1
v_mfma_f32_16x16x32_bf16 v[252:255], a[140:143], a[28:31], v[252:255]
ds_read_b64_tr_b16 a[132:133], v12 offset:43072
v_mfma_f32_16x16x32_bf16 v[196:199], a[140:143], a[24:27], v[196:199]
v_mfma_f32_16x16x32_bf16 v[140:143], a[140:143], a[20:23], v[140:143]
ds_read_b64_tr_b16 a[134:135], v12 offset:46656
v_mfma_f32_16x16x32_bf16 v[84:87], a[140:143], a[16:19], v[84:87]
s_waitcnt vmcnt(15)
s_waitcnt lgkmcnt(8)
v_mfma_f32_16x16x32_bf16 v[32:35], a[144:147], a[32:35], v[32:35]
ds_read_b64_tr_b16 a[136:137], v12 offset:28768
v_mfma_f32_16x16x32_bf16 v[88:91], a[144:147], a[36:39], v[88:91]
v_mfma_f32_16x16x32_bf16 v[144:147], a[144:147], a[40:43], v[144:147]
ds_read_b64_tr_b16 a[138:139], v12 offset:32352
v_mfma_f32_16x16x32_bf16 v[200:203], a[144:147], a[44:47], v[200:203]
s_add_u32 s64, s64, 458752
s_add_u32 m0, s65, 28672
v_mfma_f32_16x16x32_bf16 v[204:207], a[148:151], a[44:47], v[204:207]
ds_read_b64_tr_b16 a[140:141], v12 offset:43104
v_mfma_f32_16x16x32_bf16 v[148:151], a[148:151], a[40:43], v[148:151]
buffer_load_dwordx4 v4, s[40:43], s64 offen lds
v_mfma_f32_16x16x32_bf16 v[92:95], a[148:151], a[36:39], v[92:95]
ds_read_b64_tr_b16 a[142:143], v12 offset:46688
v_mfma_f32_16x16x32_bf16 v[36:39], a[148:151], a[32:35], v[36:39]
s_waitcnt lgkmcnt(8)
v_mfma_f32_16x16x32_bf16 v[40:43], a[152:155], a[32:35], v[40:43]
ds_read_b64_tr_b16 a[144:145], v12 offset:28800
v_mfma_f32_16x16x32_bf16 v[96:99], a[152:155], a[36:39], v[96:99]
s_add_u32 m0, s65, 29696
v_mfma_f32_16x16x32_bf16 v[152:155], a[152:155], a[40:43], v[152:155]
ds_read_b64_tr_b16 a[146:147], v12 offset:32384
v_mfma_f32_16x16x32_bf16 v[208:211], a[152:155], a[44:47], v[208:211]
buffer_load_dwordx4 v5, s[40:43], s64 offen lds
v_mfma_f32_16x16x32_bf16 v[212:215], a[156:159], a[44:47], v[212:215]
ds_read_b64_tr_b16 a[148:149], v12 offset:43136
v_mfma_f32_16x16x32_bf16 v[156:159], a[156:159], a[40:43], v[156:159]
v_mfma_f32_16x16x32_bf16 v[100:103], a[156:159], a[36:39], v[100:103]
ds_read_b64_tr_b16 a[150:151], v12 offset:46720
v_mfma_f32_16x16x32_bf16 v[44:47], a[156:159], a[32:35], v[44:47]
s_waitcnt lgkmcnt(8)
v_mfma_f32_16x16x32_bf16 v[48:51], a[128:131], a[32:35], v[48:51]
ds_read_b64_tr_b16 a[152:153], v12 offset:28832
v_mfma_f32_16x16x32_bf16 v[104:107], a[128:131], a[36:39], v[104:107]
s_add_u32 m0, s65, 30720
v_mfma_f32_16x16x32_bf16 v[160:163], a[128:131], a[40:43], v[160:163]
ds_read_b64_tr_b16 a[154:155], v12 offset:32416
v_mfma_f32_16x16x32_bf16 v[216:219], a[128:131], a[44:47], v[216:219]
buffer_load_dwordx4 v6, s[40:43], s64 offen lds
v_mfma_f32_16x16x32_bf16 v[220:223], a[132:135], a[44:47], v[220:223]
ds_read_b64_tr_b16 a[156:157], v12 offset:43168
v_mfma_f32_16x16x32_bf16 v[164:167], a[132:135], a[40:43], v[164:167]
v_mfma_f32_16x16x32_bf16 v[108:111], a[132:135], a[36:39], v[108:111]
ds_read_b64_tr_b16 a[158:159], v12 offset:46752
v_mfma_f32_16x16x32_bf16 v[52:55], a[132:135], a[32:35], v[52:55]
s_add_u32 m0, s65, 31744
s_waitcnt lgkmcnt(8)
v_mfma_f32_16x16x32_bf16 v[56:59], a[136:139], a[32:35], v[56:59]
ds_read_b64_tr_b16 a[128:129], v12 offset:28864
v_mfma_f32_16x16x32_bf16 v[112:115], a[136:139], a[36:39], v[112:115]
buffer_load_dwordx4 v7, s[40:43], s64 offen lds
v_mfma_f32_16x16x32_bf16 v[168:171], a[136:139], a[40:43], v[168:171]
ds_read_b64_tr_b16 a[130:131], v12 offset:32448
v_mfma_f32_16x16x32_bf16 v[224:227], a[136:139], a[44:47], v[224:227]
v_mfma_f32_16x16x32_bf16 v[228:231], a[140:143], a[44:47], v[228:231]
ds_read_b64_tr_b16 a[132:133], v12 offset:43200
v_mfma_f32_16x16x32_bf16 v[172:175], a[140:143], a[40:43], v[172:175]
v_mfma_f32_16x16x32_bf16 v[116:119], a[140:143], a[36:39], v[116:119]
ds_read_b64_tr_b16 a[134:135], v12 offset:46784
v_mfma_f32_16x16x32_bf16 v[60:63], a[140:143], a[32:35], v[60:63]
buffer_load_dwordx4 a[16:19], v14, s[44:47], s66 offen offset:1024 sc1
s_waitcnt lgkmcnt(8)
v_mfma_f32_16x16x32_bf16 v[64:67], a[144:147], a[32:35], v[64:67]
ds_read_b64_tr_b16 a[136:137], v12 offset:35840
v_mfma_f32_16x16x32_bf16 v[120:123], a[144:147], a[36:39], v[120:123]
v_mfma_f32_16x16x32_bf16 v[176:179], a[144:147], a[40:43], v[176:179]
ds_read_b64_tr_b16 a[138:139], v12 offset:39424
v_mfma_f32_16x16x32_bf16 v[232:235], a[144:147], a[44:47], v[232:235]
v_mfma_f32_16x16x32_bf16 v[236:239], a[148:151], a[44:47], v[236:239]
ds_read_b64_tr_b16 a[140:141], v12 offset:50176
v_mfma_f32_16x16x32_bf16 v[180:183], a[148:151], a[40:43], v[180:183]
buffer_load_dwordx4 a[20:23], v14, s[44:47], s66 offen offset:3072 sc1
v_mfma_f32_16x16x32_bf16 v[124:127], a[148:151], a[36:39], v[124:127]
ds_read_b64_tr_b16 a[142:143], v12 offset:53760
v_mfma_f32_16x16x32_bf16 v[68:71], a[148:151], a[32:35], v[68:71]
s_waitcnt lgkmcnt(8)
v_mfma_f32_16x16x32_bf16 v[72:75], a[152:155], a[32:35], v[72:75]
ds_read_b64_tr_b16 a[144:145], v12 offset:35872
v_mfma_f32_16x16x32_bf16 v[128:131], a[152:155], a[36:39], v[128:131]
v_mfma_f32_16x16x32_bf16 v[184:187], a[152:155], a[40:43], v[184:187]
ds_read_b64_tr_b16 a[146:147], v12 offset:39456
v_mfma_f32_16x16x32_bf16 v[240:243], a[152:155], a[44:47], v[240:243]
v_mfma_f32_16x16x32_bf16 v[244:247], a[156:159], a[44:47], v[244:247]
ds_read_b64_tr_b16 a[148:149], v12 offset:50208
v_mfma_f32_16x16x32_bf16 v[188:191], a[156:159], a[40:43], v[188:191]
buffer_load_dwordx4 a[24:27], v15, s[44:47], s66 offen offset:1024 sc1
v_mfma_f32_16x16x32_bf16 v[132:135], a[156:159], a[36:39], v[132:135]
ds_read_b64_tr_b16 a[150:151], v12 offset:53792
v_mfma_f32_16x16x32_bf16 v[76:79], a[156:159], a[32:35], v[76:79]
s_waitcnt lgkmcnt(8)
v_mfma_f32_16x16x32_bf16 v[80:83], a[128:131], a[32:35], v[80:83]
ds_read_b64_tr_b16 a[152:153], v12 offset:35904
v_mfma_f32_16x16x32_bf16 v[136:139], a[128:131], a[36:39], v[136:139]
v_mfma_f32_16x16x32_bf16 v[192:195], a[128:131], a[40:43], v[192:195]
ds_read_b64_tr_b16 a[154:155], v12 offset:39488
v_mfma_f32_16x16x32_bf16 v[248:251], a[128:131], a[44:47], v[248:251]
buffer_load_dwordx4 a[28:31], v15, s[44:47], s66 offen offset:3072 sc1
v_mfma_f32_16x16x32_bf16 v[252:255], a[132:135], a[44:47], v[252:255]
ds_read_b64_tr_b16 a[156:157], v12 offset:50240
v_mfma_f32_16x16x32_bf16 v[196:199], a[132:135], a[40:43], v[196:199]
v_mfma_f32_16x16x32_bf16 v[140:143], a[132:135], a[36:39], v[140:143]
ds_read_b64_tr_b16 a[158:159], v12 offset:53824
v_mfma_f32_16x16x32_bf16 v[84:87], a[132:135], a[32:35], v[84:87]
s_waitcnt vmcnt(15)
s_waitcnt lgkmcnt(8)
v_mfma_f32_16x16x32_bf16 v[32:35], a[136:139], a[48:51], v[32:35]
ds_read_b64_tr_b16 a[128:129], v12 offset:35936
v_mfma_f32_16x16x32_bf16 v[88:91], a[136:139], a[52:55], v[88:91]
v_mfma_f32_16x16x32_bf16 v[144:147], a[136:139], a[56:59], v[144:147]
ds_read_b64_tr_b16 a[130:131], v12 offset:39520
v_mfma_f32_16x16x32_bf16 v[200:203], a[136:139], a[60:63], v[200:203]
s_add_u32 m0, s65, 32768
v_mfma_f32_16x16x32_bf16 v[204:207], a[140:143], a[60:63], v[204:207]
ds_read_b64_tr_b16 a[132:133], v12 offset:50272
v_mfma_f32_16x16x32_bf16 v[148:151], a[140:143], a[56:59], v[148:151]
buffer_load_dwordx4 v8, s[40:43], s64 offen lds
v_mfma_f32_16x16x32_bf16 v[92:95], a[140:143], a[52:55], v[92:95]
ds_read_b64_tr_b16 a[134:135], v12 offset:53856
v_mfma_f32_16x16x32_bf16 v[36:39], a[140:143], a[48:51], v[36:39]
s_waitcnt lgkmcnt(8)
v_mfma_f32_16x16x32_bf16 v[40:43], a[144:147], a[48:51], v[40:43]
ds_read_b64_tr_b16 a[136:137], v12 offset:35968
v_mfma_f32_16x16x32_bf16 v[96:99], a[144:147], a[52:55], v[96:99]
v_mfma_f32_16x16x32_bf16 v[152:155], a[144:147], a[56:59], v[152:155]
ds_read_b64_tr_b16 a[138:139], v12 offset:39552
v_mfma_f32_16x16x32_bf16 v[208:211], a[144:147], a[60:63], v[208:211]
s_add_u32 m0, s65, 33792
v_mfma_f32_16x16x32_bf16 v[212:215], a[148:151], a[60:63], v[212:215]
ds_read_b64_tr_b16 a[140:141], v12 offset:50304
v_mfma_f32_16x16x32_bf16 v[156:159], a[148:151], a[56:59], v[156:159]
buffer_load_dwordx4 v9, s[40:43], s64 offen lds
v_mfma_f32_16x16x32_bf16 v[100:103], a[148:151], a[52:55], v[100:103]
ds_read_b64_tr_b16 a[142:143], v12 offset:53888
v_mfma_f32_16x16x32_bf16 v[44:47], a[148:151], a[48:51], v[44:47]
s_waitcnt lgkmcnt(8)
v_mfma_f32_16x16x32_bf16 v[48:51], a[152:155], a[48:51], v[48:51]
ds_read_b64_tr_b16 a[144:145], v12 offset:36000
v_mfma_f32_16x16x32_bf16 v[104:107], a[152:155], a[52:55], v[104:107]
v_mfma_f32_16x16x32_bf16 v[160:163], a[152:155], a[56:59], v[160:163]
ds_read_b64_tr_b16 a[146:147], v12 offset:39584
v_mfma_f32_16x16x32_bf16 v[216:219], a[152:155], a[60:63], v[216:219]
s_add_u32 m0, s65, 34816
v_mfma_f32_16x16x32_bf16 v[220:223], a[156:159], a[60:63], v[220:223]
ds_read_b64_tr_b16 a[148:149], v12 offset:50336
v_mfma_f32_16x16x32_bf16 v[164:167], a[156:159], a[56:59], v[164:167]
buffer_load_dwordx4 v10, s[40:43], s64 offen lds
v_mfma_f32_16x16x32_bf16 v[108:111], a[156:159], a[52:55], v[108:111]
ds_read_b64_tr_b16 a[150:151], v12 offset:53920
v_mfma_f32_16x16x32_bf16 v[52:55], a[156:159], a[48:51], v[52:55]
s_waitcnt lgkmcnt(8)
v_mfma_f32_16x16x32_bf16 v[56:59], a[128:131], a[48:51], v[56:59]
ds_read_b64_tr_b16 a[152:153], v12 offset:36032
v_mfma_f32_16x16x32_bf16 v[112:115], a[128:131], a[52:55], v[112:115]
v_mfma_f32_16x16x32_bf16 v[168:171], a[128:131], a[56:59], v[168:171]
ds_read_b64_tr_b16 a[154:155], v12 offset:39616
v_mfma_f32_16x16x32_bf16 v[224:227], a[128:131], a[60:63], v[224:227]
s_add_u32 s66, s66, 262144
v_mfma_f32_16x16x32_bf16 v[228:231], a[132:135], a[60:63], v[228:231]
ds_read_b64_tr_b16 a[156:157], v12 offset:50368
v_mfma_f32_16x16x32_bf16 v[172:175], a[132:135], a[56:59], v[172:175]
buffer_load_dwordx4 a[32:35], v14, s[44:47], s66 offen offset:0 sc1
v_mfma_f32_16x16x32_bf16 v[116:119], a[132:135], a[52:55], v[116:119]
ds_read_b64_tr_b16 a[158:159], v12 offset:53952
v_mfma_f32_16x16x32_bf16 v[60:63], a[132:135], a[48:51], v[60:63]
s_waitcnt lgkmcnt(8)
s_waitcnt vmcnt(16)
s_barrier
v_mfma_f32_16x16x32_bf16 v[64:67], a[136:139], a[48:51], v[64:67]
ds_read_b64_tr_b16 a[128:129], v11 offset:0
v_mfma_f32_16x16x32_bf16 v[120:123], a[136:139], a[52:55], v[120:123]
v_mfma_f32_16x16x32_bf16 v[176:179], a[136:139], a[56:59], v[176:179]
ds_read_b64_tr_b16 a[130:131], v11 offset:3584
v_mfma_f32_16x16x32_bf16 v[232:235], a[136:139], a[60:63], v[232:235]
buffer_load_dwordx4 a[36:39], v14, s[44:47], s66 offen offset:2048 sc1
v_mfma_f32_16x16x32_bf16 v[236:239], a[140:143], a[60:63], v[236:239]
ds_read_b64_tr_b16 a[132:133], v11 offset:14336
v_mfma_f32_16x16x32_bf16 v[180:183], a[140:143], a[56:59], v[180:183]
v_mfma_f32_16x16x32_bf16 v[124:127], a[140:143], a[52:55], v[124:127]
ds_read_b64_tr_b16 a[134:135], v11 offset:17920
v_mfma_f32_16x16x32_bf16 v[68:71], a[140:143], a[48:51], v[68:71]
s_waitcnt lgkmcnt(8)
v_mfma_f32_16x16x32_bf16 v[72:75], a[144:147], a[48:51], v[72:75]
ds_read_b64_tr_b16 a[136:137], v11 offset:32
v_mfma_f32_16x16x32_bf16 v[128:131], a[144:147], a[52:55], v[128:131]
v_mfma_f32_16x16x32_bf16 v[184:187], a[144:147], a[56:59], v[184:187]
ds_read_b64_tr_b16 a[138:139], v11 offset:3616
v_mfma_f32_16x16x32_bf16 v[240:243], a[144:147], a[60:63], v[240:243]
buffer_load_dwordx4 a[40:43], v15, s[44:47], s66 offen offset:0 sc1
v_mfma_f32_16x16x32_bf16 v[244:247], a[148:151], a[60:63], v[244:247]
ds_read_b64_tr_b16 a[140:141], v11 offset:14368
v_mfma_f32_16x16x32_bf16 v[188:191], a[148:151], a[56:59], v[188:191]
v_mfma_f32_16x16x32_bf16 v[132:135], a[148:151], a[52:55], v[132:135]
ds_read_b64_tr_b16 a[142:143], v11 offset:17952
v_mfma_f32_16x16x32_bf16 v[76:79], a[148:151], a[48:51], v[76:79]
s_waitcnt lgkmcnt(8)
v_mfma_f32_16x16x32_bf16 v[80:83], a[152:155], a[48:51], v[80:83]
ds_read_b64_tr_b16 a[144:145], v11 offset:64
v_mfma_f32_16x16x32_bf16 v[136:139], a[152:155], a[52:55], v[136:139]
v_mfma_f32_16x16x32_bf16 v[192:195], a[152:155], a[56:59], v[192:195]
ds_read_b64_tr_b16 a[146:147], v11 offset:3648
v_mfma_f32_16x16x32_bf16 v[248:251], a[152:155], a[60:63], v[248:251]
buffer_load_dwordx4 a[44:47], v15, s[44:47], s66 offen offset:2048 sc1
v_mfma_f32_16x16x32_bf16 v[252:255], a[156:159], a[60:63], v[252:255]
ds_read_b64_tr_b16 a[148:149], v11 offset:14400
v_mfma_f32_16x16x32_bf16 v[196:199], a[156:159], a[56:59], v[196:199]
v_mfma_f32_16x16x32_bf16 v[140:143], a[156:159], a[52:55], v[140:143]
ds_read_b64_tr_b16 a[150:151], v11 offset:17984
v_mfma_f32_16x16x32_bf16 v[84:87], a[156:159], a[48:51], v[84:87]
s_sub_u32 s29, s29, 1
s_cmp_lg_u32 s29, 0
s_cbranch_scc1 L_loop_u
s_waitcnt vmcnt(15)
s_waitcnt lgkmcnt(8)
v_mfma_f32_16x16x32_bf16 v[32:35], a[128:131], a[0:3], v[32:35]
ds_read_b64_tr_b16 a[152:153], v11 offset:96
v_mfma_f32_16x16x32_bf16 v[88:91], a[128:131], a[4:7], v[88:91]
v_mfma_f32_16x16x32_bf16 v[144:147], a[128:131], a[8:11], v[144:147]
ds_read_b64_tr_b16 a[154:155], v11 offset:3680
v_mfma_f32_16x16x32_bf16 v[200:203], a[128:131], a[12:15], v[200:203]
s_add_u32 s64, s64, 458752
s_add_u32 m0, s65, 57344
v_mfma_f32_16x16x32_bf16 v[204:207], a[132:135], a[12:15], v[204:207]
ds_read_b64_tr_b16 a[156:157], v11 offset:14432
v_mfma_f32_16x16x32_bf16 v[148:151], a[132:135], a[8:11], v[148:151]
buffer_load_dwordx4 v4, s[40:43], s64 offen lds
v_mfma_f32_16x16x32_bf16 v[92:95], a[132:135], a[4:7], v[92:95]
ds_read_b64_tr_b16 a[158:159], v11 offset:18016
v_mfma_f32_16x16x32_bf16 v[36:39], a[132:135], a[0:3], v[36:39]
s_waitcnt lgkmcnt(8)
v_mfma_f32_16x16x32_bf16 v[40:43], a[136:139], a[0:3], v[40:43]
ds_read_b64_tr_b16 a[128:129], v11 offset:128
v_mfma_f32_16x16x32_bf16 v[96:99], a[136:139], a[4:7], v[96:99]
s_add_u32 m0, s65, 58368
v_mfma_f32_16x16x32_bf16 v[152:155], a[136:139], a[8:11], v[152:155]
ds_read_b64_tr_b16 a[130:131], v11 offset:3712
v_mfma_f32_16x16x32_bf16 v[208:211], a[136:139], a[12:15], v[208:211]
buffer_load_dwordx4 v5, s[40:43], s64 offen lds
v_mfma_f32_16x16x32_bf16 v[212:215], a[140:143], a[12:15], v[212:215]
ds_read_b64_tr_b16 a[132:133], v11 offset:14464
v_mfma_f32_16x16x32_bf16 v[156:159], a[140:143], a[8:11], v[156:159]
v_mfma_f32_16x16x32_bf16 v[100:103], a[140:143], a[4:7], v[100:103]
ds_read_b64_tr_b16 a[134:135], v11 offset:18048
v_mfma_f32_16x16x32_bf16 v[44:47], a[140:143], a[0:3], v[44:47]
s_waitcnt lgkmcnt(8)
v_mfma_f32_16x16x32_bf16 v[48:51], a[144:147], a[0:3], v[48:51]
ds_read_b64_tr_b16 a[136:137], v11 offset:160
v_mfma_f32_16x16x32_bf16 v[104:107], a[144:147], a[4:7], v[104:107]
s_add_u32 m0, s65, 59392
v_mfma_f32_16x16x32_bf16 v[160:163], a[144:147], a[8:11], v[160:163]
ds_read_b64_tr_b16 a[138:139], v11 offset:3744
v_mfma_f32_16x16x32_bf16 v[216:219], a[144:147], a[12:15], v[216:219]
buffer_load_dwordx4 v6, s[40:43], s64 offen lds
v_mfma_f32_16x16x32_bf16 v[220:223], a[148:151], a[12:15], v[220:223]
ds_read_b64_tr_b16 a[140:141], v11 offset:14496
v_mfma_f32_16x16x32_bf16 v[164:167], a[148:151], a[8:11], v[164:167]
v_mfma_f32_16x16x32_bf16 v[108:111], a[148:151], a[4:7], v[108:111]
ds_read_b64_tr_b16 a[142:143], v11 offset:18080
v_mfma_f32_16x16x32_bf16 v[52:55], a[148:151], a[0:3], v[52:55]
s_add_u32 m0, s65, 60416
s_waitcnt lgkmcnt(8)
v_mfma_f32_16x16x32_bf16 v[56:59], a[152:155], a[0:3], v[56:59]
ds_read_b64_tr_b16 a[144:145], v11 offset:192
v_mfma_f32_16x16x32_bf16 v[112:115], a[152:155], a[4:7], v[112:115]
buffer_load_dwordx4 v7, s[40:43], s64 offen lds
v_mfma_f32_16x16x32_bf16 v[168:171], a[152:155], a[8:11], v[168:171]
ds_read_b64_tr_b16 a[146:147], v11 offset:3776
v_mfma_f32_16x16x32_bf16 v[224:227], a[152:155], a[12:15], v[224:227]
v_mfma_f32_16x16x32_bf16 v[228:231], a[156:159], a[12:15], v[228:231]
ds_read_b64_tr_b16 a[148:149], v11 offset:14528
v_mfma_f32_16x16x32_bf16 v[172:175], a[156:159], a[8:11], v[172:175]
v_mfma_f32_16x16x32_bf16 v[116:119], a[156:159], a[4:7], v[116:119]
ds_read_b64_tr_b16 a[150:151], v11 offset:18112
v_mfma_f32_16x16x32_bf16 v[60:63], a[156:159], a[0:3], v[60:63]
buffer_load_dwordx4 a[48:51], v14, s[44:47], s66 offen offset:1024 sc1
s_waitcnt lgkmcnt(8)
v_mfma_f32_16x16x32_bf16 v[64:67], a[128:131], a[0:3], v[64:67]
ds_read_b64_tr_b16 a[152:153], v11 offset:7168
v_mfma_f32_16x16x32_bf16 v[120:123], a[128:131], a[4:7], v[120:123]
v_mfma_f32_16x16x32_bf16 v[176:179], a[128:131], a[8:11], v[176:179]
ds_read_b64_tr_b16 a[154:155], v11 offset:10752
v_mfma_f32_16x16x32_bf16 v[232:235], a[128:131], a[12:15], v[232:235]
v_mfma_f32_16x16x32_bf16 v[236:239], a[132:135], a[12:15], v[236:239]
ds_read_b64_tr_b16 a[156:157], v11 offset:21504
v_mfma_f32_16x16x32_bf16 v[180:183], a[132:135], a[8:11], v[180:183]
buffer_load_dwordx4 a[52:55], v14, s[44:47], s66 offen offset:3072 sc1
v_mfma_f32_16x16x32_bf16 v[124:127], a[132:135], a[4:7], v[124:127]
ds_read_b64_tr_b16 a[158:159], v11 offset:25088
v_mfma_f32_16x16x32_bf16 v[68:71], a[132:135], a[0:3], v[68:71]
s_waitcnt lgkmcnt(8)
v_mfma_f32_16x16x32_bf16 v[72:75], a[136:139], a[0:3], v[72:75]
ds_read_b64_tr_b16 a[128:129], v11 offset:7200
v_mfma_f32_16x16x32_bf16 v[128:131], a[136:139], a[4:7], v[128:131]
v_mfma_f32_16x16x32_bf16 v[184:187], a[136:139], a[8:11], v[184:187]
ds_read_b64_tr_b16 a[130:131], v11 offset:10784
v_mfma_f32_16x16x32_bf16 v[240:243], a[136:139], a[12:15], v[240:243]
v_mfma_f32_16x16x32_bf16 v[244:247], a[140:143], a[12:15], v[244:247]
ds_read_b64_tr_b16 a[132:133], v11 offset:21536
v_mfma_f32_16x16x32_bf16 v[188:191], a[140:143], a[8:11], v[188:191]
buffer_load_dwordx4 a[56:59], v15, s[44:47], s66 offen offset:1024 sc1
v_mfma_f32_16x16x32_bf16 v[132:135], a[140:143], a[4:7], v[132:135]
ds_read_b64_tr_b16 a[134:135], v11 offset:25120
v_mfma_f32_16x16x32_bf16 v[76:79], a[140:143], a[0:3], v[76:79]
s_waitcnt lgkmcnt(8)
v_mfma_f32_16x16x32_bf16 v[80:83], a[144:147], a[0:3], v[80:83]
ds_read_b64_tr_b16 a[136:137], v11 offset:7232
v_mfma_f32_16x16x32_bf16 v[136:139], a[144:147], a[4:7], v[136:139]
v_mfma_f32_16x16x32_bf16 v[192:195], a[144:147], a[8:11], v[192:195]
ds_read_b64_tr_b16 a[138:139], v11 offset:10816
v_mfma_f32_16x16x32_bf16 v[248:251], a[144:147], a[12:15], v[248:251]
buffer_load_dwordx4 a[60:63], v15, s[44:47], s66 offen offset:3072 sc1
v_mfma_f32_16x16x32_bf16 v[252:255], a[148:151], a[12:15], v[252:255]
ds_read_b64_tr_b16 a[140:141], v11 offset:21568
v_mfma_f32_16x16x32_bf16 v[196:199], a[148:151], a[8:11], v[196:199]
v_mfma_f32_16x16x32_bf16 v[140:143], a[148:151], a[4:7], v[140:143]
ds_read_b64_tr_b16 a[142:143], v11 offset:25152
v_mfma_f32_16x16x32_bf16 v[84:87], a[148:151], a[0:3], v[84:87]
s_waitcnt vmcnt(15)
s_waitcnt lgkmcnt(8)
v_mfma_f32_16x16x32_bf16 v[32:35], a[152:155], a[16:19], v[32:35]
ds_read_b64_tr_b16 a[144:145], v11 offset:7264
v_mfma_f32_16x16x32_bf16 v[88:91], a[152:155], a[20:23], v[88:91]
v_mfma_f32_16x16x32_bf16 v[144:147], a[152:155], a[24:27], v[144:147]
ds_read_b64_tr_b16 a[146:147], v11 offset:10848
v_mfma_f32_16x16x32_bf16 v[200:203], a[152:155], a[28:31], v[200:203]
s_add_u32 m0, s65, 61440
v_mfma_f32_16x16x32_bf16 v[204:207], a[156:159], a[28:31], v[204:207]
ds_read_b64_tr_b16 a[148:149], v11 offset:21600
v_mfma_f32_16x16x32_bf16 v[148:151], a[156:159], a[24:27], v[148:151]
buffer_load_dwordx4 v8, s[40:43], s64 offen lds
v_mfma_f32_16x16x32_bf16 v[92:95], a[156:159], a[20:23], v[92:95]
ds_read_b64_tr_b16 a[150:151], v11 offset:25184
v_mfma_f32_16x16x32_bf16 v[36:39], a[156:159], a[16:19], v[36:39]
s_waitcnt lgkmcnt(8)
v_mfma_f32_16x16x32_bf16 v[40:43], a[128:131], a[16:19], v[40:43]
ds_read_b64_tr_b16 a[152:153], v11 offset:7296
v_mfma_f32_16x16x32_bf16 v[96:99], a[128:131], a[20:23], v[96:99]
v_mfma_f32_16x16x32_bf16 v[152:155], a[128:131], a[24:27], v[152:155]
ds_read_b64_tr_b16 a[154:155], v11 offset:10880
v_mfma_f32_16x16x32_bf16 v[208:211], a[128:131], a[28:31], v[208:211]
s_add_u32 m0, s65, 62464
v_mfma_f32_16x16x32_bf16 v[212:215], a[132:135], a[28:31], v[212:215]
ds_read_b64_tr_b16 a[156:157], v11 offset:21632
v_mfma_f32_16x16x32_bf16 v[156:159], a[132:135], a[24:27], v[156:159]
buffer_load_dwordx4 v9, s[40:43], s64 offen lds
v_mfma_f32_16x16x32_bf16 v[100:103], a[132:135], a[20:23], v[100:103]
ds_read_b64_tr_b16 a[158:159], v11 offset:25216
v_mfma_f32_16x16x32_bf16 v[44:47], a[132:135], a[16:19], v[44:47]
s_waitcnt lgkmcnt(8)
v_mfma_f32_16x16x32_bf16 v[48:51], a[136:139], a[16:19], v[48:51]
ds_read_b64_tr_b16 a[128:129], v11 offset:7328
v_mfma_f32_16x16x32_bf16 v[104:107], a[136:139], a[20:23], v[104:107]
v_mfma_f32_16x16x32_bf16 v[160:163], a[136:139], a[24:27], v[160:163]
ds_read_b64_tr_b16 a[130:131], v11 offset:10912
v_mfma_f32_16x16x32_bf16 v[216:219], a[136:139], a[28:31], v[216:219]
s_add_u32 m0, s65, 63488
v_mfma_f32_16x16x32_bf16 v[220:223], a[140:143], a[28:31], v[220:223]
ds_read_b64_tr_b16 a[132:133], v11 offset:21664
v_mfma_f32_16x16x32_bf16 v[164:167], a[140:143], a[24:27], v[164:167]
buffer_load_dwordx4 v10, s[40:43], s64 offen lds
v_mfma_f32_16x16x32_bf16 v[108:111], a[140:143], a[20:23], v[108:111]
ds_read_b64_tr_b16 a[134:135], v11 offset:25248
v_mfma_f32_16x16x32_bf16 v[52:55], a[140:143], a[16:19], v[52:55]
s_waitcnt lgkmcnt(8)
v_mfma_f32_16x16x32_bf16 v[56:59], a[144:147], a[16:19], v[56:59]
ds_read_b64_tr_b16 a[136:137], v11 offset:7360
v_mfma_f32_16x16x32_bf16 v[112:115], a[144:147], a[20:23], v[112:115]
v_mfma_f32_16x16x32_bf16 v[168:171], a[144:147], a[24:27], v[168:171]
ds_read_b64_tr_b16 a[138:139], v11 offset:10944
v_mfma_f32_16x16x32_bf16 v[224:227], a[144:147], a[28:31], v[224:227]
s_add_u32 s66, s66, 262144
v_mfma_f32_16x16x32_bf16 v[228:231], a[148:151], a[28:31], v[228:231]
ds_read_b64_tr_b16 a[140:141], v11 offset:21696
v_mfma_f32_16x16x32_bf16 v[172:175], a[148:151], a[24:27], v[172:175]
buffer_load_dwordx4 a[0:3], v14, s[44:47], s66 offen offset:0 sc1
v_mfma_f32_16x16x32_bf16 v[116:119], a[148:151], a[20:23], v[116:119]
ds_read_b64_tr_b16 a[142:143], v11 offset:25280
v_mfma_f32_16x16x32_bf16 v[60:63], a[148:151], a[16:19], v[60:63]
s_waitcnt lgkmcnt(8)
s_waitcnt vmcnt(16)
s_barrier
v_mfma_f32_16x16x32_bf16 v[64:67], a[152:155], a[16:19], v[64:67]
ds_read_b64_tr_b16 a[144:145], v11 offset:28672
v_mfma_f32_16x16x32_bf16 v[120:123], a[152:155], a[20:23], v[120:123]
v_mfma_f32_16x16x32_bf16 v[176:179], a[152:155], a[24:27], v[176:179]
ds_read_b64_tr_b16 a[146:147], v11 offset:32256
v_mfma_f32_16x16x32_bf16 v[232:235], a[152:155], a[28:31], v[232:235]
buffer_load_dwordx4 a[4:7], v14, s[44:47], s66 offen offset:2048 sc1
v_mfma_f32_16x16x32_bf16 v[236:239], a[156:159], a[28:31], v[236:239]
ds_read_b64_tr_b16 a[148:149], v11 offset:43008
v_mfma_f32_16x16x32_bf16 v[180:183], a[156:159], a[24:27], v[180:183]
v_mfma_f32_16x16x32_bf16 v[124:127], a[156:159], a[20:23], v[124:127]
ds_read_b64_tr_b16 a[150:151], v11 offset:46592
v_mfma_f32_16x16x32_bf16 v[68:71], a[156:159], a[16:19], v[68:71]
s_waitcnt lgkmcnt(8)
v_mfma_f32_16x16x32_bf16 v[72:75], a[128:131], a[16:19], v[72:75]
ds_read_b64_tr_b16 a[152:153], v11 offset:28704
v_mfma_f32_16x16x32_bf16 v[128:131], a[128:131], a[20:23], v[128:131]
v_mfma_f32_16x16x32_bf16 v[184:187], a[128:131], a[24:27], v[184:187]
ds_read_b64_tr_b16 a[154:155], v11 offset:32288
v_mfma_f32_16x16x32_bf16 v[240:243], a[128:131], a[28:31], v[240:243]
buffer_load_dwordx4 a[8:11], v15, s[44:47], s66 offen offset:0 sc1
v_mfma_f32_16x16x32_bf16 v[244:247], a[132:135], a[28:31], v[244:247]
ds_read_b64_tr_b16 a[156:157], v11 offset:43040
v_mfma_f32_16x16x32_bf16 v[188:191], a[132:135], a[24:27], v[188:191]
v_mfma_f32_16x16x32_bf16 v[132:135], a[132:135], a[20:23], v[132:135]
ds_read_b64_tr_b16 a[158:159], v11 offset:46624
v_mfma_f32_16x16x32_bf16 v[76:79], a[132:135], a[16:19], v[76:79]
s_waitcnt lgkmcnt(8)
v_mfma_f32_16x16x32_bf16 v[80:83], a[136:139], a[16:19], v[80:83]
ds_read_b64_tr_b16 a[128:129], v11 offset:28736
v_mfma_f32_16x16x32_bf16 v[136:139], a[136:139], a[20:23], v[136:139]
v_mfma_f32_16x16x32_bf16 v[192:195], a[136:139], a[24:27], v[192:195]
ds_read_b64_tr_b16 a[130:131], v11 offset:32320
v_mfma_f32_16x16x32_bf16 v[248:251], a[136:139], a[28:31], v[248:251]
buffer_load_dwordx4 a[12:15], v15, s[44:47], s66 offen offset:2048 sc1
v_mfma_f32_16x16x32_bf16 v[252:255], a[140:143], a[28:31], v[252:255]
ds_read_b64_tr_b16 a[132:133], v11 offset:43072
v_mfma_f32_16x16x32_bf16 v[196:199], a[140:143], a[24:27], v[196:199]
v_mfma_f32_16x16x32_bf16 v[140:143], a[140:143], a[20:23], v[140:143]
ds_read_b64_tr_b16 a[134:135], v11 offset:46656
v_mfma_f32_16x16x32_bf16 v[84:87], a[140:143], a[16:19], v[84:87]
s_waitcnt vmcnt(15)
s_waitcnt lgkmcnt(8)
v_mfma_f32_16x16x32_bf16 v[32:35], a[144:147], a[32:35], v[32:35]
ds_read_b64_tr_b16 a[136:137], v11 offset:28768
v_mfma_f32_16x16x32_bf16 v[88:91], a[144:147], a[36:39], v[88:91]
v_mfma_f32_16x16x32_bf16 v[144:147], a[144:147], a[40:43], v[144:147]
ds_read_b64_tr_b16 a[138:139], v11 offset:32352
v_mfma_f32_16x16x32_bf16 v[200:203], a[144:147], a[44:47], v[200:203]
s_add_u32 s64, s64, 458752
s_add_u32 m0, s65, 86016
v_mfma_f32_16x16x32_bf16 v[204:207], a[148:151], a[44:47], v[204:207]
ds_read_b64_tr_b16 a[140:141], v11 offset:43104
v_mfma_f32_16x16x32_bf16 v[148:151], a[148:151], a[40:43], v[148:151]
buffer_load_dwordx4 v4, s[40:43], s64 offen lds
v_mfma_f32_16x16x32_bf16 v[92:95], a[148:151], a[36:39], v[92:95]
ds_read_b64_tr_b16 a[142:143], v11 offset:46688
v_mfma_f32_16x16x32_bf16 v[36:39], a[148:151], a[32:35], v[36:39]
s_waitcnt lgkmcnt(8)
v_mfma_f32_16x16x32_bf16 v[40:43], a[152:155], a[32:35], v[40:43]
ds_read_b64_tr_b16 a[144:145], v11 offset:28800
v_mfma_f32_16x16x32_bf16 v[96:99], a[152:155], a[36:39], v[96:99]
s_add_u32 m0, s65, 87040
v_mfma_f32_16x16x32_bf16 v[152:155], a[152:155], a[40:43], v[152:155]
ds_read_b64_tr_b16 a[146:147], v11 offset:32384
v_mfma_f32_16x16x32_bf16 v[208:211], a[152:155], a[44:47], v[208:211]
buffer_load_dwordx4 v5, s[40:43], s64 offen lds
v_mfma_f32_16x16x32_bf16 v[212:215], a[156:159], a[44:47], v[212:215]
ds_read_b64_tr_b16 a[148:149], v11 offset:43136
v_mfma_f32_16x16x32_bf16 v[156:159], a[156:159], a[40:43], v[156:159]
v_mfma_f32_16x16x32_bf16 v[100:103], a[156:159], a[36:39], v[100:103]
ds_read_b64_tr_b16 a[150:151], v11 offset:46720
v_mfma_f32_16x16x32_bf16 v[44:47], a[156:159], a[32:35], v[44:47]
s_waitcnt lgkmcnt(8)
v_mfma_f32_16x16x32_bf16 v[48:51], a[128:131], a[32:35], v[48:51]
ds_read_b64_tr_b16 a[152:153], v11 offset:28832
v_mfma_f32_16x16x32_bf16 v[104:107], a[128:131], a[36:39], v[104:107]
s_add_u32 m0, s65, 88064
v_mfma_f32_16x16x32_bf16 v[160:163], a[128:131], a[40:43], v[160:163]
ds_read_b64_tr_b16 a[154:155], v11 offset:32416
v_mfma_f32_16x16x32_bf16 v[216:219], a[128:131], a[44:47], v[216:219]
buffer_load_dwordx4 v6, s[40:43], s64 offen lds
v_mfma_f32_16x16x32_bf16 v[220:223], a[132:135], a[44:47], v[220:223]
ds_read_b64_tr_b16 a[156:157], v11 offset:43168
v_mfma_f32_16x16x32_bf16 v[164:167], a[132:135], a[40:43], v[164:167]
v_mfma_f32_16x16x32_bf16 v[108:111], a[132:135], a[36:39], v[108:111]
ds_read_b64_tr_b16 a[158:159], v11 offset:46752
v_mfma_f32_16x16x32_bf16 v[52:55], a[132:135], a[32:35], v[52:55]
s_add_u32 m0, s65, 89088
s_waitcnt lgkmcnt(8)
v_mfma_f32_16x16x32_bf16 v[56:59], a[136:139], a[32:35], v[56:59]
ds_read_b64_tr_b16 a[128:129], v11 offset:28864
v_mfma_f32_16x16x32_bf16 v[112:115], a[136:139], a[36:39], v[112:115]
buffer_load_dwordx4 v7, s[40:43], s64 offen lds
v_mfma_f32_16x16x32_bf16 v[168:171], a[136:139], a[40:43], v[168:171]
ds_read_b64_tr_b16 a[130:131], v11 offset:32448
v_mfma_f32_16x16x32_bf16 v[224:227], a[136:139], a[44:47], v[224:227]
v_mfma_f32_16x16x32_bf16 v[228:231], a[140:143], a[44:47], v[228:231]
ds_read_b64_tr_b16 a[132:133], v11 offset:43200
v_mfma_f32_16x16x32_bf16 v[172:175], a[140:143], a[40:43], v[172:175]
v_mfma_f32_16x16x32_bf16 v[116:119], a[140:143], a[36:39], v[116:119]
ds_read_b64_tr_b16 a[134:135], v11 offset:46784
v_mfma_f32_16x16x32_bf16 v[60:63], a[140:143], a[32:35], v[60:63]
buffer_load_dwordx4 a[16:19], v14, s[44:47], s66 offen offset:1024 sc1
s_waitcnt lgkmcnt(8)
v_mfma_f32_16x16x32_bf16 v[64:67], a[144:147], a[32:35], v[64:67]
ds_read_b64_tr_b16 a[136:137], v11 offset:35840
v_mfma_f32_16x16x32_bf16 v[120:123], a[144:147], a[36:39], v[120:123]
v_mfma_f32_16x16x32_bf16 v[176:179], a[144:147], a[40:43], v[176:179]
ds_read_b64_tr_b16 a[138:139], v11 offset:39424
v_mfma_f32_16x16x32_bf16 v[232:235], a[144:147], a[44:47], v[232:235]
v_mfma_f32_16x16x32_bf16 v[236:239], a[148:151], a[44:47], v[236:239]
ds_read_b64_tr_b16 a[140:141], v11 offset:50176
v_mfma_f32_16x16x32_bf16 v[180:183], a[148:151], a[40:43], v[180:183]
buffer_load_dwordx4 a[20:23], v14, s[44:47], s66 offen offset:3072 sc1
v_mfma_f32_16x16x32_bf16 v[124:127], a[148:151], a[36:39], v[124:127]
ds_read_b64_tr_b16 a[142:143], v11 offset:53760
v_mfma_f32_16x16x32_bf16 v[68:71], a[148:151], a[32:35], v[68:71]
s_waitcnt lgkmcnt(8)
v_mfma_f32_16x16x32_bf16 v[72:75], a[152:155], a[32:35], v[72:75]
ds_read_b64_tr_b16 a[144:145], v11 offset:35872
v_mfma_f32_16x16x32_bf16 v[128:131], a[152:155], a[36:39], v[128:131]
v_mfma_f32_16x16x32_bf16 v[184:187], a[152:155], a[40:43], v[184:187]
ds_read_b64_tr_b16 a[146:147], v11 offset:39456
v_mfma_f32_16x16x32_bf16 v[240:243], a[152:155], a[44:47], v[240:243]
v_mfma_f32_16x16x32_bf16 v[244:247], a[156:159], a[44:47], v[244:247]
ds_read_b64_tr_b16 a[148:149], v11 offset:50208
v_mfma_f32_16x16x32_bf16 v[188:191], a[156:159], a[40:43], v[188:191]
buffer_load_dwordx4 a[24:27], v15, s[44:47], s66 offen offset:1024 sc1
v_mfma_f32_16x16x32_bf16 v[132:135], a[156:159], a[36:39], v[132:135]
ds_read_b64_tr_b16 a[150:151], v11 offset:53792
v_mfma_f32_16x16x32_bf16 v[76:79], a[156:159], a[32:35], v[76:79]
s_waitcnt lgkmcnt(8)
v_mfma_f32_16x16x32_bf16 v[80:83], a[128:131], a[32:35], v[80:83]
ds_read_b64_tr_b16 a[152:153], v11 offset:35904
v_mfma_f32_16x16x32_bf16 v[136:139], a[128:131], a[36:39], v[136:139]
v_mfma_f32_16x16x32_bf16 v[192:195], a[128:131], a[40:43], v[192:195]
ds_read_b64_tr_b16 a[154:155], v11 offset:39488
v_mfma_f32_16x16x32_bf16 v[248:251], a[128:131], a[44:47], v[248:251]
buffer_load_dwordx4 a[28:31], v15, s[44:47], s66 offen offset:3072 sc1
v_mfma_f32_16x16x32_bf16 v[252:255], a[132:135], a[44:47], v[252:255]
ds_read_b64_tr_b16 a[156:157], v11 offset:50240
v_mfma_f32_16x16x32_bf16 v[196:199], a[132:135], a[40:43], v[196:199]
v_mfma_f32_16x16x32_bf16 v[140:143], a[132:135], a[36:39], v[140:143]
ds_read_b64_tr_b16 a[158:159], v11 offset:53824
v_mfma_f32_16x16x32_bf16 v[84:87], a[132:135], a[32:35], v[84:87]
s_waitcnt vmcnt(15)
s_waitcnt lgkmcnt(8)
v_mfma_f32_16x16x32_bf16 v[32:35], a[136:139], a[48:51], v[32:35]
ds_read_b64_tr_b16 a[128:129], v11 offset:35936
v_mfma_f32_16x16x32_bf16 v[88:91], a[136:139], a[52:55], v[88:91]
v_mfma_f32_16x16x32_bf16 v[144:147], a[136:139], a[56:59], v[144:147]
ds_read_b64_tr_b16 a[130:131], v11 offset:39520
v_mfma_f32_16x16x32_bf16 v[200:203], a[136:139], a[60:63], v[200:203]
s_add_u32 m0, s65, 90112
v_mfma_f32_16x16x32_bf16 v[204:207], a[140:143], a[60:63], v[204:207]
ds_read_b64_tr_b16 a[132:133], v11 offset:50272
v_mfma_f32_16x16x32_bf16 v[148:151], a[140:143], a[56:59], v[148:151]
buffer_load_dwordx4 v8, s[40:43], s64 offen lds
v_mfma_f32_16x16x32_bf16 v[92:95], a[140:143], a[52:55], v[92:95]
ds_read_b64_tr_b16 a[134:135], v11 offset:53856
v_mfma_f32_16x16x32_bf16 v[36:39], a[140:143], a[48:51], v[36:39]
s_waitcnt lgkmcnt(8)
v_mfma_f32_16x16x32_bf16 v[40:43], a[144:147], a[48:51], v[40:43]
ds_read_b64_tr_b16 a[136:137], v11 offset:35968
v_mfma_f32_16x16x32_bf16 v[96:99], a[144:147], a[52:55], v[96:99]
v_mfma_f32_16x16x32_bf16 v[152:155], a[144:147], a[56:59], v[152:155]
ds_read_b64_tr_b16 a[138:139], v11 offset:39552
v_mfma_f32_16x16x32_bf16 v[208:211], a[144:147], a[60:63], v[208:211]
s_add_u32 m0, s65, 91136
v_mfma_f32_16x16x32_bf16 v[212:215], a[148:151], a[60:63], v[212:215]
ds_read_b64_tr_b16 a[140:141], v11 offset:50304
v_mfma_f32_16x16x32_bf16 v[156:159], a[148:151], a[56:59], v[156:159]
buffer_load_dwordx4 v9, s[40:43], s64 offen lds
v_mfma_f32_16x16x32_bf16 v[100:103], a[148:151], a[52:55], v[100:103]
ds_read_b64_tr_b16 a[142:143], v11 offset:53888
v_mfma_f32_16x16x32_bf16 v[44:47], a[148:151], a[48:51], v[44:47]
s_waitcnt lgkmcnt(8)
v_mfma_f32_16x16x32_bf16 v[48:51], a[152:155], a[48:51], v[48:51]
ds_read_b64_tr_b16 a[144:145], v11 offset:36000
v_mfma_f32_16x16x32_bf16 v[104:107], a[152:155], a[52:55], v[104:107]
v_mfma_f32_16x16x32_bf16 v[160:163], a[152:155], a[56:59], v[160:163]
ds_read_b64_tr_b16 a[146:147], v11 offset:39584
v_mfma_f32_16x16x32_bf16 v[216:219], a[152:155], a[60:63], v[216:219]
s_add_u32 m0, s65, 92160
v_mfma_f32_16x16x32_bf16 v[220:223], a[156:159], a[60:63], v[220:223]
ds_read_b64_tr_b16 a[148:149], v11 offset:50336
v_mfma_f32_16x16x32_bf16 v[164:167], a[156:159], a[56:59], v[164:167]
buffer_load_dwordx4 v10, s[40:43], s64 offen lds
v_mfma_f32_16x16x32_bf16 v[108:111], a[156:159], a[52:55], v[108:111]
ds_read_b64_tr_b16 a[150:151], v11 offset:53920
v_mfma_f32_16x16x32_bf16 v[52:55], a[156:159], a[48:51], v[52:55]
s_waitcnt lgkmcnt(8)
v_mfma_f32_16x16x32_bf16 v[56:59], a[128:131], a[48:51], v[56:59]
ds_read_b64_tr_b16 a[152:153], v11 offset:36032
v_mfma_f32_16x16x32_bf16 v[112:115], a[128:131], a[52:55], v[112:115]
v_mfma_f32_16x16x32_bf16 v[168:171], a[128:131], a[56:59], v[168:171]
ds_read_b64_tr_b16 a[154:155], v11 offset:39616
v_mfma_f32_16x16x32_bf16 v[224:227], a[128:131], a[60:63], v[224:227]
s_add_u32 s66, s66, 262144
v_mfma_f32_16x16x32_bf16 v[228:231], a[132:135], a[60:63], v[228:231]
ds_read_b64_tr_b16 a[156:157], v11 offset:50368
v_mfma_f32_16x16x32_bf16 v[172:175], a[132:135], a[56:59], v[172:175]
buffer_load_dwordx4 a[32:35], v14, s[44:47], s66 offen offset:0 sc1
v_mfma_f32_16x16x32_bf16 v[116:119], a[132:135], a[52:55], v[116:119]
ds_read_b64_tr_b16 a[158:159], v11 offset:53952
v_mfma_f32_16x16x32_bf16 v[60:63], a[132:135], a[48:51], v[60:63]
s_waitcnt lgkmcnt(8)
s_waitcnt vmcnt(16)
s_barrier
v_mfma_f32_16x16x32_bf16 v[64:67], a[136:139], a[48:51], v[64:67]
ds_read_b64_tr_b16 a[128:129], v12 offset:0
v_mfma_f32_16x16x32_bf16 v[120:123], a[136:139], a[52:55], v[120:123]
v_mfma_f32_16x16x32_bf16 v[176:179], a[136:139], a[56:59], v[176:179]
ds_read_b64_tr_b16 a[130:131], v12 offset:3584
v_mfma_f32_16x16x32_bf16 v[232:235], a[136:139], a[60:63], v[232:235]
buffer_load_dwordx4 a[36:39], v14, s[44:47], s66 offen offset:2048 sc1
v_mfma_f32_16x16x32_bf16 v[236:239], a[140:143], a[60:63], v[236:239]
ds_read_b64_tr_b16 a[132:133], v12 offset:14336
v_mfma_f32_16x16x32_bf16 v[180:183], a[140:143], a[56:59], v[180:183]
v_mfma_f32_16x16x32_bf16 v[124:127], a[140:143], a[52:55], v[124:127]
ds_read_b64_tr_b16 a[134:135], v12 offset:17920
v_mfma_f32_16x16x32_bf16 v[68:71], a[140:143], a[48:51], v[68:71]
s_waitcnt lgkmcnt(8)
v_mfma_f32_16x16x32_bf16 v[72:75], a[144:147], a[48:51], v[72:75]
ds_read_b64_tr_b16 a[136:137], v12 offset:32
v_mfma_f32_16x16x32_bf16 v[128:131], a[144:147], a[52:55], v[128:131]
v_mfma_f32_16x16x32_bf16 v[184:187], a[144:147], a[56:59], v[184:187]
ds_read_b64_tr_b16 a[138:139], v12 offset:3616
v_mfma_f32_16x16x32_bf16 v[240:243], a[144:147], a[60:63], v[240:243]
buffer_load_dwordx4 a[40:43], v15, s[44:47], s66 offen offset:0 sc1
v_mfma_f32_16x16x32_bf16 v[244:247], a[148:151], a[60:63], v[244:247]
ds_read_b64_tr_b16 a[140:141], v12 offset:14368
v_mfma_f32_16x16x32_bf16 v[188:191], a[148:151], a[56:59], v[188:191]
v_mfma_f32_16x16x32_bf16 v[132:135], a[148:151], a[52:55], v[132:135]
ds_read_b64_tr_b16 a[142:143], v12 offset:17952
v_mfma_f32_16x16x32_bf16 v[76:79], a[148:151], a[48:51], v[76:79]
s_waitcnt lgkmcnt(8)
v_mfma_f32_16x16x32_bf16 v[80:83], a[152:155], a[48:51], v[80:83]
ds_read_b64_tr_b16 a[144:145], v12 offset:64
v_mfma_f32_16x16x32_bf16 v[136:139], a[152:155], a[52:55], v[136:139]
v_mfma_f32_16x16x32_bf16 v[192:195], a[152:155], a[56:59], v[192:195]
ds_read_b64_tr_b16 a[146:147], v12 offset:3648
v_mfma_f32_16x16x32_bf16 v[248:251], a[152:155], a[60:63], v[248:251]
buffer_load_dwordx4 a[44:47], v15, s[44:47], s66 offen offset:2048 sc1
v_mfma_f32_16x16x32_bf16 v[252:255], a[156:159], a[60:63], v[252:255]
ds_read_b64_tr_b16 a[148:149], v12 offset:14400
v_mfma_f32_16x16x32_bf16 v[196:199], a[156:159], a[56:59], v[196:199]
v_mfma_f32_16x16x32_bf16 v[140:143], a[156:159], a[52:55], v[140:143]
ds_read_b64_tr_b16 a[150:151], v12 offset:17984
v_mfma_f32_16x16x32_bf16 v[84:87], a[156:159], a[48:51], v[84:87]
s_waitcnt vmcnt(15)
s_waitcnt lgkmcnt(8)
v_mfma_f32_16x16x32_bf16 v[32:35], a[128:131], a[0:3], v[32:35]
ds_read_b64_tr_b16 a[152:153], v12 offset:96
v_mfma_f32_16x16x32_bf16 v[88:91], a[128:131], a[4:7], v[88:91]
v_mfma_f32_16x16x32_bf16 v[144:147], a[128:131], a[8:11], v[144:147]
ds_read_b64_tr_b16 a[154:155], v12 offset:3680
v_mfma_f32_16x16x32_bf16 v[200:203], a[128:131], a[12:15], v[200:203]
v_mfma_f32_16x16x32_bf16 v[204:207], a[132:135], a[12:15], v[204:207]
ds_read_b64_tr_b16 a[156:157], v12 offset:14432
v_mfma_f32_16x16x32_bf16 v[148:151], a[132:135], a[8:11], v[148:151]
v_mfma_f32_16x16x32_bf16 v[92:95], a[132:135], a[4:7], v[92:95]
ds_read_b64_tr_b16 a[158:159], v12 offset:18016
v_mfma_f32_16x16x32_bf16 v[36:39], a[132:135], a[0:3], v[36:39]
buffer_load_dwordx4 a[48:51], v14, s[44:47], s66 offen offset:1024 sc1
s_waitcnt lgkmcnt(8)
v_mfma_f32_16x16x32_bf16 v[40:43], a[136:139], a[0:3], v[40:43]
ds_read_b64_tr_b16 a[128:129], v12 offset:128
v_mfma_f32_16x16x32_bf16 v[96:99], a[136:139], a[4:7], v[96:99]
v_mfma_f32_16x16x32_bf16 v[152:155], a[136:139], a[8:11], v[152:155]
ds_read_b64_tr_b16 a[130:131], v12 offset:3712
v_mfma_f32_16x16x32_bf16 v[208:211], a[136:139], a[12:15], v[208:211]
v_mfma_f32_16x16x32_bf16 v[212:215], a[140:143], a[12:15], v[212:215]
ds_read_b64_tr_b16 a[132:133], v12 offset:14464
v_mfma_f32_16x16x32_bf16 v[156:159], a[140:143], a[8:11], v[156:159]
v_mfma_f32_16x16x32_bf16 v[100:103], a[140:143], a[4:7], v[100:103]
ds_read_b64_tr_b16 a[134:135], v12 offset:18048
v_mfma_f32_16x16x32_bf16 v[44:47], a[140:143], a[0:3], v[44:47]
s_waitcnt lgkmcnt(8)
v_mfma_f32_16x16x32_bf16 v[48:51], a[144:147], a[0:3], v[48:51]
ds_read_b64_tr_b16 a[136:137], v12 offset:160
v_mfma_f32_16x16x32_bf16 v[104:107], a[144:147], a[4:7], v[104:107]
v_mfma_f32_16x16x32_bf16 v[160:163], a[144:147], a[8:11], v[160:163]
ds_read_b64_tr_b16 a[138:139], v12 offset:3744
v_mfma_f32_16x16x32_bf16 v[216:219], a[144:147], a[12:15], v[216:219]
v_mfma_f32_16x16x32_bf16 v[220:223], a[148:151], a[12:15], v[220:223]
ds_read_b64_tr_b16 a[140:141], v12 offset:14496
v_mfma_f32_16x16x32_bf16 v[164:167], a[148:151], a[8:11], v[164:167]
buffer_load_dwordx4 a[52:55], v14, s[44:47], s66 offen offset:3072 sc1
v_mfma_f32_16x16x32_bf16 v[108:111], a[148:151], a[4:7], v[108:111]
ds_read_b64_tr_b16 a[142:143], v12 offset:18080
v_mfma_f32_16x16x32_bf16 v[52:55], a[148:151], a[0:3], v[52:55]
s_waitcnt lgkmcnt(8)
v_mfma_f32_16x16x32_bf16 v[56:59], a[152:155], a[0:3], v[56:59]
ds_read_b64_tr_b16 a[144:145], v12 offset:192
v_mfma_f32_16x16x32_bf16 v[112:115], a[152:155], a[4:7], v[112:115]
v_mfma_f32_16x16x32_bf16 v[168:171], a[152:155], a[8:11], v[168:171]
ds_read_b64_tr_b16 a[146:147], v12 offset:3776
v_mfma_f32_16x16x32_bf16 v[224:227], a[152:155], a[12:15], v[224:227]
v_mfma_f32_16x16x32_bf16 v[228:231], a[156:159], a[12:15], v[228:231]
ds_read_b64_tr_b16 a[148:149], v12 offset:14528
v_mfma_f32_16x16x32_bf16 v[172:175], a[156:159], a[8:11], v[172:175]
v_mfma_f32_16x16x32_bf16 v[116:119], a[156:159], a[4:7], v[116:119]
ds_read_b64_tr_b16 a[150:151], v12 offset:18112
v_mfma_f32_16x16x32_bf16 v[60:63], a[156:159], a[0:3], v[60:63]
s_waitcnt lgkmcnt(8)
v_mfma_f32_16x16x32_bf16 v[64:67], a[128:131], a[0:3], v[64:67]
ds_read_b64_tr_b16 a[152:153], v12 offset:7168
v_mfma_f32_16x16x32_bf16 v[120:123], a[128:131], a[4:7], v[120:123]
v_mfma_f32_16x16x32_bf16 v[176:179], a[128:131], a[8:11], v[176:179]
ds_read_b64_tr_b16 a[154:155], v12 offset:10752
v_mfma_f32_16x16x32_bf16 v[232:235], a[128:131], a[12:15], v[232:235]
buffer_load_dwordx4 a[56:59], v15, s[44:47], s66 offen offset:1024 sc1
v_mfma_f32_16x16x32_bf16 v[236:239], a[132:135], a[12:15], v[236:239]
ds_read_b64_tr_b16 a[156:157], v12 offset:21504
v_mfma_f32_16x16x32_bf16 v[180:183], a[132:135], a[8:11], v[180:183]
v_mfma_f32_16x16x32_bf16 v[124:127], a[132:135], a[4:7], v[124:127]
ds_read_b64_tr_b16 a[158:159], v12 offset:25088
v_mfma_f32_16x16x32_bf16 v[68:71], a[132:135], a[0:3], v[68:71]
s_waitcnt lgkmcnt(8)
v_mfma_f32_16x16x32_bf16 v[72:75], a[136:139], a[0:3], v[72:75]
ds_read_b64_tr_b16 a[128:129], v12 offset:7200
v_mfma_f32_16x16x32_bf16 v[128:131], a[136:139], a[4:7], v[128:131]
v_mfma_f32_16x16x32_bf16 v[184:187], a[136:139], a[8:11], v[184:187]
ds_read_b64_tr_b16 a[130:131], v12 offset:10784
v_mfma_f32_16x16x32_bf16 v[240:243], a[136:139], a[12:15], v[240:243]
v_mfma_f32_16x16x32_bf16 v[244:247], a[140:143], a[12:15], v[244:247]
ds_read_b64_tr_b16 a[132:133], v12 offset:21536
v_mfma_f32_16x16x32_bf16 v[188:191], a[140:143], a[8:11], v[188:191]
v_mfma_f32_16x16x32_bf16 v[132:135], a[140:143], a[4:7], v[132:135]
ds_read_b64_tr_b16 a[134:135], v12 offset:25120
v_mfma_f32_16x16x32_bf16 v[76:79], a[140:143], a[0:3], v[76:79]
s_waitcnt lgkmcnt(8)
v_mfma_f32_16x16x32_bf16 v[80:83], a[144:147], a[0:3], v[80:83]
ds_read_b64_tr_b16 a[136:137], v12 offset:7232
v_mfma_f32_16x16x32_bf16 v[136:139], a[144:147], a[4:7], v[136:139]
buffer_load_dwordx4 a[60:63], v15, s[44:47], s66 offen offset:3072 sc1
v_mfma_f32_16x16x32_bf16 v[192:195], a[144:147], a[8:11], v[192:195]
ds_read_b64_tr_b16 a[138:139], v12 offset:10816
v_mfma_f32_16x16x32_bf16 v[248:251], a[144:147], a[12:15], v[248:251]
v_mfma_f32_16x16x32_bf16 v[252:255], a[148:151], a[12:15], v[252:255]
ds_read_b64_tr_b16 a[140:141], v12 offset:21568
v_mfma_f32_16x16x32_bf16 v[196:199], a[148:151], a[8:11], v[196:199]
v_mfma_f32_16x16x32_bf16 v[140:143], a[148:151], a[4:7], v[140:143]
ds_read_b64_tr_b16 a[142:143], v12 offset:25152
v_mfma_f32_16x16x32_bf16 v[84:87], a[148:151], a[0:3], v[84:87]
s_waitcnt vmcnt(11)
s_waitcnt lgkmcnt(8)
v_mfma_f32_16x16x32_bf16 v[32:35], a[152:155], a[16:19], v[32:35]
ds_read_b64_tr_b16 a[144:145], v12 offset:7264
v_mfma_f32_16x16x32_bf16 v[88:91], a[152:155], a[20:23], v[88:91]
v_mfma_f32_16x16x32_bf16 v[144:147], a[152:155], a[24:27], v[144:147]
ds_read_b64_tr_b16 a[146:147], v12 offset:10848
v_mfma_f32_16x16x32_bf16 v[200:203], a[152:155], a[28:31], v[200:203]
v_mfma_f32_16x16x32_bf16 v[204:207], a[156:159], a[28:31], v[204:207]
ds_read_b64_tr_b16 a[148:149], v12 offset:21600
v_mfma_f32_16x16x32_bf16 v[148:151], a[156:159], a[24:27], v[148:151]
v_mfma_f32_16x16x32_bf16 v[92:95], a[156:159], a[20:23], v[92:95]
ds_read_b64_tr_b16 a[150:151], v12 offset:25184
v_mfma_f32_16x16x32_bf16 v[36:39], a[156:159], a[16:19], v[36:39]
s_waitcnt lgkmcnt(8)
v_mfma_f32_16x16x32_bf16 v[40:43], a[128:131], a[16:19], v[40:43]
ds_read_b64_tr_b16 a[152:153], v12 offset:7296
v_mfma_f32_16x16x32_bf16 v[96:99], a[128:131], a[20:23], v[96:99]
v_mfma_f32_16x16x32_bf16 v[152:155], a[128:131], a[24:27], v[152:155]
ds_read_b64_tr_b16 a[154:155], v12 offset:10880
v_mfma_f32_16x16x32_bf16 v[208:211], a[128:131], a[28:31], v[208:211]
v_mfma_f32_16x16x32_bf16 v[212:215], a[132:135], a[28:31], v[212:215]
ds_read_b64_tr_b16 a[156:157], v12 offset:21632
v_mfma_f32_16x16x32_bf16 v[156:159], a[132:135], a[24:27], v[156:159]
v_mfma_f32_16x16x32_bf16 v[100:103], a[132:135], a[20:23], v[100:103]
ds_read_b64_tr_b16 a[158:159], v12 offset:25216
v_mfma_f32_16x16x32_bf16 v[44:47], a[132:135], a[16:19], v[44:47]
s_waitcnt lgkmcnt(8)
v_mfma_f32_16x16x32_bf16 v[48:51], a[136:139], a[16:19], v[48:51]
ds_read_b64_tr_b16 a[128:129], v12 offset:7328
v_mfma_f32_16x16x32_bf16 v[104:107], a[136:139], a[20:23], v[104:107]
v_mfma_f32_16x16x32_bf16 v[160:163], a[136:139], a[24:27], v[160:163]
ds_read_b64_tr_b16 a[130:131], v12 offset:10912
v_mfma_f32_16x16x32_bf16 v[216:219], a[136:139], a[28:31], v[216:219]
v_mfma_f32_16x16x32_bf16 v[220:223], a[140:143], a[28:31], v[220:223]
ds_read_b64_tr_b16 a[132:133], v12 offset:21664
v_mfma_f32_16x16x32_bf16 v[164:167], a[140:143], a[24:27], v[164:167]
v_mfma_f32_16x16x32_bf16 v[108:111], a[140:143], a[20:23], v[108:111]
ds_read_b64_tr_b16 a[134:135], v12 offset:25248
v_mfma_f32_16x16x32_bf16 v[52:55], a[140:143], a[16:19], v[52:55]
s_waitcnt lgkmcnt(8)
v_mfma_f32_16x16x32_bf16 v[56:59], a[144:147], a[16:19], v[56:59]
ds_read_b64_tr_b16 a[136:137], v12 offset:7360
v_mfma_f32_16x16x32_bf16 v[112:115], a[144:147], a[20:23], v[112:115]
v_mfma_f32_16x16x32_bf16 v[168:171], a[144:147], a[24:27], v[168:171]
ds_read_b64_tr_b16 a[138:139], v12 offset:10944
v_mfma_f32_16x16x32_bf16 v[224:227], a[144:147], a[28:31], v[224:227]
v_mfma_f32_16x16x32_bf16 v[228:231], a[148:151], a[28:31], v[228:231]
ds_read_b64_tr_b16 a[140:141], v12 offset:21696
v_mfma_f32_16x16x32_bf16 v[172:175], a[148:151], a[24:27], v[172:175]
v_mfma_f32_16x16x32_bf16 v[116:119], a[148:151], a[20:23], v[116:119]
ds_read_b64_tr_b16 a[142:143], v12 offset:25280
v_mfma_f32_16x16x32_bf16 v[60:63], a[148:151], a[16:19], v[60:63]
s_waitcnt lgkmcnt(8)
s_waitcnt vmcnt(8)
s_barrier
v_mfma_f32_16x16x32_bf16 v[64:67], a[152:155], a[16:19], v[64:67]
ds_read_b64_tr_b16 a[144:145], v12 offset:28672
v_mfma_f32_16x16x32_bf16 v[120:123], a[152:155], a[20:23], v[120:123]
v_mfma_f32_16x16x32_bf16 v[176:179], a[152:155], a[24:27], v[176:179]
ds_read_b64_tr_b16 a[146:147], v12 offset:32256
v_mfma_f32_16x16x32_bf16 v[232:235], a[152:155], a[28:31], v[232:235]
v_mfma_f32_16x16x32_bf16 v[236:239], a[156:159], a[28:31], v[236:239]
ds_read_b64_tr_b16 a[148:149], v12 offset:43008
v_mfma_f32_16x16x32_bf16 v[180:183], a[156:159], a[24:27], v[180:183]
v_mfma_f32_16x16x32_bf16 v[124:127], a[156:159], a[20:23], v[124:127]
ds_read_b64_tr_b16 a[150:151], v12 offset:46592
v_mfma_f32_16x16x32_bf16 v[68:71], a[156:159], a[16:19], v[68:71]
s_waitcnt lgkmcnt(8)
v_mfma_f32_16x16x32_bf16 v[72:75], a[128:131], a[16:19], v[72:75]
ds_read_b64_tr_b16 a[152:153], v12 offset:28704
v_mfma_f32_16x16x32_bf16 v[128:131], a[128:131], a[20:23], v[128:131]
v_mfma_f32_16x16x32_bf16 v[184:187], a[128:131], a[24:27], v[184:187]
ds_read_b64_tr_b16 a[154:155], v12 offset:32288
v_mfma_f32_16x16x32_bf16 v[240:243], a[128:131], a[28:31], v[240:243]
v_mfma_f32_16x16x32_bf16 v[244:247], a[132:135], a[28:31], v[244:247]
ds_read_b64_tr_b16 a[156:157], v12 offset:43040
v_mfma_f32_16x16x32_bf16 v[188:191], a[132:135], a[24:27], v[188:191]
v_mfma_f32_16x16x32_bf16 v[132:135], a[132:135], a[20:23], v[132:135]
ds_read_b64_tr_b16 a[158:159], v12 offset:46624
v_mfma_f32_16x16x32_bf16 v[76:79], a[132:135], a[16:19], v[76:79]
s_waitcnt lgkmcnt(8)
v_mfma_f32_16x16x32_bf16 v[80:83], a[136:139], a[16:19], v[80:83]
ds_read_b64_tr_b16 a[128:129], v12 offset:28736
v_mfma_f32_16x16x32_bf16 v[136:139], a[136:139], a[20:23], v[136:139]
v_mfma_f32_16x16x32_bf16 v[192:195], a[136:139], a[24:27], v[192:195]
ds_read_b64_tr_b16 a[130:131], v12 offset:32320
v_mfma_f32_16x16x32_bf16 v[248:251], a[136:139], a[28:31], v[248:251]
v_mfma_f32_16x16x32_bf16 v[252:255], a[140:143], a[28:31], v[252:255]
ds_read_b64_tr_b16 a[132:133], v12 offset:43072
v_mfma_f32_16x16x32_bf16 v[196:199], a[140:143], a[24:27], v[196:199]
v_mfma_f32_16x16x32_bf16 v[140:143], a[140:143], a[20:23], v[140:143]
ds_read_b64_tr_b16 a[134:135], v12 offset:46656
v_mfma_f32_16x16x32_bf16 v[84:87], a[140:143], a[16:19], v[84:87]
s_waitcnt vmcnt(4)
s_waitcnt lgkmcnt(8)
v_mfma_f32_16x16x32_bf16 v[32:35], a[144:147], a[32:35], v[32:35]
ds_read_b64_tr_b16 a[136:137], v12 offset:28768
v_mfma_f32_16x16x32_bf16 v[88:91], a[144:147], a[36:39], v[88:91]
v_mfma_f32_16x16x32_bf16 v[144:147], a[144:147], a[40:43], v[144:147]
ds_read_b64_tr_b16 a[138:139], v12 offset:32352
v_mfma_f32_16x16x32_bf16 v[200:203], a[144:147], a[44:47], v[200:203]
v_mfma_f32_16x16x32_bf16 v[204:207], a[148:151], a[44:47], v[204:207]
ds_read_b64_tr_b16 a[140:141], v12 offset:43104
v_mfma_f32_16x16x32_bf16 v[148:151], a[148:151], a[40:43], v[148:151]
v_mfma_f32_16x16x32_bf16 v[92:95], a[148:151], a[36:39], v[92:95]
ds_read_b64_tr_b16 a[142:143], v12 offset:46688
v_mfma_f32_16x16x32_bf16 v[36:39], a[148:151], a[32:35], v[36:39]
s_waitcnt lgkmcnt(8)
v_mfma_f32_16x16x32_bf16 v[40:43], a[152:155], a[32:35], v[40:43]
ds_read_b64_tr_b16 a[144:145], v12 offset:28800
v_mfma_f32_16x16x32_bf16 v[96:99], a[152:155], a[36:39], v[96:99]
v_mfma_f32_16x16x32_bf16 v[152:155], a[152:155], a[40:43], v[152:155]
ds_read_b64_tr_b16 a[146:147], v12 offset:32384
v_mfma_f32_16x16x32_bf16 v[208:211], a[152:155], a[44:47], v[208:211]
v_mfma_f32_16x16x32_bf16 v[212:215], a[156:159], a[44:47], v[212:215]
ds_read_b64_tr_b16 a[148:149], v12 offset:43136
v_mfma_f32_16x16x32_bf16 v[156:159], a[156:159], a[40:43], v[156:159]
v_mfma_f32_16x16x32_bf16 v[100:103], a[156:159], a[36:39], v[100:103]
ds_read_b64_tr_b16 a[150:151], v12 offset:46720
v_mfma_f32_16x16x32_bf16 v[44:47], a[156:159], a[32:35], v[44:47]
s_waitcnt lgkmcnt(8)
v_mfma_f32_16x16x32_bf16 v[48:51], a[128:131], a[32:35], v[48:51]
ds_read_b64_tr_b16 a[152:153], v12 offset:28832
v_mfma_f32_16x16x32_bf16 v[104:107], a[128:131], a[36:39], v[104:107]
v_mfma_f32_16x16x32_bf16 v[160:163], a[128:131], a[40:43], v[160:163]
ds_read_b64_tr_b16 a[154:155], v12 offset:32416
v_mfma_f32_16x16x32_bf16 v[216:219], a[128:131], a[44:47], v[216:219]
v_mfma_f32_16x16x32_bf16 v[220:223], a[132:135], a[44:47], v[220:223]
ds_read_b64_tr_b16 a[156:157], v12 offset:43168
v_mfma_f32_16x16x32_bf16 v[164:167], a[132:135], a[40:43], v[164:167]
v_mfma_f32_16x16x32_bf16 v[108:111], a[132:135], a[36:39], v[108:111]
ds_read_b64_tr_b16 a[158:159], v12 offset:46752
v_mfma_f32_16x16x32_bf16 v[52:55], a[132:135], a[32:35], v[52:55]
s_waitcnt lgkmcnt(8)
v_mfma_f32_16x16x32_bf16 v[56:59], a[136:139], a[32:35], v[56:59]
ds_read_b64_tr_b16 a[128:129], v12 offset:28864
v_mfma_f32_16x16x32_bf16 v[112:115], a[136:139], a[36:39], v[112:115]
v_mfma_f32_16x16x32_bf16 v[168:171], a[136:139], a[40:43], v[168:171]
ds_read_b64_tr_b16 a[130:131], v12 offset:32448
v_mfma_f32_16x16x32_bf16 v[224:227], a[136:139], a[44:47], v[224:227]
v_mfma_f32_16x16x32_bf16 v[228:231], a[140:143], a[44:47], v[228:231]
ds_read_b64_tr_b16 a[132:133], v12 offset:43200
v_mfma_f32_16x16x32_bf16 v[172:175], a[140:143], a[40:43], v[172:175]
v_mfma_f32_16x16x32_bf16 v[116:119], a[140:143], a[36:39], v[116:119]
ds_read_b64_tr_b16 a[134:135], v12 offset:46784
v_mfma_f32_16x16x32_bf16 v[60:63], a[140:143], a[32:35], v[60:63]
s_waitcnt lgkmcnt(8)
v_mfma_f32_16x16x32_bf16 v[64:67], a[144:147], a[32:35], v[64:67]
ds_read_b64_tr_b16 a[136:137], v12 offset:35840
v_mfma_f32_16x16x32_bf16 v[120:123], a[144:147], a[36:39], v[120:123]
v_mfma_f32_16x16x32_bf16 v[176:179], a[144:147], a[40:43], v[176:179]
ds_read_b64_tr_b16 a[138:139], v12 offset:39424
v_mfma_f32_16x16x32_bf16 v[232:235], a[144:147], a[44:47], v[232:235]
v_mfma_f32_16x16x32_bf16 v[236:239], a[148:151], a[44:47], v[236:239]
ds_read_b64_tr_b16 a[140:141], v12 offset:50176
v_mfma_f32_16x16x32_bf16 v[180:183], a[148:151], a[40:43], v[180:183]
v_mfma_f32_16x16x32_bf16 v[124:127], a[148:151], a[36:39], v[124:127]
ds_read_b64_tr_b16 a[142:143], v12 offset:53760
v_mfma_f32_16x16x32_bf16 v[68:71], a[148:151], a[32:35], v[68:71]
s_waitcnt lgkmcnt(8)
v_mfma_f32_16x16x32_bf16 v[72:75], a[152:155], a[32:35], v[72:75]
ds_read_b64_tr_b16 a[144:145], v12 offset:35872
v_mfma_f32_16x16x32_bf16 v[128:131], a[152:155], a[36:39], v[128:131]
v_mfma_f32_16x16x32_bf16 v[184:187], a[152:155], a[40:43], v[184:187]
ds_read_b64_tr_b16 a[146:147], v12 offset:39456
v_mfma_f32_16x16x32_bf16 v[240:243], a[152:155], a[44:47], v[240:243]
v_mfma_f32_16x16x32_bf16 v[244:247], a[156:159], a[44:47], v[244:247]
ds_read_b64_tr_b16 a[148:149], v12 offset:50208
v_mfma_f32_16x16x32_bf16 v[188:191], a[156:159], a[40:43], v[188:191]
v_mfma_f32_16x16x32_bf16 v[132:135], a[156:159], a[36:39], v[132:135]
ds_read_b64_tr_b16 a[150:151], v12 offset:53792
v_mfma_f32_16x16x32_bf16 v[76:79], a[156:159], a[32:35], v[76:79]
s_waitcnt lgkmcnt(8)
v_mfma_f32_16x16x32_bf16 v[80:83], a[128:131], a[32:35], v[80:83]
ds_read_b64_tr_b16 a[152:153], v12 offset:35904
v_mfma_f32_16x16x32_bf16 v[136:139], a[128:131], a[36:39], v[136:139]
v_mfma_f32_16x16x32_bf16 v[192:195], a[128:131], a[40:43], v[192:195]
ds_read_b64_tr_b16 a[154:155], v12 offset:39488
v_mfma_f32_16x16x32_bf16 v[248:251], a[128:131], a[44:47], v[248:251]
v_mfma_f32_16x16x32_bf16 v[252:255], a[132:135], a[44:47], v[252:255]
ds_read_b64_tr_b16 a[156:157], v12 offset:50240
v_mfma_f32_16x16x32_bf16 v[196:199], a[132:135], a[40:43], v[196:199]
v_mfma_f32_16x16x32_bf16 v[140:143], a[132:135], a[36:39], v[140:143]
ds_read_b64_tr_b16 a[158:159], v12 offset:53824
v_mfma_f32_16x16x32_bf16 v[84:87], a[132:135], a[32:35], v[84:87]
s_waitcnt vmcnt(0)
s_waitcnt lgkmcnt(8)
v_mfma_f32_16x16x32_bf16 v[32:35], a[136:139], a[48:51], v[32:35]
ds_read_b64_tr_b16 a[128:129], v12 offset:35936
v_mfma_f32_16x16x32_bf16 v[88:91], a[136:139], a[52:55], v[88:91]
v_mfma_f32_16x16x32_bf16 v[144:147], a[136:139], a[56:59], v[144:147]
ds_read_b64_tr_b16 a[130:131], v12 offset:39520
v_mfma_f32_16x16x32_bf16 v[200:203], a[136:139], a[60:63], v[200:203]
v_mfma_f32_16x16x32_bf16 v[204:207], a[140:143], a[60:63], v[204:207]
ds_read_b64_tr_b16 a[132:133], v12 offset:50272
v_mfma_f32_16x16x32_bf16 v[148:151], a[140:143], a[56:59], v[148:151]
v_mfma_f32_16x16x32_bf16 v[92:95], a[140:143], a[52:55], v[92:95]
ds_read_b64_tr_b16 a[134:135], v12 offset:53856
v_mfma_f32_16x16x32_bf16 v[36:39], a[140:143], a[48:51], v[36:39]
s_waitcnt lgkmcnt(8)
v_mfma_f32_16x16x32_bf16 v[40:43], a[144:147], a[48:51], v[40:43]
ds_read_b64_tr_b16 a[136:137], v12 offset:35968
v_mfma_f32_16x16x32_bf16 v[96:99], a[144:147], a[52:55], v[96:99]
v_mfma_f32_16x16x32_bf16 v[152:155], a[144:147], a[56:59], v[152:155]
ds_read_b64_tr_b16 a[138:139], v12 offset:39552
v_mfma_f32_16x16x32_bf16 v[208:211], a[144:147], a[60:63], v[208:211]
v_mfma_f32_16x16x32_bf16 v[212:215], a[148:151], a[60:63], v[212:215]
ds_read_b64_tr_b16 a[140:141], v12 offset:50304
v_mfma_f32_16x16x32_bf16 v[156:159], a[148:151], a[56:59], v[156:159]
v_mfma_f32_16x16x32_bf16 v[100:103], a[148:151], a[52:55], v[100:103]
ds_read_b64_tr_b16 a[142:143], v12 offset:53888
v_mfma_f32_16x16x32_bf16 v[44:47], a[148:151], a[48:51], v[44:47]
s_waitcnt lgkmcnt(8)
v_mfma_f32_16x16x32_bf16 v[48:51], a[152:155], a[48:51], v[48:51]
ds_read_b64_tr_b16 a[144:145], v12 offset:36000
v_mfma_f32_16x16x32_bf16 v[104:107], a[152:155], a[52:55], v[104:107]
v_mfma_f32_16x16x32_bf16 v[160:163], a[152:155], a[56:59], v[160:163]
ds_read_b64_tr_b16 a[146:147], v12 offset:39584
v_mfma_f32_16x16x32_bf16 v[216:219], a[152:155], a[60:63], v[216:219]
v_mfma_f32_16x16x32_bf16 v[220:223], a[156:159], a[60:63], v[220:223]
ds_read_b64_tr_b16 a[148:149], v12 offset:50336
v_mfma_f32_16x16x32_bf16 v[164:167], a[156:159], a[56:59], v[164:167]
v_mfma_f32_16x16x32_bf16 v[108:111], a[156:159], a[52:55], v[108:111]
ds_read_b64_tr_b16 a[150:151], v12 offset:53920
v_mfma_f32_16x16x32_bf16 v[52:55], a[156:159], a[48:51], v[52:55]
s_waitcnt lgkmcnt(8)
v_mfma_f32_16x16x32_bf16 v[56:59], a[128:131], a[48:51], v[56:59]
ds_read_b64_tr_b16 a[152:153], v12 offset:36032
v_mfma_f32_16x16x32_bf16 v[112:115], a[128:131], a[52:55], v[112:115]
v_mfma_f32_16x16x32_bf16 v[168:171], a[128:131], a[56:59], v[168:171]
ds_read_b64_tr_b16 a[154:155], v12 offset:39616
v_mfma_f32_16x16x32_bf16 v[224:227], a[128:131], a[60:63], v[224:227]
v_mfma_f32_16x16x32_bf16 v[228:231], a[132:135], a[60:63], v[228:231]
ds_read_b64_tr_b16 a[156:157], v12 offset:50368
v_mfma_f32_16x16x32_bf16 v[172:175], a[132:135], a[56:59], v[172:175]
v_mfma_f32_16x16x32_bf16 v[116:119], a[132:135], a[52:55], v[116:119]
ds_read_b64_tr_b16 a[158:159], v12 offset:53952
v_mfma_f32_16x16x32_bf16 v[60:63], a[132:135], a[48:51], v[60:63]
s_waitcnt lgkmcnt(8)
v_mfma_f32_16x16x32_bf16 v[64:67], a[136:139], a[48:51], v[64:67]
v_mfma_f32_16x16x32_bf16 v[120:123], a[136:139], a[52:55], v[120:123]
v_mfma_f32_16x16x32_bf16 v[176:179], a[136:139], a[56:59], v[176:179]
v_mfma_f32_16x16x32_bf16 v[232:235], a[136:139], a[60:63], v[232:235]
v_mfma_f32_16x16x32_bf16 v[236:239], a[140:143], a[60:63], v[236:239]
v_mfma_f32_16x16x32_bf16 v[180:183], a[140:143], a[56:59], v[180:183]
v_mfma_f32_16x16x32_bf16 v[124:127], a[140:143], a[52:55], v[124:127]
v_mfma_f32_16x16x32_bf16 v[68:71], a[140:143], a[48:51], v[68:71]
s_waitcnt lgkmcnt(4)
v_mfma_f32_16x16x32_bf16 v[72:75], a[144:147], a[48:51], v[72:75]
v_mfma_f32_16x16x32_bf16 v[128:131], a[144:147], a[52:55], v[128:131]
v_mfma_f32_16x16x32_bf16 v[184:187], a[144:147], a[56:59], v[184:187]
v_mfma_f32_16x16x32_bf16 v[240:243], a[144:147], a[60:63], v[240:243]
v_mfma_f32_16x16x32_bf16 v[244:247], a[148:151], a[60:63], v[244:247]
v_mfma_f32_16x16x32_bf16 v[188:191], a[148:151], a[56:59], v[188:191]
v_mfma_f32_16x16x32_bf16 v[132:135], a[148:151], a[52:55], v[132:135]
v_mfma_f32_16x16x32_bf16 v[76:79], a[148:151], a[48:51], v[76:79]
s_waitcnt lgkmcnt(0)
v_mfma_f32_16x16x32_bf16 v[80:83], a[152:155], a[48:51], v[80:83]
v_mfma_f32_16x16x32_bf16 v[136:139], a[152:155], a[52:55], v[136:139]
v_mfma_f32_16x16x32_bf16 v[192:195], a[152:155], a[56:59], v[192:195]
v_mfma_f32_16x16x32_bf16 v[248:251], a[152:155], a[60:63], v[248:251]
v_mfma_f32_16x16x32_bf16 v[252:255], a[156:159], a[60:63], v[252:255]
v_mfma_f32_16x16x32_bf16 v[196:199], a[156:159], a[56:59], v[196:199]
v_mfma_f32_16x16x32_bf16 v[140:143], a[156:159], a[52:55], v[140:143]
v_mfma_f32_16x16x32_bf16 v[84:87], a[156:159], a[48:51], v[84:87]
s_nop 7
v_exp_f32_e64 v20, -v32
v_exp_f32_e64 v21, -v33
v_exp_f32_e64 v22, -v34
v_exp_f32_e64 v23, -v35
v_pk_mul_f32 v[32:33], v[32:33], v[36:37]
v_pk_mul_f32 v[34:35], v[34:35], v[38:39]
v_pk_add_f32 v[20:21], v[20:21], 1.0 op_sel_hi:[1,0]
v_pk_add_f32 v[22:23], v[22:23], 1.0 op_sel_hi:[1,0]
v_rcp_f32 v20, v20
v_rcp_f32 v21, v21
v_rcp_f32 v22, v22
v_rcp_f32 v23, v23
v_pk_mul_f32 v[32:33], v[32:33], v[20:21]
v_pk_mul_f32 v[34:35], v[34:35], v[22:23]
v_cvt_pk_bf16_f32 v36, v32, v33
v_cvt_pk_bf16_f32 v37, v34, v35
v_exp_f32_e64 v24, -v88
v_exp_f32_e64 v25, -v89
v_exp_f32_e64 v26, -v90
v_exp_f32_e64 v27, -v91
v_pk_mul_f32 v[88:89], v[88:89], v[92:93]
v_pk_mul_f32 v[90:91], v[90:91], v[94:95]
v_pk_add_f32 v[24:25], v[24:25], 1.0 op_sel_hi:[1,0]
v_pk_add_f32 v[26:27], v[26:27], 1.0 op_sel_hi:[1,0]
v_rcp_f32 v24, v24
v_rcp_f32 v25, v25
v_rcp_f32 v26, v26
v_rcp_f32 v27, v27
v_pk_mul_f32 v[88:89], v[88:89], v[24:25]
v_pk_mul_f32 v[90:91], v[90:91], v[26:27]
v_cvt_pk_bf16_f32 v92, v88, v89
v_cvt_pk_bf16_f32 v93, v90, v91
v_exp_f32_e64 v20, -v144
v_exp_f32_e64 v21, -v145
v_exp_f32_e64 v22, -v146
v_exp_f32_e64 v23, -v147
v_pk_mul_f32 v[144:145], v[144:145], v[148:149]
v_pk_mul_f32 v[146:147], v[146:147], v[150:151]
v_pk_add_f32 v[20:21], v[20:21], 1.0 op_sel_hi:[1,0]
v_pk_add_f32 v[22:23], v[22:23], 1.0 op_sel_hi:[1,0]
v_rcp_f32 v20, v20
v_rcp_f32 v21, v21
v_rcp_f32 v22, v22
v_rcp_f32 v23, v23
v_pk_mul_f32 v[144:145], v[144:145], v[20:21]
v_pk_mul_f32 v[146:147], v[146:147], v[22:23]
v_cvt_pk_bf16_f32 v148, v144, v145
v_cvt_pk_bf16_f32 v149, v146, v147
v_exp_f32_e64 v24, -v200
v_exp_f32_e64 v25, -v201
v_exp_f32_e64 v26, -v202
v_exp_f32_e64 v27, -v203
v_pk_mul_f32 v[200:201], v[200:201], v[204:205]
v_pk_mul_f32 v[202:203], v[202:203], v[206:207]
v_pk_add_f32 v[24:25], v[24:25], 1.0 op_sel_hi:[1,0]
v_pk_add_f32 v[26:27], v[26:27], 1.0 op_sel_hi:[1,0]
v_rcp_f32 v24, v24
v_rcp_f32 v25, v25
v_rcp_f32 v26, v26
v_rcp_f32 v27, v27
v_pk_mul_f32 v[200:201], v[200:201], v[24:25]
v_pk_mul_f32 v[202:203], v[202:203], v[26:27]
v_cvt_pk_bf16_f32 v204, v200, v201
v_cvt_pk_bf16_f32 v205, v202, v203
v_exp_f32_e64 v20, -v40
v_exp_f32_e64 v21, -v41
v_exp_f32_e64 v22, -v42
v_exp_f32_e64 v23, -v43
v_pk_mul_f32 v[40:41], v[40:41], v[44:45]
v_pk_mul_f32 v[42:43], v[42:43], v[46:47]
v_pk_add_f32 v[20:21], v[20:21], 1.0 op_sel_hi:[1,0]
v_pk_add_f32 v[22:23], v[22:23], 1.0 op_sel_hi:[1,0]
v_rcp_f32 v20, v20
v_rcp_f32 v21, v21
v_rcp_f32 v22, v22
v_rcp_f32 v23, v23
v_pk_mul_f32 v[40:41], v[40:41], v[20:21]
v_pk_mul_f32 v[42:43], v[42:43], v[22:23]
v_cvt_pk_bf16_f32 v38, v40, v41
v_cvt_pk_bf16_f32 v39, v42, v43
buffer_store_dwordx4 v[36:39], v14, s[48:51], s69 offen offset:0 sc1
v_exp_f32_e64 v24, -v96
v_exp_f32_e64 v25, -v97
v_exp_f32_e64 v26, -v98
v_exp_f32_e64 v27, -v99
v_pk_mul_f32 v[96:97], v[96:97], v[100:101]
v_pk_mul_f32 v[98:99], v[98:99], v[102:103]
v_pk_add_f32 v[24:25], v[24:25], 1.0 op_sel_hi:[1,0]
v_pk_add_f32 v[26:27], v[26:27], 1.0 op_sel_hi:[1,0]
v_rcp_f32 v24, v24
v_rcp_f32 v25, v25
v_rcp_f32 v26, v26
v_rcp_f32 v27, v27
v_pk_mul_f32 v[96:97], v[96:97], v[24:25]
v_pk_mul_f32 v[98:99], v[98:99], v[26:27]
v_cvt_pk_bf16_f32 v94, v96, v97
v_cvt_pk_bf16_f32 v95, v98, v99
buffer_store_dwordx4 v[92:95], v14, s[48:51], s69 offen offset:2048 sc1
v_exp_f32_e64 v20, -v152
v_exp_f32_e64 v21, -v153
v_exp_f32_e64 v22, -v154
v_exp_f32_e64 v23, -v155
v_pk_mul_f32 v[152:153], v[152:153], v[156:157]
v_pk_mul_f32 v[154:155], v[154:155], v[158:159]
v_pk_add_f32 v[20:21], v[20:21], 1.0 op_sel_hi:[1,0]
v_pk_add_f32 v[22:23], v[22:23], 1.0 op_sel_hi:[1,0]
v_rcp_f32 v20, v20
v_rcp_f32 v21, v21
v_rcp_f32 v22, v22
v_rcp_f32 v23, v23
v_pk_mul_f32 v[152:153], v[152:153], v[20:21]
v_pk_mul_f32 v[154:155], v[154:155], v[22:23]
v_cvt_pk_bf16_f32 v150, v152, v153
v_cvt_pk_bf16_f32 v151, v154, v155
buffer_store_dwordx4 v[148:151], v15, s[48:51], s69 offen offset:0 sc1
v_exp_f32_e64 v24, -v208
v_exp_f32_e64 v25, -v209
v_exp_f32_e64 v26, -v210
v_exp_f32_e64 v27, -v211
v_pk_mul_f32 v[208:209], v[208:209], v[212:213]
v_pk_mul_f32 v[210:211], v[210:211], v[214:215]
v_pk_add_f32 v[24:25], v[24:25], 1.0 op_sel_hi:[1,0]
v_pk_add_f32 v[26:27], v[26:27], 1.0 op_sel_hi:[1,0]
v_rcp_f32 v24, v24
v_rcp_f32 v25, v25
v_rcp_f32 v26, v26
v_rcp_f32 v27, v27
v_pk_mul_f32 v[208:209], v[208:209], v[24:25]
v_pk_mul_f32 v[210:211], v[210:211], v[26:27]
v_cvt_pk_bf16_f32 v206, v208, v209
v_cvt_pk_bf16_f32 v207, v210, v211
buffer_store_dwordx4 v[204:207], v15, s[48:51], s69 offen offset:2048 sc1
v_exp_f32_e64 v20, -v48
v_exp_f32_e64 v21, -v49
v_exp_f32_e64 v22, -v50
v_exp_f32_e64 v23, -v51
v_pk_mul_f32 v[48:49], v[48:49], v[52:53]
v_pk_mul_f32 v[50:51], v[50:51], v[54:55]
v_pk_add_f32 v[20:21], v[20:21], 1.0 op_sel_hi:[1,0]
v_pk_add_f32 v[22:23], v[22:23], 1.0 op_sel_hi:[1,0]
v_rcp_f32 v20, v20
v_rcp_f32 v21, v21
v_rcp_f32 v22, v22
v_rcp_f32 v23, v23
v_pk_mul_f32 v[48:49], v[48:49], v[20:21]
v_pk_mul_f32 v[50:51], v[50:51], v[22:23]
v_cvt_pk_bf16_f32 v52, v48, v49
v_cvt_pk_bf16_f32 v53, v50, v51
v_exp_f32_e64 v24, -v104
v_exp_f32_e64 v25, -v105
v_exp_f32_e64 v26, -v106
v_exp_f32_e64 v27, -v107
v_pk_mul_f32 v[104:105], v[104:105], v[108:109]
v_pk_mul_f32 v[106:107], v[106:107], v[110:111]
v_pk_add_f32 v[24:25], v[24:25], 1.0 op_sel_hi:[1,0]
v_pk_add_f32 v[26:27], v[26:27], 1.0 op_sel_hi:[1,0]
v_rcp_f32 v24, v24
v_rcp_f32 v25, v25
v_rcp_f32 v26, v26
v_rcp_f32 v27, v27
v_pk_mul_f32 v[104:105], v[104:105], v[24:25]
v_pk_mul_f32 v[106:107], v[106:107], v[26:27]
v_cvt_pk_bf16_f32 v108, v104, v105
v_cvt_pk_bf16_f32 v109, v106, v107
v_exp_f32_e64 v20, -v160
v_exp_f32_e64 v21, -v161
v_exp_f32_e64 v22, -v162
v_exp_f32_e64 v23, -v163
v_pk_mul_f32 v[160:161], v[160:161], v[164:165]
v_pk_mul_f32 v[162:163], v[162:163], v[166:167]
v_pk_add_f32 v[20:21], v[20:21], 1.0 op_sel_hi:[1,0]
v_pk_add_f32 v[22:23], v[22:23], 1.0 op_sel_hi:[1,0]
v_rcp_f32 v20, v20
v_rcp_f32 v21, v21
v_rcp_f32 v22, v22
v_rcp_f32 v23, v23
v_pk_mul_f32 v[160:161], v[160:161], v[20:21]
v_pk_mul_f32 v[162:163], v[162:163], v[22:23]
v_cvt_pk_bf16_f32 v164, v160, v161
v_cvt_pk_bf16_f32 v165, v162, v163
v_exp_f32_e64 v24, -v216
v_exp_f32_e64 v25, -v217
v_exp_f32_e64 v26, -v218
v_exp_f32_e64 v27, -v219
v_pk_mul_f32 v[216:217], v[216:217], v[220:221]
v_pk_mul_f32 v[218:219], v[218:219], v[222:223]
v_pk_add_f32 v[24:25], v[24:25], 1.0 op_sel_hi:[1,0]
v_pk_add_f32 v[26:27], v[26:27], 1.0 op_sel_hi:[1,0]
v_rcp_f32 v24, v24
v_rcp_f32 v25, v25
v_rcp_f32 v26, v26
v_rcp_f32 v27, v27
v_pk_mul_f32 v[216:217], v[216:217], v[24:25]
v_pk_mul_f32 v[218:219], v[218:219], v[26:27]
v_cvt_pk_bf16_f32 v220, v216, v217
v_cvt_pk_bf16_f32 v221, v218, v219
v_exp_f32_e64 v20, -v56
v_exp_f32_e64 v21, -v57
v_exp_f32_e64 v22, -v58
v_exp_f32_e64 v23, -v59
v_pk_mul_f32 v[56:57], v[56:57], v[60:61]
v_pk_mul_f32 v[58:59], v[58:59], v[62:63]
v_pk_add_f32 v[20:21], v[20:21], 1.0 op_sel_hi:[1,0]
v_pk_add_f32 v[22:23], v[22:23], 1.0 op_sel_hi:[1,0]
v_rcp_f32 v20, v20
v_rcp_f32 v21, v21
v_rcp_f32 v22, v22
v_rcp_f32 v23, v23
v_pk_mul_f32 v[56:57], v[56:57], v[20:21]
v_pk_mul_f32 v[58:59], v[58:59], v[22:23]
v_cvt_pk_bf16_f32 v54, v56, v57
v_cvt_pk_bf16_f32 v55, v58, v59
buffer_store_dwordx4 v[52:55], v14, s[48:51], s70 offen offset:0 sc1
v_exp_f32_e64 v24, -v112
v_exp_f32_e64 v25, -v113
v_exp_f32_e64 v26, -v114
v_exp_f32_e64 v27, -v115
v_pk_mul_f32 v[112:113], v[112:113], v[116:117]
v_pk_mul_f32 v[114:115], v[114:115], v[118:119]
v_pk_add_f32 v[24:25], v[24:25], 1.0 op_sel_hi:[1,0]
v_pk_add_f32 v[26:27], v[26:27], 1.0 op_sel_hi:[1,0]
v_rcp_f32 v24, v24
v_rcp_f32 v25, v25
v_rcp_f32 v26, v26
v_rcp_f32 v27, v27
v_pk_mul_f32 v[112:113], v[112:113], v[24:25]
v_pk_mul_f32 v[114:115], v[114:115], v[26:27]
v_cvt_pk_bf16_f32 v110, v112, v113
v_cvt_pk_bf16_f32 v111, v114, v115
buffer_store_dwordx4 v[108:111], v14, s[48:51], s70 offen offset:2048 sc1
v_exp_f32_e64 v20, -v168
v_exp_f32_e64 v21, -v169
v_exp_f32_e64 v22, -v170
v_exp_f32_e64 v23, -v171
v_pk_mul_f32 v[168:169], v[168:169], v[172:173]
v_pk_mul_f32 v[170:171], v[170:171], v[174:175]
v_pk_add_f32 v[20:21], v[20:21], 1.0 op_sel_hi:[1,0]
v_pk_add_f32 v[22:23], v[22:23], 1.0 op_sel_hi:[1,0]
v_rcp_f32 v20, v20
v_rcp_f32 v21, v21
v_rcp_f32 v22, v22
v_rcp_f32 v23, v23
v_pk_mul_f32 v[168:169], v[168:169], v[20:21]
v_pk_mul_f32 v[170:171], v[170:171], v[22:23]
v_cvt_pk_bf16_f32 v166, v168, v169
v_cvt_pk_bf16_f32 v167, v170, v171
buffer_store_dwordx4 v[164:167], v15, s[48:51], s70 offen offset:0 sc1
v_exp_f32_e64 v24, -v224
v_exp_f32_e64 v25, -v225
v_exp_f32_e64 v26, -v226
v_exp_f32_e64 v27, -v227
v_pk_mul_f32 v[224:225], v[224:225], v[228:229]
v_pk_mul_f32 v[226:227], v[226:227], v[230:231]
v_pk_add_f32 v[24:25], v[24:25], 1.0 op_sel_hi:[1,0]
v_pk_add_f32 v[26:27], v[26:27], 1.0 op_sel_hi:[1,0]
v_rcp_f32 v24, v24
v_rcp_f32 v25, v25
v_rcp_f32 v26, v26
v_rcp_f32 v27, v27
v_pk_mul_f32 v[224:225], v[224:225], v[24:25]
v_pk_mul_f32 v[226:227], v[226:227], v[26:27]
v_cvt_pk_bf16_f32 v222, v224, v225
v_cvt_pk_bf16_f32 v223, v226, v227
buffer_store_dwordx4 v[220:223], v15, s[48:51], s70 offen offset:2048 sc1
v_exp_f32_e64 v20, -v64
v_exp_f32_e64 v21, -v65
v_exp_f32_e64 v22, -v66
v_exp_f32_e64 v23, -v67
v_pk_mul_f32 v[64:65], v[64:65], v[68:69]
v_pk_mul_f32 v[66:67], v[66:67], v[70:71]
v_pk_add_f32 v[20:21], v[20:21], 1.0 op_sel_hi:[1,0]
v_pk_add_f32 v[22:23], v[22:23], 1.0 op_sel_hi:[1,0]
v_rcp_f32 v20, v20
v_rcp_f32 v21, v21
v_rcp_f32 v22, v22
v_rcp_f32 v23, v23
v_pk_mul_f32 v[64:65], v[64:65], v[20:21]
v_pk_mul_f32 v[66:67], v[66:67], v[22:23]
v_cvt_pk_bf16_f32 v68, v64, v65
v_cvt_pk_bf16_f32 v69, v66, v67
v_exp_f32_e64 v24, -v120
v_exp_f32_e64 v25, -v121
v_exp_f32_e64 v26, -v122
v_exp_f32_e64 v27, -v123
v_pk_mul_f32 v[120:121], v[120:121], v[124:125]
v_pk_mul_f32 v[122:123], v[122:123], v[126:127]
v_pk_add_f32 v[24:25], v[24:25], 1.0 op_sel_hi:[1,0]
v_pk_add_f32 v[26:27], v[26:27], 1.0 op_sel_hi:[1,0]
v_rcp_f32 v24, v24
v_rcp_f32 v25, v25
v_rcp_f32 v26, v26
v_rcp_f32 v27, v27
v_pk_mul_f32 v[120:121], v[120:121], v[24:25]
v_pk_mul_f32 v[122:123], v[122:123], v[26:27]
v_cvt_pk_bf16_f32 v124, v120, v121
v_cvt_pk_bf16_f32 v125, v122, v123
v_exp_f32_e64 v20, -v176
v_exp_f32_e64 v21, -v177
v_exp_f32_e64 v22, -v178
v_exp_f32_e64 v23, -v179
v_pk_mul_f32 v[176:177], v[176:177], v[180:181]
v_pk_mul_f32 v[178:179], v[178:179], v[182:183]
v_pk_add_f32 v[20:21], v[20:21], 1.0 op_sel_hi:[1,0]
v_pk_add_f32 v[22:23], v[22:23], 1.0 op_sel_hi:[1,0]
v_rcp_f32 v20, v20
v_rcp_f32 v21, v21
v_rcp_f32 v22, v22
v_rcp_f32 v23, v23
v_pk_mul_f32 v[176:177], v[176:177], v[20:21]
v_pk_mul_f32 v[178:179], v[178:179], v[22:23]
v_cvt_pk_bf16_f32 v180, v176, v177
v_cvt_pk_bf16_f32 v181, v178, v179
v_exp_f32_e64 v24, -v232
v_exp_f32_e64 v25, -v233
v_exp_f32_e64 v26, -v234
v_exp_f32_e64 v27, -v235
v_pk_mul_f32 v[232:233], v[232:233], v[236:237]
v_pk_mul_f32 v[234:235], v[234:235], v[238:239]
v_pk_add_f32 v[24:25], v[24:25], 1.0 op_sel_hi:[1,0]
v_pk_add_f32 v[26:27], v[26:27], 1.0 op_sel_hi:[1,0]
v_rcp_f32 v24, v24
v_rcp_f32 v25, v25
v_rcp_f32 v26, v26
v_rcp_f32 v27, v27
v_pk_mul_f32 v[232:233], v[232:233], v[24:25]
v_pk_mul_f32 v[234:235], v[234:235], v[26:27]
v_cvt_pk_bf16_f32 v236, v232, v233
v_cvt_pk_bf16_f32 v237, v234, v235
v_exp_f32_e64 v20, -v72
v_exp_f32_e64 v21, -v73
v_exp_f32_e64 v22, -v74
v_exp_f32_e64 v23, -v75
v_pk_mul_f32 v[72:73], v[72:73], v[76:77]
v_pk_mul_f32 v[74:75], v[74:75], v[78:79]
v_pk_add_f32 v[20:21], v[20:21], 1.0 op_sel_hi:[1,0]
v_pk_add_f32 v[22:23], v[22:23], 1.0 op_sel_hi:[1,0]
v_rcp_f32 v20, v20
v_rcp_f32 v21, v21
v_rcp_f32 v22, v22
v_rcp_f32 v23, v23
v_pk_mul_f32 v[72:73], v[72:73], v[20:21]
v_pk_mul_f32 v[74:75], v[74:75], v[22:23]
v_cvt_pk_bf16_f32 v70, v72, v73
v_cvt_pk_bf16_f32 v71, v74, v75
buffer_store_dwordx4 v[68:71], v14, s[48:51], s71 offen offset:0 sc1
v_exp_f32_e64 v24, -v128
v_exp_f32_e64 v25, -v129
v_exp_f32_e64 v26, -v130
v_exp_f32_e64 v27, -v131
v_pk_mul_f32 v[128:129], v[128:129], v[132:133]
v_pk_mul_f32 v[130:131], v[130:131], v[134:135]
v_pk_add_f32 v[24:25], v[24:25], 1.0 op_sel_hi:[1,0]
v_pk_add_f32 v[26:27], v[26:27], 1.0 op_sel_hi:[1,0]
v_rcp_f32 v24, v24
v_rcp_f32 v25, v25
v_rcp_f32 v26, v26
v_rcp_f32 v27, v27
v_pk_mul_f32 v[128:129], v[128:129], v[24:25]
v_pk_mul_f32 v[130:131], v[130:131], v[26:27]
v_cvt_pk_bf16_f32 v126, v128, v129
v_cvt_pk_bf16_f32 v127, v130, v131
buffer_store_dwordx4 v[124:127], v14, s[48:51], s71 offen offset:2048 sc1
v_exp_f32_e64 v20, -v184
v_exp_f32_e64 v21, -v185
v_exp_f32_e64 v22, -v186
v_exp_f32_e64 v23, -v187
v_pk_mul_f32 v[184:185], v[184:185], v[188:189]
v_pk_mul_f32 v[186:187], v[186:187], v[190:191]
v_pk_add_f32 v[20:21], v[20:21], 1.0 op_sel_hi:[1,0]
v_pk_add_f32 v[22:23], v[22:23], 1.0 op_sel_hi:[1,0]
v_rcp_f32 v20, v20
v_rcp_f32 v21, v21
v_rcp_f32 v22, v22
v_rcp_f32 v23, v23
v_pk_mul_f32 v[184:185], v[184:185], v[20:21]
v_pk_mul_f32 v[186:187], v[186:187], v[22:23]
v_cvt_pk_bf16_f32 v182, v184, v185
v_cvt_pk_bf16_f32 v183, v186, v187
buffer_store_dwordx4 v[180:183], v15, s[48:51], s71 offen offset:0 sc1
v_exp_f32_e64 v24, -v240
v_exp_f32_e64 v25, -v241
v_exp_f32_e64 v26, -v242
v_exp_f32_e64 v27, -v243
v_pk_mul_f32 v[240:241], v[240:241], v[244:245]
v_pk_mul_f32 v[242:243], v[242:243], v[246:247]
v_pk_add_f32 v[24:25], v[24:25], 1.0 op_sel_hi:[1,0]
v_pk_add_f32 v[26:27], v[26:27], 1.0 op_sel_hi:[1,0]
v_rcp_f32 v24, v24
v_rcp_f32 v25, v25
v_rcp_f32 v26, v26
v_rcp_f32 v27, v27
v_pk_mul_f32 v[240:241], v[240:241], v[24:25]
v_pk_mul_f32 v[242:243], v[242:243], v[26:27]
v_cvt_pk_bf16_f32 v238, v240, v241
v_cvt_pk_bf16_f32 v239, v242, v243
buffer_store_dwordx4 v[236:239], v15, s[48:51], s71 offen offset:2048 sc1
v_exp_f32_e64 v20, -v80
v_exp_f32_e64 v21, -v81
v_exp_f32_e64 v22, -v82
v_exp_f32_e64 v23, -v83
v_pk_mul_f32 v[80:81], v[80:81], v[84:85]
v_pk_mul_f32 v[82:83], v[82:83], v[86:87]
v_pk_add_f32 v[20:21], v[20:21], 1.0 op_sel_hi:[1,0]
v_pk_add_f32 v[22:23], v[22:23], 1.0 op_sel_hi:[1,0]
v_rcp_f32 v20, v20
v_rcp_f32 v21, v21
v_rcp_f32 v22, v22
v_rcp_f32 v23, v23
v_pk_mul_f32 v[80:81], v[80:81], v[20:21]
v_pk_mul_f32 v[82:83], v[82:83], v[22:23]
v_cvt_pk_bf16_f32 v84, v80, v81
v_cvt_pk_bf16_f32 v85, v82, v83
buffer_store_dwordx2 v[84:85], v14, s[48:51], s72 offen offset:0 sc1
v_exp_f32_e64 v24, -v136
v_exp_f32_e64 v25, -v137
v_exp_f32_e64 v26, -v138
v_exp_f32_e64 v27, -v139
v_pk_mul_f32 v[136:137], v[136:137], v[140:141]
v_pk_mul_f32 v[138:139], v[138:139], v[142:143]
v_pk_add_f32 v[24:25], v[24:25], 1.0 op_sel_hi:[1,0]
v_pk_add_f32 v[26:27], v[26:27], 1.0 op_sel_hi:[1,0]
v_rcp_f32 v24, v24
v_rcp_f32 v25, v25
v_rcp_f32 v26, v26
v_rcp_f32 v27, v27
v_pk_mul_f32 v[136:137], v[136:137], v[24:25]
v_pk_mul_f32 v[138:139], v[138:139], v[26:27]
v_cvt_pk_bf16_f32 v140, v136, v137
v_cvt_pk_bf16_f32 v141, v138, v139
buffer_store_dwordx2 v[140:141], v14, s[48:51], s72 offen offset:2048 sc1
v_exp_f32_e64 v20, -v192
v_exp_f32_e64 v21, -v193
v_exp_f32_e64 v22, -v194
v_exp_f32_e64 v23, -v195
v_pk_mul_f32 v[192:193], v[192:193], v[196:197]
v_pk_mul_f32 v[194:195], v[194:195], v[198:199]
v_pk_add_f32 v[20:21], v[20:21], 1.0 op_sel_hi:[1,0]
v_pk_add_f32 v[22:23], v[22:23], 1.0 op_sel_hi:[1,0]
v_rcp_f32 v20, v20
v_rcp_f32 v21, v21
v_rcp_f32 v22, v22
v_rcp_f32 v23, v23
v_pk_mul_f32 v[192:193], v[192:193], v[20:21]
v_pk_mul_f32 v[194:195], v[194:195], v[22:23]
v_cvt_pk_bf16_f32 v196, v192, v193
v_cvt_pk_bf16_f32 v197, v194, v195
buffer_store_dwordx2 v[196:197], v15, s[48:51], s72 offen offset:0 sc1
v_exp_f32_e64 v24, -v248
v_exp_f32_e64 v25, -v249
v_exp_f32_e64 v26, -v250
v_exp_f32_e64 v27, -v251
v_pk_mul_f32 v[248:249], v[248:249], v[252:253]
v_pk_mul_f32 v[250:251], v[250:251], v[254:255]
v_pk_add_f32 v[24:25], v[24:25], 1.0 op_sel_hi:[1,0]
v_pk_add_f32 v[26:27], v[26:27], 1.0 op_sel_hi:[1,0]
v_rcp_f32 v24, v24
v_rcp_f32 v25, v25
v_rcp_f32 v26, v26
v_rcp_f32 v27, v27
v_pk_mul_f32 v[248:249], v[248:249], v[24:25]
v_pk_mul_f32 v[250:251], v[250:251], v[26:27]
v_cvt_pk_bf16_f32 v252, v248, v249
v_cvt_pk_bf16_f32 v253, v250, v251
buffer_store_dwordx2 v[252:253], v15, s[48:51], s72 offen offset:2048 sc1
s_lshr_b32 s77, s28, 3
s_waitcnt vmcnt(0)
s_barrier
s_cmp_lg_u32 s24, 0
s_cbranch_scc1 L_sig23
s_lshl_b32 s33, s25, 3
s_add_u32 s33, s33, 256
s_add_u32 s33, s33, s77
s_lshl_b32 s33, s33, 7
v_mov_b32 v2, s33
v_mov_b32 v3, 1
s_mov_b64 exec, 1
global_atomic_add v2, v3, s[34:35]
s_mov_b64 exec, -1
L_sig23:
s_and_b32 s31, s26, 1
s_lshl_b32 s31, s31, 2
s_add_u32 s31, s31, s27
s_lshl_b32 s31, s31, 8
s_lshr_b32 s32, s26, 1
s_mul_i32 s32, s32, 896
v_lshrrev_b32 v16, 4, v1
v_mul_u32_u24 v17, 32768, v16
v_and_b32 v18, 15, v1
s_lshr_b32 s30, s26, 1
s_lshl_b32 s30, s30, 2
v_add_u32 v18, s30, v18
v_and_b32 v18, 15, v18
v_lshlrev_b32 v18, 4, v18
v_add3_u32 v4, v17, v18, s31
s_lshl_b32 s30, s24, 2
s_add_u32 s30, s30, s32
s_mul_i32 s64, s30, 2048
s_mul_i32 s65, s24, 4224
s_add_u32 s65, s65, 0
v_lshrrev_b32 v16, 2, v1
v_mul_u32_u24 v11, 1056, v16
v_and_b32 v16, 3, v1
v_lshlrev_b32 v16, 3, v16
v_add_u32 v11, v11, v16
s_mov_b32 s40, s18
s_mov_b32 s41, s19
s_mov_b32 s42, 7340032
s_mov_b32 s43, 0x20000
s_add_u32 m0, s65, 0
s_nop 0
buffer_load_dwordx4 v4, s[40:43], s64 offen lds
s_add_u32 s64, s64, 2048
s_add_u32 m0, s65, 1056
s_nop 0
buffer_load_dwordx4 v4, s[40:43], s64 offen lds
s_add_u32 s64, s64, 2048
s_add_u32 m0, s65, 2112
s_nop 0
buffer_load_dwordx4 v4, s[40:43], s64 offen lds
s_add_u32 s64, s64, 2048
s_add_u32 m0, s65, 3168
s_nop 0
buffer_load_dwordx4 v4, s[40:43], s64 offen lds
s_add_u32 s64, s64, 124928
s_add_u32 m0, s65, 16896
s_nop 0
buffer_load_dwordx4 v4, s[40:43], s64 offen lds
s_add_u32 s64, s64, 2048
s_add_u32 m0, s65, 17952
s_nop 0
buffer_load_dwordx4 v4, s[40:43], s64 offen lds
s_add_u32 s64, s64, 2048
s_add_u32 m0, s65, 19008
s_nop 0
buffer_load_dwordx4 v4, s[40:43], s64 offen lds
s_add_u32 s64, s64, 2048
s_add_u32 m0, s65, 20064
s_nop 0
buffer_load_dwordx4 v4, s[40:43], s64 offen lds
s_add_u32 s44, s22, 58720256
s_addc_u32 s45, s23, 0
s_mov_b32 s46, 14680064
s_mov_b32 s47, 0x20000
s_lshr_b32 s66, s26, 1
s_mul_i32 s66, s66, 3670016
v_mov_b32 v64, 0
v_mov_b32 v65, 0
v_mov_b32 v66, 0
v_mov_b32 v67, 0
v_mov_b32 v68, 0
v_mov_b32 v69, 0
v_mov_b32 v70, 0
v_mov_b32 v71, 0
v_mov_b32 v72, 0
v_mov_b32 v73, 0
v_mov_b32 v74, 0
v_mov_b32 v75, 0
v_mov_b32 v76, 0
v_mov_b32 v77, 0
v_mov_b32 v78, 0
v_mov_b32 v79, 0
v_mov_b32 v80, 0
v_mov_b32 v81, 0
v_mov_b32 v82, 0
v_mov_b32 v83, 0
v_mov_b32 v84, 0
v_mov_b32 v85, 0
v_mov_b32 v86, 0
v_mov_b32 v87, 0
v_mov_b32 v88, 0
v_mov_b32 v89, 0
v_mov_b32 v90, 0
v_mov_b32 v91, 0
v_mov_b32 v92, 0
v_mov_b32 v93, 0
v_mov_b32 v94, 0
v_mov_b32 v95, 0
v_mov_b32 v96, 0
v_mov_b32 v97, 0
v_mov_b32 v98, 0
v_mov_b32 v99, 0
v_mov_b32 v100, 0
v_mov_b32 v101, 0
v_mov_b32 v102, 0
v_mov_b32 v103, 0
v_mov_b32 v104, 0
v_mov_b32 v105, 0
v_mov_b32 v106, 0
v_mov_b32 v107, 0
v_mov_b32 v108, 0
v_mov_b32 v109, 0
v_mov_b32 v110, 0
v_mov_b32 v111, 0
v_mov_b32 v112, 0
v_mov_b32 v113, 0
v_mov_b32 v114, 0
v_mov_b32 v115, 0
v_mov_b32 v116, 0
v_mov_b32 v117, 0
v_mov_b32 v118, 0
v_mov_b32 v119, 0
v_mov_b32 v120, 0
v_mov_b32 v121, 0
v_mov_b32 v122, 0
v_mov_b32 v123, 0
v_mov_b32 v124, 0
v_mov_b32 v125, 0
v_mov_b32 v126, 0
v_mov_b32 v127, 0
v_mov_b32 v128, 0
v_mov_b32 v129, 0
v_mov_b32 v130, 0
v_mov_b32 v131, 0
v_mov_b32 v132, 0
v_mov_b32 v133, 0
v_mov_b32 v134, 0
v_mov_b32 v135, 0
v_mov_b32 v136, 0
v_mov_b32 v137, 0
v_mov_b32 v138, 0
v_mov_b32 v139, 0
v_mov_b32 v140, 0
v_mov_b32 v141, 0
v_mov_b32 v142, 0
v_mov_b32 v143, 0
v_mov_b32 v144, 0
v_mov_b32 v145, 0
v_mov_b32 v146, 0
v_mov_b32 v147, 0
v_mov_b32 v148, 0
v_mov_b32 v149, 0
v_mov_b32 v150, 0
v_mov_b32 v151, 0
v_mov_b32 v152, 0
v_mov_b32 v153, 0
v_mov_b32 v154, 0
v_mov_b32 v155, 0
v_mov_b32 v156, 0
v_mov_b32 v157, 0
v_mov_b32 v158, 0
v_mov_b32 v159, 0
v_mov_b32 v160, 0
v_mov_b32 v161, 0
v_mov_b32 v162, 0
v_mov_b32 v163, 0
v_mov_b32 v164, 0
v_mov_b32 v165, 0
v_mov_b32 v166, 0
v_mov_b32 v167, 0
v_mov_b32 v168, 0
v_mov_b32 v169, 0
v_mov_b32 v170, 0
v_mov_b32 v171, 0
v_mov_b32 v172, 0
v_mov_b32 v173, 0
v_mov_b32 v174, 0
v_mov_b32 v175, 0
v_mov_b32 v176, 0
v_mov_b32 v177, 0
v_mov_b32 v178, 0
v_mov_b32 v179, 0
v_mov_b32 v180, 0
v_mov_b32 v181, 0
v_mov_b32 v182, 0
v_mov_b32 v183, 0
v_mov_b32 v184, 0
v_mov_b32 v185, 0
v_mov_b32 v186, 0
v_mov_b32 v187, 0
v_mov_b32 v188, 0
v_mov_b32 v189, 0
v_mov_b32 v190, 0
v_mov_b32 v191, 0
s_waitcnt vmcnt(4)
s_barrier
ds_read_b64_tr_b16 a[128:129], v11 offset:0
ds_read_b64_tr_b16 a[130:131], v11 offset:256
ds_read_b64_tr_b16 a[132:133], v11 offset:32
ds_read_b64_tr_b16 a[134:135], v11 offset:288
ds_read_b64_tr_b16 a[136:137], v11 offset:64
ds_read_b64_tr_b16 a[138:139], v11 offset:320
ds_read_b64_tr_b16 a[140:141], v11 offset:96
ds_read_b64_tr_b16 a[142:143], v11 offset:352
ds_read_b64_tr_b16 a[144:145], v11 offset:128
ds_read_b64_tr_b16 a[146:147], v11 offset:384
ds_read_b64_tr_b16 a[148:149], v11 offset:160
ds_read_b64_tr_b16 a[150:151], v11 offset:416
s_lshr_b32 s77, s26, 1
s_cmp_lg_u32 s24, 0
s_cbranch_scc1 L_wt24
s_lshl_b32 s33, s25, 3
s_add_u32 s33, s33, 256
s_add_u32 s33, s33, s77
s_lshl_b32 s33, s33, 7
v_mov_b32 v2, s33
s_mov_b32 s32, 1048576
L_poll25:
global_load_dword v3, v2, s[34:35] sc1
s_waitcnt vmcnt(0)
v_readfirstlane_b32 s31, v3
s_nop 0
s_cmp_ge_u32 s31, 8
s_cbranch_scc1 L_pd26
s_sub_u32 s32, s32, 1
s_cmp_eq_u32 s32, 0
s_cbranch_scc1 L_pd26
s_sleep 2
s_branch L_poll25
L_pd26:
L_wt24:
s_barrier
s_add_u32 s48, s22, 88080384
s_addc_u32 s49, s23, 0
s_mov_b32 s50, 12582912
s_mov_b32 s51, 0x20000
s_lshr_b32 s67, s26, 1
s_and_b32 s68, s26, 1
s_lshl_b32 s68, s68, 2
s_add_u32 s68, s68, s27
s_lshl_b32 s30, s24, 12
v_lshlrev_b32 v63, 4, v1
v_add_u32 v63, s30, v63
s_lshl_b32 s70, s25, 3
s_add_u32 s70, s70, s68
s_lshl_b32 s70, s70, 2
s_add_u32 s30, s67, 1
s_and_b32 s30, s30, 3
s_add_u32 s30, s30, s70
s_mul_i32 s30, s30, 3
s_add_u32 s30, s30, 0
s_lshl_b32 s75, s30, 14
s_add_u32 s30, s67, 2
s_and_b32 s30, s30, 3
s_add_u32 s30, s30, s70
s_mul_i32 s30, s30, 3
s_add_u32 s30, s30, 1
s_lshl_b32 s76, s30, 14
s_add_u32 s30, s67, 3
s_and_b32 s30, s30, 3
s_add_u32 s30, s30, s70
s_mul_i32 s30, s30, 3
s_add_u32 s30, s30, 2
s_lshl_b32 s77, s30, 14
buffer_load_dwordx4 a[0:3], v14, s[44:47], s66 offen offset:0 sc1
buffer_load_dwordx4 a[4:7], v14, s[44:47], s66 offen offset:2048 sc1
buffer_load_dwordx4 a[8:11], v15, s[44:47], s66 offen offset:0 sc1
buffer_load_dwordx4 a[12:15], v15, s[44:47], s66 offen offset:2048 sc1
buffer_load_dwordx4 a[16:19], v14, s[44:47], s66 offen offset:1024 sc1
buffer_load_dwordx4 a[20:23], v14, s[44:47], s66 offen offset:3072 sc1
buffer_load_dwordx4 a[24:27], v15, s[44:47], s66 offen offset:1024 sc1
buffer_load_dwordx4 a[28:31], v15, s[44:47], s66 offen offset:3072 sc1
s_add_u32 s66, s66, 262144
buffer_load_dwordx4 a[32:35], v14, s[44:47], s66 offen offset:0 sc1
buffer_load_dwordx4 a[36:39], v14, s[44:47], s66 offen offset:2048 sc1
buffer_load_dwordx4 a[40:43], v15, s[44:47], s66 offen offset:0 sc1
buffer_load_dwordx4 a[44:47], v15, s[44:47], s66 offen offset:2048 sc1
s_mov_b32 s29, 3
L_loop_d:
s_waitcnt vmcnt(8)
s_waitcnt lgkmcnt(8)
v_mfma_f32_16x16x32_bf16 v[64:67], a[128:131], a[0:3], v[64:67]
ds_read_b64_tr_b16 a[152:153], v11 offset:192
v_mfma_f32_16x16x32_bf16 v[96:99], a[128:131], a[4:7], v[96:99]
s_add_u32 s64, s64, 124928
s_add_u32 m0, s65, 33792
v_mfma_f32_16x16x32_bf16 v[128:131], a[128:131], a[8:11], v[128:131]
ds_read_b64_tr_b16 a[154:155], v11 offset:448
v_mfma_f32_16x16x32_bf16 v[160:163], a[128:131], a[12:15], v[160:163]
buffer_load_dwordx4 v4, s[40:43], s64 offen lds
v_mfma_f32_16x16x32_bf16 v[164:167], a[132:135], a[12:15], v[164:167]
ds_read_b64_tr_b16 a[156:157], v11 offset:224
v_mfma_f32_16x16x32_bf16 v[132:135], a[132:135], a[8:11], v[132:135]
v_mfma_f32_16x16x32_bf16 v[100:103], a[132:135], a[4:7], v[100:103]
ds_read_b64_tr_b16 a[158:159], v11 offset:480
v_mfma_f32_16x16x32_bf16 v[68:71], a[132:135], a[0:3], v[68:71]
s_add_u32 s64, s64, 2048
s_add_u32 m0, s65, 34848
s_waitcnt lgkmcnt(8)
v_mfma_f32_16x16x32_bf16 v[72:75], a[136:139], a[0:3], v[72:75]
ds_read_b64_tr_b16 a[128:129], v11 offset:512
v_mfma_f32_16x16x32_bf16 v[104:107], a[136:139], a[4:7], v[104:107]
buffer_load_dwordx4 v4, s[40:43], s64 offen lds
v_mfma_f32_16x16x32_bf16 v[136:139], a[136:139], a[8:11], v[136:139]
ds_read_b64_tr_b16 a[130:131], v11 offset:768
v_mfma_f32_16x16x32_bf16 v[168:171], a[136:139], a[12:15], v[168:171]
v_mfma_f32_16x16x32_bf16 v[172:175], a[140:143], a[12:15], v[172:175]
ds_read_b64_tr_b16 a[132:133], v11 offset:544
v_mfma_f32_16x16x32_bf16 v[140:143], a[140:143], a[8:11], v[140:143]
buffer_load_dwordx4 a[48:51], v14, s[44:47], s66 offen offset:1024 sc1
v_mfma_f32_16x16x32_bf16 v[108:111], a[140:143], a[4:7], v[108:111]
ds_read_b64_tr_b16 a[134:135], v11 offset:800
v_mfma_f32_16x16x32_bf16 v[76:79], a[140:143], a[0:3], v[76:79]
s_waitcnt lgkmcnt(8)
v_mfma_f32_16x16x32_bf16 v[80:83], a[144:147], a[0:3], v[80:83]
ds_read_b64_tr_b16 a[136:137], v11 offset:576
v_mfma_f32_16x16x32_bf16 v[112:115], a[144:147], a[4:7], v[112:115]
buffer_load_dwordx4 a[52:55], v14, s[44:47], s66 offen offset:3072 sc1
v_mfma_f32_16x16x32_bf16 v[144:147], a[144:147], a[8:11], v[144:147]
ds_read_b64_tr_b16 a[138:139], v11 offset:832
v_mfma_f32_16x16x32_bf16 v[176:179], a[144:147], a[12:15], v[176:179]
v_mfma_f32_16x16x32_bf16 v[180:183], a[148:151], a[12:15], v[180:183]
ds_read_b64_tr_b16 a[140:141], v11 offset:608
v_mfma_f32_16x16x32_bf16 v[148:151], a[148:151], a[8:11], v[148:151]
v_mfma_f32_16x16x32_bf16 v[116:119], a[148:151], a[4:7], v[116:119]
ds_read_b64_tr_b16 a[142:143], v11 offset:864
v_mfma_f32_16x16x32_bf16 v[84:87], a[148:151], a[0:3], v[84:87]
buffer_load_dwordx4 a[56:59], v15, s[44:47], s66 offen offset:1024 sc1
s_waitcnt lgkmcnt(8)
v_mfma_f32_16x16x32_bf16 v[88:91], a[152:155], a[0:3], v[88:91]
ds_read_b64_tr_b16 a[144:145], v11 offset:640
v_mfma_f32_16x16x32_bf16 v[120:123], a[152:155], a[4:7], v[120:123]
v_mfma_f32_16x16x32_bf16 v[152:155], a[152:155], a[8:11], v[152:155]
ds_read_b64_tr_b16 a[146:147], v11 offset:896
v_mfma_f32_16x16x32_bf16 v[184:187], a[152:155], a[12:15], v[184:187]
v_mfma_f32_16x16x32_bf16 v[188:191], a[156:159], a[12:15], v[188:191]
ds_read_b64_tr_b16 a[148:149], v11 offset:672
v_mfma_f32_16x16x32_bf16 v[156:159], a[156:159], a[8:11], v[156:159]
buffer_load_dwordx4 a[60:63], v15, s[44:47], s66 offen offset:3072 sc1
v_mfma_f32_16x16x32_bf16 v[124:127], a[156:159], a[4:7], v[124:127]
ds_read_b64_tr_b16 a[150:151], v11 offset:928
v_mfma_f32_16x16x32_bf16 v[92:95], a[156:159], a[0:3], v[92:95]
s_waitcnt vmcnt(10)
s_waitcnt lgkmcnt(8)
v_mfma_f32_16x16x32_bf16 v[64:67], a[128:131], a[16:19], v[64:67]
ds_read_b64_tr_b16 a[152:153], v11 offset:704
v_mfma_f32_16x16x32_bf16 v[96:99], a[128:131], a[20:23], v[96:99]
s_add_u32 s64, s64, 2048
s_add_u32 m0, s65, 35904
v_mfma_f32_16x16x32_bf16 v[128:131], a[128:131], a[24:27], v[128:131]
ds_read_b64_tr_b16 a[154:155], v11 offset:960
v_mfma_f32_16x16x32_bf16 v[160:163], a[128:131], a[28:31], v[160:163]
buffer_load_dwordx4 v4, s[40:43], s64 offen lds
v_mfma_f32_16x16x32_bf16 v[164:167], a[132:135], a[28:31], v[164:167]
ds_read_b64_tr_b16 a[156:157], v11 offset:736
v_mfma_f32_16x16x32_bf16 v[132:135], a[132:135], a[24:27], v[132:135]
v_mfma_f32_16x16x32_bf16 v[100:103], a[132:135], a[20:23], v[100:103]
ds_read_b64_tr_b16 a[158:159], v11 offset:992
v_mfma_f32_16x16x32_bf16 v[68:71], a[132:135], a[16:19], v[68:71]
s_add_u32 s64, s64, 2048
s_add_u32 m0, s65, 36960
s_waitcnt lgkmcnt(8)
s_waitcnt vmcnt(11)
s_barrier
v_mfma_f32_16x16x32_bf16 v[72:75], a[136:139], a[16:19], v[72:75]
ds_read_b64_tr_b16 a[128:129], v11 offset:16896
v_mfma_f32_16x16x32_bf16 v[104:107], a[136:139], a[20:23], v[104:107]
buffer_load_dwordx4 v4, s[40:43], s64 offen lds
v_mfma_f32_16x16x32_bf16 v[136:139], a[136:139], a[24:27], v[136:139]
ds_read_b64_tr_b16 a[130:131], v11 offset:17152
v_mfma_f32_16x16x32_bf16 v[168:171], a[136:139], a[28:31], v[168:171]
v_mfma_f32_16x16x32_bf16 v[172:175], a[140:143], a[28:31], v[172:175]
ds_read_b64_tr_b16 a[132:133], v11 offset:16928
v_mfma_f32_16x16x32_bf16 v[140:143], a[140:143], a[24:27], v[140:143]
s_add_u32 s66, s66, 262144
v_mfma_f32_16x16x32_bf16 v[108:111], a[140:143], a[20:23], v[108:111]
ds_read_b64_tr_b16 a[134:135], v11 offset:17184
v_mfma_f32_16x16x32_bf16 v[76:79], a[140:143], a[16:19], v[76:79]
buffer_load_dwordx4 a[0:3], v14, s[44:47], s66 offen offset:0 sc1
s_waitcnt lgkmcnt(8)
v_mfma_f32_16x16x32_bf16 v[80:83], a[144:147], a[16:19], v[80:83]
ds_read_b64_tr_b16 a[136:137], v11 offset:16960
v_mfma_f32_16x16x32_bf16 v[112:115], a[144:147], a[20:23], v[112:115]
buffer_load_dwordx4 a[4:7], v14, s[44:47], s66 offen offset:2048 sc1
v_mfma_f32_16x16x32_bf16 v[144:147], a[144:147], a[24:27], v[144:147]
ds_read_b64_tr_b16 a[138:139], v11 offset:17216
v_mfma_f32_16x16x32_bf16 v[176:179], a[144:147], a[28:31], v[176:179]
v_mfma_f32_16x16x32_bf16 v[180:183], a[148:151], a[28:31], v[180:183]
ds_read_b64_tr_b16 a[140:141], v11 offset:16992
v_mfma_f32_16x16x32_bf16 v[148:151], a[148:151], a[24:27], v[148:151]
v_mfma_f32_16x16x32_bf16 v[116:119], a[148:151], a[20:23], v[116:119]
ds_read_b64_tr_b16 a[142:143], v11 offset:17248
v_mfma_f32_16x16x32_bf16 v[84:87], a[148:151], a[16:19], v[84:87]
buffer_load_dwordx4 a[8:11], v15, s[44:47], s66 offen offset:0 sc1
s_waitcnt lgkmcnt(8)
v_mfma_f32_16x16x32_bf16 v[88:91], a[152:155], a[16:19], v[88:91]
ds_read_b64_tr_b16 a[144:145], v11 offset:17024
v_mfma_f32_16x16x32_bf16 v[120:123], a[152:155], a[20:23], v[120:123]
v_mfma_f32_16x16x32_bf16 v[152:155], a[152:155], a[24:27], v[152:155]
ds_read_b64_tr_b16 a[146:147], v11 offset:17280
v_mfma_f32_16x16x32_bf16 v[184:187], a[152:155], a[28:31], v[184:187]
v_mfma_f32_16x16x32_bf16 v[188:191], a[156:159], a[28:31], v[188:191]
ds_read_b64_tr_b16 a[148:149], v11 offset:17056
v_mfma_f32_16x16x32_bf16 v[156:159], a[156:159], a[24:27], v[156:159]
buffer_load_dwordx4 a[12:15], v15, s[44:47], s66 offen offset:2048 sc1
v_mfma_f32_16x16x32_bf16 v[124:127], a[156:159], a[20:23], v[124:127]
ds_read_b64_tr_b16 a[150:151], v11 offset:17312
v_mfma_f32_16x16x32_bf16 v[92:95], a[156:159], a[16:19], v[92:95]
s_waitcnt vmcnt(12)
s_waitcnt lgkmcnt(8)
v_mfma_f32_16x16x32_bf16 v[64:67], a[128:131], a[32:35], v[64:67]
ds_read_b64_tr_b16 a[152:153], v11 offset:17088
v_mfma_f32_16x16x32_bf16 v[96:99], a[128:131], a[36:39], v[96:99]
s_add_u32 s64, s64, 124928
s_add_u32 m0, s65, 50688
v_mfma_f32_16x16x32_bf16 v[128:131], a[128:131], a[40:43], v[128:131]
ds_read_b64_tr_b16 a[154:155], v11 offset:17344
v_mfma_f32_16x16x32_bf16 v[160:163], a[128:131], a[44:47], v[160:163]
buffer_load_dwordx4 v4, s[40:43], s64 offen lds
v_mfma_f32_16x16x32_bf16 v[164:167], a[132:135], a[44:47], v[164:167]
ds_read_b64_tr_b16 a[156:157], v11 offset:17120
v_mfma_f32_16x16x32_bf16 v[132:135], a[132:135], a[40:43], v[132:135]
v_mfma_f32_16x16x32_bf16 v[100:103], a[132:135], a[36:39], v[100:103]
ds_read_b64_tr_b16 a[158:159], v11 offset:17376
v_mfma_f32_16x16x32_bf16 v[68:71], a[132:135], a[32:35], v[68:71]
s_add_u32 s64, s64, 2048
s_add_u32 m0, s65, 51744
s_waitcnt lgkmcnt(8)
v_mfma_f32_16x16x32_bf16 v[72:75], a[136:139], a[32:35], v[72:75]
ds_read_b64_tr_b16 a[128:129], v11 offset:17408
v_mfma_f32_16x16x32_bf16 v[104:107], a[136:139], a[36:39], v[104:107]
buffer_load_dwordx4 v4, s[40:43], s64 offen lds
v_mfma_f32_16x16x32_bf16 v[136:139], a[136:139], a[40:43], v[136:139]
ds_read_b64_tr_b16 a[130:131], v11 offset:17664
v_mfma_f32_16x16x32_bf16 v[168:171], a[136:139], a[44:47], v[168:171]
v_mfma_f32_16x16x32_bf16 v[172:175], a[140:143], a[44:47], v[172:175]
ds_read_b64_tr_b16 a[132:133], v11 offset:17440
v_mfma_f32_16x16x32_bf16 v[140:143], a[140:143], a[40:43], v[140:143]
buffer_load_dwordx4 a[16:19], v14, s[44:47], s66 offen offset:1024 sc1
v_mfma_f32_16x16x32_bf16 v[108:111], a[140:143], a[36:39], v[108:111]
ds_read_b64_tr_b16 a[134:135], v11 offset:17696
v_mfma_f32_16x16x32_bf16 v[76:79], a[140:143], a[32:35], v[76:79]
s_waitcnt lgkmcnt(8)
v_mfma_f32_16x16x32_bf16 v[80:83], a[144:147], a[32:35], v[80:83]
ds_read_b64_tr_b16 a[136:137], v11 offset:17472
v_mfma_f32_16x16x32_bf16 v[112:115], a[144:147], a[36:39], v[112:115]
buffer_load_dwordx4 a[20:23], v14, s[44:47], s66 offen offset:3072 sc1
v_mfma_f32_16x16x32_bf16 v[144:147], a[144:147], a[40:43], v[144:147]
ds_read_b64_tr_b16 a[138:139], v11 offset:17728
v_mfma_f32_16x16x32_bf16 v[176:179], a[144:147], a[44:47], v[176:179]
v_mfma_f32_16x16x32_bf16 v[180:183], a[148:151], a[44:47], v[180:183]
ds_read_b64_tr_b16 a[140:141], v11 offset:17504
v_mfma_f32_16x16x32_bf16 v[148:151], a[148:151], a[40:43], v[148:151]
v_mfma_f32_16x16x32_bf16 v[116:119], a[148:151], a[36:39], v[116:119]
ds_read_b64_tr_b16 a[142:143], v11 offset:17760
v_mfma_f32_16x16x32_bf16 v[84:87], a[148:151], a[32:35], v[84:87]
buffer_load_dwordx4 a[24:27], v15, s[44:47], s66 offen offset:1024 sc1
s_waitcnt lgkmcnt(8)
v_mfma_f32_16x16x32_bf16 v[88:91], a[152:155], a[32:35], v[88:91]
ds_read_b64_tr_b16 a[144:145], v11 offset:17536
v_mfma_f32_16x16x32_bf16 v[120:123], a[152:155], a[36:39], v[120:123]
v_mfma_f32_16x16x32_bf16 v[152:155], a[152:155], a[40:43], v[152:155]
ds_read_b64_tr_b16 a[146:147], v11 offset:17792
v_mfma_f32_16x16x32_bf16 v[184:187], a[152:155], a[44:47], v[184:187]
v_mfma_f32_16x16x32_bf16 v[188:191], a[156:159], a[44:47], v[188:191]
ds_read_b64_tr_b16 a[148:149], v11 offset:17568
v_mfma_f32_16x16x32_bf16 v[156:159], a[156:159], a[40:43], v[156:159]
buffer_load_dwordx4 a[28:31], v15, s[44:47], s66 offen offset:3072 sc1
v_mfma_f32_16x16x32_bf16 v[124:127], a[156:159], a[36:39], v[124:127]
ds_read_b64_tr_b16 a[150:151], v11 offset:17824
v_mfma_f32_16x16x32_bf16 v[92:95], a[156:159], a[32:35], v[92:95]
s_waitcnt vmcnt(12)
s_waitcnt lgkmcnt(8)
v_mfma_f32_16x16x32_bf16 v[64:67], a[128:131], a[48:51], v[64:67]
ds_read_b64_tr_b16 a[152:153], v11 offset:17600
v_mfma_f32_16x16x32_bf16 v[96:99], a[128:131], a[52:55], v[96:99]
s_add_u32 s64, s64, 2048
s_add_u32 m0, s65, 52800
v_mfma_f32_16x16x32_bf16 v[128:131], a[128:131], a[56:59], v[128:131]
ds_read_b64_tr_b16 a[154:155], v11 offset:17856
v_mfma_f32_16x16x32_bf16 v[160:163], a[128:131], a[60:63], v[160:163]
buffer_load_dwordx4 v4, s[40:43], s64 offen lds
v_mfma_f32_16x16x32_bf16 v[164:167], a[132:135], a[60:63], v[164:167]
ds_read_b64_tr_b16 a[156:157], v11 offset:17632
v_mfma_f32_16x16x32_bf16 v[132:135], a[132:135], a[56:59], v[132:135]
v_mfma_f32_16x16x32_bf16 v[100:103], a[132:135], a[52:55], v[100:103]
ds_read_b64_tr_b16 a[158:159], v11 offset:17888
v_mfma_f32_16x16x32_bf16 v[68:71], a[132:135], a[48:51], v[68:71]
s_add_u32 s64, s64, 2048
s_add_u32 m0, s65, 53856
s_waitcnt lgkmcnt(8)
s_waitcnt vmcnt(11)
s_barrier
v_mfma_f32_16x16x32_bf16 v[72:75], a[136:139], a[48:51], v[72:75]
ds_read_b64_tr_b16 a[128:129], v11 offset:33792
v_mfma_f32_16x16x32_bf16 v[104:107], a[136:139], a[52:55], v[104:107]
buffer_load_dwordx4 v4, s[40:43], s64 offen lds
v_mfma_f32_16x16x32_bf16 v[136:139], a[136:139], a[56:59], v[136:139]
ds_read_b64_tr_b16 a[130:131], v11 offset:34048
v_mfma_f32_16x16x32_bf16 v[168:171], a[136:139], a[60:63], v[168:171]
v_mfma_f32_16x16x32_bf16 v[172:175], a[140:143], a[60:63], v[172:175]
ds_read_b64_tr_b16 a[132:133], v11 offset:33824
v_mfma_f32_16x16x32_bf16 v[140:143], a[140:143], a[56:59], v[140:143]
s_add_u32 s66, s66, 262144
v_mfma_f32_16x16x32_bf16 v[108:111], a[140:143], a[52:55], v[108:111]
ds_read_b64_tr_b16 a[134:135], v11 offset:34080
v_mfma_f32_16x16x32_bf16 v[76:79], a[140:143], a[48:51], v[76:79]
buffer_load_dwordx4 a[32:35], v14, s[44:47], s66 offen offset:0 sc1
s_waitcnt lgkmcnt(8)
v_mfma_f32_16x16x32_bf16 v[80:83], a[144:147], a[48:51], v[80:83]
ds_read_b64_tr_b16 a[136:137], v11 offset:33856
v_mfma_f32_16x16x32_bf16 v[112:115], a[144:147], a[52:55], v[112:115]
buffer_load_dwordx4 a[36:39], v14, s[44:47], s66 offen offset:2048 sc1
v_mfma_f32_16x16x32_bf16 v[144:147], a[144:147], a[56:59], v[144:147]
ds_read_b64_tr_b16 a[138:139], v11 offset:34112
v_mfma_f32_16x16x32_bf16 v[176:179], a[144:147], a[60:63], v[176:179]
v_mfma_f32_16x16x32_bf16 v[180:183], a[148:151], a[60:63], v[180:183]
ds_read_b64_tr_b16 a[140:141], v11 offset:33888
v_mfma_f32_16x16x32_bf16 v[148:151], a[148:151], a[56:59], v[148:151]
v_mfma_f32_16x16x32_bf16 v[116:119], a[148:151], a[52:55], v[116:119]
ds_read_b64_tr_b16 a[142:143], v11 offset:34144
v_mfma_f32_16x16x32_bf16 v[84:87], a[148:151], a[48:51], v[84:87]
buffer_load_dwordx4 a[40:43], v15, s[44:47], s66 offen offset:0 sc1
s_waitcnt lgkmcnt(8)
v_mfma_f32_16x16x32_bf16 v[88:91], a[152:155], a[48:51], v[88:91]
ds_read_b64_tr_b16 a[144:145], v11 offset:33920
v_mfma_f32_16x16x32_bf16 v[120:123], a[152:155], a[52:55], v[120:123]
v_mfma_f32_16x16x32_bf16 v[152:155], a[152:155], a[56:59], v[152:155]
ds_read_b64_tr_b16 a[146:147], v11 offset:34176
v_mfma_f32_16x16x32_bf16 v[184:187], a[152:155], a[60:63], v[184:187]
v_mfma_f32_16x16x32_bf16 v[188:191], a[156:159], a[60:63], v[188:191]
ds_read_b64_tr_b16 a[148:149], v11 offset:33952
v_mfma_f32_16x16x32_bf16 v[156:159], a[156:159], a[56:59], v[156:159]
buffer_load_dwordx4 a[44:47], v15, s[44:47], s66 offen offset:2048 sc1
v_mfma_f32_16x16x32_bf16 v[124:127], a[156:159], a[52:55], v[124:127]
ds_read_b64_tr_b16 a[150:151], v11 offset:34208
v_mfma_f32_16x16x32_bf16 v[92:95], a[156:159], a[48:51], v[92:95]
s_waitcnt vmcnt(12)
s_waitcnt lgkmcnt(8)
v_mfma_f32_16x16x32_bf16 v[64:67], a[128:131], a[0:3], v[64:67]
ds_read_b64_tr_b16 a[152:153], v11 offset:33984
v_mfma_f32_16x16x32_bf16 v[96:99], a[128:131], a[4:7], v[96:99]
s_add_u32 s64, s64, 124928
s_add_u32 m0, s65, 0
v_mfma_f32_16x16x32_bf16 v[128:131], a[128:131], a[8:11], v[128:131]
ds_read_b64_tr_b16 a[154:155], v11 offset:34240
v_mfma_f32_16x16x32_bf16 v[160:163], a[128:131], a[12:15], v[160:163]
buffer_load_dwordx4 v4, s[40:43], s64 offen lds
v_mfma_f32_16x16x32_bf16 v[164:167], a[132:135], a[12:15], v[164:167]
ds_read_b64_tr_b16 a[156:157], v11 offset:34016
v_mfma_f32_16x16x32_bf16 v[132:135], a[132:135], a[8:11], v[132:135]
v_mfma_f32_16x16x32_bf16 v[100:103], a[132:135], a[4:7], v[100:103]
ds_read_b64_tr_b16 a[158:159], v11 offset:34272
v_mfma_f32_16x16x32_bf16 v[68:71], a[132:135], a[0:3], v[68:71]
s_add_u32 s64, s64, 2048
s_add_u32 m0, s65, 1056
s_waitcnt lgkmcnt(8)
v_mfma_f32_16x16x32_bf16 v[72:75], a[136:139], a[0:3], v[72:75]
ds_read_b64_tr_b16 a[128:129], v11 offset:34304
v_mfma_f32_16x16x32_bf16 v[104:107], a[136:139], a[4:7], v[104:107]
buffer_load_dwordx4 v4, s[40:43], s64 offen lds
v_mfma_f32_16x16x32_bf16 v[136:139], a[136:139], a[8:11], v[136:139]
ds_read_b64_tr_b16 a[130:131], v11 offset:34560
v_mfma_f32_16x16x32_bf16 v[168:171], a[136:139], a[12:15], v[168:171]
v_mfma_f32_16x16x32_bf16 v[172:175], a[140:143], a[12:15], v[172:175]
ds_read_b64_tr_b16 a[132:133], v11 offset:34336
v_mfma_f32_16x16x32_bf16 v[140:143], a[140:143], a[8:11], v[140:143]
buffer_load_dwordx4 a[48:51], v14, s[44:47], s66 offen offset:1024 sc1
v_mfma_f32_16x16x32_bf16 v[108:111], a[140:143], a[4:7], v[108:111]
ds_read_b64_tr_b16 a[134:135], v11 offset:34592
v_mfma_f32_16x16x32_bf16 v[76:79], a[140:143], a[0:3], v[76:79]
s_waitcnt lgkmcnt(8)
v_mfma_f32_16x16x32_bf16 v[80:83], a[144:147], a[0:3], v[80:83]
ds_read_b64_tr_b16 a[136:137], v11 offset:34368
v_mfma_f32_16x16x32_bf16 v[112:115], a[144:147], a[4:7], v[112:115]
buffer_load_dwordx4 a[52:55], v14, s[44:47], s66 offen offset:3072 sc1
v_mfma_f32_16x16x32_bf16 v[144:147], a[144:147], a[8:11], v[144:147]
ds_read_b64_tr_b16 a[138:139], v11 offset:34624
v_mfma_f32_16x16x32_bf16 v[176:179], a[144:147], a[12:15], v[176:179]
v_mfma_f32_16x16x32_bf16 v[180:183], a[148:151], a[12:15], v[180:183]
ds_read_b64_tr_b16 a[140:141], v11 offset:34400
v_mfma_f32_16x16x32_bf16 v[148:151], a[148:151], a[8:11], v[148:151]
v_mfma_f32_16x16x32_bf16 v[116:119], a[148:151], a[4:7], v[116:119]
ds_read_b64_tr_b16 a[142:143], v11 offset:34656
v_mfma_f32_16x16x32_bf16 v[84:87], a[148:151], a[0:3], v[84:87]
buffer_load_dwordx4 a[56:59], v15, s[44:47], s66 offen offset:1024 sc1
s_waitcnt lgkmcnt(8)
v_mfma_f32_16x16x32_bf16 v[88:91], a[152:155], a[0:3], v[88:91]
ds_read_b64_tr_b16 a[144:145], v11 offset:34432
v_mfma_f32_16x16x32_bf16 v[120:123], a[152:155], a[4:7], v[120:123]
v_mfma_f32_16x16x32_bf16 v[152:155], a[152:155], a[8:11], v[152:155]
ds_read_b64_tr_b16 a[146:147], v11 offset:34688
v_mfma_f32_16x16x32_bf16 v[184:187], a[152:155], a[12:15], v[184:187]
v_mfma_f32_16x16x32_bf16 v[188:191], a[156:159], a[12:15], v[188:191]
ds_read_b64_tr_b16 a[148:149], v11 offset:34464
v_mfma_f32_16x16x32_bf16 v[156:159], a[156:159], a[8:11], v[156:159]
buffer_load_dwordx4 a[60:63], v15, s[44:47], s66 offen offset:3072 sc1
v_mfma_f32_16x16x32_bf16 v[124:127], a[156:159], a[4:7], v[124:127]
ds_read_b64_tr_b16 a[150:151], v11 offset:34720
v_mfma_f32_16x16x32_bf16 v[92:95], a[156:159], a[0:3], v[92:95]
s_waitcnt vmcnt(12)
s_waitcnt lgkmcnt(8)
v_mfma_f32_16x16x32_bf16 v[64:67], a[128:131], a[16:19], v[64:67]
ds_read_b64_tr_b16 a[152:153], v11 offset:34496
v_mfma_f32_16x16x32_bf16 v[96:99], a[128:131], a[20:23], v[96:99]
s_add_u32 s64, s64, 2048
s_add_u32 m0, s65, 2112
v_mfma_f32_16x16x32_bf16 v[128:131], a[128:131], a[24:27], v[128:131]
ds_read_b64_tr_b16 a[154:155], v11 offset:34752
v_mfma_f32_16x16x32_bf16 v[160:163], a[128:131], a[28:31], v[160:163]
buffer_load_dwordx4 v4, s[40:43], s64 offen lds
v_mfma_f32_16x16x32_bf16 v[164:167], a[132:135], a[28:31], v[164:167]
ds_read_b64_tr_b16 a[156:157], v11 offset:34528
v_mfma_f32_16x16x32_bf16 v[132:135], a[132:135], a[24:27], v[132:135]
v_mfma_f32_16x16x32_bf16 v[100:103], a[132:135], a[20:23], v[100:103]
ds_read_b64_tr_b16 a[158:159], v11 offset:34784
v_mfma_f32_16x16x32_bf16 v[68:71], a[132:135], a[16:19], v[68:71]
s_add_u32 s64, s64, 2048
s_add_u32 m0, s65, 3168
s_waitcnt lgkmcnt(8)
s_waitcnt vmcnt(11)
s_barrier
v_mfma_f32_16x16x32_bf16 v[72:75], a[136:139], a[16:19], v[72:75]
ds_read_b64_tr_b16 a[128:129], v11 offset:50688
v_mfma_f32_16x16x32_bf16 v[104:107], a[136:139], a[20:23], v[104:107]
buffer_load_dwordx4 v4, s[40:43], s64 offen lds
v_mfma_f32_16x16x32_bf16 v[136:139], a[136:139], a[24:27], v[136:139]
ds_read_b64_tr_b16 a[130:131], v11 offset:50944
v_mfma_f32_16x16x32_bf16 v[168:171], a[136:139], a[28:31], v[168:171]
v_mfma_f32_16x16x32_bf16 v[172:175], a[140:143], a[28:31], v[172:175]
ds_read_b64_tr_b16 a[132:133], v11 offset:50720
v_mfma_f32_16x16x32_bf16 v[140:143], a[140:143], a[24:27], v[140:143]
s_add_u32 s66, s66, 262144
v_mfma_f32_16x16x32_bf16 v[108:111], a[140:143], a[20:23], v[108:111]
ds_read_b64_tr_b16 a[134:135], v11 offset:50976
v_mfma_f32_16x16x32_bf16 v[76:79], a[140:143], a[16:19], v[76:79]
buffer_load_dwordx4 a[0:3], v14, s[44:47], s66 offen offset:0 sc1
s_waitcnt lgkmcnt(8)
v_mfma_f32_16x16x32_bf16 v[80:83], a[144:147], a[16:19], v[80:83]
ds_read_b64_tr_b16 a[136:137], v11 offset:50752
v_mfma_f32_16x16x32_bf16 v[112:115], a[144:147], a[20:23], v[112:115]
buffer_load_dwordx4 a[4:7], v14, s[44:47], s66 offen offset:2048 sc1
v_mfma_f32_16x16x32_bf16 v[144:147], a[144:147], a[24:27], v[144:147]
ds_read_b64_tr_b16 a[138:139], v11 offset:51008
v_mfma_f32_16x16x32_bf16 v[176:179], a[144:147], a[28:31], v[176:179]
v_mfma_f32_16x16x32_bf16 v[180:183], a[148:151], a[28:31], v[180:183]
ds_read_b64_tr_b16 a[140:141], v11 offset:50784
v_mfma_f32_16x16x32_bf16 v[148:151], a[148:151], a[24:27], v[148:151]
v_mfma_f32_16x16x32_bf16 v[116:119], a[148:151], a[20:23], v[116:119]
ds_read_b64_tr_b16 a[142:143], v11 offset:51040
v_mfma_f32_16x16x32_bf16 v[84:87], a[148:151], a[16:19], v[84:87]
buffer_load_dwordx4 a[8:11], v15, s[44:47], s66 offen offset:0 sc1
s_waitcnt lgkmcnt(8)
v_mfma_f32_16x16x32_bf16 v[88:91], a[152:155], a[16:19], v[88:91]
ds_read_b64_tr_b16 a[144:145], v11 offset:50816
v_mfma_f32_16x16x32_bf16 v[120:123], a[152:155], a[20:23], v[120:123]
v_mfma_f32_16x16x32_bf16 v[152:155], a[152:155], a[24:27], v[152:155]
ds_read_b64_tr_b16 a[146:147], v11 offset:51072
v_mfma_f32_16x16x32_bf16 v[184:187], a[152:155], a[28:31], v[184:187]
v_mfma_f32_16x16x32_bf16 v[188:191], a[156:159], a[28:31], v[188:191]
ds_read_b64_tr_b16 a[148:149], v11 offset:50848
v_mfma_f32_16x16x32_bf16 v[156:159], a[156:159], a[24:27], v[156:159]
buffer_load_dwordx4 a[12:15], v15, s[44:47], s66 offen offset:2048 sc1
v_mfma_f32_16x16x32_bf16 v[124:127], a[156:159], a[20:23], v[124:127]
ds_read_b64_tr_b16 a[150:151], v11 offset:51104
v_mfma_f32_16x16x32_bf16 v[92:95], a[156:159], a[16:19], v[92:95]
s_waitcnt vmcnt(12)
s_waitcnt lgkmcnt(8)
v_mfma_f32_16x16x32_bf16 v[64:67], a[128:131], a[32:35], v[64:67]
ds_read_b64_tr_b16 a[152:153], v11 offset:50880
v_mfma_f32_16x16x32_bf16 v[96:99], a[128:131], a[36:39], v[96:99]
s_add_u32 s64, s64, 124928
s_add_u32 m0, s65, 16896
v_mfma_f32_16x16x32_bf16 v[128:131], a[128:131], a[40:43], v[128:131]
ds_read_b64_tr_b16 a[154:155], v11 offset:51136
v_mfma_f32_16x16x32_bf16 v[160:163], a[128:131], a[44:47], v[160:163]
buffer_load_dwordx4 v4, s[40:43], s64 offen lds
v_mfma_f32_16x16x32_bf16 v[164:167], a[132:135], a[44:47], v[164:167]
ds_read_b64_tr_b16 a[156:157], v11 offset:50912
v_mfma_f32_16x16x32_bf16 v[132:135], a[132:135], a[40:43], v[132:135]
v_mfma_f32_16x16x32_bf16 v[100:103], a[132:135], a[36:39], v[100:103]
ds_read_b64_tr_b16 a[158:159], v11 offset:51168
v_mfma_f32_16x16x32_bf16 v[68:71], a[132:135], a[32:35], v[68:71]
s_add_u32 s64, s64, 2048
s_add_u32 m0, s65, 17952
s_waitcnt lgkmcnt(8)
v_mfma_f32_16x16x32_bf16 v[72:75], a[136:139], a[32:35], v[72:75]
ds_read_b64_tr_b16 a[128:129], v11 offset:51200
v_mfma_f32_16x16x32_bf16 v[104:107], a[136:139], a[36:39], v[104:107]
buffer_load_dwordx4 v4, s[40:43], s64 offen lds
v_mfma_f32_16x16x32_bf16 v[136:139], a[136:139], a[40:43], v[136:139]
ds_read_b64_tr_b16 a[130:131], v11 offset:51456
v_mfma_f32_16x16x32_bf16 v[168:171], a[136:139], a[44:47], v[168:171]
v_mfma_f32_16x16x32_bf16 v[172:175], a[140:143], a[44:47], v[172:175]
ds_read_b64_tr_b16 a[132:133], v11 offset:51232
v_mfma_f32_16x16x32_bf16 v[140:143], a[140:143], a[40:43], v[140:143]
buffer_load_dwordx4 a[16:19], v14, s[44:47], s66 offen offset:1024 sc1
v_mfma_f32_16x16x32_bf16 v[108:111], a[140:143], a[36:39], v[108:111]
ds_read_b64_tr_b16 a[134:135], v11 offset:51488
v_mfma_f32_16x16x32_bf16 v[76:79], a[140:143], a[32:35], v[76:79]
s_waitcnt lgkmcnt(8)
v_mfma_f32_16x16x32_bf16 v[80:83], a[144:147], a[32:35], v[80:83]
ds_read_b64_tr_b16 a[136:137], v11 offset:51264
v_mfma_f32_16x16x32_bf16 v[112:115], a[144:147], a[36:39], v[112:115]
buffer_load_dwordx4 a[20:23], v14, s[44:47], s66 offen offset:3072 sc1
v_mfma_f32_16x16x32_bf16 v[144:147], a[144:147], a[40:43], v[144:147]
ds_read_b64_tr_b16 a[138:139], v11 offset:51520
v_mfma_f32_16x16x32_bf16 v[176:179], a[144:147], a[44:47], v[176:179]
v_mfma_f32_16x16x32_bf16 v[180:183], a[148:151], a[44:47], v[180:183]
ds_read_b64_tr_b16 a[140:141], v11 offset:51296
v_mfma_f32_16x16x32_bf16 v[148:151], a[148:151], a[40:43], v[148:151]
v_mfma_f32_16x16x32_bf16 v[116:119], a[148:151], a[36:39], v[116:119]
ds_read_b64_tr_b16 a[142:143], v11 offset:51552
v_mfma_f32_16x16x32_bf16 v[84:87], a[148:151], a[32:35], v[84:87]
buffer_load_dwordx4 a[24:27], v15, s[44:47], s66 offen offset:1024 sc1
s_waitcnt lgkmcnt(8)
v_mfma_f32_16x16x32_bf16 v[88:91], a[152:155], a[32:35], v[88:91]
ds_read_b64_tr_b16 a[144:145], v11 offset:51328
v_mfma_f32_16x16x32_bf16 v[120:123], a[152:155], a[36:39], v[120:123]
v_mfma_f32_16x16x32_bf16 v[152:155], a[152:155], a[40:43], v[152:155]
ds_read_b64_tr_b16 a[146:147], v11 offset:51584
v_mfma_f32_16x16x32_bf16 v[184:187], a[152:155], a[44:47], v[184:187]
v_mfma_f32_16x16x32_bf16 v[188:191], a[156:159], a[44:47], v[188:191]
ds_read_b64_tr_b16 a[148:149], v11 offset:51360
v_mfma_f32_16x16x32_bf16 v[156:159], a[156:159], a[40:43], v[156:159]
buffer_load_dwordx4 a[28:31], v15, s[44:47], s66 offen offset:3072 sc1
v_mfma_f32_16x16x32_bf16 v[124:127], a[156:159], a[36:39], v[124:127]
ds_read_b64_tr_b16 a[150:151], v11 offset:51616
v_mfma_f32_16x16x32_bf16 v[92:95], a[156:159], a[32:35], v[92:95]
s_waitcnt vmcnt(12)
s_waitcnt lgkmcnt(8)
v_mfma_f32_16x16x32_bf16 v[64:67], a[128:131], a[48:51], v[64:67]
ds_read_b64_tr_b16 a[152:153], v11 offset:51392
v_mfma_f32_16x16x32_bf16 v[96:99], a[128:131], a[52:55], v[96:99]
s_add_u32 s64, s64, 2048
s_add_u32 m0, s65, 19008
v_mfma_f32_16x16x32_bf16 v[128:131], a[128:131], a[56:59], v[128:131]
ds_read_b64_tr_b16 a[154:155], v11 offset:51648
v_mfma_f32_16x16x32_bf16 v[160:163], a[128:131], a[60:63], v[160:163]
buffer_load_dwordx4 v4, s[40:43], s64 offen lds
v_mfma_f32_16x16x32_bf16 v[164:167], a[132:135], a[60:63], v[164:167]
ds_read_b64_tr_b16 a[156:157], v11 offset:51424
v_mfma_f32_16x16x32_bf16 v[132:135], a[132:135], a[56:59], v[132:135]
v_mfma_f32_16x16x32_bf16 v[100:103], a[132:135], a[52:55], v[100:103]
ds_read_b64_tr_b16 a[158:159], v11 offset:51680
v_mfma_f32_16x16x32_bf16 v[68:71], a[132:135], a[48:51], v[68:71]
s_add_u32 s64, s64, 2048
s_add_u32 m0, s65, 20064
s_waitcnt lgkmcnt(8)
s_waitcnt vmcnt(11)
s_barrier
v_mfma_f32_16x16x32_bf16 v[72:75], a[136:139], a[48:51], v[72:75]
ds_read_b64_tr_b16 a[128:129], v11 offset:0
v_mfma_f32_16x16x32_bf16 v[104:107], a[136:139], a[52:55], v[104:107]
buffer_load_dwordx4 v4, s[40:43], s64 offen lds
v_mfma_f32_16x16x32_bf16 v[136:139], a[136:139], a[56:59], v[136:139]
ds_read_b64_tr_b16 a[130:131], v11 offset:256
v_mfma_f32_16x16x32_bf16 v[168:171], a[136:139], a[60:63], v[168:171]
v_mfma_f32_16x16x32_bf16 v[172:175], a[140:143], a[60:63], v[172:175]
ds_read_b64_tr_b16 a[132:133], v11 offset:32
v_mfma_f32_16x16x32_bf16 v[140:143], a[140:143], a[56:59], v[140:143]
s_add_u32 s66, s66, 262144
v_mfma_f32_16x16x32_bf16 v[108:111], a[140:143], a[52:55], v[108:111]
ds_read_b64_tr_b16 a[134:135], v11 offset:288
v_mfma_f32_16x16x32_bf16 v[76:79], a[140:143], a[48:51], v[76:79]
buffer_load_dwordx4 a[32:35], v14, s[44:47], s66 offen offset:0 sc1
s_waitcnt lgkmcnt(8)
v_mfma_f32_16x16x32_bf16 v[80:83], a[144:147], a[48:51], v[80:83]
ds_read_b64_tr_b16 a[136:137], v11 offset:64
v_mfma_f32_16x16x32_bf16 v[112:115], a[144:147], a[52:55], v[112:115]
buffer_load_dwordx4 a[36:39], v14, s[44:47], s66 offen offset:2048 sc1
v_mfma_f32_16x16x32_bf16 v[144:147], a[144:147], a[56:59], v[144:147]
ds_read_b64_tr_b16 a[138:139], v11 offset:320
v_mfma_f32_16x16x32_bf16 v[176:179], a[144:147], a[60:63], v[176:179]
v_mfma_f32_16x16x32_bf16 v[180:183], a[148:151], a[60:63], v[180:183]
ds_read_b64_tr_b16 a[140:141], v11 offset:96
v_mfma_f32_16x16x32_bf16 v[148:151], a[148:151], a[56:59], v[148:151]
v_mfma_f32_16x16x32_bf16 v[116:119], a[148:151], a[52:55], v[116:119]
ds_read_b64_tr_b16 a[142:143], v11 offset:352
v_mfma_f32_16x16x32_bf16 v[84:87], a[148:151], a[48:51], v[84:87]
buffer_load_dwordx4 a[40:43], v15, s[44:47], s66 offen offset:0 sc1
s_waitcnt lgkmcnt(8)
v_mfma_f32_16x16x32_bf16 v[88:91], a[152:155], a[48:51], v[88:91]
ds_read_b64_tr_b16 a[144:145], v11 offset:128
v_mfma_f32_16x16x32_bf16 v[120:123], a[152:155], a[52:55], v[120:123]
v_mfma_f32_16x16x32_bf16 v[152:155], a[152:155], a[56:59], v[152:155]
ds_read_b64_tr_b16 a[146:147], v11 offset:384
v_mfma_f32_16x16x32_bf16 v[184:187], a[152:155], a[60:63], v[184:187]
v_mfma_f32_16x16x32_bf16 v[188:191], a[156:159], a[60:63], v[188:191]
ds_read_b64_tr_b16 a[148:149], v11 offset:160
v_mfma_f32_16x16x32_bf16 v[156:159], a[156:159], a[56:59], v[156:159]
buffer_load_dwordx4 a[44:47], v15, s[44:47], s66 offen offset:2048 sc1
v_mfma_f32_16x16x32_bf16 v[124:127], a[156:159], a[52:55], v[124:127]
ds_read_b64_tr_b16 a[150:151], v11 offset:416
v_mfma_f32_16x16x32_bf16 v[92:95], a[156:159], a[48:51], v[92:95]
s_sub_u32 s29, s29, 1
s_cmp_lg_u32 s29, 0
s_cbranch_scc1 L_loop_d
s_waitcnt vmcnt(12)
s_waitcnt lgkmcnt(8)
v_mfma_f32_16x16x32_bf16 v[64:67], a[128:131], a[0:3], v[64:67]
ds_read_b64_tr_b16 a[152:153], v11 offset:192
v_mfma_f32_16x16x32_bf16 v[96:99], a[128:131], a[4:7], v[96:99]
v_mfma_f32_16x16x32_bf16 v[128:131], a[128:131], a[8:11], v[128:131]
ds_read_b64_tr_b16 a[154:155], v11 offset:448
v_mfma_f32_16x16x32_bf16 v[160:163], a[128:131], a[12:15], v[160:163]
buffer_load_dwordx4 a[48:51], v14, s[44:47], s66 offen offset:1024 sc1
v_mfma_f32_16x16x32_bf16 v[164:167], a[132:135], a[12:15], v[164:167]
ds_read_b64_tr_b16 a[156:157], v11 offset:224
v_mfma_f32_16x16x32_bf16 v[132:135], a[132:135], a[8:11], v[132:135]
v_mfma_f32_16x16x32_bf16 v[100:103], a[132:135], a[4:7], v[100:103]
ds_read_b64_tr_b16 a[158:159], v11 offset:480
v_mfma_f32_16x16x32_bf16 v[68:71], a[132:135], a[0:3], v[68:71]
s_waitcnt lgkmcnt(8)
v_mfma_f32_16x16x32_bf16 v[72:75], a[136:139], a[0:3], v[72:75]
ds_read_b64_tr_b16 a[128:129], v11 offset:512
v_mfma_f32_16x16x32_bf16 v[104:107], a[136:139], a[4:7], v[104:107]
v_mfma_f32_16x16x32_bf16 v[136:139], a[136:139], a[8:11], v[136:139]
ds_read_b64_tr_b16 a[130:131], v11 offset:768
v_mfma_f32_16x16x32_bf16 v[168:171], a[136:139], a[12:15], v[168:171]
buffer_load_dwordx4 a[52:55], v14, s[44:47], s66 offen offset:3072 sc1
v_mfma_f32_16x16x32_bf16 v[172:175], a[140:143], a[12:15], v[172:175]
ds_read_b64_tr_b16 a[132:133], v11 offset:544
v_mfma_f32_16x16x32_bf16 v[140:143], a[140:143], a[8:11], v[140:143]
v_mfma_f32_16x16x32_bf16 v[108:111], a[140:143], a[4:7], v[108:111]
ds_read_b64_tr_b16 a[134:135], v11 offset:800
v_mfma_f32_16x16x32_bf16 v[76:79], a[140:143], a[0:3], v[76:79]
s_waitcnt lgkmcnt(8)
v_mfma_f32_16x16x32_bf16 v[80:83], a[144:147], a[0:3], v[80:83]
ds_read_b64_tr_b16 a[136:137], v11 offset:576
v_mfma_f32_16x16x32_bf16 v[112:115], a[144:147], a[4:7], v[112:115]
v_mfma_f32_16x16x32_bf16 v[144:147], a[144:147], a[8:11], v[144:147]
ds_read_b64_tr_b16 a[138:139], v11 offset:832
v_mfma_f32_16x16x32_bf16 v[176:179], a[144:147], a[12:15], v[176:179]
buffer_load_dwordx4 a[56:59], v15, s[44:47], s66 offen offset:1024 sc1
v_mfma_f32_16x16x32_bf16 v[180:183], a[148:151], a[12:15], v[180:183]
ds_read_b64_tr_b16 a[140:141], v11 offset:608
v_mfma_f32_16x16x32_bf16 v[148:151], a[148:151], a[8:11], v[148:151]
v_mfma_f32_16x16x32_bf16 v[116:119], a[148:151], a[4:7], v[116:119]
ds_read_b64_tr_b16 a[142:143], v11 offset:864
v_mfma_f32_16x16x32_bf16 v[84:87], a[148:151], a[0:3], v[84:87]
s_waitcnt lgkmcnt(8)
v_mfma_f32_16x16x32_bf16 v[88:91], a[152:155], a[0:3], v[88:91]
ds_read_b64_tr_b16 a[144:145], v11 offset:640
v_mfma_f32_16x16x32_bf16 v[120:123], a[152:155], a[4:7], v[120:123]
v_mfma_f32_16x16x32_bf16 v[152:155], a[152:155], a[8:11], v[152:155]
ds_read_b64_tr_b16 a[146:147], v11 offset:896
v_mfma_f32_16x16x32_bf16 v[184:187], a[152:155], a[12:15], v[184:187]
buffer_load_dwordx4 a[60:63], v15, s[44:47], s66 offen offset:3072 sc1
v_mfma_f32_16x16x32_bf16 v[188:191], a[156:159], a[12:15], v[188:191]
ds_read_b64_tr_b16 a[148:149], v11 offset:672
v_mfma_f32_16x16x32_bf16 v[156:159], a[156:159], a[8:11], v[156:159]
v_mfma_f32_16x16x32_bf16 v[124:127], a[156:159], a[4:7], v[124:127]
ds_read_b64_tr_b16 a[150:151], v11 offset:928
v_mfma_f32_16x16x32_bf16 v[92:95], a[156:159], a[0:3], v[92:95]
s_waitcnt vmcnt(10)
s_waitcnt lgkmcnt(8)
v_mfma_f32_16x16x32_bf16 v[64:67], a[128:131], a[16:19], v[64:67]
ds_read_b64_tr_b16 a[152:153], v11 offset:704
v_mfma_f32_16x16x32_bf16 v[96:99], a[128:131], a[20:23], v[96:99]
v_mfma_f32_16x16x32_bf16 v[128:131], a[128:131], a[24:27], v[128:131]
ds_read_b64_tr_b16 a[154:155], v11 offset:960
v_mfma_f32_16x16x32_bf16 v[160:163], a[128:131], a[28:31], v[160:163]
v_mfma_f32_16x16x32_bf16 v[164:167], a[132:135], a[28:31], v[164:167]
ds_read_b64_tr_b16 a[156:157], v11 offset:736
v_mfma_f32_16x16x32_bf16 v[132:135], a[132:135], a[24:27], v[132:135]
v_mfma_f32_16x16x32_bf16 v[100:103], a[132:135], a[20:23], v[100:103]
ds_read_b64_tr_b16 a[158:159], v11 offset:992
v_mfma_f32_16x16x32_bf16 v[68:71], a[132:135], a[16:19], v[68:71]
s_waitcnt lgkmcnt(8)
s_waitcnt vmcnt(8)
s_barrier
v_mfma_f32_16x16x32_bf16 v[72:75], a[136:139], a[16:19], v[72:75]
ds_read_b64_tr_b16 a[128:129], v11 offset:16896
v_mfma_f32_16x16x32_bf16 v[104:107], a[136:139], a[20:23], v[104:107]
v_mfma_f32_16x16x32_bf16 v[136:139], a[136:139], a[24:27], v[136:139]
ds_read_b64_tr_b16 a[130:131], v11 offset:17152
v_mfma_f32_16x16x32_bf16 v[168:171], a[136:139], a[28:31], v[168:171]
v_mfma_f32_16x16x32_bf16 v[172:175], a[140:143], a[28:31], v[172:175]
ds_read_b64_tr_b16 a[132:133], v11 offset:16928
v_mfma_f32_16x16x32_bf16 v[140:143], a[140:143], a[24:27], v[140:143]
v_mfma_f32_16x16x32_bf16 v[108:111], a[140:143], a[20:23], v[108:111]
ds_read_b64_tr_b16 a[134:135], v11 offset:17184
v_mfma_f32_16x16x32_bf16 v[76:79], a[140:143], a[16:19], v[76:79]
s_waitcnt lgkmcnt(8)
v_mfma_f32_16x16x32_bf16 v[80:83], a[144:147], a[16:19], v[80:83]
ds_read_b64_tr_b16 a[136:137], v11 offset:16960
v_mfma_f32_16x16x32_bf16 v[112:115], a[144:147], a[20:23], v[112:115]
v_mfma_f32_16x16x32_bf16 v[144:147], a[144:147], a[24:27], v[144:147]
ds_read_b64_tr_b16 a[138:139], v11 offset:17216
v_mfma_f32_16x16x32_bf16 v[176:179], a[144:147], a[28:31], v[176:179]
v_mfma_f32_16x16x32_bf16 v[180:183], a[148:151], a[28:31], v[180:183]
ds_read_b64_tr_b16 a[140:141], v11 offset:16992
v_mfma_f32_16x16x32_bf16 v[148:151], a[148:151], a[24:27], v[148:151]
v_mfma_f32_16x16x32_bf16 v[116:119], a[148:151], a[20:23], v[116:119]
ds_read_b64_tr_b16 a[142:143], v11 offset:17248
v_mfma_f32_16x16x32_bf16 v[84:87], a[148:151], a[16:19], v[84:87]
s_waitcnt lgkmcnt(8)
v_mfma_f32_16x16x32_bf16 v[88:91], a[152:155], a[16:19], v[88:91]
ds_read_b64_tr_b16 a[144:145], v11 offset:17024
v_mfma_f32_16x16x32_bf16 v[120:123], a[152:155], a[20:23], v[120:123]
v_mfma_f32_16x16x32_bf16 v[152:155], a[152:155], a[24:27], v[152:155]
ds_read_b64_tr_b16 a[146:147], v11 offset:17280
v_mfma_f32_16x16x32_bf16 v[184:187], a[152:155], a[28:31], v[184:187]
v_mfma_f32_16x16x32_bf16 v[188:191], a[156:159], a[28:31], v[188:191]
ds_read_b64_tr_b16 a[148:149], v11 offset:17056
v_mfma_f32_16x16x32_bf16 v[156:159], a[156:159], a[24:27], v[156:159]
v_mfma_f32_16x16x32_bf16 v[124:127], a[156:159], a[20:23], v[124:127]
ds_read_b64_tr_b16 a[150:151], v11 offset:17312
v_mfma_f32_16x16x32_bf16 v[92:95], a[156:159], a[16:19], v[92:95]
s_waitcnt vmcnt(4)
s_waitcnt lgkmcnt(8)
v_mfma_f32_16x16x32_bf16 v[64:67], a[128:131], a[32:35], v[64:67]
ds_read_b64_tr_b16 a[152:153], v11 offset:17088
v_mfma_f32_16x16x32_bf16 v[96:99], a[128:131], a[36:39], v[96:99]
v_mfma_f32_16x16x32_bf16 v[128:131], a[128:131], a[40:43], v[128:131]
ds_read_b64_tr_b16 a[154:155], v11 offset:17344
v_mfma_f32_16x16x32_bf16 v[160:163], a[128:131], a[44:47], v[160:163]
v_mfma_f32_16x16x32_bf16 v[164:167], a[132:135], a[44:47], v[164:167]
ds_read_b64_tr_b16 a[156:157], v11 offset:17120
v_mfma_f32_16x16x32_bf16 v[132:135], a[132:135], a[40:43], v[132:135]
v_mfma_f32_16x16x32_bf16 v[100:103], a[132:135], a[36:39], v[100:103]
ds_read_b64_tr_b16 a[158:159], v11 offset:17376
v_mfma_f32_16x16x32_bf16 v[68:71], a[132:135], a[32:35], v[68:71]
s_waitcnt lgkmcnt(8)
v_mfma_f32_16x16x32_bf16 v[72:75], a[136:139], a[32:35], v[72:75]
ds_read_b64_tr_b16 a[128:129], v11 offset:17408
v_mfma_f32_16x16x32_bf16 v[104:107], a[136:139], a[36:39], v[104:107]
v_mfma_f32_16x16x32_bf16 v[136:139], a[136:139], a[40:43], v[136:139]
ds_read_b64_tr_b16 a[130:131], v11 offset:17664
v_mfma_f32_16x16x32_bf16 v[168:171], a[136:139], a[44:47], v[168:171]
v_mfma_f32_16x16x32_bf16 v[172:175], a[140:143], a[44:47], v[172:175]
ds_read_b64_tr_b16 a[132:133], v11 offset:17440
v_mfma_f32_16x16x32_bf16 v[140:143], a[140:143], a[40:43], v[140:143]
v_mfma_f32_16x16x32_bf16 v[108:111], a[140:143], a[36:39], v[108:111]
ds_read_b64_tr_b16 a[134:135], v11 offset:17696
v_mfma_f32_16x16x32_bf16 v[76:79], a[140:143], a[32:35], v[76:79]
s_waitcnt lgkmcnt(8)
v_mfma_f32_16x16x32_bf16 v[80:83], a[144:147], a[32:35], v[80:83]
ds_read_b64_tr_b16 a[136:137], v11 offset:17472
v_mfma_f32_16x16x32_bf16 v[112:115], a[144:147], a[36:39], v[112:115]
v_mfma_f32_16x16x32_bf16 v[144:147], a[144:147], a[40:43], v[144:147]
ds_read_b64_tr_b16 a[138:139], v11 offset:17728
v_mfma_f32_16x16x32_bf16 v[176:179], a[144:147], a[44:47], v[176:179]
v_mfma_f32_16x16x32_bf16 v[180:183], a[148:151], a[44:47], v[180:183]
ds_read_b64_tr_b16 a[140:141], v11 offset:17504
v_mfma_f32_16x16x32_bf16 v[148:151], a[148:151], a[40:43], v[148:151]
v_mfma_f32_16x16x32_bf16 v[116:119], a[148:151], a[36:39], v[116:119]
ds_read_b64_tr_b16 a[142:143], v11 offset:17760
v_mfma_f32_16x16x32_bf16 v[84:87], a[148:151], a[32:35], v[84:87]
s_waitcnt lgkmcnt(8)
v_mfma_f32_16x16x32_bf16 v[88:91], a[152:155], a[32:35], v[88:91]
ds_read_b64_tr_b16 a[144:145], v11 offset:17536
v_mfma_f32_16x16x32_bf16 v[120:123], a[152:155], a[36:39], v[120:123]
v_mfma_f32_16x16x32_bf16 v[152:155], a[152:155], a[40:43], v[152:155]
ds_read_b64_tr_b16 a[146:147], v11 offset:17792
v_mfma_f32_16x16x32_bf16 v[184:187], a[152:155], a[44:47], v[184:187]
v_mfma_f32_16x16x32_bf16 v[188:191], a[156:159], a[44:47], v[188:191]
ds_read_b64_tr_b16 a[148:149], v11 offset:17568
v_mfma_f32_16x16x32_bf16 v[156:159], a[156:159], a[40:43], v[156:159]
v_mfma_f32_16x16x32_bf16 v[124:127], a[156:159], a[36:39], v[124:127]
ds_read_b64_tr_b16 a[150:151], v11 offset:17824
v_mfma_f32_16x16x32_bf16 v[92:95], a[156:159], a[32:35], v[92:95]
s_waitcnt vmcnt(0)
s_waitcnt lgkmcnt(8)
v_mfma_f32_16x16x32_bf16 v[64:67], a[128:131], a[48:51], v[64:67]
ds_read_b64_tr_b16 a[152:153], v11 offset:17600
v_mfma_f32_16x16x32_bf16 v[96:99], a[128:131], a[52:55], v[96:99]
v_mfma_f32_16x16x32_bf16 v[128:131], a[128:131], a[56:59], v[128:131]
ds_read_b64_tr_b16 a[154:155], v11 offset:17856
v_mfma_f32_16x16x32_bf16 v[160:163], a[128:131], a[60:63], v[160:163]
v_mfma_f32_16x16x32_bf16 v[164:167], a[132:135], a[60:63], v[164:167]
ds_read_b64_tr_b16 a[156:157], v11 offset:17632
v_mfma_f32_16x16x32_bf16 v[132:135], a[132:135], a[56:59], v[132:135]
v_mfma_f32_16x16x32_bf16 v[100:103], a[132:135], a[52:55], v[100:103]
ds_read_b64_tr_b16 a[158:159], v11 offset:17888
v_mfma_f32_16x16x32_bf16 v[68:71], a[132:135], a[48:51], v[68:71]
s_waitcnt lgkmcnt(8)
v_mfma_f32_16x16x32_bf16 v[72:75], a[136:139], a[48:51], v[72:75]
v_mfma_f32_16x16x32_bf16 v[104:107], a[136:139], a[52:55], v[104:107]
v_mfma_f32_16x16x32_bf16 v[136:139], a[136:139], a[56:59], v[136:139]
v_mfma_f32_16x16x32_bf16 v[168:171], a[136:139], a[60:63], v[168:171]
v_mfma_f32_16x16x32_bf16 v[172:175], a[140:143], a[60:63], v[172:175]
v_mfma_f32_16x16x32_bf16 v[140:143], a[140:143], a[56:59], v[140:143]
v_mfma_f32_16x16x32_bf16 v[108:111], a[140:143], a[52:55], v[108:111]
v_mfma_f32_16x16x32_bf16 v[76:79], a[140:143], a[48:51], v[76:79]
s_waitcnt lgkmcnt(4)
v_mfma_f32_16x16x32_bf16 v[80:83], a[144:147], a[48:51], v[80:83]
v_mfma_f32_16x16x32_bf16 v[112:115], a[144:147], a[52:55], v[112:115]
v_mfma_f32_16x16x32_bf16 v[144:147], a[144:147], a[56:59], v[144:147]
v_mfma_f32_16x16x32_bf16 v[176:179], a[144:147], a[60:63], v[176:179]
v_mfma_f32_16x16x32_bf16 v[180:183], a[148:151], a[60:63], v[180:183]
v_mfma_f32_16x16x32_bf16 v[148:151], a[148:151], a[56:59], v[148:151]
v_mfma_f32_16x16x32_bf16 v[116:119], a[148:151], a[52:55], v[116:119]
v_mfma_f32_16x16x32_bf16 v[84:87], a[148:151], a[48:51], v[84:87]
s_waitcnt lgkmcnt(0)
v_mfma_f32_16x16x32_bf16 v[88:91], a[152:155], a[48:51], v[88:91]
v_mfma_f32_16x16x32_bf16 v[120:123], a[152:155], a[52:55], v[120:123]
v_mfma_f32_16x16x32_bf16 v[152:155], a[152:155], a[56:59], v[152:155]
v_mfma_f32_16x16x32_bf16 v[184:187], a[152:155], a[60:63], v[184:187]
v_mfma_f32_16x16x32_bf16 v[188:191], a[156:159], a[60:63], v[188:191]
v_mfma_f32_16x16x32_bf16 v[156:159], a[156:159], a[56:59], v[156:159]
v_mfma_f32_16x16x32_bf16 v[124:127], a[156:159], a[52:55], v[124:127]
v_mfma_f32_16x16x32_bf16 v[92:95], a[156:159], a[48:51], v[92:95]
s_nop 7
v_cvt_pk_bf16_f32 v72, v72, v73
v_cvt_pk_bf16_f32 v73, v74, v75
v_cvt_pk_bf16_f32 v74, v76, v77
v_cvt_pk_bf16_f32 v75, v78, v79
buffer_store_dwordx4 v[72:75], v63, s[48:51], s75 offen offset:0 sc1
v_cvt_pk_bf16_f32 v104, v104, v105
v_cvt_pk_bf16_f32 v105, v106, v107
v_cvt_pk_bf16_f32 v106, v108, v109
v_cvt_pk_bf16_f32 v107, v110, v111
buffer_store_dwordx4 v[104:107], v63, s[48:51], s75 offen offset:1024 sc1
v_cvt_pk_bf16_f32 v136, v136, v137
v_cvt_pk_bf16_f32 v137, v138, v139
v_cvt_pk_bf16_f32 v138, v140, v141
v_cvt_pk_bf16_f32 v139, v142, v143
buffer_store_dwordx4 v[136:139], v63, s[48:51], s75 offen offset:2048 sc1
v_cvt_pk_bf16_f32 v168, v168, v169
v_cvt_pk_bf16_f32 v169, v170, v171
v_cvt_pk_bf16_f32 v170, v172, v173
v_cvt_pk_bf16_f32 v171, v174, v175
buffer_store_dwordx4 v[168:171], v63, s[48:51], s75 offen offset:3072 sc1
v_cvt_pk_bf16_f32 v80, v80, v81
v_cvt_pk_bf16_f32 v81, v82, v83
v_cvt_pk_bf16_f32 v82, v84, v85
v_cvt_pk_bf16_f32 v83, v86, v87
buffer_store_dwordx4 v[80:83], v63, s[48:51], s76 offen offset:0 sc1
v_cvt_pk_bf16_f32 v112, v112, v113
v_cvt_pk_bf16_f32 v113, v114, v115
v_cvt_pk_bf16_f32 v114, v116, v117
v_cvt_pk_bf16_f32 v115, v118, v119
buffer_store_dwordx4 v[112:115], v63, s[48:51], s76 offen offset:1024 sc1
v_cvt_pk_bf16_f32 v144, v144, v145
v_cvt_pk_bf16_f32 v145, v146, v147
v_cvt_pk_bf16_f32 v146, v148, v149
v_cvt_pk_bf16_f32 v147, v150, v151
buffer_store_dwordx4 v[144:147], v63, s[48:51], s76 offen offset:2048 sc1
v_cvt_pk_bf16_f32 v176, v176, v177
v_cvt_pk_bf16_f32 v177, v178, v179
v_cvt_pk_bf16_f32 v178, v180, v181
v_cvt_pk_bf16_f32 v179, v182, v183
buffer_store_dwordx4 v[176:179], v63, s[48:51], s76 offen offset:3072 sc1
v_cvt_pk_bf16_f32 v88, v88, v89
v_cvt_pk_bf16_f32 v89, v90, v91
v_cvt_pk_bf16_f32 v90, v92, v93
v_cvt_pk_bf16_f32 v91, v94, v95
buffer_store_dwordx4 v[88:91], v63, s[48:51], s77 offen offset:0 sc1
v_cvt_pk_bf16_f32 v120, v120, v121
v_cvt_pk_bf16_f32 v121, v122, v123
v_cvt_pk_bf16_f32 v122, v124, v125
v_cvt_pk_bf16_f32 v123, v126, v127
buffer_store_dwordx4 v[120:123], v63, s[48:51], s77 offen offset:1024 sc1
v_cvt_pk_bf16_f32 v152, v152, v153
v_cvt_pk_bf16_f32 v153, v154, v155
v_cvt_pk_bf16_f32 v154, v156, v157
v_cvt_pk_bf16_f32 v155, v158, v159
buffer_store_dwordx4 v[152:155], v63, s[48:51], s77 offen offset:2048 sc1
v_cvt_pk_bf16_f32 v184, v184, v185
v_cvt_pk_bf16_f32 v185, v186, v187
v_cvt_pk_bf16_f32 v186, v188, v189
v_cvt_pk_bf16_f32 v187, v190, v191
buffer_store_dwordx4 v[184:187], v63, s[48:51], s77 offen offset:3072 sc1
s_add_u32 s52, s22, 46137344
s_addc_u32 s53, s23, 0
s_mov_b32 s54, 4194304
s_mov_b32 s55, 0x20000
s_lshl_b32 s30, s68, 2
s_add_u32 s71, s30, s67
s_lshr_b32 s30, s71, 1
s_lshl_b32 s30, s30, 18
s_and_b32 s31, s71, 1
s_lshl_b32 s31, s31, 10
s_add_u32 s30, s30, s31
s_mov_b32 s74, s30
s_add_u32 s56, s22, 76546048
s_addc_u32 s57, s23, 0
s_mov_b32 s58, 98304
s_mov_b32 s59, 0x20000
v_lshrrev_b32 v17, 4, v1
v_lshlrev_b32 v17, 4, v17
s_lshl_b32 s30, s71, 7
v_add_u32 v17, s30, v17
s_mov_b32 s30, 20480
buffer_load_dwordx4 v[28:31], v17, s[56:59], s30 offen sc1
buffer_load_dwordx4 v[32:35], v17, s[56:59], s30 offen offset:64 sc1
s_mov_b32 s30, 45056
buffer_load_dwordx4 v[36:39], v17, s[56:59], s30 offen sc1
buffer_load_dwordx4 v[40:43], v17, s[56:59], s30 offen offset:64 sc1
s_mov_b32 s30, 69632
buffer_load_dwordx4 v[44:47], v17, s[56:59], s30 offen sc1
buffer_load_dwordx4 v[48:51], v17, s[56:59], s30 offen offset:64 sc1
s_mov_b32 s30, 94208
buffer_load_dwordx4 v[52:55], v17, s[56:59], s30 offen sc1
buffer_load_dwordx4 v[56:59], v17, s[56:59], s30 offen offset:64 sc1
s_mov_b32 s60, s20
s_mov_b32 s61, s21
s_mov_b32 s62, 4194304
s_mov_b32 s63, 0x20000
s_lshl_b32 s30, s25, 8
s_lshl_b32 s31, s24, 6
s_add_u32 s30, s30, s31
v_and_b32 v18, 15, v1
v_add_u32 v18, s30, v18
v_lshlrev_b32 v18, 11, v18
v_lshrrev_b32 v19, 4, v1
v_lshlrev_b32 v19, 3, v19
s_lshl_b32 s30, s71, 6
v_add3_u32 v18, v18, v19, s30
s_waitcnt vmcnt(0)
v_pk_add_f32 v[28:29], v[28:29], v[36:37]
v_pk_add_f32 v[44:45], v[44:45], v[52:53]
v_pk_add_f32 v[30:31], v[30:31], v[38:39]
v_pk_add_f32 v[46:47], v[46:47], v[54:55]
v_pk_add_f32 v[32:33], v[32:33], v[40:41]
v_pk_add_f32 v[48:49], v[48:49], v[56:57]
v_pk_add_f32 v[34:35], v[34:35], v[42:43]
v_pk_add_f32 v[50:51], v[50:51], v[58:59]
v_pk_add_f32 v[20:21], v[28:29], v[44:45]
v_pk_add_f32 v[22:23], v[30:31], v[46:47]
v_pk_add_f32 v[24:25], v[32:33], v[48:49]
v_pk_add_f32 v[26:27], v[34:35], v[50:51]
v_mul_f32 v20, 0x3ef5fdf0, v20
v_mul_f32 v21, 0x3ef5fdf0, v21
v_mul_f32 v22, 0x3ef5fdf0, v22
v_mul_f32 v23, 0x3ef5fdf0, v23
v_mul_f32 v24, 0x3ef5fdf0, v24
v_mul_f32 v25, 0x3ef5fdf0, v25
v_mul_f32 v26, 0x3ef5fdf0, v26
v_mul_f32 v27, 0x3ef5fdf0, v27
s_mov_b32 s72, 0x00003f80
s_mov_b32 s73, 0x3f800000
s_add_u32 s30, s70, s67
s_mul_i32 s30, s30, 3
s_lshl_b32 s69, s30, 14
s_waitcnt vmcnt(0)
s_barrier
s_cmp_lg_u32 s24, 0
s_cbranch_scc1 L_sig27
s_lshl_b32 s33, s25, 3
s_add_u32 s33, s33, 320
s_add_u32 s33, s33, s68
s_lshl_b32 s33, s33, 7
v_mov_b32 v2, s33
v_mov_b32 v3, 1
s_mov_b64 exec, 1
global_atomic_add v2, v3, s[34:35]
s_mov_b64 exec, -1
L_sig27:
s_cmp_lg_u32 s24, 0
s_cbranch_scc1 L_wt28
s_lshl_b32 s33, s25, 3
s_add_u32 s33, s33, 320
s_add_u32 s33, s33, s68
s_lshl_b32 s33, s33, 7
v_mov_b32 v2, s33
s_mov_b32 s32, 1048576
L_poll29:
global_load_dword v3, v2, s[34:35] sc1
s_waitcnt vmcnt(0)
v_readfirstlane_b32 s31, v3
s_nop 0
s_cmp_ge_u32 s31, 4
s_cbranch_scc1 L_pd30
s_sub_u32 s32, s32, 1
s_cmp_eq_u32 s32, 0
s_cbranch_scc1 L_pd30
s_sleep 2
s_branch L_poll29
L_pd30:
L_wt28:
s_barrier
buffer_load_dwordx4 v[240:243], v14, s[52:55], s74 offen offset:0 sc1
buffer_load_dwordx4 v[244:247], v14, s[52:55], s74 offen offset:2048 sc1
buffer_load_dwordx4 v[248:251], v15, s[52:55], s74 offen offset:0 sc1
buffer_load_dwordx4 v[252:255], v15, s[52:55], s74 offen offset:2048 sc1
buffer_load_dwordx4 v[192:195], v63, s[48:51], s69 offen offset:0 sc1
buffer_load_dwordx4 v[196:199], v63, s[48:51], s69 offen offset:1024 sc1
buffer_load_dwordx4 v[200:203], v63, s[48:51], s69 offen offset:2048 sc1
buffer_load_dwordx4 v[204:207], v63, s[48:51], s69 offen offset:3072 sc1
s_add_u32 s69, s69, 16384
buffer_load_dwordx4 v[208:211], v63, s[48:51], s69 offen offset:0 sc1
buffer_load_dwordx4 v[212:215], v63, s[48:51], s69 offen offset:1024 sc1
buffer_load_dwordx4 v[216:219], v63, s[48:51], s69 offen offset:2048 sc1
buffer_load_dwordx4 v[220:223], v63, s[48:51], s69 offen offset:3072 sc1
s_add_u32 s69, s69, 16384
buffer_load_dwordx4 v[224:227], v63, s[48:51], s69 offen offset:0 sc1
buffer_load_dwordx4 v[228:231], v63, s[48:51], s69 offen offset:1024 sc1
buffer_load_dwordx4 v[232:235], v63, s[48:51], s69 offen offset:2048 sc1
buffer_load_dwordx4 v[236:239], v63, s[48:51], s69 offen offset:3072 sc1
s_mov_b32 s31, 32768
s_waitcnt vmcnt(11)
v_dot2_f32_bf16 v64, v192, s72, v64
v_dot2_f32_bf16 v65, v192, s73, v65
v_dot2_f32_bf16 v66, v193, s72, v66
v_dot2_f32_bf16 v67, v193, s73, v67
v_dot2_f32_bf16 v68, v194, s72, v68
v_dot2_f32_bf16 v69, v194, s73, v69
v_dot2_f32_bf16 v70, v195, s72, v70
v_dot2_f32_bf16 v71, v195, s73, v71
s_waitcnt vmcnt(7)
v_dot2_f32_bf16 v64, v208, s72, v64
v_dot2_f32_bf16 v65, v208, s73, v65
v_dot2_f32_bf16 v66, v209, s72, v66
v_dot2_f32_bf16 v67, v209, s73, v67
v_dot2_f32_bf16 v68, v210, s72, v68
v_dot2_f32_bf16 v69, v210, s73, v69
v_dot2_f32_bf16 v70, v211, s72, v70
v_dot2_f32_bf16 v71, v211, s73, v71
s_waitcnt vmcnt(3)
v_dot2_f32_bf16 v64, v224, s72, v64
v_dot2_f32_bf16 v65, v224, s73, v65
v_dot2_f32_bf16 v66, v225, s72, v66
v_dot2_f32_bf16 v67, v225, s73, v67
v_dot2_f32_bf16 v68, v226, s72, v68
v_dot2_f32_bf16 v69, v226, s73, v69
v_dot2_f32_bf16 v70, v227, s72, v70
v_dot2_f32_bf16 v71, v227, s73, v71
v_lshlrev_b32 v60, 16, v240
v_and_b32 v61, 0xffff0000, v240
v_pk_fma_f32 v[64:65], v[64:65], v[20:21], v[60:61]
v_lshlrev_b32 v60, 16, v241
v_and_b32 v61, 0xffff0000, v241
v_pk_fma_f32 v[66:67], v[66:67], v[22:23], v[60:61]
v_lshlrev_b32 v60, 16, v242
v_and_b32 v61, 0xffff0000, v242
v_pk_fma_f32 v[68:69], v[68:69], v[24:25], v[60:61]
v_lshlrev_b32 v60, 16, v243
v_and_b32 v61, 0xffff0000, v243
v_pk_fma_f32 v[70:71], v[70:71], v[26:27], v[60:61]
v_cvt_pk_bf16_f32 v64, v64, v65
v_cvt_pk_bf16_f32 v65, v66, v67
v_cvt_pk_bf16_f32 v66, v68, v69
v_cvt_pk_bf16_f32 v67, v70, v71
buffer_store_dwordx2 v[64:65], v18, s[60:63], 0 offen
buffer_store_dwordx2 v[66:67], v18, s[60:63], 0 offen offset:32
s_waitcnt vmcnt(12)
v_dot2_f32_bf16 v96, v196, s72, v96
v_dot2_f32_bf16 v97, v196, s73, v97
v_dot2_f32_bf16 v98, v197, s72, v98
v_dot2_f32_bf16 v99, v197, s73, v99
v_dot2_f32_bf16 v100, v198, s72, v100
v_dot2_f32_bf16 v101, v198, s73, v101
v_dot2_f32_bf16 v102, v199, s72, v102
v_dot2_f32_bf16 v103, v199, s73, v103
s_waitcnt vmcnt(8)
v_dot2_f32_bf16 v96, v212, s72, v96
v_dot2_f32_bf16 v97, v212, s73, v97
v_dot2_f32_bf16 v98, v213, s72, v98
v_dot2_f32_bf16 v99, v213, s73, v99
v_dot2_f32_bf16 v100, v214, s72, v100
v_dot2_f32_bf16 v101, v214, s73, v101
v_dot2_f32_bf16 v102, v215, s72, v102
v_dot2_f32_bf16 v103, v215, s73, v103
s_waitcnt vmcnt(4)
v_dot2_f32_bf16 v96, v228, s72, v96
v_dot2_f32_bf16 v97, v228, s73, v97
v_dot2_f32_bf16 v98, v229, s72, v98
v_dot2_f32_bf16 v99, v229, s73, v99
v_dot2_f32_bf16 v100, v230, s72, v100
v_dot2_f32_bf16 v101, v230, s73, v101
v_dot2_f32_bf16 v102, v231, s72, v102
v_dot2_f32_bf16 v103, v231, s73, v103
v_lshlrev_b32 v60, 16, v244
v_and_b32 v61, 0xffff0000, v244
v_pk_fma_f32 v[96:97], v[96:97], v[20:21], v[60:61]
v_lshlrev_b32 v60, 16, v245
v_and_b32 v61, 0xffff0000, v245
v_pk_fma_f32 v[98:99], v[98:99], v[22:23], v[60:61]
v_lshlrev_b32 v60, 16, v246
v_and_b32 v61, 0xffff0000, v246
v_pk_fma_f32 v[100:101], v[100:101], v[24:25], v[60:61]
v_lshlrev_b32 v60, 16, v247
v_and_b32 v61, 0xffff0000, v247
v_pk_fma_f32 v[102:103], v[102:103], v[26:27], v[60:61]
v_cvt_pk_bf16_f32 v96, v96, v97
v_cvt_pk_bf16_f32 v97, v98, v99
v_cvt_pk_bf16_f32 v98, v100, v101
v_cvt_pk_bf16_f32 v99, v102, v103
buffer_store_dwordx2 v[96:97], v18, s[60:63], s31 offen
buffer_store_dwordx2 v[98:99], v18, s[60:63], s31 offen offset:32
s_waitcnt vmcnt(13)
v_dot2_f32_bf16 v128, v200, s72, v128
v_dot2_f32_bf16 v129, v200, s73, v129
v_dot2_f32_bf16 v130, v201, s72, v130
v_dot2_f32_bf16 v131, v201, s73, v131
v_dot2_f32_bf16 v132, v202, s72, v132
v_dot2_f32_bf16 v133, v202, s73, v133
v_dot2_f32_bf16 v134, v203, s72, v134
v_dot2_f32_bf16 v135, v203, s73, v135
s_waitcnt vmcnt(9)
v_dot2_f32_bf16 v128, v216, s72, v128
v_dot2_f32_bf16 v129, v216, s73, v129
v_dot2_f32_bf16 v130, v217, s72, v130
v_dot2_f32_bf16 v131, v217, s73, v131
v_dot2_f32_bf16 v132, v218, s72, v132
v_dot2_f32_bf16 v133, v218, s73, v133
v_dot2_f32_bf16 v134, v219, s72, v134
v_dot2_f32_bf16 v135, v219, s73, v135
s_waitcnt vmcnt(5)
v_dot2_f32_bf16 v128, v232, s72, v128
v_dot2_f32_bf16 v129, v232, s73, v129
v_dot2_f32_bf16 v130, v233, s72, v130
v_dot2_f32_bf16 v131, v233, s73, v131
v_dot2_f32_bf16 v132, v234, s72, v132
v_dot2_f32_bf16 v133, v234, s73, v133
v_dot2_f32_bf16 v134, v235, s72, v134
v_dot2_f32_bf16 v135, v235, s73, v135
v_lshlrev_b32 v60, 16, v248
v_and_b32 v61, 0xffff0000, v248
v_pk_fma_f32 v[128:129], v[128:129], v[20:21], v[60:61]
v_lshlrev_b32 v60, 16, v249
v_and_b32 v61, 0xffff0000, v249
v_pk_fma_f32 v[130:131], v[130:131], v[22:23], v[60:61]
v_lshlrev_b32 v60, 16, v250
v_and_b32 v61, 0xffff0000, v250
v_pk_fma_f32 v[132:133], v[132:133], v[24:25], v[60:61]
v_lshlrev_b32 v60, 16, v251
v_and_b32 v61, 0xffff0000, v251
v_pk_fma_f32 v[134:135], v[134:135], v[26:27], v[60:61]
v_cvt_pk_bf16_f32 v128, v128, v129
v_cvt_pk_bf16_f32 v129, v130, v131
v_cvt_pk_bf16_f32 v130, v132, v133
v_cvt_pk_bf16_f32 v131, v134, v135
s_mov_b32 s30, 65536
buffer_store_dwordx2 v[128:129], v18, s[60:63], s30 offen
buffer_store_dwordx2 v[130:131], v18, s[60:63], s30 offen offset:32
s_waitcnt vmcnt(14)
v_dot2_f32_bf16 v160, v204, s72, v160
v_dot2_f32_bf16 v161, v204, s73, v161
v_dot2_f32_bf16 v162, v205, s72, v162
v_dot2_f32_bf16 v163, v205, s73, v163
v_dot2_f32_bf16 v164, v206, s72, v164
v_dot2_f32_bf16 v165, v206, s73, v165
v_dot2_f32_bf16 v166, v207, s72, v166
v_dot2_f32_bf16 v167, v207, s73, v167
s_waitcnt vmcnt(10)
v_dot2_f32_bf16 v160, v220, s72, v160
v_dot2_f32_bf16 v161, v220, s73, v161
v_dot2_f32_bf16 v162, v221, s72, v162
v_dot2_f32_bf16 v163, v221, s73, v163
v_dot2_f32_bf16 v164, v222, s72, v164
v_dot2_f32_bf16 v165, v222, s73, v165
v_dot2_f32_bf16 v166, v223, s72, v166
v_dot2_f32_bf16 v167, v223, s73, v167
s_waitcnt vmcnt(6)
v_dot2_f32_bf16 v160, v236, s72, v160
v_dot2_f32_bf16 v161, v236, s73, v161
v_dot2_f32_bf16 v162, v237, s72, v162
v_dot2_f32_bf16 v163, v237, s73, v163
v_dot2_f32_bf16 v164, v238, s72, v164
v_dot2_f32_bf16 v165, v238, s73, v165
v_dot2_f32_bf16 v166, v239, s72, v166
v_dot2_f32_bf16 v167, v239, s73, v167
v_lshlrev_b32 v60, 16, v252
v_and_b32 v61, 0xffff0000, v252
v_pk_fma_f32 v[160:161], v[160:161], v[20:21], v[60:61]
v_lshlrev_b32 v60, 16, v253
v_and_b32 v61, 0xffff0000, v253
v_pk_fma_f32 v[162:163], v[162:163], v[22:23], v[60:61]
v_lshlrev_b32 v60, 16, v254
v_and_b32 v61, 0xffff0000, v254
v_pk_fma_f32 v[164:165], v[164:165], v[24:25], v[60:61]
v_lshlrev_b32 v60, 16, v255
v_and_b32 v61, 0xffff0000, v255
v_pk_fma_f32 v[166:167], v[166:167], v[26:27], v[60:61]
v_cvt_pk_bf16_f32 v160, v160, v161
v_cvt_pk_bf16_f32 v161, v162, v163
v_cvt_pk_bf16_f32 v162, v164, v165
v_cvt_pk_bf16_f32 v163, v166, v167
s_mov_b32 s30, 98304
buffer_store_dwordx2 v[160:161], v18, s[60:63], s30 offen
buffer_store_dwordx2 v[162:163], v18, s[60:63], s30 offen offset:32
s_endpgm
L_rare0_main_kernel:
s_nop 15
v_max3_f32 v52, v64, v65, v66
v_max3_f32 v52, v52, v67, v80
v_max3_f32 v52, v52, v81, v82
v_max3_f32 v52, v52, v83, v96
v_max3_f32 v52, v52, v97, v98
v_max3_f32 v52, v52, v99, v112
v_max3_f32 v52, v52, v113, v114
v_max_f32 v52, v52, v115
v_mov_b32 v53, v52
s_nop 1
v_permlane32_swap_b32 v52, v53
s_nop 1
v_max_f32 v52, v52, v53
v_mov_b32 v53, v52
s_nop 1
v_permlane16_swap_b32 v52, v53
s_nop 1
v_max_f32 v52, v52, v53
v_add_f32 v52, 0x42b40000, v52
v_max_f32 v52, 0, v52
v_sub_f32 v64, v64, v52
v_sub_f32 v128, v128, v52
v_sub_f32 v65, v65, v52
v_sub_f32 v129, v129, v52
v_sub_f32 v66, v66, v52
v_sub_f32 v130, v130, v52
v_sub_f32 v67, v67, v52
v_sub_f32 v131, v131, v52
v_sub_f32 v80, v80, v52
v_sub_f32 v144, v144, v52
v_sub_f32 v81, v81, v52
v_sub_f32 v145, v145, v52
v_sub_f32 v82, v82, v52
v_sub_f32 v146, v146, v52
v_sub_f32 v83, v83, v52
v_sub_f32 v147, v147, v52
v_sub_f32 v96, v96, v52
v_sub_f32 v160, v160, v52
v_sub_f32 v97, v97, v52
v_sub_f32 v161, v161, v52
v_sub_f32 v98, v98, v52
v_sub_f32 v162, v162, v52
v_sub_f32 v99, v99, v52
v_sub_f32 v163, v163, v52
v_sub_f32 v112, v112, v52
v_sub_f32 v176, v176, v52
v_sub_f32 v113, v113, v52
v_sub_f32 v177, v177, v52
v_sub_f32 v114, v114, v52
v_sub_f32 v178, v178, v52
v_sub_f32 v115, v115, v52
v_sub_f32 v179, v179, v52
v_sub_f32 v32, v32, v52
v_sub_f32 v33, v33, v52
v_sub_f32 v34, v34, v52
v_sub_f32 v35, v35, v52
v_sub_f32 v54, 0, v52
v_exp_f32 v54, v54
s_nop 0
v_accvgpr_read_b32 v53, a0
s_nop 0
v_mul_f32 v53, v53, v54
v_accvgpr_write_b32 a0, v53
v_accvgpr_read_b32 v53, a1
s_nop 0
v_mul_f32 v53, v53, v54
v_accvgpr_write_b32 a1, v53
v_accvgpr_read_b32 v53, a2
s_nop 0
v_mul_f32 v53, v53, v54
v_accvgpr_write_b32 a2, v53
v_accvgpr_read_b32 v53, a3
s_nop 0
v_mul_f32 v53, v53, v54
v_accvgpr_write_b32 a3, v53
v_accvgpr_read_b32 v53, a16
s_nop 0
v_mul_f32 v53, v53, v54
v_accvgpr_write_b32 a16, v53
v_accvgpr_read_b32 v53, a17
s_nop 0
v_mul_f32 v53, v53, v54
v_accvgpr_write_b32 a17, v53
v_accvgpr_read_b32 v53, a18
s_nop 0
v_mul_f32 v53, v53, v54
v_accvgpr_write_b32 a18, v53
v_accvgpr_read_b32 v53, a19
s_nop 0
v_mul_f32 v53, v53, v54
v_accvgpr_write_b32 a19, v53
v_accvgpr_read_b32 v53, a32
s_nop 0
v_mul_f32 v53, v53, v54
v_accvgpr_write_b32 a32, v53
v_accvgpr_read_b32 v53, a33
s_nop 0
v_mul_f32 v53, v53, v54
v_accvgpr_write_b32 a33, v53
v_accvgpr_read_b32 v53, a34
s_nop 0
v_mul_f32 v53, v53, v54
v_accvgpr_write_b32 a34, v53
v_accvgpr_read_b32 v53, a35
s_nop 0
v_mul_f32 v53, v53, v54
v_accvgpr_write_b32 a35, v53
v_accvgpr_read_b32 v53, a48
s_nop 0
v_mul_f32 v53, v53, v54
v_accvgpr_write_b32 a48, v53
v_accvgpr_read_b32 v53, a49
s_nop 0
v_mul_f32 v53, v53, v54
v_accvgpr_write_b32 a49, v53
v_accvgpr_read_b32 v53, a50
s_nop 0
v_mul_f32 v53, v53, v54
v_accvgpr_write_b32 a50, v53
v_accvgpr_read_b32 v53, a51
s_nop 0
v_mul_f32 v53, v53, v54
v_accvgpr_write_b32 a51, v53
v_accvgpr_read_b32 v53, a64
s_nop 0
v_mul_f32 v53, v53, v54
v_accvgpr_write_b32 a64, v53
v_accvgpr_read_b32 v53, a65
s_nop 0
v_mul_f32 v53, v53, v54
v_accvgpr_write_b32 a65, v53
v_accvgpr_read_b32 v53, a66
s_nop 0
v_mul_f32 v53, v53, v54
v_accvgpr_write_b32 a66, v53
v_accvgpr_read_b32 v53, a67
s_nop 0
v_mul_f32 v53, v53, v54
v_accvgpr_write_b32 a67, v53
v_accvgpr_read_b32 v53, a80
s_nop 0
v_mul_f32 v53, v53, v54
v_accvgpr_write_b32 a80, v53
v_accvgpr_read_b32 v53, a81
s_nop 0
v_mul_f32 v53, v53, v54
v_accvgpr_write_b32 a81, v53
v_accvgpr_read_b32 v53, a82
s_nop 0
v_mul_f32 v53, v53, v54
v_accvgpr_write_b32 a82, v53
v_accvgpr_read_b32 v53, a83
s_nop 0
v_mul_f32 v53, v53, v54
v_accvgpr_write_b32 a83, v53
v_accvgpr_read_b32 v53, a96
s_nop 0
v_mul_f32 v53, v53, v54
v_accvgpr_write_b32 a96, v53
v_accvgpr_read_b32 v53, a97
s_nop 0
v_mul_f32 v53, v53, v54
v_accvgpr_write_b32 a97, v53
v_accvgpr_read_b32 v53, a98
s_nop 0
v_mul_f32 v53, v53, v54
v_accvgpr_write_b32 a98, v53
v_accvgpr_read_b32 v53, a99
s_nop 0
v_mul_f32 v53, v53, v54
v_accvgpr_write_b32 a99, v53
v_accvgpr_read_b32 v53, a112
s_nop 0
v_mul_f32 v53, v53, v54
v_accvgpr_write_b32 a112, v53
v_accvgpr_read_b32 v53, a113
s_nop 0
v_mul_f32 v53, v53, v54
v_accvgpr_write_b32 a113, v53
v_accvgpr_read_b32 v53, a114
s_nop 0
v_mul_f32 v53, v53, v54
v_accvgpr_write_b32 a114, v53
v_accvgpr_read_b32 v53, a115
s_nop 0
v_mul_f32 v53, v53, v54
v_accvgpr_write_b32 a115, v53
v_accvgpr_read_b32 v53, a192
s_nop 0
v_mul_f32 v53, v53, v54
v_accvgpr_write_b32 a192, v53
v_accvgpr_read_b32 v53, a193
s_nop 0
v_mul_f32 v53, v53, v54
v_accvgpr_write_b32 a193, v53
v_accvgpr_read_b32 v53, a194
s_nop 0
v_mul_f32 v53, v53, v54
v_accvgpr_write_b32 a194, v53
v_accvgpr_read_b32 v53, a195
s_nop 0
v_mul_f32 v53, v53, v54
v_accvgpr_write_b32 a195, v53
v_max3_f32 v52, v68, v69, v70
v_max3_f32 v52, v52, v71, v84
v_max3_f32 v52, v52, v85, v86
v_max3_f32 v52, v52, v87, v100
v_max3_f32 v52, v52, v101, v102
v_max3_f32 v52, v52, v103, v116
v_max3_f32 v52, v52, v117, v118
v_max_f32 v52, v52, v119
v_mov_b32 v53, v52
s_nop 1
v_permlane32_swap_b32 v52, v53
s_nop 1
v_max_f32 v52, v52, v53
v_mov_b32 v53, v52
s_nop 1
v_permlane16_swap_b32 v52, v53
s_nop 1
v_max_f32 v52, v52, v53
v_add_f32 v52, 0x42b40000, v52
v_max_f32 v52, 0, v52
v_sub_f32 v68, v68, v52
v_sub_f32 v132, v132, v52
v_sub_f32 v69, v69, v52
v_sub_f32 v133, v133, v52
v_sub_f32 v70, v70, v52
v_sub_f32 v134, v134, v52
v_sub_f32 v71, v71, v52
v_sub_f32 v135, v135, v52
v_sub_f32 v84, v84, v52
v_sub_f32 v148, v148, v52
v_sub_f32 v85, v85, v52
v_sub_f32 v149, v149, v52
v_sub_f32 v86, v86, v52
v_sub_f32 v150, v150, v52
v_sub_f32 v87, v87, v52
v_sub_f32 v151, v151, v52
v_sub_f32 v100, v100, v52
v_sub_f32 v164, v164, v52
v_sub_f32 v101, v101, v52
v_sub_f32 v165, v165, v52
v_sub_f32 v102, v102, v52
v_sub_f32 v166, v166, v52
v_sub_f32 v103, v103, v52
v_sub_f32 v167, v167, v52
v_sub_f32 v116, v116, v52
v_sub_f32 v180, v180, v52
v_sub_f32 v117, v117, v52
v_sub_f32 v181, v181, v52
v_sub_f32 v118, v118, v52
v_sub_f32 v182, v182, v52
v_sub_f32 v119, v119, v52
v_sub_f32 v183, v183, v52
v_sub_f32 v36, v36, v52
v_sub_f32 v37, v37, v52
v_sub_f32 v38, v38, v52
v_sub_f32 v39, v39, v52
v_sub_f32 v54, 0, v52
v_exp_f32 v54, v54
s_nop 0
v_accvgpr_read_b32 v53, a4
s_nop 0
v_mul_f32 v53, v53, v54
v_accvgpr_write_b32 a4, v53
v_accvgpr_read_b32 v53, a5
s_nop 0
v_mul_f32 v53, v53, v54
v_accvgpr_write_b32 a5, v53
v_accvgpr_read_b32 v53, a6
s_nop 0
v_mul_f32 v53, v53, v54
v_accvgpr_write_b32 a6, v53
v_accvgpr_read_b32 v53, a7
s_nop 0
v_mul_f32 v53, v53, v54
v_accvgpr_write_b32 a7, v53
v_accvgpr_read_b32 v53, a20
s_nop 0
v_mul_f32 v53, v53, v54
v_accvgpr_write_b32 a20, v53
v_accvgpr_read_b32 v53, a21
s_nop 0
v_mul_f32 v53, v53, v54
v_accvgpr_write_b32 a21, v53
v_accvgpr_read_b32 v53, a22
s_nop 0
v_mul_f32 v53, v53, v54
v_accvgpr_write_b32 a22, v53
v_accvgpr_read_b32 v53, a23
s_nop 0
v_mul_f32 v53, v53, v54
v_accvgpr_write_b32 a23, v53
v_accvgpr_read_b32 v53, a36
s_nop 0
v_mul_f32 v53, v53, v54
v_accvgpr_write_b32 a36, v53
v_accvgpr_read_b32 v53, a37
s_nop 0
v_mul_f32 v53, v53, v54
v_accvgpr_write_b32 a37, v53
v_accvgpr_read_b32 v53, a38
s_nop 0
v_mul_f32 v53, v53, v54
v_accvgpr_write_b32 a38, v53
v_accvgpr_read_b32 v53, a39
s_nop 0
v_mul_f32 v53, v53, v54
v_accvgpr_write_b32 a39, v53
v_accvgpr_read_b32 v53, a52
s_nop 0
v_mul_f32 v53, v53, v54
v_accvgpr_write_b32 a52, v53
v_accvgpr_read_b32 v53, a53
s_nop 0
v_mul_f32 v53, v53, v54
v_accvgpr_write_b32 a53, v53
v_accvgpr_read_b32 v53, a54
s_nop 0
v_mul_f32 v53, v53, v54
v_accvgpr_write_b32 a54, v53
v_accvgpr_read_b32 v53, a55
s_nop 0
v_mul_f32 v53, v53, v54
v_accvgpr_write_b32 a55, v53
v_accvgpr_read_b32 v53, a68
s_nop 0
v_mul_f32 v53, v53, v54
v_accvgpr_write_b32 a68, v53
v_accvgpr_read_b32 v53, a69
s_nop 0
v_mul_f32 v53, v53, v54
v_accvgpr_write_b32 a69, v53
v_accvgpr_read_b32 v53, a70
s_nop 0
v_mul_f32 v53, v53, v54
v_accvgpr_write_b32 a70, v53
v_accvgpr_read_b32 v53, a71
s_nop 0
v_mul_f32 v53, v53, v54
v_accvgpr_write_b32 a71, v53
v_accvgpr_read_b32 v53, a84
s_nop 0
v_mul_f32 v53, v53, v54
v_accvgpr_write_b32 a84, v53
v_accvgpr_read_b32 v53, a85
s_nop 0
v_mul_f32 v53, v53, v54
v_accvgpr_write_b32 a85, v53
v_accvgpr_read_b32 v53, a86
s_nop 0
v_mul_f32 v53, v53, v54
v_accvgpr_write_b32 a86, v53
v_accvgpr_read_b32 v53, a87
s_nop 0
v_mul_f32 v53, v53, v54
v_accvgpr_write_b32 a87, v53
v_accvgpr_read_b32 v53, a100
s_nop 0
v_mul_f32 v53, v53, v54
v_accvgpr_write_b32 a100, v53
v_accvgpr_read_b32 v53, a101
s_nop 0
v_mul_f32 v53, v53, v54
v_accvgpr_write_b32 a101, v53
v_accvgpr_read_b32 v53, a102
s_nop 0
v_mul_f32 v53, v53, v54
v_accvgpr_write_b32 a102, v53
v_accvgpr_read_b32 v53, a103
s_nop 0
v_mul_f32 v53, v53, v54
v_accvgpr_write_b32 a103, v53
v_accvgpr_read_b32 v53, a116
s_nop 0
v_mul_f32 v53, v53, v54
v_accvgpr_write_b32 a116, v53
v_accvgpr_read_b32 v53, a117
s_nop 0
v_mul_f32 v53, v53, v54
v_accvgpr_write_b32 a117, v53
v_accvgpr_read_b32 v53, a118
s_nop 0
v_mul_f32 v53, v53, v54
v_accvgpr_write_b32 a118, v53
v_accvgpr_read_b32 v53, a119
s_nop 0
v_mul_f32 v53, v53, v54
v_accvgpr_write_b32 a119, v53
v_accvgpr_read_b32 v53, a196
s_nop 0
v_mul_f32 v53, v53, v54
v_accvgpr_write_b32 a196, v53
v_accvgpr_read_b32 v53, a197
s_nop 0
v_mul_f32 v53, v53, v54
v_accvgpr_write_b32 a197, v53
v_accvgpr_read_b32 v53, a198
s_nop 0
v_mul_f32 v53, v53, v54
v_accvgpr_write_b32 a198, v53
v_accvgpr_read_b32 v53, a199
s_nop 0
v_mul_f32 v53, v53, v54
v_accvgpr_write_b32 a199, v53
v_max3_f32 v52, v72, v73, v74
v_max3_f32 v52, v52, v75, v88
v_max3_f32 v52, v52, v89, v90
v_max3_f32 v52, v52, v91, v104
v_max3_f32 v52, v52, v105, v106
v_max3_f32 v52, v52, v107, v120
v_max3_f32 v52, v52, v121, v122
v_max_f32 v52, v52, v123
v_mov_b32 v53, v52
s_nop 1
v_permlane32_swap_b32 v52, v53
s_nop 1
v_max_f32 v52, v52, v53
v_mov_b32 v53, v52
s_nop 1
v_permlane16_swap_b32 v52, v53
s_nop 1
v_max_f32 v52, v52, v53
v_add_f32 v52, 0x42b40000, v52
v_max_f32 v52, 0, v52
v_sub_f32 v72, v72, v52
v_sub_f32 v136, v136, v52
v_sub_f32 v73, v73, v52
v_sub_f32 v137, v137, v52
v_sub_f32 v74, v74, v52
v_sub_f32 v138, v138, v52
v_sub_f32 v75, v75, v52
v_sub_f32 v139, v139, v52
v_sub_f32 v88, v88, v52
v_sub_f32 v152, v152, v52
v_sub_f32 v89, v89, v52
v_sub_f32 v153, v153, v52
v_sub_f32 v90, v90, v52
v_sub_f32 v154, v154, v52
v_sub_f32 v91, v91, v52
v_sub_f32 v155, v155, v52
v_sub_f32 v104, v104, v52
v_sub_f32 v168, v168, v52
v_sub_f32 v105, v105, v52
v_sub_f32 v169, v169, v52
v_sub_f32 v106, v106, v52
v_sub_f32 v170, v170, v52
v_sub_f32 v107, v107, v52
v_sub_f32 v171, v171, v52
v_sub_f32 v120, v120, v52
v_sub_f32 v184, v184, v52
v_sub_f32 v121, v121, v52
v_sub_f32 v185, v185, v52
v_sub_f32 v122, v122, v52
v_sub_f32 v186, v186, v52
v_sub_f32 v123, v123, v52
v_sub_f32 v187, v187, v52
v_sub_f32 v40, v40, v52
v_sub_f32 v41, v41, v52
v_sub_f32 v42, v42, v52
v_sub_f32 v43, v43, v52
v_sub_f32 v54, 0, v52
v_exp_f32 v54, v54
s_nop 0
v_accvgpr_read_b32 v53, a8
s_nop 0
v_mul_f32 v53, v53, v54
v_accvgpr_write_b32 a8, v53
v_accvgpr_read_b32 v53, a9
s_nop 0
v_mul_f32 v53, v53, v54
v_accvgpr_write_b32 a9, v53
v_accvgpr_read_b32 v53, a10
s_nop 0
v_mul_f32 v53, v53, v54
v_accvgpr_write_b32 a10, v53
v_accvgpr_read_b32 v53, a11
s_nop 0
v_mul_f32 v53, v53, v54
v_accvgpr_write_b32 a11, v53
v_accvgpr_read_b32 v53, a24
s_nop 0
v_mul_f32 v53, v53, v54
v_accvgpr_write_b32 a24, v53
v_accvgpr_read_b32 v53, a25
s_nop 0
v_mul_f32 v53, v53, v54
v_accvgpr_write_b32 a25, v53
v_accvgpr_read_b32 v53, a26
s_nop 0
v_mul_f32 v53, v53, v54
v_accvgpr_write_b32 a26, v53
v_accvgpr_read_b32 v53, a27
s_nop 0
v_mul_f32 v53, v53, v54
v_accvgpr_write_b32 a27, v53
v_accvgpr_read_b32 v53, a40
s_nop 0
v_mul_f32 v53, v53, v54
v_accvgpr_write_b32 a40, v53
v_accvgpr_read_b32 v53, a41
s_nop 0
v_mul_f32 v53, v53, v54
v_accvgpr_write_b32 a41, v53
v_accvgpr_read_b32 v53, a42
s_nop 0
v_mul_f32 v53, v53, v54
v_accvgpr_write_b32 a42, v53
v_accvgpr_read_b32 v53, a43
s_nop 0
v_mul_f32 v53, v53, v54
v_accvgpr_write_b32 a43, v53
v_accvgpr_read_b32 v53, a56
s_nop 0
v_mul_f32 v53, v53, v54
v_accvgpr_write_b32 a56, v53
v_accvgpr_read_b32 v53, a57
s_nop 0
v_mul_f32 v53, v53, v54
v_accvgpr_write_b32 a57, v53
v_accvgpr_read_b32 v53, a58
s_nop 0
v_mul_f32 v53, v53, v54
v_accvgpr_write_b32 a58, v53
v_accvgpr_read_b32 v53, a59
s_nop 0
v_mul_f32 v53, v53, v54
v_accvgpr_write_b32 a59, v53
v_accvgpr_read_b32 v53, a72
s_nop 0
v_mul_f32 v53, v53, v54
v_accvgpr_write_b32 a72, v53
v_accvgpr_read_b32 v53, a73
s_nop 0
v_mul_f32 v53, v53, v54
v_accvgpr_write_b32 a73, v53
v_accvgpr_read_b32 v53, a74
s_nop 0
v_mul_f32 v53, v53, v54
v_accvgpr_write_b32 a74, v53
v_accvgpr_read_b32 v53, a75
s_nop 0
v_mul_f32 v53, v53, v54
v_accvgpr_write_b32 a75, v53
v_accvgpr_read_b32 v53, a88
s_nop 0
v_mul_f32 v53, v53, v54
v_accvgpr_write_b32 a88, v53
v_accvgpr_read_b32 v53, a89
s_nop 0
v_mul_f32 v53, v53, v54
v_accvgpr_write_b32 a89, v53
v_accvgpr_read_b32 v53, a90
s_nop 0
v_mul_f32 v53, v53, v54
v_accvgpr_write_b32 a90, v53
v_accvgpr_read_b32 v53, a91
s_nop 0
v_mul_f32 v53, v53, v54
v_accvgpr_write_b32 a91, v53
v_accvgpr_read_b32 v53, a104
s_nop 0
v_mul_f32 v53, v53, v54
v_accvgpr_write_b32 a104, v53
v_accvgpr_read_b32 v53, a105
s_nop 0
v_mul_f32 v53, v53, v54
v_accvgpr_write_b32 a105, v53
v_accvgpr_read_b32 v53, a106
s_nop 0
v_mul_f32 v53, v53, v54
v_accvgpr_write_b32 a106, v53
v_accvgpr_read_b32 v53, a107
s_nop 0
v_mul_f32 v53, v53, v54
v_accvgpr_write_b32 a107, v53
v_accvgpr_read_b32 v53, a120
s_nop 0
v_mul_f32 v53, v53, v54
v_accvgpr_write_b32 a120, v53
v_accvgpr_read_b32 v53, a121
s_nop 0
v_mul_f32 v53, v53, v54
v_accvgpr_write_b32 a121, v53
v_accvgpr_read_b32 v53, a122
s_nop 0
v_mul_f32 v53, v53, v54
v_accvgpr_write_b32 a122, v53
v_accvgpr_read_b32 v53, a123
s_nop 0
v_mul_f32 v53, v53, v54
v_accvgpr_write_b32 a123, v53
v_accvgpr_read_b32 v53, a200
s_nop 0
v_mul_f32 v53, v53, v54
v_accvgpr_write_b32 a200, v53
v_accvgpr_read_b32 v53, a201
s_nop 0
v_mul_f32 v53, v53, v54
v_accvgpr_write_b32 a201, v53
v_accvgpr_read_b32 v53, a202
s_nop 0
v_mul_f32 v53, v53, v54
v_accvgpr_write_b32 a202, v53
v_accvgpr_read_b32 v53, a203
s_nop 0
v_mul_f32 v53, v53, v54
v_accvgpr_write_b32 a203, v53
v_max3_f32 v52, v76, v77, v78
v_max3_f32 v52, v52, v79, v92
v_max3_f32 v52, v52, v93, v94
v_max3_f32 v52, v52, v95, v108
v_max3_f32 v52, v52, v109, v110
v_max3_f32 v52, v52, v111, v124
v_max3_f32 v52, v52, v125, v126
v_max_f32 v52, v52, v127
v_mov_b32 v53, v52
s_nop 1
v_permlane32_swap_b32 v52, v53
s_nop 1
v_max_f32 v52, v52, v53
v_mov_b32 v53, v52
s_nop 1
v_permlane16_swap_b32 v52, v53
s_nop 1
v_max_f32 v52, v52, v53
v_add_f32 v52, 0x42b40000, v52
v_max_f32 v52, 0, v52
v_sub_f32 v76, v76, v52
v_sub_f32 v140, v140, v52
v_sub_f32 v77, v77, v52
v_sub_f32 v141, v141, v52
v_sub_f32 v78, v78, v52
v_sub_f32 v142, v142, v52
v_sub_f32 v79, v79, v52
v_sub_f32 v143, v143, v52
v_sub_f32 v92, v92, v52
v_sub_f32 v156, v156, v52
v_sub_f32 v93, v93, v52
v_sub_f32 v157, v157, v52
v_sub_f32 v94, v94, v52
v_sub_f32 v158, v158, v52
v_sub_f32 v95, v95, v52
v_sub_f32 v159, v159, v52
v_sub_f32 v108, v108, v52
v_sub_f32 v172, v172, v52
v_sub_f32 v109, v109, v52
v_sub_f32 v173, v173, v52
v_sub_f32 v110, v110, v52
v_sub_f32 v174, v174, v52
v_sub_f32 v111, v111, v52
v_sub_f32 v175, v175, v52
v_sub_f32 v124, v124, v52
v_sub_f32 v188, v188, v52
v_sub_f32 v125, v125, v52
v_sub_f32 v189, v189, v52
v_sub_f32 v126, v126, v52
v_sub_f32 v190, v190, v52
v_sub_f32 v127, v127, v52
v_sub_f32 v191, v191, v52
v_sub_f32 v44, v44, v52
v_sub_f32 v45, v45, v52
v_sub_f32 v46, v46, v52
v_sub_f32 v47, v47, v52
v_sub_f32 v54, 0, v52
v_exp_f32 v54, v54
s_nop 0
v_accvgpr_read_b32 v53, a12
s_nop 0
v_mul_f32 v53, v53, v54
v_accvgpr_write_b32 a12, v53
v_accvgpr_read_b32 v53, a13
s_nop 0
v_mul_f32 v53, v53, v54
v_accvgpr_write_b32 a13, v53
v_accvgpr_read_b32 v53, a14
s_nop 0
v_mul_f32 v53, v53, v54
v_accvgpr_write_b32 a14, v53
v_accvgpr_read_b32 v53, a15
s_nop 0
v_mul_f32 v53, v53, v54
v_accvgpr_write_b32 a15, v53
v_accvgpr_read_b32 v53, a28
s_nop 0
v_mul_f32 v53, v53, v54
v_accvgpr_write_b32 a28, v53
v_accvgpr_read_b32 v53, a29
s_nop 0
v_mul_f32 v53, v53, v54
v_accvgpr_write_b32 a29, v53
v_accvgpr_read_b32 v53, a30
s_nop 0
v_mul_f32 v53, v53, v54
v_accvgpr_write_b32 a30, v53
v_accvgpr_read_b32 v53, a31
s_nop 0
v_mul_f32 v53, v53, v54
v_accvgpr_write_b32 a31, v53
v_accvgpr_read_b32 v53, a44
s_nop 0
v_mul_f32 v53, v53, v54
v_accvgpr_write_b32 a44, v53
v_accvgpr_read_b32 v53, a45
s_nop 0
v_mul_f32 v53, v53, v54
v_accvgpr_write_b32 a45, v53
v_accvgpr_read_b32 v53, a46
s_nop 0
v_mul_f32 v53, v53, v54
v_accvgpr_write_b32 a46, v53
v_accvgpr_read_b32 v53, a47
s_nop 0
v_mul_f32 v53, v53, v54
v_accvgpr_write_b32 a47, v53
v_accvgpr_read_b32 v53, a60
s_nop 0
v_mul_f32 v53, v53, v54
v_accvgpr_write_b32 a60, v53
v_accvgpr_read_b32 v53, a61
s_nop 0
v_mul_f32 v53, v53, v54
v_accvgpr_write_b32 a61, v53
v_accvgpr_read_b32 v53, a62
s_nop 0
v_mul_f32 v53, v53, v54
v_accvgpr_write_b32 a62, v53
v_accvgpr_read_b32 v53, a63
s_nop 0
v_mul_f32 v53, v53, v54
v_accvgpr_write_b32 a63, v53
v_accvgpr_read_b32 v53, a76
s_nop 0
v_mul_f32 v53, v53, v54
v_accvgpr_write_b32 a76, v53
v_accvgpr_read_b32 v53, a77
s_nop 0
v_mul_f32 v53, v53, v54
v_accvgpr_write_b32 a77, v53
v_accvgpr_read_b32 v53, a78
s_nop 0
v_mul_f32 v53, v53, v54
v_accvgpr_write_b32 a78, v53
v_accvgpr_read_b32 v53, a79
s_nop 0
v_mul_f32 v53, v53, v54
v_accvgpr_write_b32 a79, v53
v_accvgpr_read_b32 v53, a92
s_nop 0
v_mul_f32 v53, v53, v54
v_accvgpr_write_b32 a92, v53
v_accvgpr_read_b32 v53, a93
s_nop 0
v_mul_f32 v53, v53, v54
v_accvgpr_write_b32 a93, v53
v_accvgpr_read_b32 v53, a94
s_nop 0
v_mul_f32 v53, v53, v54
v_accvgpr_write_b32 a94, v53
v_accvgpr_read_b32 v53, a95
s_nop 0
v_mul_f32 v53, v53, v54
v_accvgpr_write_b32 a95, v53
v_accvgpr_read_b32 v53, a108
s_nop 0
v_mul_f32 v53, v53, v54
v_accvgpr_write_b32 a108, v53
v_accvgpr_read_b32 v53, a109
s_nop 0
v_mul_f32 v53, v53, v54
v_accvgpr_write_b32 a109, v53
v_accvgpr_read_b32 v53, a110
s_nop 0
v_mul_f32 v53, v53, v54
v_accvgpr_write_b32 a110, v53
v_accvgpr_read_b32 v53, a111
s_nop 0
v_mul_f32 v53, v53, v54
v_accvgpr_write_b32 a111, v53
v_accvgpr_read_b32 v53, a124
s_nop 0
v_mul_f32 v53, v53, v54
v_accvgpr_write_b32 a124, v53
v_accvgpr_read_b32 v53, a125
s_nop 0
v_mul_f32 v53, v53, v54
v_accvgpr_write_b32 a125, v53
v_accvgpr_read_b32 v53, a126
s_nop 0
v_mul_f32 v53, v53, v54
v_accvgpr_write_b32 a126, v53
v_accvgpr_read_b32 v53, a127
s_nop 0
v_mul_f32 v53, v53, v54
v_accvgpr_write_b32 a127, v53
v_accvgpr_read_b32 v53, a204
s_nop 0
v_mul_f32 v53, v53, v54
v_accvgpr_write_b32 a204, v53
v_accvgpr_read_b32 v53, a205
s_nop 0
v_mul_f32 v53, v53, v54
v_accvgpr_write_b32 a205, v53
v_accvgpr_read_b32 v53, a206
s_nop 0
v_mul_f32 v53, v53, v54
v_accvgpr_write_b32 a206, v53
v_accvgpr_read_b32 v53, a207
s_nop 0
v_mul_f32 v53, v53, v54
v_accvgpr_write_b32 a207, v53
v_exp_f32 v56, v64
v_exp_f32 v57, v65
v_exp_f32 v58, v66
v_cvt_pk_bf16_f32 v192, v56, v57
v_exp_f32 v59, v67
v_exp_f32 v60, v80
v_cvt_pk_bf16_f32 v193, v58, v59
v_exp_f32 v61, v81
v_exp_f32 v62, v82
v_cvt_pk_bf16_f32 v194, v60, v61
v_exp_f32 v63, v83
v_exp_f32 v56, v68
v_cvt_pk_bf16_f32 v195, v62, v63
v_or_b32 v25, v192, v193
v_or3_b32 v25, v25, v194, v195
v_exp_f32 v57, v69
v_exp_f32 v58, v70
v_cvt_pk_bf16_f32 v196, v56, v57
v_exp_f32 v59, v71
v_exp_f32 v60, v84
v_cvt_pk_bf16_f32 v197, v58, v59
v_exp_f32 v61, v85
v_exp_f32 v62, v86
v_cvt_pk_bf16_f32 v198, v60, v61
v_exp_f32 v63, v87
v_exp_f32 v56, v72
v_cvt_pk_bf16_f32 v199, v62, v63
v_or3_b32 v25, v25, v196, v197
v_or3_b32 v25, v25, v198, v199
v_exp_f32 v57, v73
v_exp_f32 v58, v74
v_cvt_pk_bf16_f32 v200, v56, v57
v_exp_f32 v59, v75
v_exp_f32 v60, v88
v_cvt_pk_bf16_f32 v201, v58, v59
v_exp_f32 v61, v89
v_exp_f32 v62, v90
v_cvt_pk_bf16_f32 v202, v60, v61
v_exp_f32 v63, v91
v_exp_f32 v56, v76
v_cvt_pk_bf16_f32 v203, v62, v63
v_or3_b32 v25, v25, v200, v201
v_or3_b32 v25, v25, v202, v203
v_exp_f32 v57, v77
v_exp_f32 v58, v78
v_cvt_pk_bf16_f32 v204, v56, v57
v_exp_f32 v59, v79
v_exp_f32 v60, v92
v_cvt_pk_bf16_f32 v205, v58, v59
v_exp_f32 v61, v93
v_exp_f32 v62, v94
v_cvt_pk_bf16_f32 v206, v60, v61
v_exp_f32 v63, v95
v_exp_f32 v56, v96
v_cvt_pk_bf16_f32 v207, v62, v63
v_or3_b32 v25, v25, v204, v205
v_or3_b32 v25, v25, v206, v207
v_exp_f32 v57, v97
v_exp_f32 v58, v98
v_cvt_pk_bf16_f32 v208, v56, v57
v_exp_f32 v59, v99
v_exp_f32 v60, v112
v_cvt_pk_bf16_f32 v209, v58, v59
v_exp_f32 v61, v113
v_exp_f32 v62, v114
v_cvt_pk_bf16_f32 v210, v60, v61
v_exp_f32 v63, v115
v_exp_f32 v56, v100
v_cvt_pk_bf16_f32 v211, v62, v63
v_or3_b32 v25, v25, v208, v209
v_or3_b32 v25, v25, v210, v211
v_exp_f32 v57, v101
v_exp_f32 v58, v102
v_cvt_pk_bf16_f32 v212, v56, v57
v_exp_f32 v59, v103
v_exp_f32 v60, v116
v_cvt_pk_bf16_f32 v213, v58, v59
v_exp_f32 v61, v117
v_exp_f32 v62, v118
v_cvt_pk_bf16_f32 v214, v60, v61
v_exp_f32 v63, v119
v_exp_f32 v56, v104
v_cvt_pk_bf16_f32 v215, v62, v63
v_or3_b32 v25, v25, v212, v213
v_or3_b32 v25, v25, v214, v215
v_exp_f32 v57, v105
v_exp_f32 v58, v106
v_cvt_pk_bf16_f32 v216, v56, v57
v_exp_f32 v59, v107
v_exp_f32 v60, v120
v_cvt_pk_bf16_f32 v217, v58, v59
v_exp_f32 v61, v121
v_exp_f32 v62, v122
v_cvt_pk_bf16_f32 v218, v60, v61
v_exp_f32 v63, v123
v_exp_f32 v56, v108
v_cvt_pk_bf16_f32 v219, v62, v63
v_or3_b32 v25, v25, v216, v217
v_or3_b32 v25, v25, v218, v219
v_exp_f32 v57, v109
v_exp_f32 v58, v110
v_cvt_pk_bf16_f32 v220, v56, v57
v_exp_f32 v59, v111
v_exp_f32 v60, v124
v_cvt_pk_bf16_f32 v221, v58, v59
v_exp_f32 v61, v125
v_exp_f32 v62, v126
v_cvt_pk_bf16_f32 v222, v60, v61
v_exp_f32 v63, v127
s_nop 0
v_cvt_pk_bf16_f32 v223, v62, v63
v_or3_b32 v25, v25, v220, v221
v_or3_b32 v25, v25, v222, v223
s_nop 1
s_setpc_b64 s[36:37]
L_rare1_main_kernel:
s_nop 15
v_max3_f32 v52, v128, v129, v130
v_max3_f32 v52, v52, v131, v144
v_max3_f32 v52, v52, v145, v146
v_max3_f32 v52, v52, v147, v160
v_max3_f32 v52, v52, v161, v162
v_max3_f32 v52, v52, v163, v176
v_max3_f32 v52, v52, v177, v178
v_max_f32 v52, v52, v179
v_mov_b32 v53, v52
s_nop 1
v_permlane32_swap_b32 v52, v53
s_nop 1
v_max_f32 v52, v52, v53
v_mov_b32 v53, v52
s_nop 1
v_permlane16_swap_b32 v52, v53
s_nop 1
v_max_f32 v52, v52, v53
v_add_f32 v52, 0x42b40000, v52
v_max_f32 v52, 0, v52
v_sub_f32 v128, v128, v52
v_sub_f32 v64, v64, v52
v_sub_f32 v129, v129, v52
v_sub_f32 v65, v65, v52
v_sub_f32 v130, v130, v52
v_sub_f32 v66, v66, v52
v_sub_f32 v131, v131, v52
v_sub_f32 v67, v67, v52
v_sub_f32 v144, v144, v52
v_sub_f32 v80, v80, v52
v_sub_f32 v145, v145, v52
v_sub_f32 v81, v81, v52
v_sub_f32 v146, v146, v52
v_sub_f32 v82, v82, v52
v_sub_f32 v147, v147, v52
v_sub_f32 v83, v83, v52
v_sub_f32 v160, v160, v52
v_sub_f32 v96, v96, v52
v_sub_f32 v161, v161, v52
v_sub_f32 v97, v97, v52
v_sub_f32 v162, v162, v52
v_sub_f32 v98, v98, v52
v_sub_f32 v163, v163, v52
v_sub_f32 v99, v99, v52
v_sub_f32 v176, v176, v52
v_sub_f32 v112, v112, v52
v_sub_f32 v177, v177, v52
v_sub_f32 v113, v113, v52
v_sub_f32 v178, v178, v52
v_sub_f32 v114, v114, v52
v_sub_f32 v179, v179, v52
v_sub_f32 v115, v115, v52
v_sub_f32 v32, v32, v52
v_sub_f32 v33, v33, v52
v_sub_f32 v34, v34, v52
v_sub_f32 v35, v35, v52
v_sub_f32 v54, 0, v52
v_exp_f32 v54, v54
s_nop 0
v_accvgpr_read_b32 v53, a0
s_nop 0
v_mul_f32 v53, v53, v54
v_accvgpr_write_b32 a0, v53
v_accvgpr_read_b32 v53, a1
s_nop 0
v_mul_f32 v53, v53, v54
v_accvgpr_write_b32 a1, v53
v_accvgpr_read_b32 v53, a2
s_nop 0
v_mul_f32 v53, v53, v54
v_accvgpr_write_b32 a2, v53
v_accvgpr_read_b32 v53, a3
s_nop 0
v_mul_f32 v53, v53, v54
v_accvgpr_write_b32 a3, v53
v_accvgpr_read_b32 v53, a16
s_nop 0
v_mul_f32 v53, v53, v54
v_accvgpr_write_b32 a16, v53
v_accvgpr_read_b32 v53, a17
s_nop 0
v_mul_f32 v53, v53, v54
v_accvgpr_write_b32 a17, v53
v_accvgpr_read_b32 v53, a18
s_nop 0
v_mul_f32 v53, v53, v54
v_accvgpr_write_b32 a18, v53
v_accvgpr_read_b32 v53, a19
s_nop 0
v_mul_f32 v53, v53, v54
v_accvgpr_write_b32 a19, v53
v_accvgpr_read_b32 v53, a32
s_nop 0
v_mul_f32 v53, v53, v54
v_accvgpr_write_b32 a32, v53
v_accvgpr_read_b32 v53, a33
s_nop 0
v_mul_f32 v53, v53, v54
v_accvgpr_write_b32 a33, v53
v_accvgpr_read_b32 v53, a34
s_nop 0
v_mul_f32 v53, v53, v54
v_accvgpr_write_b32 a34, v53
v_accvgpr_read_b32 v53, a35
s_nop 0
v_mul_f32 v53, v53, v54
v_accvgpr_write_b32 a35, v53
v_accvgpr_read_b32 v53, a48
s_nop 0
v_mul_f32 v53, v53, v54
v_accvgpr_write_b32 a48, v53
v_accvgpr_read_b32 v53, a49
s_nop 0
v_mul_f32 v53, v53, v54
v_accvgpr_write_b32 a49, v53
v_accvgpr_read_b32 v53, a50
s_nop 0
v_mul_f32 v53, v53, v54
v_accvgpr_write_b32 a50, v53
v_accvgpr_read_b32 v53, a51
s_nop 0
v_mul_f32 v53, v53, v54
v_accvgpr_write_b32 a51, v53
v_accvgpr_read_b32 v53, a64
s_nop 0
v_mul_f32 v53, v53, v54
v_accvgpr_write_b32 a64, v53
v_accvgpr_read_b32 v53, a65
s_nop 0
v_mul_f32 v53, v53, v54
v_accvgpr_write_b32 a65, v53
v_accvgpr_read_b32 v53, a66
s_nop 0
v_mul_f32 v53, v53, v54
v_accvgpr_write_b32 a66, v53
v_accvgpr_read_b32 v53, a67
s_nop 0
v_mul_f32 v53, v53, v54
v_accvgpr_write_b32 a67, v53
v_accvgpr_read_b32 v53, a80
s_nop 0
v_mul_f32 v53, v53, v54
v_accvgpr_write_b32 a80, v53
v_accvgpr_read_b32 v53, a81
s_nop 0
v_mul_f32 v53, v53, v54
v_accvgpr_write_b32 a81, v53
v_accvgpr_read_b32 v53, a82
s_nop 0
v_mul_f32 v53, v53, v54
v_accvgpr_write_b32 a82, v53
v_accvgpr_read_b32 v53, a83
s_nop 0
v_mul_f32 v53, v53, v54
v_accvgpr_write_b32 a83, v53
v_accvgpr_read_b32 v53, a96
s_nop 0
v_mul_f32 v53, v53, v54
v_accvgpr_write_b32 a96, v53
v_accvgpr_read_b32 v53, a97
s_nop 0
v_mul_f32 v53, v53, v54
v_accvgpr_write_b32 a97, v53
v_accvgpr_read_b32 v53, a98
s_nop 0
v_mul_f32 v53, v53, v54
v_accvgpr_write_b32 a98, v53
v_accvgpr_read_b32 v53, a99
s_nop 0
v_mul_f32 v53, v53, v54
v_accvgpr_write_b32 a99, v53
v_accvgpr_read_b32 v53, a112
s_nop 0
v_mul_f32 v53, v53, v54
v_accvgpr_write_b32 a112, v53
v_accvgpr_read_b32 v53, a113
s_nop 0
v_mul_f32 v53, v53, v54
v_accvgpr_write_b32 a113, v53
v_accvgpr_read_b32 v53, a114
s_nop 0
v_mul_f32 v53, v53, v54
v_accvgpr_write_b32 a114, v53
v_accvgpr_read_b32 v53, a115
s_nop 0
v_mul_f32 v53, v53, v54
v_accvgpr_write_b32 a115, v53
v_accvgpr_read_b32 v53, a192
s_nop 0
v_mul_f32 v53, v53, v54
v_accvgpr_write_b32 a192, v53
v_accvgpr_read_b32 v53, a193
s_nop 0
v_mul_f32 v53, v53, v54
v_accvgpr_write_b32 a193, v53
v_accvgpr_read_b32 v53, a194
s_nop 0
v_mul_f32 v53, v53, v54
v_accvgpr_write_b32 a194, v53
v_accvgpr_read_b32 v53, a195
s_nop 0
v_mul_f32 v53, v53, v54
v_accvgpr_write_b32 a195, v53
v_max3_f32 v52, v132, v133, v134
v_max3_f32 v52, v52, v135, v148
v_max3_f32 v52, v52, v149, v150
v_max3_f32 v52, v52, v151, v164
v_max3_f32 v52, v52, v165, v166
v_max3_f32 v52, v52, v167, v180
v_max3_f32 v52, v52, v181, v182
v_max_f32 v52, v52, v183
v_mov_b32 v53, v52
s_nop 1
v_permlane32_swap_b32 v52, v53
s_nop 1
v_max_f32 v52, v52, v53
v_mov_b32 v53, v52
s_nop 1
v_permlane16_swap_b32 v52, v53
s_nop 1
v_max_f32 v52, v52, v53
v_add_f32 v52, 0x42b40000, v52
v_max_f32 v52, 0, v52
v_sub_f32 v132, v132, v52
v_sub_f32 v68, v68, v52
v_sub_f32 v133, v133, v52
v_sub_f32 v69, v69, v52
v_sub_f32 v134, v134, v52
v_sub_f32 v70, v70, v52
v_sub_f32 v135, v135, v52
v_sub_f32 v71, v71, v52
v_sub_f32 v148, v148, v52
v_sub_f32 v84, v84, v52
v_sub_f32 v149, v149, v52
v_sub_f32 v85, v85, v52
v_sub_f32 v150, v150, v52
v_sub_f32 v86, v86, v52
v_sub_f32 v151, v151, v52
v_sub_f32 v87, v87, v52
v_sub_f32 v164, v164, v52
v_sub_f32 v100, v100, v52
v_sub_f32 v165, v165, v52
v_sub_f32 v101, v101, v52
v_sub_f32 v166, v166, v52
v_sub_f32 v102, v102, v52
v_sub_f32 v167, v167, v52
v_sub_f32 v103, v103, v52
v_sub_f32 v180, v180, v52
v_sub_f32 v116, v116, v52
v_sub_f32 v181, v181, v52
v_sub_f32 v117, v117, v52
v_sub_f32 v182, v182, v52
v_sub_f32 v118, v118, v52
v_sub_f32 v183, v183, v52
v_sub_f32 v119, v119, v52
v_sub_f32 v36, v36, v52
v_sub_f32 v37, v37, v52
v_sub_f32 v38, v38, v52
v_sub_f32 v39, v39, v52
v_sub_f32 v54, 0, v52
v_exp_f32 v54, v54
s_nop 0
v_accvgpr_read_b32 v53, a4
s_nop 0
v_mul_f32 v53, v53, v54
v_accvgpr_write_b32 a4, v53
v_accvgpr_read_b32 v53, a5
s_nop 0
v_mul_f32 v53, v53, v54
v_accvgpr_write_b32 a5, v53
v_accvgpr_read_b32 v53, a6
s_nop 0
v_mul_f32 v53, v53, v54
v_accvgpr_write_b32 a6, v53
v_accvgpr_read_b32 v53, a7
s_nop 0
v_mul_f32 v53, v53, v54
v_accvgpr_write_b32 a7, v53
v_accvgpr_read_b32 v53, a20
s_nop 0
v_mul_f32 v53, v53, v54
v_accvgpr_write_b32 a20, v53
v_accvgpr_read_b32 v53, a21
s_nop 0
v_mul_f32 v53, v53, v54
v_accvgpr_write_b32 a21, v53
v_accvgpr_read_b32 v53, a22
s_nop 0
v_mul_f32 v53, v53, v54
v_accvgpr_write_b32 a22, v53
v_accvgpr_read_b32 v53, a23
s_nop 0
v_mul_f32 v53, v53, v54
v_accvgpr_write_b32 a23, v53
v_accvgpr_read_b32 v53, a36
s_nop 0
v_mul_f32 v53, v53, v54
v_accvgpr_write_b32 a36, v53
v_accvgpr_read_b32 v53, a37
s_nop 0
v_mul_f32 v53, v53, v54
v_accvgpr_write_b32 a37, v53
v_accvgpr_read_b32 v53, a38
s_nop 0
v_mul_f32 v53, v53, v54
v_accvgpr_write_b32 a38, v53
v_accvgpr_read_b32 v53, a39
s_nop 0
v_mul_f32 v53, v53, v54
v_accvgpr_write_b32 a39, v53
v_accvgpr_read_b32 v53, a52
s_nop 0
v_mul_f32 v53, v53, v54
v_accvgpr_write_b32 a52, v53
v_accvgpr_read_b32 v53, a53
s_nop 0
v_mul_f32 v53, v53, v54
v_accvgpr_write_b32 a53, v53
v_accvgpr_read_b32 v53, a54
s_nop 0
v_mul_f32 v53, v53, v54
v_accvgpr_write_b32 a54, v53
v_accvgpr_read_b32 v53, a55
s_nop 0
v_mul_f32 v53, v53, v54
v_accvgpr_write_b32 a55, v53
v_accvgpr_read_b32 v53, a68
s_nop 0
v_mul_f32 v53, v53, v54
v_accvgpr_write_b32 a68, v53
v_accvgpr_read_b32 v53, a69
s_nop 0
v_mul_f32 v53, v53, v54
v_accvgpr_write_b32 a69, v53
v_accvgpr_read_b32 v53, a70
s_nop 0
v_mul_f32 v53, v53, v54
v_accvgpr_write_b32 a70, v53
v_accvgpr_read_b32 v53, a71
s_nop 0
v_mul_f32 v53, v53, v54
v_accvgpr_write_b32 a71, v53
v_accvgpr_read_b32 v53, a84
s_nop 0
v_mul_f32 v53, v53, v54
v_accvgpr_write_b32 a84, v53
v_accvgpr_read_b32 v53, a85
s_nop 0
v_mul_f32 v53, v53, v54
v_accvgpr_write_b32 a85, v53
v_accvgpr_read_b32 v53, a86
s_nop 0
v_mul_f32 v53, v53, v54
v_accvgpr_write_b32 a86, v53
v_accvgpr_read_b32 v53, a87
s_nop 0
v_mul_f32 v53, v53, v54
v_accvgpr_write_b32 a87, v53
v_accvgpr_read_b32 v53, a100
s_nop 0
v_mul_f32 v53, v53, v54
v_accvgpr_write_b32 a100, v53
v_accvgpr_read_b32 v53, a101
s_nop 0
v_mul_f32 v53, v53, v54
v_accvgpr_write_b32 a101, v53
v_accvgpr_read_b32 v53, a102
s_nop 0
v_mul_f32 v53, v53, v54
v_accvgpr_write_b32 a102, v53
v_accvgpr_read_b32 v53, a103
s_nop 0
v_mul_f32 v53, v53, v54
v_accvgpr_write_b32 a103, v53
v_accvgpr_read_b32 v53, a116
s_nop 0
v_mul_f32 v53, v53, v54
v_accvgpr_write_b32 a116, v53
v_accvgpr_read_b32 v53, a117
s_nop 0
v_mul_f32 v53, v53, v54
v_accvgpr_write_b32 a117, v53
v_accvgpr_read_b32 v53, a118
s_nop 0
v_mul_f32 v53, v53, v54
v_accvgpr_write_b32 a118, v53
v_accvgpr_read_b32 v53, a119
s_nop 0
v_mul_f32 v53, v53, v54
v_accvgpr_write_b32 a119, v53
v_accvgpr_read_b32 v53, a196
s_nop 0
v_mul_f32 v53, v53, v54
v_accvgpr_write_b32 a196, v53
v_accvgpr_read_b32 v53, a197
s_nop 0
v_mul_f32 v53, v53, v54
v_accvgpr_write_b32 a197, v53
v_accvgpr_read_b32 v53, a198
s_nop 0
v_mul_f32 v53, v53, v54
v_accvgpr_write_b32 a198, v53
v_accvgpr_read_b32 v53, a199
s_nop 0
v_mul_f32 v53, v53, v54
v_accvgpr_write_b32 a199, v53
v_max3_f32 v52, v136, v137, v138
v_max3_f32 v52, v52, v139, v152
v_max3_f32 v52, v52, v153, v154
v_max3_f32 v52, v52, v155, v168
v_max3_f32 v52, v52, v169, v170
v_max3_f32 v52, v52, v171, v184
v_max3_f32 v52, v52, v185, v186
v_max_f32 v52, v52, v187
v_mov_b32 v53, v52
s_nop 1
v_permlane32_swap_b32 v52, v53
s_nop 1
v_max_f32 v52, v52, v53
v_mov_b32 v53, v52
s_nop 1
v_permlane16_swap_b32 v52, v53
s_nop 1
v_max_f32 v52, v52, v53
v_add_f32 v52, 0x42b40000, v52
v_max_f32 v52, 0, v52
v_sub_f32 v136, v136, v52
v_sub_f32 v72, v72, v52
v_sub_f32 v137, v137, v52
v_sub_f32 v73, v73, v52
v_sub_f32 v138, v138, v52
v_sub_f32 v74, v74, v52
v_sub_f32 v139, v139, v52
v_sub_f32 v75, v75, v52
v_sub_f32 v152, v152, v52
v_sub_f32 v88, v88, v52
v_sub_f32 v153, v153, v52
v_sub_f32 v89, v89, v52
v_sub_f32 v154, v154, v52
v_sub_f32 v90, v90, v52
v_sub_f32 v155, v155, v52
v_sub_f32 v91, v91, v52
v_sub_f32 v168, v168, v52
v_sub_f32 v104, v104, v52
v_sub_f32 v169, v169, v52
v_sub_f32 v105, v105, v52
v_sub_f32 v170, v170, v52
v_sub_f32 v106, v106, v52
v_sub_f32 v171, v171, v52
v_sub_f32 v107, v107, v52
v_sub_f32 v184, v184, v52
v_sub_f32 v120, v120, v52
v_sub_f32 v185, v185, v52
v_sub_f32 v121, v121, v52
v_sub_f32 v186, v186, v52
v_sub_f32 v122, v122, v52
v_sub_f32 v187, v187, v52
v_sub_f32 v123, v123, v52
v_sub_f32 v40, v40, v52
v_sub_f32 v41, v41, v52
v_sub_f32 v42, v42, v52
v_sub_f32 v43, v43, v52
v_sub_f32 v54, 0, v52
v_exp_f32 v54, v54
s_nop 0
v_accvgpr_read_b32 v53, a8
s_nop 0
v_mul_f32 v53, v53, v54
v_accvgpr_write_b32 a8, v53
v_accvgpr_read_b32 v53, a9
s_nop 0
v_mul_f32 v53, v53, v54
v_accvgpr_write_b32 a9, v53
v_accvgpr_read_b32 v53, a10
s_nop 0
v_mul_f32 v53, v53, v54
v_accvgpr_write_b32 a10, v53
v_accvgpr_read_b32 v53, a11
s_nop 0
v_mul_f32 v53, v53, v54
v_accvgpr_write_b32 a11, v53
v_accvgpr_read_b32 v53, a24
s_nop 0
v_mul_f32 v53, v53, v54
v_accvgpr_write_b32 a24, v53
v_accvgpr_read_b32 v53, a25
s_nop 0
v_mul_f32 v53, v53, v54
v_accvgpr_write_b32 a25, v53
v_accvgpr_read_b32 v53, a26
s_nop 0
v_mul_f32 v53, v53, v54
v_accvgpr_write_b32 a26, v53
v_accvgpr_read_b32 v53, a27
s_nop 0
v_mul_f32 v53, v53, v54
v_accvgpr_write_b32 a27, v53
v_accvgpr_read_b32 v53, a40
s_nop 0
v_mul_f32 v53, v53, v54
v_accvgpr_write_b32 a40, v53
v_accvgpr_read_b32 v53, a41
s_nop 0
v_mul_f32 v53, v53, v54
v_accvgpr_write_b32 a41, v53
v_accvgpr_read_b32 v53, a42
s_nop 0
v_mul_f32 v53, v53, v54
v_accvgpr_write_b32 a42, v53
v_accvgpr_read_b32 v53, a43
s_nop 0
v_mul_f32 v53, v53, v54
v_accvgpr_write_b32 a43, v53
v_accvgpr_read_b32 v53, a56
s_nop 0
v_mul_f32 v53, v53, v54
v_accvgpr_write_b32 a56, v53
v_accvgpr_read_b32 v53, a57
s_nop 0
v_mul_f32 v53, v53, v54
v_accvgpr_write_b32 a57, v53
v_accvgpr_read_b32 v53, a58
s_nop 0
v_mul_f32 v53, v53, v54
v_accvgpr_write_b32 a58, v53
v_accvgpr_read_b32 v53, a59
s_nop 0
v_mul_f32 v53, v53, v54
v_accvgpr_write_b32 a59, v53
v_accvgpr_read_b32 v53, a72
s_nop 0
v_mul_f32 v53, v53, v54
v_accvgpr_write_b32 a72, v53
v_accvgpr_read_b32 v53, a73
s_nop 0
v_mul_f32 v53, v53, v54
v_accvgpr_write_b32 a73, v53
v_accvgpr_read_b32 v53, a74
s_nop 0
v_mul_f32 v53, v53, v54
v_accvgpr_write_b32 a74, v53
v_accvgpr_read_b32 v53, a75
s_nop 0
v_mul_f32 v53, v53, v54
v_accvgpr_write_b32 a75, v53
v_accvgpr_read_b32 v53, a88
s_nop 0
v_mul_f32 v53, v53, v54
v_accvgpr_write_b32 a88, v53
v_accvgpr_read_b32 v53, a89
s_nop 0
v_mul_f32 v53, v53, v54
v_accvgpr_write_b32 a89, v53
v_accvgpr_read_b32 v53, a90
s_nop 0
v_mul_f32 v53, v53, v54
v_accvgpr_write_b32 a90, v53
v_accvgpr_read_b32 v53, a91
s_nop 0
v_mul_f32 v53, v53, v54
v_accvgpr_write_b32 a91, v53
v_accvgpr_read_b32 v53, a104
s_nop 0
v_mul_f32 v53, v53, v54
v_accvgpr_write_b32 a104, v53
v_accvgpr_read_b32 v53, a105
s_nop 0
v_mul_f32 v53, v53, v54
v_accvgpr_write_b32 a105, v53
v_accvgpr_read_b32 v53, a106
s_nop 0
v_mul_f32 v53, v53, v54
v_accvgpr_write_b32 a106, v53
v_accvgpr_read_b32 v53, a107
s_nop 0
v_mul_f32 v53, v53, v54
v_accvgpr_write_b32 a107, v53
v_accvgpr_read_b32 v53, a120
s_nop 0
v_mul_f32 v53, v53, v54
v_accvgpr_write_b32 a120, v53
v_accvgpr_read_b32 v53, a121
s_nop 0
v_mul_f32 v53, v53, v54
v_accvgpr_write_b32 a121, v53
v_accvgpr_read_b32 v53, a122
s_nop 0
v_mul_f32 v53, v53, v54
v_accvgpr_write_b32 a122, v53
v_accvgpr_read_b32 v53, a123
s_nop 0
v_mul_f32 v53, v53, v54
v_accvgpr_write_b32 a123, v53
v_accvgpr_read_b32 v53, a200
s_nop 0
v_mul_f32 v53, v53, v54
v_accvgpr_write_b32 a200, v53
v_accvgpr_read_b32 v53, a201
s_nop 0
v_mul_f32 v53, v53, v54
v_accvgpr_write_b32 a201, v53
v_accvgpr_read_b32 v53, a202
s_nop 0
v_mul_f32 v53, v53, v54
v_accvgpr_write_b32 a202, v53
v_accvgpr_read_b32 v53, a203
s_nop 0
v_mul_f32 v53, v53, v54
v_accvgpr_write_b32 a203, v53
v_max3_f32 v52, v140, v141, v142
v_max3_f32 v52, v52, v143, v156
v_max3_f32 v52, v52, v157, v158
v_max3_f32 v52, v52, v159, v172
v_max3_f32 v52, v52, v173, v174
v_max3_f32 v52, v52, v175, v188
v_max3_f32 v52, v52, v189, v190
v_max_f32 v52, v52, v191
v_mov_b32 v53, v52
s_nop 1
v_permlane32_swap_b32 v52, v53
s_nop 1
v_max_f32 v52, v52, v53
v_mov_b32 v53, v52
s_nop 1
v_permlane16_swap_b32 v52, v53
s_nop 1
v_max_f32 v52, v52, v53
v_add_f32 v52, 0x42b40000, v52
v_max_f32 v52, 0, v52
v_sub_f32 v140, v140, v52
v_sub_f32 v76, v76, v52
v_sub_f32 v141, v141, v52
v_sub_f32 v77, v77, v52
v_sub_f32 v142, v142, v52
v_sub_f32 v78, v78, v52
v_sub_f32 v143, v143, v52
v_sub_f32 v79, v79, v52
v_sub_f32 v156, v156, v52
v_sub_f32 v92, v92, v52
v_sub_f32 v157, v157, v52
v_sub_f32 v93, v93, v52
v_sub_f32 v158, v158, v52
v_sub_f32 v94, v94, v52
v_sub_f32 v159, v159, v52
v_sub_f32 v95, v95, v52
v_sub_f32 v172, v172, v52
v_sub_f32 v108, v108, v52
v_sub_f32 v173, v173, v52
v_sub_f32 v109, v109, v52
v_sub_f32 v174, v174, v52
v_sub_f32 v110, v110, v52
v_sub_f32 v175, v175, v52
v_sub_f32 v111, v111, v52
v_sub_f32 v188, v188, v52
v_sub_f32 v124, v124, v52
v_sub_f32 v189, v189, v52
v_sub_f32 v125, v125, v52
v_sub_f32 v190, v190, v52
v_sub_f32 v126, v126, v52
v_sub_f32 v191, v191, v52
v_sub_f32 v127, v127, v52
v_sub_f32 v44, v44, v52
v_sub_f32 v45, v45, v52
v_sub_f32 v46, v46, v52
v_sub_f32 v47, v47, v52
v_sub_f32 v54, 0, v52
v_exp_f32 v54, v54
s_nop 0
v_accvgpr_read_b32 v53, a12
s_nop 0
v_mul_f32 v53, v53, v54
v_accvgpr_write_b32 a12, v53
v_accvgpr_read_b32 v53, a13
s_nop 0
v_mul_f32 v53, v53, v54
v_accvgpr_write_b32 a13, v53
v_accvgpr_read_b32 v53, a14
s_nop 0
v_mul_f32 v53, v53, v54
v_accvgpr_write_b32 a14, v53
v_accvgpr_read_b32 v53, a15
s_nop 0
v_mul_f32 v53, v53, v54
v_accvgpr_write_b32 a15, v53
v_accvgpr_read_b32 v53, a28
s_nop 0
v_mul_f32 v53, v53, v54
v_accvgpr_write_b32 a28, v53
v_accvgpr_read_b32 v53, a29
s_nop 0
v_mul_f32 v53, v53, v54
v_accvgpr_write_b32 a29, v53
v_accvgpr_read_b32 v53, a30
s_nop 0
v_mul_f32 v53, v53, v54
v_accvgpr_write_b32 a30, v53
v_accvgpr_read_b32 v53, a31
s_nop 0
v_mul_f32 v53, v53, v54
v_accvgpr_write_b32 a31, v53
v_accvgpr_read_b32 v53, a44
s_nop 0
v_mul_f32 v53, v53, v54
v_accvgpr_write_b32 a44, v53
v_accvgpr_read_b32 v53, a45
s_nop 0
v_mul_f32 v53, v53, v54
v_accvgpr_write_b32 a45, v53
v_accvgpr_read_b32 v53, a46
s_nop 0
v_mul_f32 v53, v53, v54
v_accvgpr_write_b32 a46, v53
v_accvgpr_read_b32 v53, a47
s_nop 0
v_mul_f32 v53, v53, v54
v_accvgpr_write_b32 a47, v53
v_accvgpr_read_b32 v53, a60
s_nop 0
v_mul_f32 v53, v53, v54
v_accvgpr_write_b32 a60, v53
v_accvgpr_read_b32 v53, a61
s_nop 0
v_mul_f32 v53, v53, v54
v_accvgpr_write_b32 a61, v53
v_accvgpr_read_b32 v53, a62
s_nop 0
v_mul_f32 v53, v53, v54
v_accvgpr_write_b32 a62, v53
v_accvgpr_read_b32 v53, a63
s_nop 0
v_mul_f32 v53, v53, v54
v_accvgpr_write_b32 a63, v53
v_accvgpr_read_b32 v53, a76
s_nop 0
v_mul_f32 v53, v53, v54
v_accvgpr_write_b32 a76, v53
v_accvgpr_read_b32 v53, a77
s_nop 0
v_mul_f32 v53, v53, v54
v_accvgpr_write_b32 a77, v53
v_accvgpr_read_b32 v53, a78
s_nop 0
v_mul_f32 v53, v53, v54
v_accvgpr_write_b32 a78, v53
v_accvgpr_read_b32 v53, a79
s_nop 0
v_mul_f32 v53, v53, v54
v_accvgpr_write_b32 a79, v53
v_accvgpr_read_b32 v53, a92
s_nop 0
v_mul_f32 v53, v53, v54
v_accvgpr_write_b32 a92, v53
v_accvgpr_read_b32 v53, a93
s_nop 0
v_mul_f32 v53, v53, v54
v_accvgpr_write_b32 a93, v53
v_accvgpr_read_b32 v53, a94
s_nop 0
v_mul_f32 v53, v53, v54
v_accvgpr_write_b32 a94, v53
v_accvgpr_read_b32 v53, a95
s_nop 0
v_mul_f32 v53, v53, v54
v_accvgpr_write_b32 a95, v53
v_accvgpr_read_b32 v53, a108
s_nop 0
v_mul_f32 v53, v53, v54
v_accvgpr_write_b32 a108, v53
v_accvgpr_read_b32 v53, a109
s_nop 0
v_mul_f32 v53, v53, v54
v_accvgpr_write_b32 a109, v53
v_accvgpr_read_b32 v53, a110
s_nop 0
v_mul_f32 v53, v53, v54
v_accvgpr_write_b32 a110, v53
v_accvgpr_read_b32 v53, a111
s_nop 0
v_mul_f32 v53, v53, v54
v_accvgpr_write_b32 a111, v53
v_accvgpr_read_b32 v53, a124
s_nop 0
v_mul_f32 v53, v53, v54
v_accvgpr_write_b32 a124, v53
v_accvgpr_read_b32 v53, a125
s_nop 0
v_mul_f32 v53, v53, v54
v_accvgpr_write_b32 a125, v53
v_accvgpr_read_b32 v53, a126
s_nop 0
v_mul_f32 v53, v53, v54
v_accvgpr_write_b32 a126, v53
v_accvgpr_read_b32 v53, a127
s_nop 0
v_mul_f32 v53, v53, v54
v_accvgpr_write_b32 a127, v53
v_accvgpr_read_b32 v53, a204
s_nop 0
v_mul_f32 v53, v53, v54
v_accvgpr_write_b32 a204, v53
v_accvgpr_read_b32 v53, a205
s_nop 0
v_mul_f32 v53, v53, v54
v_accvgpr_write_b32 a205, v53
v_accvgpr_read_b32 v53, a206
s_nop 0
v_mul_f32 v53, v53, v54
v_accvgpr_write_b32 a206, v53
v_accvgpr_read_b32 v53, a207
s_nop 0
v_mul_f32 v53, v53, v54
v_accvgpr_write_b32 a207, v53
v_exp_f32 v56, v128
v_exp_f32 v57, v129
v_exp_f32 v58, v130
v_cvt_pk_bf16_f32 v224, v56, v57
v_exp_f32 v59, v131
v_exp_f32 v60, v144
v_cvt_pk_bf16_f32 v225, v58, v59
v_exp_f32 v61, v145
v_exp_f32 v62, v146
v_cvt_pk_bf16_f32 v226, v60, v61
v_exp_f32 v63, v147
v_exp_f32 v56, v132
v_cvt_pk_bf16_f32 v227, v62, v63
v_or_b32 v25, v224, v225
v_or3_b32 v25, v25, v226, v227
v_exp_f32 v57, v133
v_exp_f32 v58, v134
v_cvt_pk_bf16_f32 v228, v56, v57
v_exp_f32 v59, v135
v_exp_f32 v60, v148
v_cvt_pk_bf16_f32 v229, v58, v59
v_exp_f32 v61, v149
v_exp_f32 v62, v150
v_cvt_pk_bf16_f32 v230, v60, v61
v_exp_f32 v63, v151
v_exp_f32 v56, v136
v_cvt_pk_bf16_f32 v231, v62, v63
v_or3_b32 v25, v25, v228, v229
v_or3_b32 v25, v25, v230, v231
v_exp_f32 v57, v137
v_exp_f32 v58, v138
v_cvt_pk_bf16_f32 v232, v56, v57
v_exp_f32 v59, v139
v_exp_f32 v60, v152
v_cvt_pk_bf16_f32 v233, v58, v59
v_exp_f32 v61, v153
v_exp_f32 v62, v154
v_cvt_pk_bf16_f32 v234, v60, v61
v_exp_f32 v63, v155
v_exp_f32 v56, v140
v_cvt_pk_bf16_f32 v235, v62, v63
v_or3_b32 v25, v25, v232, v233
v_or3_b32 v25, v25, v234, v235
v_exp_f32 v57, v141
v_exp_f32 v58, v142
v_cvt_pk_bf16_f32 v236, v56, v57
v_exp_f32 v59, v143
v_exp_f32 v60, v156
v_cvt_pk_bf16_f32 v237, v58, v59
v_exp_f32 v61, v157
v_exp_f32 v62, v158
v_cvt_pk_bf16_f32 v238, v60, v61
v_exp_f32 v63, v159
v_exp_f32 v56, v160
v_cvt_pk_bf16_f32 v239, v62, v63
v_or3_b32 v25, v25, v236, v237
v_or3_b32 v25, v25, v238, v239
v_exp_f32 v57, v161
v_exp_f32 v58, v162
v_cvt_pk_bf16_f32 v240, v56, v57
v_exp_f32 v59, v163
v_exp_f32 v60, v176
v_cvt_pk_bf16_f32 v241, v58, v59
v_exp_f32 v61, v177
v_exp_f32 v62, v178
v_cvt_pk_bf16_f32 v242, v60, v61
v_exp_f32 v63, v179
v_exp_f32 v56, v164
v_cvt_pk_bf16_f32 v243, v62, v63
v_or3_b32 v25, v25, v240, v241
v_or3_b32 v25, v25, v242, v243
v_exp_f32 v57, v165
v_exp_f32 v58, v166
v_cvt_pk_bf16_f32 v244, v56, v57
v_exp_f32 v59, v167
v_exp_f32 v60, v180
v_cvt_pk_bf16_f32 v245, v58, v59
v_exp_f32 v61, v181
v_exp_f32 v62, v182
v_cvt_pk_bf16_f32 v246, v60, v61
v_exp_f32 v63, v183
v_exp_f32 v56, v168
v_cvt_pk_bf16_f32 v247, v62, v63
v_or3_b32 v25, v25, v244, v245
v_or3_b32 v25, v25, v246, v247
v_exp_f32 v57, v169
v_exp_f32 v58, v170
v_cvt_pk_bf16_f32 v248, v56, v57
v_exp_f32 v59, v171
v_exp_f32 v60, v184
v_cvt_pk_bf16_f32 v249, v58, v59
v_exp_f32 v61, v185
v_exp_f32 v62, v186
v_cvt_pk_bf16_f32 v250, v60, v61
v_exp_f32 v63, v187
v_exp_f32 v56, v172
v_cvt_pk_bf16_f32 v251, v62, v63
v_or3_b32 v25, v25, v248, v249
v_or3_b32 v25, v25, v250, v251
v_exp_f32 v57, v173
v_exp_f32 v58, v174
v_cvt_pk_bf16_f32 v252, v56, v57
v_exp_f32 v59, v175
v_exp_f32 v60, v188
v_cvt_pk_bf16_f32 v253, v58, v59
v_exp_f32 v61, v189
v_exp_f32 v62, v190
v_cvt_pk_bf16_f32 v254, v60, v61
v_exp_f32 v63, v191
s_nop 0
v_cvt_pk_bf16_f32 v255, v62, v63
v_or3_b32 v25, v25, v252, v253
v_or3_b32 v25, v25, v254, v255
s_nop 1
s_setpc_b64 s[36:37]
L_end_main_kernel:
s_endpgm
.section .rodata,"a"
.p2align 6
.amdhsa_kernel first_kernel
.amdhsa_next_free_vgpr 73
.amdhsa_next_free_sgpr 102
.amdhsa_accum_offset 76
.amdhsa_group_segment_fixed_size 0
.amdhsa_kernarg_size 112
.amdhsa_user_sgpr_count 2
.amdhsa_user_sgpr_kernarg_segment_ptr 1
.amdhsa_system_sgpr_workgroup_id_x 1
.amdhsa_float_denorm_mode_32 3
.amdhsa_float_denorm_mode_16_64 3
.amdhsa_ieee_mode 0
.amdhsa_dx10_clamp 0
.end_amdhsa_kernel
.p2align 6
.amdhsa_kernel main_kernel
.amdhsa_next_free_vgpr 512
.amdhsa_next_free_sgpr 102
.amdhsa_accum_offset 256
.amdhsa_group_segment_fixed_size 0
.amdhsa_kernarg_size 112
.amdhsa_user_sgpr_count 2
.amdhsa_user_sgpr_kernarg_segment_ptr 1
.amdhsa_system_sgpr_workgroup_id_x 1
.amdhsa_float_denorm_mode_32 3
.amdhsa_float_denorm_mode_16_64 3
.amdhsa_ieee_mode 0
.amdhsa_dx10_clamp 0
.end_amdhsa_kernel
```
